```python
import torch

def _softmax(x, axis=-1):
    return torch.softmax(x, dim=axis)
def _gelu(x):
    return torch.nn.functional.gelu(x, approximate="tanh")
def _silu(x):
    return torch.nn.functional.silu(x)
def _sigmoid(x):
    return torch.sigmoid(x)
def _layernorm(x, axis=-1, eps=1e-5):
    m = x.mean(dim=axis, keepdim=True)
    v = x.var(dim=axis, keepdim=True, unbiased=False)
    return (x - m) / torch.sqrt(v + eps)
def _scatter_add(tgt, idx, src, axis=0):
    return tgt.clone().index_add_(axis, idx, src)
def _segment_sum(src, seg, n):
    out = torch.zeros((n,) + src.shape[1:], dtype=src.dtype)
    return out.index_add_(0, seg, src)
def _pad(x, pw):
    flat = tuple(v for pair in reversed(pw) for v in pair)
    return torch.nn.functional.pad(x, flat)

kernel_name = 'standalone__gqa_block_cached__near_ridge'

def setup_inputs():

    _w = (lambda a: (lambda t: t.to(torch.bfloat16) if t.is_floating_point() else t)(torch.as_tensor(a)))
    B, Sq, D = 32, 96, 448
    Hq, Hkv, Sk, Dh = 16, 8, 512, 256
    assert Hq % Hkv == 0, (Hq, Hkv)
    return {
        "x": _w((lambda *s: torch.randn(*s, dtype=torch.bfloat16) * 0.8)(B, Sq, D)),
        "k_cache": _w((lambda *s: torch.randn(*s, dtype=torch.bfloat16) * 0.8)(B, Hkv, Sk, Dh)),
        "v_cache": _w((lambda *s: torch.randn(*s, dtype=torch.bfloat16) * 0.05)(B, Hkv, Sk, Dh)),
        "wq": _w((lambda *s: torch.randn(*s, dtype=torch.bfloat16) * 0.8)(D, Hq * Dh) * (D ** -0.5)),
        "wo": _w((lambda *s: torch.randn(*s, dtype=torch.bfloat16) * 0.05)(Hq * Dh, D) * ((Hq * Dh) ** -0.5)),
    }

def reference(x, k_cache, v_cache, wq, wo):
    B, Sq, D = x.shape
    Hq, Dh = 16, 256
    Hkv = k_cache.shape[1]
    rep = Hq // Hkv
    q = (lambda x, *d: x.permute(*d))((x @ wq).reshape(B, Sq, Hq, Dh), 0, 2, 1, 3)
    k = (lambda x, n, axis: torch.repeat_interleave(x, n, dim=axis))(k_cache, rep, axis=1)
    v = (lambda x, n, axis: torch.repeat_interleave(x, n, dim=axis))(v_cache, rep, axis=1)
    scores = torch.einsum("bhqd,bhkd->bhqk", q, k) * (Dh ** -0.5)
    p = _softmax(scores, axis=-1)
    o = torch.einsum("bhqk,bhkd->bhqd", p, v)
    return (lambda x, *d: x.permute(*d))(o, 0, 2, 1, 3).reshape(B, Sq, Hq * Dh) @ wo
```

```asm
; @launch grid=(256,1,1) block=(256,1,1) lds=163840
.amdgcn_target "amdgcn-amd-amdhsa--gfx950"
.text
.globl standalone__gqa_block_cached__near_ridge_kernel
.p2align 8
.type standalone__gqa_block_cached__near_ridge_kernel,@function
standalone__gqa_block_cached__near_ridge_kernel:
s_cmp_ge_u32 s2, 256
s_cbranch_scc1 L_end
s_load_dwordx16 s[4:19], s[0:1], 0
s_getpc_b64 s[24:25]
L_pc:
s_lshr_b32 s22, s2, 3
v_lshl_add_u32 v250, v0, 5, s22
v_lshlrev_b32 v250, 7, v250
v_min_u32 v250, (L_end-L_pc), v250
global_load_dword v251, v250, s[24:25]
v_lshrrev_b32 v244, 6, v0
v_and_b32 v0, 63, v0
s_lshr_b32 s52, s2, 4
v_readfirstlane_b32 s3, v244
s_bfe_u32 s67, s2, 0x10002
s_lshl_b32 s67, s67, 4
s_add_u32 s52, s52, s67
s_and_b32 s53, s2, 3
s_lshl_b32 s53, s53, 1
s_bfe_u32 s67, s2, 0x10003
s_add_u32 s53, s53, s67
v_lshrrev_b32 v236, 1, v0
v_lshrrev_b32 v237, 4, v0
v_xor_b32 v236, v236, v237
v_xor_b32 v228, v0, v237
v_and_b32 v4, 3, v236
v_and_b32 v238, 1, v0
v_and_b32 v237, 2, v236
v_lshl_or_b32 v4, v4, 1, v238
v_or_b32 v237, v237, v238
v_and_b32 v236, 1, v236
v_lshl_or_b32 v237, v237, 1, v236
v_bfe_u32 v238, v0, 3, 2
v_lshlrev_b32 v237, 4, v237
v_lshl_add_u32 v237, v238, 13, v237
v_lshrrev_b32 v238, 5, v0
v_lshl_add_u32 v224, v238, 16, v237
s_and_b32 s80, s3, 1
v_add_u32 v225, 31744, v224
s_lshr_b32 s81, s3, 1
v_add_u32 v226, 129024, v224
s_lshl_b32 s82, s80, 9
v_add_u32 v227, 160768, v224
s_lshl_b32 s58, s3, 12
s_mul_i32 s91, s3, 3072
s_mul_i32 s67, s3, 21504
s_lshl_b32 s77, s80, 6
v_and_b32 v228, 7, v228
v_lshlrev_b32 v228, 4, v228
v_xor_b32 v228, s77, v228
v_lshrrev_b32 v236, 3, v0
v_mul_u32_u24 v236, 896, v236
v_add3_u32 v228, v228, v236, s67
s_xor_b32 s76, s52, s53
v_xor_b32 v229, 64, v228
s_and_b32 s76, s76, 1
v_add_u32 v230, 12288, v228
s_mul_i32 s76, s76, 3
v_add_u32 v229, 6144, v229
s_lshl_b32 s60, s76, 19
s_add_u32 s60, s60, s82
s_lshl_b32 s84, s76, 7
s_lshl_b32 s67, s53, 10
s_lshl_b32 s77, s81, 18
s_mul_i32 s78, s52, 86016
s_waitcnt lgkmcnt(0)
s_add_u32 s10, s10, s67
s_addc_u32 s11, s11, 0
s_and_b32 s11, s11, 0xffff
s_add_u32 s32, s10, s77
s_addc_u32 s33, s11, 0
s_and_b32 s33, s33, 0xffff
s_mov_b32 s34, 3662848
s_mov_b32 s35, 0x20000
s_add_u32 m0, s58, 134144
s_nop 0
buffer_load_dwordx4 v224, s[32:35], s60 offen offset:0 lds
buffer_load_dwordx4 v225, s[32:35], s60 offen offset:1024 lds
buffer_load_dwordx4 v226, s[32:35], s60 offen offset:2048 lds
buffer_load_dwordx4 v227, s[32:35], s60 offen offset:3072 lds
s_add_u32 s20, s4, s78
s_addc_u32 s21, s5, 0
s_and_b32 s21, s21, 0xffff
s_mov_b32 s22, 86016
s_mov_b32 s23, 0x20000
s_add_u32 m0, s91, 33792
s_nop 0
buffer_load_dwordx4 v228, s[20:23], s84 offen offset:0 lds
buffer_load_dwordx4 v229, s[20:23], s84 offen offset:1024 lds
buffer_load_dwordx4 v230, s[20:23], s84 offen offset:2048 lds
v_bfe_u32 v208, v0, 2, 3
v_and_b32 v210, 3, v0
v_lshlrev_b32 v209, 7, v208
v_lshl_add_u32 v209, v210, 3, v209
v_lshrrev_b32 v210, 5, v0
v_lshl_add_u32 v209, v210, 11, v209
s_lshl_b32 s67, s80, 12
v_add_u32 v209, s67, v209
v_lshrrev_b32 v208, 1, v208
v_xor_b32 v210, 0, v208
v_lshl_add_u32 v10, v210, 5, v209
v_add_u32 v246, 101376, v10
v_xor_b32 v210, 1, v208
v_lshl_add_u32 v11, v210, 5, v209
v_add_u32 v247, 101376, v11
v_xor_b32 v210, 2, v208
v_lshl_add_u32 v12, v210, 5, v209
v_add_u32 v248, 101376, v12
v_xor_b32 v210, 3, v208
v_lshl_add_u32 v13, v210, 5, v209
v_add_u32 v249, 101376, v13
v_and_b32 v208, 15, v0
v_lshlrev_b32 v209, 7, v208
s_mul_i32 s67, s81, 6144
s_add_u32 s67, s67, 33792
v_add_u32 v209, s67, v209
v_lshrrev_b32 v208, 1, v208
v_lshrrev_b32 v210, 4, v0
v_xor_b32 v208, v208, v210
v_lshl_add_u32 v232, v208, 4, v209
v_xor_b32 v208, 4, v208
v_lshl_add_u32 v233, v208, 4, v209
v_add_u32 v252, 116736, v232
v_add_u32 v253, 116736, v233
s_add_u32 s77, s60, 128
s_add_u32 m0, s58, 0
s_nop 0
buffer_load_dwordx4 v224, s[32:35], s77 offen offset:0 lds
buffer_load_dwordx4 v225, s[32:35], s77 offen offset:1024 lds
buffer_load_dwordx4 v226, s[32:35], s77 offen offset:2048 lds
buffer_load_dwordx4 v227, s[32:35], s77 offen offset:3072 lds
s_add_u32 s76, s76, 1
s_cmp_eq_u32 s76, 7
s_cselect_b32 s76, 0, s76
s_lshl_b32 s61, s76, 19
s_add_u32 s61, s61, s82
s_lshl_b32 s85, s76, 7
s_add_u32 s76, s76, 1
s_cmp_eq_u32 s76, 7
s_cselect_b32 s76, 0, s76
s_lshl_b32 s62, s76, 19
s_add_u32 s62, s62, s82
s_lshl_b32 s86, s76, 7
s_add_u32 s76, s76, 1
s_cmp_eq_u32 s76, 7
s_cselect_b32 s76, 0, s76
s_lshl_b32 s63, s76, 19
s_add_u32 s63, s63, s82
s_lshl_b32 s87, s76, 7
s_add_u32 s76, s76, 1
s_cmp_eq_u32 s76, 7
s_cselect_b32 s76, 0, s76
s_lshl_b32 s64, s76, 19
s_add_u32 s64, s64, s82
s_lshl_b32 s88, s76, 7
s_add_u32 s76, s76, 1
s_cmp_eq_u32 s76, 7
s_cselect_b32 s76, 0, s76
s_lshl_b32 s65, s76, 19
s_add_u32 s65, s65, s82
s_lshl_b32 s89, s76, 7
s_add_u32 s76, s76, 1
s_cmp_eq_u32 s76, 7
s_cselect_b32 s76, 0, s76
s_lshl_b32 s66, s76, 19
s_add_u32 s66, s66, s82
s_lshl_b32 s90, s76, 7
s_mul_i32 s67, s52, 37
s_lshr_b32 s67, s67, 8
s_mul_i32 s67, s67, 7
s_sub_u32 s54, s52, s67
v_lshlrev_b32 v14, 4, v0
s_lshl_b32 s67, s52, 3
s_add_u32 s67, s67, s53
s_xor_b32 s67, s67, 0
s_lshl_b32 s76, s67, 18
s_sub_u32 s67, s76, 96
s_cselect_b32 s77, -1, 0
s_add_u32 s24, s6, s67
s_addc_u32 s25, s7, s77
s_and_b32 s25, s25, 0xffff
s_mov_b32 s26, 262240
s_mov_b32 s27, 0x20000
s_sub_u32 s67, s76, 512
s_add_u32 s28, s8, s67
s_addc_u32 s29, s9, s77
s_and_b32 s29, s29, 0xffff
s_mov_b32 s30, 262656
s_mov_b32 s31, 0x20000
s_add_u32 m0, s91, 46080
s_nop 0
buffer_load_dwordx4 v228, s[20:23], s85 offen offset:0 lds
buffer_load_dwordx4 v229, s[20:23], s85 offen offset:1024 lds
buffer_load_dwordx4 v230, s[20:23], s85 offen offset:2048 lds
s_add_u32 m0, s58, 16384
s_nop 0
buffer_load_dwordx4 v224, s[32:35], s61 offen offset:0 lds
buffer_load_dwordx4 v225, s[32:35], s61 offen offset:1024 lds
buffer_load_dwordx4 v226, s[32:35], s61 offen offset:2048 lds
buffer_load_dwordx4 v227, s[32:35], s61 offen offset:3072 lds
s_add_u32 m0, s91, 58368
s_nop 0
buffer_load_dwordx4 v228, s[20:23], s86 offen offset:0 lds
buffer_load_dwordx4 v229, s[20:23], s86 offen offset:1024 lds
buffer_load_dwordx4 v230, s[20:23], s86 offen offset:2048 lds
s_mul_i32 s67, s53, 458752
s_add_u32 s36, s12, s67
s_addc_u32 s37, s13, 0
s_and_b32 s37, s37, 0xffff
s_mov_b32 s38, 458752
s_mov_b32 s39, 0x20000
s_mul_i32 s67, s52, 688128
s_add_u32 s40, s18, s67
s_addc_u32 s41, s19, 0
s_and_b32 s41, s41, 0xffff
s_mov_b32 s42, 688128
s_mov_b32 s43, 0x20000
s_add_u32 s48, s14, s78
s_addc_u32 s49, s15, 0
s_and_b32 s49, s49, 0xffff
s_mov_b32 s50, 86016
s_mov_b32 s51, 0x20000
s_add_u32 s44, s16, 0
s_addc_u32 s45, s17, 0
s_and_b32 s45, s45, 0xffff
s_mov_b32 s46, 256
s_mov_b32 s47, 0x20000
s_mov_b32 s55, 0x3db8aa3b
s_mov_b32 s56, 0x41000000
s_mul_i32 s57, s3, 4224
s_lshl_b32 s82, s3, 12
s_lshl_b32 s68, s3, 14
s_lshl_b32 s59, s80, 13
s_lshl_b32 s67, s81, 12
s_add_u32 s59, s59, s67
s_mul_i32 s79, s80, 229376
s_mul_i32 s67, s81, 28672
s_add_u32 s79, s79, s67
v_mov_b32 v8, v14
v_add_u32 v5, 96, v8
v_add_u32 v6, 64, v8
v_add_u32 v7, 32, v8
v_and_b32 v208, 7, v0
v_mul_u32_u24 v208, 1056, v208
v_bfe_u32 v209, v0, 3, 1
v_lshl_add_u32 v208, v209, 9, v208
v_lshrrev_b32 v209, 4, v0
v_lshl_add_u32 v208, v209, 4, v208
v_add_u32 v1, 33792, v208
s_add_u32 s67, s57, 101376
v_add_u32 v245, s67, v14
v_lshlrev_b32 v209, 4, v4
v_lshrrev_b32 v208, 3, v0
v_lshl_add_u32 v3, v208, 10, v209
v_mul_u32_u24 v208, 896, v208
v_add_u32 v4, v208, v209
s_add_u32 s77, s61, 128
s_add_u32 m0, s58, 101376
s_nop 0
buffer_load_dwordx4 v224, s[32:35], s77 offen offset:0 lds
buffer_load_dwordx4 v225, s[32:35], s77 offen offset:1024 lds
buffer_load_dwordx4 v226, s[32:35], s77 offen offset:2048 lds
buffer_load_dwordx4 v227, s[32:35], s77 offen offset:3072 lds
s_and_b32 s67, s52, 15
s_mul_i32 s67, s67, 28
s_lshl_b32 s77, s3, 4
s_add_u32 s77, s77, s67
s_add_u32 s67, s67, 27
v_lshrrev_b32 v208, 2, v0
v_add_u32 v208, s77, v208
v_min_u32 v208, s67, v208
v_lshlrev_b32 v208, 13, v208
v_and_b32 v209, 1, v0
v_and_b32 v210, 2, v0
v_lshl_or_b32 v209, v210, 1, v209
v_or_b32 v209, 2, v209
v_lshl_add_u32 v234, v209, 7, v208
s_add_u32 s12, s10, 0
s_addc_u32 s13, s11, 0
s_and_b32 s13, s13, 0xffff
s_mov_b32 s14, 3662848
s_mov_b32 s15, 0x20000
s_lshl_b32 s67, s52, 2
s_add_u32 s67, s67, s3
s_lshl_b32 s67, s67, 7
s_add_u32 s67, s67, 33554432
s_add_u32 s4, s18, s67
s_addc_u32 s5, s19, 0
s_and_b32 s5, s5, 0xffff
s_mov_b32 s6, 32
s_mov_b32 s7, 0x20000
s_lshl_b32 s67, s53, 2
v_lshlrev_b32 v208, 12, v0
v_add_u32 v112, s67, v208
v_mov_b32 v113, 0
buffer_store_dword v113, v112, s[4:7], 0 offen sc1
s_waitcnt vmcnt(12)
s_barrier
ds_read_b128 a[88:91], v232 offset:0
ds_read_b128 a[92:95], v232 offset:2048
ds_read_b128 a[96:99], v232 offset:4096
ds_read_b128 a[100:103], v233 offset:0
ds_read_b128 a[104:107], v233 offset:2048
ds_read_b128 a[108:111], v233 offset:4096
ds_read_b64_tr_b16 v[160:161], v246 offset:32768
ds_read_b64_tr_b16 v[162:163], v246 offset:33792
ds_read_b64_tr_b16 v[164:165], v246 offset:40960
ds_read_b64_tr_b16 v[166:167], v246 offset:41984
ds_read_b64_tr_b16 v[168:169], v247 offset:32768
ds_read_b64_tr_b16 v[170:171], v247 offset:33792
ds_read_b64_tr_b16 v[172:173], v247 offset:40960
ds_read_b64_tr_b16 v[174:175], v247 offset:41984
s_add_u32 m0, s58, 117760
s_waitcnt lgkmcnt(4)
v_mfma_f32_16x16x32_bf16 v[16:19], v[160:163], a[88:91], 0
buffer_load_dwordx4 v224, s[32:35], s62 offen offset:0 lds
v_mfma_f32_16x16x32_bf16 v[16:19], v[164:167], a[100:103], v[16:19]
ds_read_b64_tr_b16 v[176:177], v248 offset:32768
ds_read_b64_tr_b16 v[178:179], v248 offset:33792
v_mfma_f32_16x16x32_bf16 v[20:23], v[164:167], a[104:107], 0
buffer_load_dwordx4 v225, s[32:35], s62 offen offset:1024 lds
v_mfma_f32_16x16x32_bf16 v[20:23], v[160:163], a[92:95], v[20:23]
ds_read_b64_tr_b16 v[180:181], v248 offset:40960
ds_read_b64_tr_b16 v[182:183], v248 offset:41984
v_mfma_f32_16x16x32_bf16 v[24:27], v[160:163], a[96:99], 0
buffer_load_dwordx4 v226, s[32:35], s62 offen offset:2048 lds
v_mfma_f32_16x16x32_bf16 v[24:27], v[164:167], a[108:111], v[24:27]
s_waitcnt lgkmcnt(4)
buffer_load_dwordx4 v227, s[32:35], s62 offen offset:3072 lds
v_mfma_f32_16x16x32_bf16 v[28:31], v[168:171], a[88:91], 0
ds_read_b64_tr_b16 v[184:185], v249 offset:32768
ds_read_b64_tr_b16 v[186:187], v249 offset:33792
v_mfma_f32_16x16x32_bf16 v[28:31], v[172:175], a[100:103], v[28:31]
ds_read_b64_tr_b16 v[188:189], v249 offset:40960
ds_read_b64_tr_b16 v[190:191], v249 offset:41984
v_mfma_f32_16x16x32_bf16 v[32:35], v[172:175], a[104:107], 0
s_add_u32 s77, s62, 128
ds_read_b128 a[112:115], v232 offset:12288
s_add_u32 m0, s58, 134144
v_mfma_f32_16x16x32_bf16 v[32:35], v[168:171], a[92:95], v[32:35]
ds_read_b128 a[116:119], v232 offset:14336
v_mfma_f32_16x16x32_bf16 v[36:39], v[168:171], a[96:99], 0
ds_read_b128 a[120:123], v232 offset:16384
v_mfma_f32_16x16x32_bf16 v[36:39], v[172:175], a[108:111], v[36:39]
s_waitcnt vmcnt(19) lgkmcnt(3)
s_barrier
ds_read_b64_tr_b16 v[192:193], v10 offset:0
v_mfma_f32_16x16x32_bf16 v[40:43], v[176:179], a[88:91], 0
buffer_load_dwordx4 v224, s[32:35], s77 offen offset:0 lds
v_mfma_f32_16x16x32_bf16 v[40:43], v[180:183], a[100:103], v[40:43]
ds_read_b64_tr_b16 v[194:195], v10 offset:1024
ds_read_b64_tr_b16 v[196:197], v10 offset:8192
v_mfma_f32_16x16x32_bf16 v[44:47], v[180:183], a[104:107], 0
ds_read_b64_tr_b16 v[198:199], v10 offset:9216
ds_read_b64_tr_b16 v[200:201], v11 offset:0
v_mfma_f32_16x16x32_bf16 v[44:47], v[176:179], a[92:95], v[44:47]
buffer_load_dwordx4 v225, s[32:35], s77 offen offset:1024 lds
v_mfma_f32_16x16x32_bf16 v[48:51], v[176:179], a[96:99], 0
ds_read_b64_tr_b16 v[202:203], v11 offset:1024
v_mfma_f32_16x16x32_bf16 v[48:51], v[180:183], a[108:111], v[48:51]
ds_read_b64_tr_b16 v[204:205], v11 offset:8192
v_mfma_f32_16x16x32_bf16 v[52:55], v[184:187], a[88:91], 0
buffer_load_dwordx4 v226, s[32:35], s77 offen offset:2048 lds
v_mfma_f32_16x16x32_bf16 v[52:55], v[188:191], a[100:103], v[52:55]
ds_read_b64_tr_b16 v[206:207], v11 offset:9216
v_mfma_f32_16x16x32_bf16 v[56:59], v[188:191], a[104:107], 0
ds_read_b64_tr_b16 v[160:161], v12 offset:0
v_mfma_f32_16x16x32_bf16 v[56:59], v[184:187], a[92:95], v[56:59]
buffer_load_dwordx4 v227, s[32:35], s77 offen offset:3072 lds
v_mfma_f32_16x16x32_bf16 v[60:63], v[184:187], a[96:99], 0
s_add_u32 m0, s91, 70656
ds_read_b64_tr_b16 v[162:163], v12 offset:1024
v_mfma_f32_16x16x32_bf16 v[60:63], v[188:191], a[108:111], v[60:63]
s_waitcnt lgkmcnt(6)
ds_read_b64_tr_b16 v[164:165], v12 offset:8192
v_mfma_f32_16x16x32_bf16 v[64:67], v[192:195], a[88:91], 0
buffer_load_dwordx4 v228, s[20:23], s87 offen offset:0 lds
v_mfma_f32_16x16x32_bf16 v[64:67], v[196:199], a[100:103], v[64:67]
ds_read_b64_tr_b16 v[166:167], v12 offset:9216
v_mfma_f32_16x16x32_bf16 v[68:71], v[196:199], a[104:107], 0
ds_read_b64_tr_b16 v[168:169], v13 offset:0
v_mfma_f32_16x16x32_bf16 v[68:71], v[192:195], a[92:95], v[68:71]
buffer_load_dwordx4 v229, s[20:23], s87 offen offset:1024 lds
v_mfma_f32_16x16x32_bf16 v[72:75], v[192:195], a[96:99], 0
ds_read_b64_tr_b16 v[170:171], v13 offset:1024
v_mfma_f32_16x16x32_bf16 v[72:75], v[196:199], a[108:111], v[72:75]
s_waitcnt lgkmcnt(6)
ds_read_b64_tr_b16 v[172:173], v13 offset:8192
v_mfma_f32_16x16x32_bf16 v[76:79], v[200:203], a[88:91], 0
ds_read_b64_tr_b16 v[174:175], v13 offset:9216
v_mfma_f32_16x16x32_bf16 v[76:79], v[204:207], a[100:103], v[76:79]
buffer_load_dwordx4 v230, s[20:23], s87 offen offset:2048 lds
v_mfma_f32_16x16x32_bf16 v[80:83], v[204:207], a[104:107], 0
s_add_u32 m0, s58, 0
ds_read_b128 a[124:127], v233 offset:12288
v_mfma_f32_16x16x32_bf16 v[80:83], v[200:203], a[92:95], v[80:83]
ds_read_b128 a[128:131], v233 offset:14336
v_mfma_f32_16x16x32_bf16 v[84:87], v[200:203], a[96:99], 0
ds_read_b128 a[132:135], v233 offset:16384
v_mfma_f32_16x16x32_bf16 v[84:87], v[204:207], a[108:111], v[84:87]
s_waitcnt vmcnt(16) lgkmcnt(3)
s_barrier
ds_read_b64_tr_b16 v[176:177], v10 offset:16384
v_mfma_f32_16x16x32_bf16 v[88:91], v[160:163], a[88:91], 0
buffer_load_dwordx4 v224, s[32:35], s63 offen offset:0 lds
v_mfma_f32_16x16x32_bf16 v[88:91], v[164:167], a[100:103], v[88:91]
ds_read_b64_tr_b16 v[178:179], v10 offset:17408
v_mfma_f32_16x16x32_bf16 v[92:95], v[164:167], a[104:107], 0
ds_read_b64_tr_b16 v[180:181], v10 offset:24576
v_mfma_f32_16x16x32_bf16 v[92:95], v[160:163], a[92:95], v[92:95]
buffer_load_dwordx4 v225, s[32:35], s63 offen offset:1024 lds
v_mfma_f32_16x16x32_bf16 v[96:99], v[160:163], a[96:99], 0
ds_read_b64_tr_b16 v[182:183], v10 offset:25600
v_mfma_f32_16x16x32_bf16 v[96:99], v[164:167], a[108:111], v[96:99]
ds_read_b64_tr_b16 v[184:185], v11 offset:16384
v_mfma_f32_16x16x32_bf16 v[100:103], v[168:171], a[88:91], 0
buffer_load_dwordx4 v226, s[32:35], s63 offen offset:2048 lds
v_mfma_f32_16x16x32_bf16 v[100:103], v[172:175], a[100:103], v[100:103]
ds_read_b64_tr_b16 v[186:187], v11 offset:17408
v_mfma_f32_16x16x32_bf16 v[104:107], v[172:175], a[104:107], 0
ds_read_b64_tr_b16 v[188:189], v11 offset:24576
v_mfma_f32_16x16x32_bf16 v[104:107], v[168:171], a[92:95], v[104:107]
buffer_load_dwordx4 v227, s[32:35], s63 offen offset:3072 lds
v_mfma_f32_16x16x32_bf16 v[108:111], v[168:171], a[96:99], 0
s_add_u32 m0, s58, 16384
ds_read_b64_tr_b16 v[190:191], v11 offset:25600
v_mfma_f32_16x16x32_bf16 v[108:111], v[172:175], a[108:111], v[108:111]
s_waitcnt lgkmcnt(4)
ds_read_b64_tr_b16 v[192:193], v12 offset:16384
v_mfma_f32_16x16x32_bf16 v[16:19], v[176:179], a[112:115], v[16:19]
ds_read_b64_tr_b16 v[194:195], v12 offset:17408
v_mfma_f32_16x16x32_bf16 v[16:19], v[180:183], a[124:127], v[16:19]
ds_read_b64_tr_b16 v[196:197], v12 offset:24576
ds_read_b64_tr_b16 v[198:199], v12 offset:25600
v_mfma_f32_16x16x32_bf16 v[20:23], v[180:183], a[128:131], v[20:23]
ds_read_b64_tr_b16 v[200:201], v13 offset:16384
v_mfma_f32_16x16x32_bf16 v[20:23], v[176:179], a[116:119], v[20:23]
ds_read_b64_tr_b16 v[202:203], v13 offset:17408
v_mfma_f32_16x16x32_bf16 v[24:27], v[176:179], a[120:123], v[24:27]
ds_read_b64_tr_b16 v[204:205], v13 offset:24576
v_mfma_f32_16x16x32_bf16 v[24:27], v[180:183], a[132:135], v[24:27]
s_waitcnt lgkmcnt(7)
ds_read_b64_tr_b16 v[206:207], v13 offset:25600
v_mfma_f32_16x16x32_bf16 v[28:31], v[184:187], a[112:115], v[28:31]
ds_read_b128 a[136:139], v232 offset:24576
v_mfma_f32_16x16x32_bf16 v[28:31], v[188:191], a[124:127], v[28:31]
ds_read_b128 a[140:143], v232 offset:26624
v_mfma_f32_16x16x32_bf16 v[32:35], v[188:191], a[128:131], v[32:35]
ds_read_b128 a[144:147], v232 offset:28672
v_mfma_f32_16x16x32_bf16 v[32:35], v[184:187], a[116:119], v[32:35]
v_mfma_f32_16x16x32_bf16 v[36:39], v[184:187], a[120:123], v[36:39]
v_mfma_f32_16x16x32_bf16 v[36:39], v[188:191], a[132:135], v[36:39]
s_waitcnt vmcnt(16) lgkmcnt(3)
s_barrier
ds_read_b64_tr_b16 v[160:161], v246 offset:0
v_mfma_f32_16x16x32_bf16 v[40:43], v[192:195], a[112:115], v[40:43]
buffer_load_dwordx4 v224, s[32:35], s64 offen offset:0 lds
v_mfma_f32_16x16x32_bf16 v[40:43], v[196:199], a[124:127], v[40:43]
ds_read_b64_tr_b16 v[162:163], v246 offset:1024
ds_read_b64_tr_b16 v[164:165], v246 offset:8192
v_mfma_f32_16x16x32_bf16 v[44:47], v[196:199], a[128:131], v[44:47]
ds_read_b64_tr_b16 v[166:167], v246 offset:9216
ds_read_b64_tr_b16 v[168:169], v247 offset:0
v_mfma_f32_16x16x32_bf16 v[44:47], v[192:195], a[116:119], v[44:47]
buffer_load_dwordx4 v225, s[32:35], s64 offen offset:1024 lds
v_mfma_f32_16x16x32_bf16 v[48:51], v[192:195], a[120:123], v[48:51]
ds_read_b64_tr_b16 v[170:171], v247 offset:1024
v_mfma_f32_16x16x32_bf16 v[48:51], v[196:199], a[132:135], v[48:51]
ds_read_b64_tr_b16 v[172:173], v247 offset:8192
v_mfma_f32_16x16x32_bf16 v[52:55], v[200:203], a[112:115], v[52:55]
buffer_load_dwordx4 v226, s[32:35], s64 offen offset:2048 lds
v_mfma_f32_16x16x32_bf16 v[52:55], v[204:207], a[124:127], v[52:55]
ds_read_b64_tr_b16 v[174:175], v247 offset:9216
v_mfma_f32_16x16x32_bf16 v[56:59], v[204:207], a[128:131], v[56:59]
ds_read_b64_tr_b16 v[176:177], v248 offset:0
v_mfma_f32_16x16x32_bf16 v[56:59], v[200:203], a[116:119], v[56:59]
buffer_load_dwordx4 v227, s[32:35], s64 offen offset:3072 lds
v_mfma_f32_16x16x32_bf16 v[60:63], v[200:203], a[120:123], v[60:63]
s_add_u32 m0, s91, 82944
ds_read_b64_tr_b16 v[178:179], v248 offset:1024
v_mfma_f32_16x16x32_bf16 v[60:63], v[204:207], a[132:135], v[60:63]
s_waitcnt lgkmcnt(6)
ds_read_b64_tr_b16 v[180:181], v248 offset:8192
v_mfma_f32_16x16x32_bf16 v[64:67], v[160:163], a[112:115], v[64:67]
buffer_load_dwordx4 v228, s[20:23], s88 offen offset:0 lds
v_mfma_f32_16x16x32_bf16 v[64:67], v[164:167], a[124:127], v[64:67]
ds_read_b64_tr_b16 v[182:183], v248 offset:9216
ds_read_b64_tr_b16 v[184:185], v249 offset:0
v_mfma_f32_16x16x32_bf16 v[68:71], v[164:167], a[128:131], v[68:71]
ds_read_b64_tr_b16 v[186:187], v249 offset:1024
ds_read_b64_tr_b16 v[188:189], v249 offset:8192
v_mfma_f32_16x16x32_bf16 v[68:71], v[160:163], a[116:119], v[68:71]
buffer_load_dwordx4 v229, s[20:23], s88 offen offset:1024 lds
v_mfma_f32_16x16x32_bf16 v[72:75], v[160:163], a[120:123], v[72:75]
ds_read_b64_tr_b16 v[190:191], v249 offset:9216
v_mfma_f32_16x16x32_bf16 v[72:75], v[164:167], a[132:135], v[72:75]
s_waitcnt lgkmcnt(8)
ds_read_b128 a[148:151], v233 offset:24576
v_mfma_f32_16x16x32_bf16 v[76:79], v[168:171], a[112:115], v[76:79]
buffer_load_dwordx4 v230, s[20:23], s88 offen offset:2048 lds
v_mfma_f32_16x16x32_bf16 v[76:79], v[172:175], a[124:127], v[76:79]
s_add_u32 m0, s58, 101376
ds_read_b128 a[152:155], v233 offset:26624
v_mfma_f32_16x16x32_bf16 v[80:83], v[172:175], a[128:131], v[80:83]
ds_read_b128 a[156:159], v233 offset:28672
v_mfma_f32_16x16x32_bf16 v[80:83], v[168:171], a[116:119], v[80:83]
v_mfma_f32_16x16x32_bf16 v[84:87], v[168:171], a[120:123], v[84:87]
v_mfma_f32_16x16x32_bf16 v[84:87], v[172:175], a[132:135], v[84:87]
s_waitcnt vmcnt(11) lgkmcnt(3)
s_barrier
ds_read_b64_tr_b16 v[192:193], v246 offset:16384
v_mfma_f32_16x16x32_bf16 v[88:91], v[176:179], a[112:115], v[88:91]
buffer_load_dwordx4 v224, s[32:35], s65 offen offset:0 lds
v_mfma_f32_16x16x32_bf16 v[88:91], v[180:183], a[124:127], v[88:91]
ds_read_b64_tr_b16 v[194:195], v246 offset:17408
ds_read_b64_tr_b16 v[196:197], v246 offset:24576
v_mfma_f32_16x16x32_bf16 v[92:95], v[180:183], a[128:131], v[92:95]
ds_read_b64_tr_b16 v[198:199], v246 offset:25600
ds_read_b64_tr_b16 v[200:201], v247 offset:16384
v_mfma_f32_16x16x32_bf16 v[92:95], v[176:179], a[116:119], v[92:95]
buffer_load_dwordx4 v225, s[32:35], s65 offen offset:1024 lds
v_mfma_f32_16x16x32_bf16 v[96:99], v[176:179], a[120:123], v[96:99]
ds_read_b64_tr_b16 v[202:203], v247 offset:17408
v_mfma_f32_16x16x32_bf16 v[96:99], v[180:183], a[132:135], v[96:99]
ds_read_b64_tr_b16 v[204:205], v247 offset:24576
v_mfma_f32_16x16x32_bf16 v[100:103], v[184:187], a[112:115], v[100:103]
buffer_load_dwordx4 v226, s[32:35], s65 offen offset:2048 lds
v_mfma_f32_16x16x32_bf16 v[100:103], v[188:191], a[124:127], v[100:103]
ds_read_b64_tr_b16 v[206:207], v247 offset:25600
v_mfma_f32_16x16x32_bf16 v[104:107], v[188:191], a[128:131], v[104:107]
ds_read_b64_tr_b16 v[160:161], v248 offset:16384
v_mfma_f32_16x16x32_bf16 v[104:107], v[184:187], a[116:119], v[104:107]
buffer_load_dwordx4 v227, s[32:35], s65 offen offset:3072 lds
v_mfma_f32_16x16x32_bf16 v[108:111], v[184:187], a[120:123], v[108:111]
s_add_u32 m0, s91, 150528
ds_read_b64_tr_b16 v[162:163], v248 offset:17408
v_mfma_f32_16x16x32_bf16 v[108:111], v[188:191], a[132:135], v[108:111]
s_waitcnt lgkmcnt(6)
ds_read_b64_tr_b16 v[164:165], v248 offset:24576
v_mfma_f32_16x16x32_bf16 v[16:19], v[192:195], a[136:139], v[16:19]
buffer_load_dwordx4 v228, s[20:23], s89 offen offset:0 lds
v_mfma_f32_16x16x32_bf16 v[16:19], v[196:199], a[148:151], v[16:19]
ds_read_b64_tr_b16 v[166:167], v248 offset:25600
ds_read_b64_tr_b16 v[168:169], v249 offset:16384
v_mfma_f32_16x16x32_bf16 v[20:23], v[196:199], a[152:155], v[20:23]
ds_read_b64_tr_b16 v[170:171], v249 offset:17408
ds_read_b64_tr_b16 v[172:173], v249 offset:24576
v_mfma_f32_16x16x32_bf16 v[20:23], v[192:195], a[140:143], v[20:23]
buffer_load_dwordx4 v229, s[20:23], s89 offen offset:1024 lds
v_mfma_f32_16x16x32_bf16 v[24:27], v[192:195], a[144:147], v[24:27]
ds_read_b64_tr_b16 v[174:175], v249 offset:25600
v_mfma_f32_16x16x32_bf16 v[24:27], v[196:199], a[156:159], v[24:27]
s_waitcnt lgkmcnt(8)
ds_read_b128 a[160:163], v232 offset:36864
v_mfma_f32_16x16x32_bf16 v[28:31], v[200:203], a[136:139], v[28:31]
buffer_load_dwordx4 v230, s[20:23], s89 offen offset:2048 lds
v_mfma_f32_16x16x32_bf16 v[28:31], v[204:207], a[148:151], v[28:31]
s_add_u32 m0, s58, 117760
ds_read_b128 a[164:167], v232 offset:38912
v_mfma_f32_16x16x32_bf16 v[32:35], v[204:207], a[152:155], v[32:35]
ds_read_b128 a[168:171], v232 offset:40960
v_mfma_f32_16x16x32_bf16 v[32:35], v[200:203], a[140:143], v[32:35]
v_mfma_f32_16x16x32_bf16 v[36:39], v[200:203], a[144:147], v[36:39]
v_mfma_f32_16x16x32_bf16 v[36:39], v[204:207], a[156:159], v[36:39]
s_waitcnt vmcnt(21) lgkmcnt(3)
s_barrier
ds_read_b64_tr_b16 v[176:177], v246 offset:32768
v_mfma_f32_16x16x32_bf16 v[40:43], v[160:163], a[136:139], v[40:43]
buffer_load_dwordx4 v224, s[32:35], s66 offen offset:0 lds
v_mfma_f32_16x16x32_bf16 v[40:43], v[164:167], a[148:151], v[40:43]
ds_read_b64_tr_b16 v[178:179], v246 offset:33792
ds_read_b64_tr_b16 v[180:181], v246 offset:40960
v_mfma_f32_16x16x32_bf16 v[44:47], v[164:167], a[152:155], v[44:47]
ds_read_b64_tr_b16 v[182:183], v246 offset:41984
ds_read_b64_tr_b16 v[184:185], v247 offset:32768
v_mfma_f32_16x16x32_bf16 v[44:47], v[160:163], a[140:143], v[44:47]
buffer_load_dwordx4 v225, s[32:35], s66 offen offset:1024 lds
v_mfma_f32_16x16x32_bf16 v[48:51], v[160:163], a[144:147], v[48:51]
ds_read_b64_tr_b16 v[186:187], v247 offset:33792
v_mfma_f32_16x16x32_bf16 v[48:51], v[164:167], a[156:159], v[48:51]
ds_read_b64_tr_b16 v[188:189], v247 offset:40960
v_mfma_f32_16x16x32_bf16 v[52:55], v[168:171], a[136:139], v[52:55]
buffer_load_dwordx4 v226, s[32:35], s66 offen offset:2048 lds
v_mfma_f32_16x16x32_bf16 v[52:55], v[172:175], a[148:151], v[52:55]
ds_read_b64_tr_b16 v[190:191], v247 offset:41984
v_mfma_f32_16x16x32_bf16 v[56:59], v[172:175], a[152:155], v[56:59]
ds_read_b64_tr_b16 v[192:193], v248 offset:32768
v_mfma_f32_16x16x32_bf16 v[56:59], v[168:171], a[140:143], v[56:59]
buffer_load_dwordx4 v227, s[32:35], s66 offen offset:3072 lds
v_mfma_f32_16x16x32_bf16 v[60:63], v[168:171], a[144:147], v[60:63]
s_add_u32 m0, s91, 33792
ds_read_b64_tr_b16 v[194:195], v248 offset:33792
v_mfma_f32_16x16x32_bf16 v[60:63], v[172:175], a[156:159], v[60:63]
s_waitcnt lgkmcnt(6)
ds_read_b64_tr_b16 v[196:197], v248 offset:40960
v_mfma_f32_16x16x32_bf16 v[64:67], v[176:179], a[136:139], v[64:67]
buffer_load_dwordx4 v228, s[20:23], s90 offen offset:0 lds
v_mfma_f32_16x16x32_bf16 v[64:67], v[180:183], a[148:151], v[64:67]
ds_read_b64_tr_b16 v[198:199], v248 offset:41984
v_mfma_f32_16x16x32_bf16 v[68:71], v[180:183], a[152:155], v[68:71]
ds_read_b64_tr_b16 v[200:201], v249 offset:32768
v_mfma_f32_16x16x32_bf16 v[68:71], v[176:179], a[140:143], v[68:71]
buffer_load_dwordx4 v229, s[20:23], s90 offen offset:1024 lds
v_mfma_f32_16x16x32_bf16 v[72:75], v[176:179], a[144:147], v[72:75]
ds_read_b64_tr_b16 v[202:203], v249 offset:33792
ds_read_b64_tr_b16 v[204:205], v249 offset:40960
v_mfma_f32_16x16x32_bf16 v[72:75], v[180:183], a[156:159], v[72:75]
s_waitcnt lgkmcnt(7)
ds_read_b64_tr_b16 v[206:207], v249 offset:41984
v_mfma_f32_16x16x32_bf16 v[76:79], v[184:187], a[136:139], v[76:79]
buffer_load_dwordx4 v230, s[20:23], s90 offen offset:2048 lds
v_mfma_f32_16x16x32_bf16 v[76:79], v[188:191], a[148:151], v[76:79]
s_add_u32 s77, s63, 128
ds_read_b128 a[172:175], v233 offset:36864
s_add_u32 m0, s58, 134144
v_mfma_f32_16x16x32_bf16 v[80:83], v[188:191], a[152:155], v[80:83]
ds_read_b128 a[176:179], v233 offset:38912
v_mfma_f32_16x16x32_bf16 v[80:83], v[184:187], a[140:143], v[80:83]
ds_read_b128 a[180:183], v233 offset:40960
v_mfma_f32_16x16x32_bf16 v[84:87], v[184:187], a[144:147], v[84:87]
v_mfma_f32_16x16x32_bf16 v[84:87], v[188:191], a[156:159], v[84:87]
s_waitcnt vmcnt(14) lgkmcnt(3)
s_barrier
ds_read_b64_tr_b16 v[160:161], v10 offset:0
v_mfma_f32_16x16x32_bf16 v[88:91], v[192:195], a[136:139], v[88:91]
buffer_load_dwordx4 v224, s[32:35], s77 offen offset:0 lds
v_mfma_f32_16x16x32_bf16 v[88:91], v[196:199], a[148:151], v[88:91]
ds_read_b64_tr_b16 v[162:163], v10 offset:1024
ds_read_b64_tr_b16 v[164:165], v10 offset:8192
v_mfma_f32_16x16x32_bf16 v[92:95], v[196:199], a[152:155], v[92:95]
ds_read_b64_tr_b16 v[166:167], v10 offset:9216
ds_read_b64_tr_b16 v[168:169], v11 offset:0
v_mfma_f32_16x16x32_bf16 v[92:95], v[192:195], a[140:143], v[92:95]
buffer_load_dwordx4 v225, s[32:35], s77 offen offset:1024 lds
v_mfma_f32_16x16x32_bf16 v[96:99], v[192:195], a[144:147], v[96:99]
ds_read_b64_tr_b16 v[170:171], v11 offset:1024
v_mfma_f32_16x16x32_bf16 v[96:99], v[196:199], a[156:159], v[96:99]
ds_read_b64_tr_b16 v[172:173], v11 offset:8192
v_mfma_f32_16x16x32_bf16 v[100:103], v[200:203], a[136:139], v[100:103]
buffer_load_dwordx4 v226, s[32:35], s77 offen offset:2048 lds
v_mfma_f32_16x16x32_bf16 v[100:103], v[204:207], a[148:151], v[100:103]
ds_read_b64_tr_b16 v[174:175], v11 offset:9216
v_mfma_f32_16x16x32_bf16 v[104:107], v[204:207], a[152:155], v[104:107]
ds_read_b64_tr_b16 v[176:177], v12 offset:0
v_mfma_f32_16x16x32_bf16 v[104:107], v[200:203], a[140:143], v[104:107]
buffer_load_dwordx4 v227, s[32:35], s77 offen offset:3072 lds
v_mfma_f32_16x16x32_bf16 v[108:111], v[200:203], a[144:147], v[108:111]
s_add_u32 s77, s64, 128
ds_read_b64_tr_b16 v[178:179], v12 offset:1024
s_add_u32 m0, s58, 0
v_mfma_f32_16x16x32_bf16 v[108:111], v[204:207], a[156:159], v[108:111]
s_waitcnt lgkmcnt(6)
ds_read_b64_tr_b16 v[180:181], v12 offset:8192
v_mfma_f32_16x16x32_bf16 v[16:19], v[160:163], a[160:163], v[16:19]
ds_read_b64_tr_b16 v[182:183], v12 offset:9216
v_mfma_f32_16x16x32_bf16 v[16:19], v[164:167], a[172:175], v[16:19]
ds_read_b64_tr_b16 v[184:185], v13 offset:0
v_mfma_f32_16x16x32_bf16 v[20:23], v[164:167], a[176:179], v[20:23]
ds_read_b64_tr_b16 v[186:187], v13 offset:1024
v_mfma_f32_16x16x32_bf16 v[20:23], v[160:163], a[164:167], v[20:23]
ds_read_b64_tr_b16 v[188:189], v13 offset:8192
v_mfma_f32_16x16x32_bf16 v[24:27], v[160:163], a[168:171], v[24:27]
ds_read_b64_tr_b16 v[190:191], v13 offset:9216
v_mfma_f32_16x16x32_bf16 v[24:27], v[164:167], a[180:183], v[24:27]
s_waitcnt lgkmcnt(8)
ds_read_b128 a[184:187], v232 offset:49152
v_mfma_f32_16x16x32_bf16 v[28:31], v[168:171], a[160:163], v[28:31]
ds_read_b128 a[188:191], v232 offset:51200
v_mfma_f32_16x16x32_bf16 v[28:31], v[172:175], a[172:175], v[28:31]
ds_read_b128 a[192:195], v232 offset:53248
v_mfma_f32_16x16x32_bf16 v[32:35], v[172:175], a[176:179], v[32:35]
ds_read_b128 a[196:199], v233 offset:49152
v_mfma_f32_16x16x32_bf16 v[32:35], v[168:171], a[164:167], v[32:35]
ds_read_b128 a[200:203], v233 offset:51200
v_mfma_f32_16x16x32_bf16 v[36:39], v[168:171], a[168:171], v[36:39]
ds_read_b128 a[204:207], v233 offset:53248
v_mfma_f32_16x16x32_bf16 v[36:39], v[172:175], a[180:183], v[36:39]
s_waitcnt vmcnt(11) lgkmcnt(6)
s_barrier
ds_read_b64_tr_b16 v[192:193], v10 offset:16384
v_mfma_f32_16x16x32_bf16 v[40:43], v[176:179], a[160:163], v[40:43]
buffer_load_dwordx4 v224, s[32:35], s77 offen offset:0 lds
v_mfma_f32_16x16x32_bf16 v[40:43], v[180:183], a[172:175], v[40:43]
ds_read_b64_tr_b16 v[194:195], v10 offset:17408
ds_read_b64_tr_b16 v[196:197], v10 offset:24576
v_mfma_f32_16x16x32_bf16 v[44:47], v[180:183], a[176:179], v[44:47]
ds_read_b64_tr_b16 v[198:199], v10 offset:25600
ds_read_b64_tr_b16 v[200:201], v11 offset:16384
v_mfma_f32_16x16x32_bf16 v[44:47], v[176:179], a[164:167], v[44:47]
buffer_load_dwordx4 v225, s[32:35], s77 offen offset:1024 lds
v_mfma_f32_16x16x32_bf16 v[48:51], v[176:179], a[168:171], v[48:51]
ds_read_b64_tr_b16 v[202:203], v11 offset:17408
ds_read_b64_tr_b16 v[204:205], v11 offset:24576
v_mfma_f32_16x16x32_bf16 v[48:51], v[180:183], a[180:183], v[48:51]
ds_read_b64_tr_b16 v[206:207], v11 offset:25600
v_mfma_f32_16x16x32_bf16 v[52:55], v[184:187], a[160:163], v[52:55]
buffer_load_dwordx4 v226, s[32:35], s77 offen offset:2048 lds
v_mfma_f32_16x16x32_bf16 v[52:55], v[188:191], a[172:175], v[52:55]
ds_read_b64_tr_b16 v[160:161], v12 offset:16384
v_mfma_f32_16x16x32_bf16 v[56:59], v[188:191], a[176:179], v[56:59]
ds_read_b64_tr_b16 v[162:163], v12 offset:17408
v_mfma_f32_16x16x32_bf16 v[56:59], v[184:187], a[164:167], v[56:59]
buffer_load_dwordx4 v227, s[32:35], s77 offen offset:3072 lds
v_mfma_f32_16x16x32_bf16 v[60:63], v[184:187], a[168:171], v[60:63]
ds_read_b64_tr_b16 v[164:165], v12 offset:24576
v_mfma_f32_16x16x32_bf16 v[60:63], v[188:191], a[180:183], v[60:63]
s_waitcnt lgkmcnt(7)
ds_read_b64_tr_b16 v[166:167], v12 offset:25600
v_mfma_f32_16x16x32_bf16 v[16:19], v[192:195], a[184:187], v[16:19]
buffer_load_dword v242, v234, s[12:15], 0 offen
v_mfma_f32_16x16x32_bf16 v[16:19], v[196:199], a[196:199], v[16:19]
s_add_u32 s77, s65, 128
ds_read_b64_tr_b16 v[168:169], v13 offset:16384
s_add_u32 m0, s58, 16384
v_mfma_f32_16x16x32_bf16 v[20:23], v[196:199], a[200:203], v[20:23]
ds_read_b64_tr_b16 v[170:171], v13 offset:17408
v_mfma_f32_16x16x32_bf16 v[20:23], v[192:195], a[188:191], v[20:23]
ds_read_b64_tr_b16 v[172:173], v13 offset:24576
v_mfma_f32_16x16x32_bf16 v[24:27], v[192:195], a[192:195], v[24:27]
ds_read_b64_tr_b16 v[174:175], v13 offset:25600
v_mfma_f32_16x16x32_bf16 v[24:27], v[196:199], a[204:207], v[24:27]
s_waitcnt lgkmcnt(8)
ds_read_b128 a[208:211], v252 offset:0
v_mfma_f32_16x16x32_bf16 v[28:31], v[200:203], a[184:187], v[28:31]
ds_read_b128 a[212:215], v252 offset:2048
v_mfma_f32_16x16x32_bf16 v[28:31], v[204:207], a[196:199], v[28:31]
ds_read_b128 a[216:219], v252 offset:4096
v_mfma_f32_16x16x32_bf16 v[32:35], v[204:207], a[200:203], v[32:35]
ds_read_b128 a[220:223], v253 offset:0
v_mfma_f32_16x16x32_bf16 v[32:35], v[200:203], a[188:191], v[32:35]
ds_read_b128 a[224:227], v253 offset:2048
v_mfma_f32_16x16x32_bf16 v[36:39], v[200:203], a[192:195], v[36:39]
ds_read_b128 a[228:231], v253 offset:4096
v_mfma_f32_16x16x32_bf16 v[36:39], v[204:207], a[204:207], v[36:39]
s_waitcnt vmcnt(9) lgkmcnt(6)
s_barrier
ds_read_b64_tr_b16 v[176:177], v246 offset:0
v_mfma_f32_16x16x32_bf16 v[40:43], v[160:163], a[184:187], v[40:43]
buffer_load_dwordx4 v224, s[32:35], s77 offen offset:0 lds
v_mfma_f32_16x16x32_bf16 v[40:43], v[164:167], a[196:199], v[40:43]
ds_read_b64_tr_b16 v[178:179], v246 offset:1024
ds_read_b64_tr_b16 v[180:181], v246 offset:8192
v_mfma_f32_16x16x32_bf16 v[44:47], v[164:167], a[200:203], v[44:47]
ds_read_b64_tr_b16 v[182:183], v246 offset:9216
ds_read_b64_tr_b16 v[184:185], v247 offset:0
v_mfma_f32_16x16x32_bf16 v[44:47], v[160:163], a[188:191], v[44:47]
buffer_load_dwordx4 v225, s[32:35], s77 offen offset:1024 lds
v_mfma_f32_16x16x32_bf16 v[48:51], v[160:163], a[192:195], v[48:51]
ds_read_b64_tr_b16 v[186:187], v247 offset:1024
v_mfma_f32_16x16x32_bf16 v[48:51], v[164:167], a[204:207], v[48:51]
ds_read_b64_tr_b16 v[188:189], v247 offset:8192
v_mfma_f32_16x16x32_bf16 v[52:55], v[168:171], a[184:187], v[52:55]
buffer_load_dwordx4 v226, s[32:35], s77 offen offset:2048 lds
v_mfma_f32_16x16x32_bf16 v[52:55], v[172:175], a[196:199], v[52:55]
ds_read_b64_tr_b16 v[190:191], v247 offset:9216
v_mfma_f32_16x16x32_bf16 v[56:59], v[172:175], a[200:203], v[56:59]
ds_read_b64_tr_b16 v[192:193], v248 offset:0
v_mfma_f32_16x16x32_bf16 v[56:59], v[168:171], a[188:191], v[56:59]
buffer_load_dwordx4 v227, s[32:35], s77 offen offset:3072 lds
v_mfma_f32_16x16x32_bf16 v[60:63], v[168:171], a[192:195], v[60:63]
s_add_u32 s77, s66, 128
ds_read_b64_tr_b16 v[194:195], v248 offset:1024
s_add_u32 m0, s58, 101376
v_mfma_f32_16x16x32_bf16 v[60:63], v[172:175], a[204:207], v[60:63]
s_waitcnt lgkmcnt(6)
ds_read_b64_tr_b16 v[196:197], v248 offset:8192
v_mfma_f32_16x16x32_bf16 v[16:19], v[176:179], a[208:211], v[16:19]
ds_read_b64_tr_b16 v[198:199], v248 offset:9216
v_mfma_f32_16x16x32_bf16 v[16:19], v[180:183], a[220:223], v[16:19]
ds_read_b64_tr_b16 v[200:201], v249 offset:0
v_mfma_f32_16x16x32_bf16 v[20:23], v[180:183], a[224:227], v[20:23]
ds_read_b64_tr_b16 v[202:203], v249 offset:1024
v_mfma_f32_16x16x32_bf16 v[20:23], v[176:179], a[212:215], v[20:23]
ds_read_b64_tr_b16 v[204:205], v249 offset:8192
v_mfma_f32_16x16x32_bf16 v[24:27], v[176:179], a[216:219], v[24:27]
ds_read_b64_tr_b16 v[206:207], v249 offset:9216
v_mfma_f32_16x16x32_bf16 v[24:27], v[180:183], a[228:231], v[24:27]
s_waitcnt lgkmcnt(8)
ds_read_b128 a[232:235], v232 offset:0
v_mfma_f32_16x16x32_bf16 v[28:31], v[184:187], a[208:211], v[28:31]
ds_read_b128 a[236:239], v232 offset:2048
v_mfma_f32_16x16x32_bf16 v[28:31], v[188:191], a[220:223], v[28:31]
ds_read_b128 a[240:243], v232 offset:4096
v_mfma_f32_16x16x32_bf16 v[32:35], v[188:191], a[224:227], v[32:35]
ds_read_b128 a[244:247], v233 offset:0
v_mfma_f32_16x16x32_bf16 v[32:35], v[184:187], a[212:215], v[32:35]
ds_read_b128 a[248:251], v233 offset:2048
v_mfma_f32_16x16x32_bf16 v[36:39], v[184:187], a[216:219], v[36:39]
ds_read_b128 a[252:255], v233 offset:4096
v_mfma_f32_16x16x32_bf16 v[36:39], v[188:191], a[228:231], v[36:39]
s_waitcnt vmcnt(16) lgkmcnt(6)
s_barrier
ds_read_b64_tr_b16 v[160:161], v246 offset:16384
v_mfma_f32_16x16x32_bf16 v[40:43], v[192:195], a[208:211], v[40:43]
buffer_load_dwordx4 v224, s[32:35], s77 offen offset:0 lds
v_mfma_f32_16x16x32_bf16 v[40:43], v[196:199], a[220:223], v[40:43]
ds_read_b64_tr_b16 v[162:163], v246 offset:17408
v_mfma_f32_16x16x32_bf16 v[44:47], v[196:199], a[224:227], v[44:47]
ds_read_b64_tr_b16 v[164:165], v246 offset:24576
v_mfma_f32_16x16x32_bf16 v[44:47], v[192:195], a[212:215], v[44:47]
buffer_load_dwordx4 v225, s[32:35], s77 offen offset:1024 lds
v_mfma_f32_16x16x32_bf16 v[48:51], v[192:195], a[216:219], v[48:51]
ds_read_b64_tr_b16 v[166:167], v246 offset:25600
v_mfma_f32_16x16x32_bf16 v[48:51], v[196:199], a[228:231], v[48:51]
ds_read_b64_tr_b16 v[168:169], v247 offset:16384
v_mfma_f32_16x16x32_bf16 v[52:55], v[200:203], a[208:211], v[52:55]
buffer_load_dwordx4 v226, s[32:35], s77 offen offset:2048 lds
v_mfma_f32_16x16x32_bf16 v[52:55], v[204:207], a[220:223], v[52:55]
ds_read_b64_tr_b16 v[170:171], v247 offset:17408
v_mfma_f32_16x16x32_bf16 v[56:59], v[204:207], a[224:227], v[56:59]
ds_read_b64_tr_b16 v[172:173], v247 offset:24576
v_mfma_f32_16x16x32_bf16 v[56:59], v[200:203], a[212:215], v[56:59]
buffer_load_dwordx4 v227, s[32:35], s77 offen offset:3072 lds
v_mfma_f32_16x16x32_bf16 v[60:63], v[200:203], a[216:219], v[60:63]
s_add_u32 s77, s60, 256
ds_read_b64_tr_b16 v[174:175], v247 offset:25600
s_add_u32 m0, s58, 117760
v_mfma_f32_16x16x32_bf16 v[60:63], v[204:207], a[228:231], v[60:63]
s_waitcnt lgkmcnt(4)
ds_read_b64_tr_b16 v[176:177], v248 offset:16384
v_mfma_f32_16x16x32_bf16 v[16:19], v[160:163], a[232:235], v[16:19]
ds_read_b64_tr_b16 v[178:179], v248 offset:17408
v_mfma_f32_16x16x32_bf16 v[16:19], v[164:167], a[244:247], v[16:19]
ds_read_b64_tr_b16 v[180:181], v248 offset:24576
v_mfma_f32_16x16x32_bf16 v[20:23], v[164:167], a[248:251], v[20:23]
ds_read_b64_tr_b16 v[182:183], v248 offset:25600
v_mfma_f32_16x16x32_bf16 v[20:23], v[160:163], a[236:239], v[20:23]
ds_read_b64_tr_b16 v[184:185], v249 offset:16384
v_mfma_f32_16x16x32_bf16 v[24:27], v[160:163], a[240:243], v[24:27]
ds_read_b64_tr_b16 v[186:187], v249 offset:17408
v_mfma_f32_16x16x32_bf16 v[24:27], v[164:167], a[252:255], v[24:27]
s_waitcnt lgkmcnt(6)
ds_read_b64_tr_b16 v[188:189], v249 offset:24576
v_mfma_f32_16x16x32_bf16 v[28:31], v[168:171], a[232:235], v[28:31]
ds_read_b64_tr_b16 v[190:191], v249 offset:25600
v_mfma_f32_16x16x32_bf16 v[28:31], v[172:175], a[244:247], v[28:31]
v_mfma_f32_16x16x32_bf16 v[32:35], v[172:175], a[248:251], v[32:35]
v_mfma_f32_16x16x32_bf16 v[32:35], v[168:171], a[236:239], v[32:35]
v_mfma_f32_16x16x32_bf16 v[36:39], v[168:171], a[240:243], v[36:39]
v_mfma_f32_16x16x32_bf16 v[36:39], v[172:175], a[252:255], v[36:39]
s_waitcnt vmcnt(13) lgkmcnt(0)
s_barrier
ds_read_b64_tr_b16 v[192:193], v246 offset:32768
v_mfma_f32_16x16x32_bf16 v[40:43], v[176:179], a[232:235], v[40:43]
buffer_load_dwordx4 v224, s[32:35], s77 offen offset:0 lds
v_mfma_f32_16x16x32_bf16 v[40:43], v[180:183], a[244:247], v[40:43]
ds_read_b64_tr_b16 v[194:195], v246 offset:33792
ds_read_b64_tr_b16 v[196:197], v246 offset:40960
v_mfma_f32_16x16x32_bf16 v[44:47], v[180:183], a[248:251], v[44:47]
buffer_load_dwordx4 v225, s[32:35], s77 offen offset:1024 lds
v_mfma_f32_16x16x32_bf16 v[44:47], v[176:179], a[236:239], v[44:47]
ds_read_b64_tr_b16 v[198:199], v246 offset:41984
ds_read_b64_tr_b16 v[200:201], v247 offset:32768
v_mfma_f32_16x16x32_bf16 v[48:51], v[176:179], a[240:243], v[48:51]
buffer_load_dwordx4 v226, s[32:35], s77 offen offset:2048 lds
v_mfma_f32_16x16x32_bf16 v[48:51], v[180:183], a[252:255], v[48:51]
ds_read_b64_tr_b16 v[202:203], v247 offset:33792
ds_read_b64_tr_b16 v[204:205], v247 offset:40960
v_mfma_f32_16x16x32_bf16 v[52:55], v[184:187], a[232:235], v[52:55]
buffer_load_dwordx4 v227, s[32:35], s77 offen offset:3072 lds
v_mfma_f32_16x16x32_bf16 v[52:55], v[188:191], a[244:247], v[52:55]
s_add_u32 s83, s82, 16384
s_add_u32 m0, s57, 50688
ds_read_b64_tr_b16 v[206:207], v247 offset:41984
v_mfma_f32_16x16x32_bf16 v[56:59], v[188:191], a[248:251], v[56:59]
buffer_load_dwordx4 v5, s[24:27], s83 offen offset:0 nt lds
v_mfma_f32_16x16x32_bf16 v[56:59], v[184:187], a[236:239], v[56:59]
ds_read_b64_tr_b16 v[160:161], v248 offset:32768
v_mul_f32 v16, s55, v16
v_mfma_f32_16x16x32_bf16 v[60:63], v[184:187], a[240:243], v[60:63]
buffer_load_dwordx4 v6, s[24:27], s83 offen offset:1056 nt lds
v_mfma_f32_16x16x32_bf16 v[60:63], v[188:191], a[252:255], v[60:63]
s_waitcnt lgkmcnt(5)
ds_read_b64_tr_b16 v[162:163], v248 offset:33792
v_mul_f32 v17, s55, v17
v_mfma_f32_16x16x32_bf16 v[64:67], v[192:195], a[160:163], v[64:67]
buffer_load_dwordx4 v7, s[24:27], s83 offen offset:2112 nt lds
v_mfma_f32_16x16x32_bf16 v[64:67], v[196:199], a[172:175], v[64:67]
ds_read_b64_tr_b16 v[164:165], v248 offset:40960
v_mul_f32 v18, s55, v18
v_mfma_f32_16x16x32_bf16 v[68:71], v[196:199], a[176:179], v[68:71]
buffer_load_dwordx4 v8, s[24:27], s83 offen offset:3168 nt lds
v_mfma_f32_16x16x32_bf16 v[68:71], v[192:195], a[164:167], v[68:71]
s_add_u32 s77, s61, 256
ds_read_b64_tr_b16 v[166:167], v248 offset:41984
v_mul_f32 v19, s55, v19
v_mfma_f32_16x16x32_bf16 v[72:75], v[192:195], a[168:171], v[72:75]
s_add_u32 m0, s58, 134144
ds_read_b64_tr_b16 v[168:169], v249 offset:32768
v_mul_f32 v28, s55, v28
v_mfma_f32_16x16x32_bf16 v[72:75], v[196:199], a[180:183], v[72:75]
s_waitcnt lgkmcnt(5)
ds_read_b64_tr_b16 v[170:171], v249 offset:33792
v_mul_f32 v29, s55, v29
v_mfma_f32_16x16x32_bf16 v[76:79], v[200:203], a[160:163], v[76:79]
ds_read_b64_tr_b16 v[172:173], v249 offset:40960
v_mul_f32 v30, s55, v30
v_mfma_f32_16x16x32_bf16 v[76:79], v[204:207], a[172:175], v[76:79]
ds_read_b64_tr_b16 v[174:175], v249 offset:41984
v_mul_f32 v31, s55, v31
v_mfma_f32_16x16x32_bf16 v[80:83], v[204:207], a[176:179], v[80:83]
v_cvt_pk_bf16_f32 v16, v16, v17
v_cvt_pk_bf16_f32 v28, v28, v29
v_mfma_f32_16x16x32_bf16 v[80:83], v[200:203], a[164:167], v[80:83]
v_cvt_pk_bf16_f32 v17, v18, v19
v_cvt_pk_bf16_f32 v29, v30, v31
v_mfma_f32_16x16x32_bf16 v[84:87], v[200:203], a[168:171], v[84:87]
v_mul_f32 v20, s55, v20
v_mul_f32 v21, s55, v21
v_mfma_f32_16x16x32_bf16 v[84:87], v[204:207], a[180:183], v[84:87]
s_waitcnt vmcnt(17) lgkmcnt(0)
s_barrier
ds_read_b64_tr_b16 v[176:177], v10 offset:0
v_mfma_f32_16x16x32_bf16 v[88:91], v[160:163], a[160:163], v[88:91]
ds_read_b64_tr_b16 v[178:179], v10 offset:1024
v_mul_f32 v22, s55, v22
v_mfma_f32_16x16x32_bf16 v[88:91], v[164:167], a[172:175], v[88:91]
ds_read_b64_tr_b16 v[180:181], v10 offset:8192
v_mul_f32 v23, s55, v23
v_mfma_f32_16x16x32_bf16 v[92:95], v[164:167], a[176:179], v[92:95]
ds_read_b64_tr_b16 v[182:183], v10 offset:9216
v_mul_f32 v32, s55, v32
v_mfma_f32_16x16x32_bf16 v[92:95], v[160:163], a[164:167], v[92:95]
ds_read_b64_tr_b16 v[184:185], v11 offset:0
v_mul_f32 v33, s55, v33
v_mfma_f32_16x16x32_bf16 v[96:99], v[160:163], a[168:171], v[96:99]
ds_read_b64_tr_b16 v[186:187], v11 offset:1024
v_mul_f32 v34, s55, v34
v_mfma_f32_16x16x32_bf16 v[96:99], v[164:167], a[180:183], v[96:99]
ds_read_b64_tr_b16 v[188:189], v11 offset:8192
v_mul_f32 v35, s55, v35
v_mfma_f32_16x16x32_bf16 v[100:103], v[168:171], a[160:163], v[100:103]
ds_read_b64_tr_b16 v[190:191], v11 offset:9216
v_cvt_pk_bf16_f32 v20, v20, v21
v_mfma_f32_16x16x32_bf16 v[100:103], v[172:175], a[172:175], v[100:103]
ds_read_b64_tr_b16 v[192:193], v12 offset:0
v_cvt_pk_bf16_f32 v32, v32, v33
v_mfma_f32_16x16x32_bf16 v[104:107], v[172:175], a[176:179], v[104:107]
ds_read_b64_tr_b16 v[194:195], v12 offset:1024
v_cvt_pk_bf16_f32 v21, v22, v23
v_mfma_f32_16x16x32_bf16 v[104:107], v[168:171], a[164:167], v[104:107]
ds_read_b64_tr_b16 v[196:197], v12 offset:8192
v_cvt_pk_bf16_f32 v33, v34, v35
v_mfma_f32_16x16x32_bf16 v[108:111], v[168:171], a[168:171], v[108:111]
ds_read_b64_tr_b16 v[198:199], v12 offset:9216
v_mul_f32 v24, s55, v24
v_mfma_f32_16x16x32_bf16 v[108:111], v[172:175], a[180:183], v[108:111]
s_waitcnt lgkmcnt(8)
ds_read_b64_tr_b16 v[200:201], v13 offset:0
v_mul_f32 v25, s55, v25
v_mfma_f32_16x16x32_bf16 v[64:67], v[176:179], a[184:187], v[64:67]
ds_read_b64_tr_b16 v[202:203], v13 offset:1024
v_mul_f32 v26, s55, v26
v_mfma_f32_16x16x32_bf16 v[64:67], v[180:183], a[196:199], v[64:67]
ds_read_b64_tr_b16 v[204:205], v13 offset:8192
v_mul_f32 v27, s55, v27
v_mfma_f32_16x16x32_bf16 v[68:71], v[180:183], a[200:203], v[68:71]
ds_read_b64_tr_b16 v[206:207], v13 offset:9216
v_mul_f32 v36, s55, v36
v_mfma_f32_16x16x32_bf16 v[68:71], v[176:179], a[188:191], v[68:71]
v_permlane16_swap_b32 v16, v28
v_mfma_f32_16x16x32_bf16 v[72:75], v[176:179], a[192:195], v[72:75]
v_permlane16_swap_b32 v17, v29
v_mfma_f32_16x16x32_bf16 v[72:75], v[180:183], a[204:207], v[72:75]
s_waitcnt lgkmcnt(8)
v_permlane16_swap_b32 v20, v32
v_mfma_f32_16x16x32_bf16 v[76:79], v[184:187], a[184:187], v[76:79]
v_permlane16_swap_b32 v21, v33
v_mfma_f32_16x16x32_bf16 v[76:79], v[188:191], a[196:199], v[76:79]
v_accvgpr_write_b32 a0, v16
v_accvgpr_write_b32 a2, v28
v_mfma_f32_16x16x32_bf16 v[80:83], v[188:191], a[200:203], v[80:83]
v_accvgpr_write_b32 a1, v17
v_accvgpr_write_b32 a3, v29
v_mfma_f32_16x16x32_bf16 v[80:83], v[184:187], a[188:191], v[80:83]
v_accvgpr_write_b32 a4, v20
v_accvgpr_write_b32 a6, v32
v_mfma_f32_16x16x32_bf16 v[84:87], v[184:187], a[192:195], v[84:87]
v_accvgpr_write_b32 a5, v21
v_accvgpr_write_b32 a7, v33
v_mfma_f32_16x16x32_bf16 v[84:87], v[188:191], a[204:207], v[84:87]
s_waitcnt vmcnt(12) lgkmcnt(0)
s_barrier
ds_read_b64_tr_b16 v[160:161], v10 offset:16384
v_mfma_f32_16x16x32_bf16 v[88:91], v[192:195], a[184:187], v[88:91]
buffer_load_dwordx4 v224, s[32:35], s77 offen offset:0 lds
v_mfma_f32_16x16x32_bf16 v[88:91], v[196:199], a[196:199], v[88:91]
ds_read_b64_tr_b16 v[162:163], v10 offset:17408
ds_read_b64_tr_b16 v[164:165], v10 offset:24576
v_mfma_f32_16x16x32_bf16 v[92:95], v[196:199], a[200:203], v[92:95]
ds_read_b64_tr_b16 v[166:167], v10 offset:25600
ds_read_b64_tr_b16 v[168:169], v11 offset:16384
v_mfma_f32_16x16x32_bf16 v[92:95], v[192:195], a[188:191], v[92:95]
buffer_load_dwordx4 v225, s[32:35], s77 offen offset:1024 lds
v_mfma_f32_16x16x32_bf16 v[96:99], v[192:195], a[192:195], v[96:99]
ds_read_b64_tr_b16 v[170:171], v11 offset:17408
v_mul_f32 v37, s55, v37
v_mfma_f32_16x16x32_bf16 v[96:99], v[196:199], a[204:207], v[96:99]
ds_read_b64_tr_b16 v[172:173], v11 offset:24576
v_mul_f32 v38, s55, v38
v_mfma_f32_16x16x32_bf16 v[100:103], v[200:203], a[184:187], v[100:103]
buffer_load_dwordx4 v226, s[32:35], s77 offen offset:2048 lds
v_mfma_f32_16x16x32_bf16 v[100:103], v[204:207], a[196:199], v[100:103]
ds_read_b64_tr_b16 v[174:175], v11 offset:25600
v_mul_f32 v39, s55, v39
v_mfma_f32_16x16x32_bf16 v[104:107], v[204:207], a[200:203], v[104:107]
ds_read_b64_tr_b16 v[176:177], v12 offset:16384
v_cvt_pk_bf16_f32 v24, v24, v25
v_mfma_f32_16x16x32_bf16 v[104:107], v[200:203], a[188:191], v[104:107]
buffer_load_dwordx4 v227, s[32:35], s77 offen offset:3072 lds
v_mfma_f32_16x16x32_bf16 v[108:111], v[200:203], a[192:195], v[108:111]
s_add_u32 s77, s62, 256
ds_read_b64_tr_b16 v[178:179], v12 offset:17408
s_add_u32 m0, s58, 0
v_mfma_f32_16x16x32_bf16 v[108:111], v[204:207], a[204:207], v[108:111]
s_waitcnt lgkmcnt(6)
ds_read_b64_tr_b16 v[180:181], v12 offset:24576
v_cvt_pk_bf16_f32 v36, v36, v37
v_mfma_f32_16x16x32_bf16 v[64:67], v[160:163], a[208:211], v[64:67]
buffer_load_dwordx4 v224, s[32:35], s77 offen offset:0 lds
v_mfma_f32_16x16x32_bf16 v[64:67], v[164:167], a[220:223], v[64:67]
ds_read_b64_tr_b16 v[182:183], v12 offset:25600
v_cvt_pk_bf16_f32 v25, v26, v27
v_mfma_f32_16x16x32_bf16 v[68:71], v[164:167], a[224:227], v[68:71]
ds_read_b64_tr_b16 v[184:185], v13 offset:16384
v_cvt_pk_bf16_f32 v37, v38, v39
v_mfma_f32_16x16x32_bf16 v[68:71], v[160:163], a[212:215], v[68:71]
buffer_load_dwordx4 v225, s[32:35], s77 offen offset:1024 lds
v_mfma_f32_16x16x32_bf16 v[72:75], v[160:163], a[216:219], v[72:75]
ds_read_b64_tr_b16 v[186:187], v13 offset:17408
v_mul_f32 v40, s55, v40
v_mfma_f32_16x16x32_bf16 v[72:75], v[164:167], a[228:231], v[72:75]
s_waitcnt lgkmcnt(6)
ds_read_b64_tr_b16 v[188:189], v13 offset:24576
v_mul_f32 v41, s55, v41
v_mfma_f32_16x16x32_bf16 v[76:79], v[168:171], a[208:211], v[76:79]
ds_read_b64_tr_b16 v[190:191], v13 offset:25600
v_mul_f32 v42, s55, v42
v_mfma_f32_16x16x32_bf16 v[76:79], v[172:175], a[220:223], v[76:79]
buffer_load_dwordx4 v226, s[32:35], s77 offen offset:2048 lds
v_mfma_f32_16x16x32_bf16 v[80:83], v[172:175], a[224:227], v[80:83]
v_permlane16_swap_b32 v24, v36
v_mfma_f32_16x16x32_bf16 v[80:83], v[168:171], a[212:215], v[80:83]
buffer_load_dwordx4 v227, s[32:35], s77 offen offset:3072 lds
v_mfma_f32_16x16x32_bf16 v[84:87], v[168:171], a[216:219], v[84:87]
s_add_u32 s77, s63, 256
s_add_u32 m0, s58, 16384
v_accvgpr_write_b32 a8, v24
v_mfma_f32_16x16x32_bf16 v[84:87], v[172:175], a[228:231], v[84:87]
s_waitcnt vmcnt(16) lgkmcnt(0)
s_barrier
ds_read_b64_tr_b16 v[192:193], v246 offset:0
v_mfma_f32_16x16x32_bf16 v[88:91], v[176:179], a[208:211], v[88:91]
buffer_load_dwordx4 v224, s[32:35], s77 offen offset:0 lds
v_mfma_f32_16x16x32_bf16 v[88:91], v[180:183], a[220:223], v[88:91]
ds_read_b64_tr_b16 v[194:195], v246 offset:1024
v_accvgpr_write_b32 a10, v36
v_mfma_f32_16x16x32_bf16 v[92:95], v[180:183], a[224:227], v[92:95]
ds_read_b64_tr_b16 v[196:197], v246 offset:8192
v_mul_f32 v43, s55, v43
v_mfma_f32_16x16x32_bf16 v[92:95], v[176:179], a[212:215], v[92:95]
buffer_load_dwordx4 v225, s[32:35], s77 offen offset:1024 lds
v_mfma_f32_16x16x32_bf16 v[96:99], v[176:179], a[216:219], v[96:99]
ds_read_b64_tr_b16 v[198:199], v246 offset:9216
v_mul_f32 v52, s55, v52
v_mfma_f32_16x16x32_bf16 v[96:99], v[180:183], a[228:231], v[96:99]
ds_read_b64_tr_b16 v[200:201], v247 offset:0
v_mul_f32 v53, s55, v53
v_mfma_f32_16x16x32_bf16 v[100:103], v[184:187], a[208:211], v[100:103]
buffer_load_dwordx4 v226, s[32:35], s77 offen offset:2048 lds
v_mfma_f32_16x16x32_bf16 v[100:103], v[188:191], a[220:223], v[100:103]
ds_read_b64_tr_b16 v[202:203], v247 offset:1024
v_mul_f32 v54, s55, v54
v_mfma_f32_16x16x32_bf16 v[104:107], v[188:191], a[224:227], v[104:107]
ds_read_b64_tr_b16 v[204:205], v247 offset:8192
v_mul_f32 v55, s55, v55
v_mfma_f32_16x16x32_bf16 v[104:107], v[184:187], a[212:215], v[104:107]
buffer_load_dwordx4 v227, s[32:35], s77 offen offset:3072 lds
v_mfma_f32_16x16x32_bf16 v[108:111], v[184:187], a[216:219], v[108:111]
s_add_u32 s77, s64, 256
ds_read_b64_tr_b16 v[206:207], v247 offset:9216
v_cvt_pk_bf16_f32 v40, v40, v41
v_mfma_f32_16x16x32_bf16 v[108:111], v[188:191], a[228:231], v[108:111]
s_waitcnt lgkmcnt(4)
ds_read_b64_tr_b16 v[160:161], v248 offset:0
v_cvt_pk_bf16_f32 v52, v52, v53
v_mfma_f32_16x16x32_bf16 v[64:67], v[192:195], a[232:235], v[64:67]
s_add_u32 m0, s58, 101376
ds_read_b64_tr_b16 v[162:163], v248 offset:1024
v_cvt_pk_bf16_f32 v41, v42, v43
v_mfma_f32_16x16x32_bf16 v[64:67], v[196:199], a[244:247], v[64:67]
ds_read_b64_tr_b16 v[164:165], v248 offset:8192
v_cvt_pk_bf16_f32 v53, v54, v55
v_mfma_f32_16x16x32_bf16 v[68:71], v[196:199], a[248:251], v[68:71]
ds_read_b64_tr_b16 v[166:167], v248 offset:9216
v_mul_f32 v44, s55, v44
v_mfma_f32_16x16x32_bf16 v[68:71], v[192:195], a[236:239], v[68:71]
ds_read_b64_tr_b16 v[168:169], v249 offset:0
v_mul_f32 v45, s55, v45
v_mfma_f32_16x16x32_bf16 v[72:75], v[192:195], a[240:243], v[72:75]
ds_read_b64_tr_b16 v[170:171], v249 offset:1024
v_mul_f32 v46, s55, v46
v_mfma_f32_16x16x32_bf16 v[72:75], v[196:199], a[252:255], v[72:75]
s_waitcnt lgkmcnt(6)
ds_read_b64_tr_b16 v[172:173], v249 offset:8192
v_mul_f32 v47, s55, v47
v_mfma_f32_16x16x32_bf16 v[76:79], v[200:203], a[232:235], v[76:79]
ds_read_b64_tr_b16 v[174:175], v249 offset:9216
v_mul_f32 v56, s55, v56
v_mfma_f32_16x16x32_bf16 v[76:79], v[204:207], a[244:247], v[76:79]
v_permlane16_swap_b32 v25, v37
v_mfma_f32_16x16x32_bf16 v[80:83], v[204:207], a[248:251], v[80:83]
v_permlane16_swap_b32 v40, v52
v_mfma_f32_16x16x32_bf16 v[80:83], v[200:203], a[236:239], v[80:83]
v_permlane16_swap_b32 v41, v53
v_mfma_f32_16x16x32_bf16 v[84:87], v[200:203], a[240:243], v[84:87]
v_accvgpr_write_b32 a9, v25
v_accvgpr_write_b32 a11, v37
v_mfma_f32_16x16x32_bf16 v[84:87], v[204:207], a[252:255], v[84:87]
s_waitcnt vmcnt(16) lgkmcnt(0)
s_barrier
ds_read_b64_tr_b16 v[176:177], v246 offset:16384
v_mfma_f32_16x16x32_bf16 v[88:91], v[160:163], a[232:235], v[88:91]
buffer_load_dwordx4 v224, s[32:35], s77 offen offset:0 lds
v_mfma_f32_16x16x32_bf16 v[88:91], v[164:167], a[244:247], v[88:91]
ds_read_b64_tr_b16 v[178:179], v246 offset:17408
ds_read_b64_tr_b16 v[180:181], v246 offset:24576
v_mfma_f32_16x16x32_bf16 v[92:95], v[164:167], a[248:251], v[92:95]
buffer_load_dwordx4 v225, s[32:35], s77 offen offset:1024 lds
v_mfma_f32_16x16x32_bf16 v[92:95], v[160:163], a[236:239], v[92:95]
ds_read_b64_tr_b16 v[182:183], v246 offset:25600
ds_read_b64_tr_b16 v[184:185], v247 offset:16384
v_mfma_f32_16x16x32_bf16 v[96:99], v[160:163], a[240:243], v[96:99]
buffer_load_dwordx4 v226, s[32:35], s77 offen offset:2048 lds
v_mfma_f32_16x16x32_bf16 v[96:99], v[164:167], a[252:255], v[96:99]
ds_read_b64_tr_b16 v[186:187], v247 offset:17408
ds_read_b64_tr_b16 v[188:189], v247 offset:24576
v_mfma_f32_16x16x32_bf16 v[100:103], v[168:171], a[232:235], v[100:103]
buffer_load_dwordx4 v227, s[32:35], s77 offen offset:3072 lds
v_mfma_f32_16x16x32_bf16 v[100:103], v[172:175], a[244:247], v[100:103]
s_add_u32 s83, s82, 32768
s_add_u32 m0, s57, 67584
ds_read_b64_tr_b16 v[190:191], v247 offset:25600
v_mfma_f32_16x16x32_bf16 v[104:107], v[172:175], a[248:251], v[104:107]
buffer_load_dwordx4 v5, s[24:27], s83 offen offset:0 nt lds
v_mfma_f32_16x16x32_bf16 v[104:107], v[168:171], a[236:239], v[104:107]
ds_read_b64_tr_b16 v[192:193], v248 offset:16384
v_accvgpr_write_b32 a12, v40
v_mfma_f32_16x16x32_bf16 v[108:111], v[168:171], a[240:243], v[108:111]
buffer_load_dwordx4 v6, s[24:27], s83 offen offset:1056 nt lds
v_mfma_f32_16x16x32_bf16 v[108:111], v[172:175], a[252:255], v[108:111]
s_waitcnt lgkmcnt(5)
ds_read_b64_tr_b16 v[194:195], v248 offset:17408
v_accvgpr_write_b32 a14, v52
v_mfma_f32_16x16x32_bf16 v[112:115], v[176:179], a[88:91], 0
buffer_load_dwordx4 v7, s[24:27], s83 offen offset:2112 nt lds
v_mfma_f32_16x16x32_bf16 v[112:115], v[180:183], a[100:103], v[112:115]
ds_read_b64_tr_b16 v[196:197], v248 offset:24576
v_accvgpr_write_b32 a13, v41
v_mfma_f32_16x16x32_bf16 v[116:119], v[180:183], a[104:107], 0
buffer_load_dwordx4 v8, s[24:27], s83 offen offset:3168 nt lds
v_mfma_f32_16x16x32_bf16 v[116:119], v[176:179], a[92:95], v[116:119]
s_add_u32 s77, s65, 256
ds_read_b64_tr_b16 v[198:199], v248 offset:25600
v_accvgpr_write_b32 a15, v53
v_mfma_f32_16x16x32_bf16 v[120:123], v[176:179], a[96:99], 0
s_add_u32 m0, s58, 117760
ds_read_b64_tr_b16 v[200:201], v249 offset:16384
v_mul_f32 v57, s55, v57
v_mfma_f32_16x16x32_bf16 v[120:123], v[180:183], a[108:111], v[120:123]
s_waitcnt lgkmcnt(5)
ds_read_b64_tr_b16 v[202:203], v249 offset:17408
v_mul_f32 v58, s55, v58
v_mfma_f32_16x16x32_bf16 v[124:127], v[184:187], a[88:91], 0
ds_read_b64_tr_b16 v[204:205], v249 offset:24576
v_mul_f32 v59, s55, v59
v_mfma_f32_16x16x32_bf16 v[124:127], v[188:191], a[100:103], v[124:127]
ds_read_b64_tr_b16 v[206:207], v249 offset:25600
v_cvt_pk_bf16_f32 v44, v44, v45
v_mfma_f32_16x16x32_bf16 v[128:131], v[188:191], a[104:107], 0
v_cvt_pk_bf16_f32 v56, v56, v57
v_cvt_pk_bf16_f32 v45, v46, v47
v_mfma_f32_16x16x32_bf16 v[128:131], v[184:187], a[92:95], v[128:131]
v_cvt_pk_bf16_f32 v57, v58, v59
v_mul_f32 v48, s55, v48
v_mfma_f32_16x16x32_bf16 v[132:135], v[184:187], a[96:99], 0
v_mul_f32 v49, s55, v49
v_mul_f32 v50, s55, v50
v_mfma_f32_16x16x32_bf16 v[132:135], v[188:191], a[108:111], v[132:135]
s_waitcnt vmcnt(16) lgkmcnt(0)
s_barrier
ds_read_b64_tr_b16 v[160:161], v246 offset:32768
v_mfma_f32_16x16x32_bf16 v[136:139], v[192:195], a[88:91], 0
ds_read_b64_tr_b16 v[162:163], v246 offset:33792
v_mul_f32 v51, s55, v51
v_mfma_f32_16x16x32_bf16 v[136:139], v[196:199], a[100:103], v[136:139]
ds_read_b64_tr_b16 v[164:165], v246 offset:40960
v_mul_f32 v60, s55, v60
v_mfma_f32_16x16x32_bf16 v[140:143], v[196:199], a[104:107], 0
ds_read_b64_tr_b16 v[166:167], v246 offset:41984
v_mul_f32 v61, s55, v61
v_mfma_f32_16x16x32_bf16 v[140:143], v[192:195], a[92:95], v[140:143]
ds_read_b64_tr_b16 v[168:169], v247 offset:32768
v_mul_f32 v62, s55, v62
v_mfma_f32_16x16x32_bf16 v[144:147], v[192:195], a[96:99], 0
ds_read_b64_tr_b16 v[170:171], v247 offset:33792
v_mul_f32 v63, s55, v63
v_mfma_f32_16x16x32_bf16 v[144:147], v[196:199], a[108:111], v[144:147]
ds_read_b64_tr_b16 v[172:173], v247 offset:40960
v_cvt_pk_bf16_f32 v48, v48, v49
v_mfma_f32_16x16x32_bf16 v[148:151], v[200:203], a[88:91], 0
ds_read_b64_tr_b16 v[174:175], v247 offset:41984
v_cvt_pk_bf16_f32 v60, v60, v61
v_mfma_f32_16x16x32_bf16 v[148:151], v[204:207], a[100:103], v[148:151]
ds_read_b64_tr_b16 v[176:177], v248 offset:32768
v_cvt_pk_bf16_f32 v49, v50, v51
v_mfma_f32_16x16x32_bf16 v[152:155], v[204:207], a[104:107], 0
ds_read_b64_tr_b16 v[178:179], v248 offset:33792
v_cvt_pk_bf16_f32 v61, v62, v63
v_mfma_f32_16x16x32_bf16 v[152:155], v[200:203], a[92:95], v[152:155]
ds_read_b64_tr_b16 v[180:181], v248 offset:40960
v_mul_f32 v64, s55, v64
v_mfma_f32_16x16x32_bf16 v[156:159], v[200:203], a[96:99], 0
ds_read_b64_tr_b16 v[182:183], v248 offset:41984
v_mul_f32 v65, s55, v65
v_mfma_f32_16x16x32_bf16 v[156:159], v[204:207], a[108:111], v[156:159]
s_waitcnt lgkmcnt(8)
ds_read_b64_tr_b16 v[184:185], v249 offset:32768
v_mul_f32 v66, s55, v66
v_mfma_f32_16x16x32_bf16 v[112:115], v[160:163], a[112:115], v[112:115]
ds_read_b64_tr_b16 v[186:187], v249 offset:33792
v_mul_f32 v67, s55, v67
v_mfma_f32_16x16x32_bf16 v[112:115], v[164:167], a[124:127], v[112:115]
ds_read_b64_tr_b16 v[188:189], v249 offset:40960
v_mul_f32 v76, s55, v76
v_mfma_f32_16x16x32_bf16 v[116:119], v[164:167], a[128:131], v[116:119]
ds_read_b64_tr_b16 v[190:191], v249 offset:41984
v_mul_f32 v77, s55, v77
v_mfma_f32_16x16x32_bf16 v[116:119], v[160:163], a[116:119], v[116:119]
v_permlane16_swap_b32 v44, v56
v_mfma_f32_16x16x32_bf16 v[120:123], v[160:163], a[120:123], v[120:123]
v_permlane16_swap_b32 v45, v57
v_mfma_f32_16x16x32_bf16 v[120:123], v[164:167], a[132:135], v[120:123]
s_waitcnt lgkmcnt(8)
v_permlane16_swap_b32 v48, v60
v_mfma_f32_16x16x32_bf16 v[124:127], v[168:171], a[112:115], v[124:127]
v_permlane16_swap_b32 v49, v61
v_mfma_f32_16x16x32_bf16 v[124:127], v[172:175], a[124:127], v[124:127]
v_accvgpr_write_b32 a16, v44
v_accvgpr_write_b32 a18, v56
v_mfma_f32_16x16x32_bf16 v[128:131], v[172:175], a[128:131], v[128:131]
v_accvgpr_write_b32 a17, v45
v_accvgpr_write_b32 a19, v57
v_mfma_f32_16x16x32_bf16 v[128:131], v[168:171], a[116:119], v[128:131]
v_accvgpr_write_b32 a20, v48
v_accvgpr_write_b32 a22, v60
v_mfma_f32_16x16x32_bf16 v[132:135], v[168:171], a[120:123], v[132:135]
v_accvgpr_write_b32 a21, v49
v_accvgpr_write_b32 a23, v61
v_mfma_f32_16x16x32_bf16 v[132:135], v[172:175], a[132:135], v[132:135]
s_waitcnt vmcnt(12) lgkmcnt(0)
s_barrier
ds_read_b64_tr_b16 v[192:193], v10 offset:0
v_mfma_f32_16x16x32_bf16 v[136:139], v[176:179], a[112:115], v[136:139]
buffer_load_dwordx4 v224, s[32:35], s77 offen offset:0 lds
v_mfma_f32_16x16x32_bf16 v[136:139], v[180:183], a[124:127], v[136:139]
ds_read_b64_tr_b16 v[194:195], v10 offset:1024
ds_read_b64_tr_b16 v[196:197], v10 offset:8192
v_mfma_f32_16x16x32_bf16 v[140:143], v[180:183], a[128:131], v[140:143]
ds_read_b64_tr_b16 v[198:199], v10 offset:9216
ds_read_b64_tr_b16 v[200:201], v11 offset:0
v_mfma_f32_16x16x32_bf16 v[140:143], v[176:179], a[116:119], v[140:143]
buffer_load_dwordx4 v225, s[32:35], s77 offen offset:1024 lds
v_mfma_f32_16x16x32_bf16 v[144:147], v[176:179], a[120:123], v[144:147]
ds_read_b64_tr_b16 v[202:203], v11 offset:1024
v_mul_f32 v78, s55, v78
v_mfma_f32_16x16x32_bf16 v[144:147], v[180:183], a[132:135], v[144:147]
ds_read_b64_tr_b16 v[204:205], v11 offset:8192
v_mul_f32 v79, s55, v79
v_mfma_f32_16x16x32_bf16 v[148:151], v[184:187], a[112:115], v[148:151]
buffer_load_dwordx4 v226, s[32:35], s77 offen offset:2048 lds
v_mfma_f32_16x16x32_bf16 v[148:151], v[188:191], a[124:127], v[148:151]
ds_read_b64_tr_b16 v[206:207], v11 offset:9216
v_cvt_pk_bf16_f32 v64, v64, v65
v_mfma_f32_16x16x32_bf16 v[152:155], v[188:191], a[128:131], v[152:155]
ds_read_b64_tr_b16 v[160:161], v12 offset:0
v_cvt_pk_bf16_f32 v76, v76, v77
v_mfma_f32_16x16x32_bf16 v[152:155], v[184:187], a[116:119], v[152:155]
buffer_load_dwordx4 v227, s[32:35], s77 offen offset:3072 lds
v_mfma_f32_16x16x32_bf16 v[156:159], v[184:187], a[120:123], v[156:159]
s_add_u32 s77, s66, 256
ds_read_b64_tr_b16 v[162:163], v12 offset:1024
s_add_u32 m0, s58, 134144
v_mfma_f32_16x16x32_bf16 v[156:159], v[188:191], a[132:135], v[156:159]
s_waitcnt lgkmcnt(6)
ds_read_b64_tr_b16 v[164:165], v12 offset:8192
v_cvt_pk_bf16_f32 v65, v66, v67
v_mfma_f32_16x16x32_bf16 v[112:115], v[192:195], a[136:139], v[112:115]
buffer_load_dwordx4 v224, s[32:35], s77 offen offset:0 lds
v_mfma_f32_16x16x32_bf16 v[112:115], v[196:199], a[148:151], v[112:115]
ds_read_b64_tr_b16 v[166:167], v12 offset:9216
v_cvt_pk_bf16_f32 v77, v78, v79
v_mfma_f32_16x16x32_bf16 v[116:119], v[196:199], a[152:155], v[116:119]
ds_read_b64_tr_b16 v[168:169], v13 offset:0
v_mul_f32 v68, s55, v68
v_mfma_f32_16x16x32_bf16 v[116:119], v[192:195], a[140:143], v[116:119]
buffer_load_dwordx4 v225, s[32:35], s77 offen offset:1024 lds
v_mfma_f32_16x16x32_bf16 v[120:123], v[192:195], a[144:147], v[120:123]
ds_read_b64_tr_b16 v[170:171], v13 offset:1024
v_mul_f32 v69, s55, v69
v_mfma_f32_16x16x32_bf16 v[120:123], v[196:199], a[156:159], v[120:123]
s_waitcnt lgkmcnt(6)
ds_read_b64_tr_b16 v[172:173], v13 offset:8192
v_mul_f32 v70, s55, v70
v_mfma_f32_16x16x32_bf16 v[124:127], v[200:203], a[136:139], v[124:127]
ds_read_b64_tr_b16 v[174:175], v13 offset:9216
v_mul_f32 v71, s55, v71
v_mfma_f32_16x16x32_bf16 v[124:127], v[204:207], a[148:151], v[124:127]
buffer_load_dwordx4 v226, s[32:35], s77 offen offset:2048 lds
v_mfma_f32_16x16x32_bf16 v[128:131], v[204:207], a[152:155], v[128:131]
v_permlane16_swap_b32 v64, v76
v_mfma_f32_16x16x32_bf16 v[128:131], v[200:203], a[140:143], v[128:131]
buffer_load_dwordx4 v227, s[32:35], s77 offen offset:3072 lds
v_mfma_f32_16x16x32_bf16 v[132:135], v[200:203], a[144:147], v[132:135]
s_add_u32 s77, s60, 384
s_add_u32 m0, s58, 0
v_accvgpr_write_b32 a24, v64
v_mfma_f32_16x16x32_bf16 v[132:135], v[204:207], a[156:159], v[132:135]
s_waitcnt vmcnt(16) lgkmcnt(0)
s_barrier
ds_read_b64_tr_b16 v[176:177], v10 offset:16384
v_mfma_f32_16x16x32_bf16 v[136:139], v[160:163], a[136:139], v[136:139]
buffer_load_dwordx4 v224, s[32:35], s77 offen offset:0 lds
v_mfma_f32_16x16x32_bf16 v[136:139], v[164:167], a[148:151], v[136:139]
ds_read_b64_tr_b16 v[178:179], v10 offset:17408
v_accvgpr_write_b32 a26, v76
v_mfma_f32_16x16x32_bf16 v[140:143], v[164:167], a[152:155], v[140:143]
ds_read_b64_tr_b16 v[180:181], v10 offset:24576
v_mul_f32 v80, s55, v80
v_mfma_f32_16x16x32_bf16 v[140:143], v[160:163], a[140:143], v[140:143]
buffer_load_dwordx4 v225, s[32:35], s77 offen offset:1024 lds
v_mfma_f32_16x16x32_bf16 v[144:147], v[160:163], a[144:147], v[144:147]
ds_read_b64_tr_b16 v[182:183], v10 offset:25600
v_mul_f32 v81, s55, v81
v_mfma_f32_16x16x32_bf16 v[144:147], v[164:167], a[156:159], v[144:147]
ds_read_b64_tr_b16 v[184:185], v11 offset:16384
v_mul_f32 v82, s55, v82
v_mfma_f32_16x16x32_bf16 v[148:151], v[168:171], a[136:139], v[148:151]
buffer_load_dwordx4 v226, s[32:35], s77 offen offset:2048 lds
v_mfma_f32_16x16x32_bf16 v[148:151], v[172:175], a[148:151], v[148:151]
ds_read_b64_tr_b16 v[186:187], v11 offset:17408
v_mul_f32 v83, s55, v83
v_mfma_f32_16x16x32_bf16 v[152:155], v[172:175], a[152:155], v[152:155]
ds_read_b64_tr_b16 v[188:189], v11 offset:24576
v_cvt_pk_bf16_f32 v68, v68, v69
v_mfma_f32_16x16x32_bf16 v[152:155], v[168:171], a[140:143], v[152:155]
buffer_load_dwordx4 v227, s[32:35], s77 offen offset:3072 lds
v_mfma_f32_16x16x32_bf16 v[156:159], v[168:171], a[144:147], v[156:159]
s_add_u32 s77, s61, 384
ds_read_b64_tr_b16 v[190:191], v11 offset:25600
v_cvt_pk_bf16_f32 v80, v80, v81
v_mfma_f32_16x16x32_bf16 v[156:159], v[172:175], a[156:159], v[156:159]
s_waitcnt lgkmcnt(4)
ds_read_b64_tr_b16 v[192:193], v12 offset:16384
v_cvt_pk_bf16_f32 v69, v70, v71
v_mfma_f32_16x16x32_bf16 v[112:115], v[176:179], a[160:163], v[112:115]
s_add_u32 m0, s58, 16384
ds_read_b64_tr_b16 v[194:195], v12 offset:17408
v_cvt_pk_bf16_f32 v81, v82, v83
v_mfma_f32_16x16x32_bf16 v[112:115], v[180:183], a[172:175], v[112:115]
ds_read_b64_tr_b16 v[196:197], v12 offset:24576
v_mul_f32 v72, s55, v72
v_mfma_f32_16x16x32_bf16 v[116:119], v[180:183], a[176:179], v[116:119]
ds_read_b64_tr_b16 v[198:199], v12 offset:25600
v_mul_f32 v73, s55, v73
v_mfma_f32_16x16x32_bf16 v[116:119], v[176:179], a[164:167], v[116:119]
ds_read_b64_tr_b16 v[200:201], v13 offset:16384
v_mul_f32 v74, s55, v74
v_mfma_f32_16x16x32_bf16 v[120:123], v[176:179], a[168:171], v[120:123]
ds_read_b64_tr_b16 v[202:203], v13 offset:17408
v_mul_f32 v75, s55, v75
v_mfma_f32_16x16x32_bf16 v[120:123], v[180:183], a[180:183], v[120:123]
s_waitcnt lgkmcnt(6)
ds_read_b64_tr_b16 v[204:205], v13 offset:24576
v_mul_f32 v84, s55, v84
v_mfma_f32_16x16x32_bf16 v[124:127], v[184:187], a[160:163], v[124:127]
ds_read_b64_tr_b16 v[206:207], v13 offset:25600
v_mul_f32 v85, s55, v85
v_mfma_f32_16x16x32_bf16 v[124:127], v[188:191], a[172:175], v[124:127]
v_permlane16_swap_b32 v65, v77
v_mfma_f32_16x16x32_bf16 v[128:131], v[188:191], a[176:179], v[128:131]
v_permlane16_swap_b32 v68, v80
v_mfma_f32_16x16x32_bf16 v[128:131], v[184:187], a[164:167], v[128:131]
v_permlane16_swap_b32 v69, v81
v_mfma_f32_16x16x32_bf16 v[132:135], v[184:187], a[168:171], v[132:135]
v_accvgpr_write_b32 a25, v65
v_accvgpr_write_b32 a27, v77
v_mfma_f32_16x16x32_bf16 v[132:135], v[188:191], a[180:183], v[132:135]
s_waitcnt vmcnt(16) lgkmcnt(0)
s_barrier
ds_read_b64_tr_b16 v[160:161], v246 offset:0
v_mfma_f32_16x16x32_bf16 v[136:139], v[192:195], a[160:163], v[136:139]
buffer_load_dwordx4 v224, s[32:35], s77 offen offset:0 lds
v_mfma_f32_16x16x32_bf16 v[136:139], v[196:199], a[172:175], v[136:139]
ds_read_b64_tr_b16 v[162:163], v246 offset:1024
ds_read_b64_tr_b16 v[164:165], v246 offset:8192
v_mfma_f32_16x16x32_bf16 v[140:143], v[196:199], a[176:179], v[140:143]
buffer_load_dwordx4 v225, s[32:35], s77 offen offset:1024 lds
v_mfma_f32_16x16x32_bf16 v[140:143], v[192:195], a[164:167], v[140:143]
ds_read_b64_tr_b16 v[166:167], v246 offset:9216
ds_read_b64_tr_b16 v[168:169], v247 offset:0
v_mfma_f32_16x16x32_bf16 v[144:147], v[192:195], a[168:171], v[144:147]
buffer_load_dwordx4 v226, s[32:35], s77 offen offset:2048 lds
v_mfma_f32_16x16x32_bf16 v[144:147], v[196:199], a[180:183], v[144:147]
ds_read_b64_tr_b16 v[170:171], v247 offset:1024
ds_read_b64_tr_b16 v[172:173], v247 offset:8192
v_mfma_f32_16x16x32_bf16 v[148:151], v[200:203], a[160:163], v[148:151]
buffer_load_dwordx4 v227, s[32:35], s77 offen offset:3072 lds
v_mfma_f32_16x16x32_bf16 v[148:151], v[204:207], a[172:175], v[148:151]
s_add_u32 s83, s82, 49152
s_add_u32 m0, s57, 84480
ds_read_b64_tr_b16 v[174:175], v247 offset:9216
v_mfma_f32_16x16x32_bf16 v[152:155], v[204:207], a[176:179], v[152:155]
buffer_load_dwordx4 v5, s[24:27], s83 offen offset:0 nt lds
v_mfma_f32_16x16x32_bf16 v[152:155], v[200:203], a[164:167], v[152:155]
ds_read_b64_tr_b16 v[176:177], v248 offset:0
v_accvgpr_write_b32 a28, v68
v_mfma_f32_16x16x32_bf16 v[156:159], v[200:203], a[168:171], v[156:159]
buffer_load_dwordx4 v6, s[24:27], s83 offen offset:1056 nt lds
v_mfma_f32_16x16x32_bf16 v[156:159], v[204:207], a[180:183], v[156:159]
s_waitcnt lgkmcnt(5)
ds_read_b64_tr_b16 v[178:179], v248 offset:1024
v_accvgpr_write_b32 a30, v80
v_mfma_f32_16x16x32_bf16 v[112:115], v[160:163], a[184:187], v[112:115]
buffer_load_dwordx4 v7, s[24:27], s83 offen offset:2112 nt lds
v_mfma_f32_16x16x32_bf16 v[112:115], v[164:167], a[196:199], v[112:115]
ds_read_b64_tr_b16 v[180:181], v248 offset:8192
v_accvgpr_write_b32 a29, v69
v_mfma_f32_16x16x32_bf16 v[116:119], v[164:167], a[200:203], v[116:119]
buffer_load_dwordx4 v8, s[24:27], s83 offen offset:3168 nt lds
v_mfma_f32_16x16x32_bf16 v[116:119], v[160:163], a[188:191], v[116:119]
s_add_u32 s77, s62, 384
ds_read_b64_tr_b16 v[182:183], v248 offset:9216
v_accvgpr_write_b32 a31, v81
v_mfma_f32_16x16x32_bf16 v[120:123], v[160:163], a[192:195], v[120:123]
s_add_u32 m0, s58, 101376
ds_read_b64_tr_b16 v[184:185], v249 offset:0
v_mul_f32 v86, s55, v86
v_mfma_f32_16x16x32_bf16 v[120:123], v[164:167], a[204:207], v[120:123]
s_waitcnt lgkmcnt(5)
ds_read_b64_tr_b16 v[186:187], v249 offset:1024
v_mul_f32 v87, s55, v87
v_mfma_f32_16x16x32_bf16 v[124:127], v[168:171], a[184:187], v[124:127]
ds_read_b64_tr_b16 v[188:189], v249 offset:8192
v_cvt_pk_bf16_f32 v72, v72, v73
v_mfma_f32_16x16x32_bf16 v[124:127], v[172:175], a[196:199], v[124:127]
ds_read_b64_tr_b16 v[190:191], v249 offset:9216
v_cvt_pk_bf16_f32 v84, v84, v85
v_mfma_f32_16x16x32_bf16 v[128:131], v[172:175], a[200:203], v[128:131]
v_cvt_pk_bf16_f32 v73, v74, v75
v_cvt_pk_bf16_f32 v85, v86, v87
v_mfma_f32_16x16x32_bf16 v[128:131], v[168:171], a[188:191], v[128:131]
v_mul_f32 v88, s55, v88
v_mul_f32 v89, s55, v89
v_mfma_f32_16x16x32_bf16 v[132:135], v[168:171], a[192:195], v[132:135]
v_permlane16_swap_b32 v72, v84
v_mfma_f32_16x16x32_bf16 v[132:135], v[172:175], a[204:207], v[132:135]
s_waitcnt vmcnt(16) lgkmcnt(0)
s_barrier
ds_read_b64_tr_b16 v[192:193], v246 offset:16384
v_mfma_f32_16x16x32_bf16 v[136:139], v[176:179], a[184:187], v[136:139]
ds_read_b64_tr_b16 v[194:195], v246 offset:17408
v_accvgpr_write_b32 a32, v72
v_mfma_f32_16x16x32_bf16 v[136:139], v[180:183], a[196:199], v[136:139]
ds_read_b64_tr_b16 v[196:197], v246 offset:24576
v_accvgpr_write_b32 a34, v84
v_mfma_f32_16x16x32_bf16 v[140:143], v[180:183], a[200:203], v[140:143]
ds_read_b64_tr_b16 v[198:199], v246 offset:25600
v_mul_f32 v90, s55, v90
v_mfma_f32_16x16x32_bf16 v[140:143], v[176:179], a[188:191], v[140:143]
ds_read_b64_tr_b16 v[200:201], v247 offset:16384
v_mul_f32 v91, s55, v91
v_mfma_f32_16x16x32_bf16 v[144:147], v[176:179], a[192:195], v[144:147]
ds_read_b64_tr_b16 v[202:203], v247 offset:17408
v_mul_f32 v100, s55, v100
v_mfma_f32_16x16x32_bf16 v[144:147], v[180:183], a[204:207], v[144:147]
ds_read_b64_tr_b16 v[204:205], v247 offset:24576
v_mul_f32 v101, s55, v101
v_mfma_f32_16x16x32_bf16 v[148:151], v[184:187], a[184:187], v[148:151]
ds_read_b64_tr_b16 v[206:207], v247 offset:25600
v_mul_f32 v102, s55, v102
v_mfma_f32_16x16x32_bf16 v[148:151], v[188:191], a[196:199], v[148:151]
ds_read_b64_tr_b16 v[160:161], v248 offset:16384
v_mul_f32 v103, s55, v103
v_mfma_f32_16x16x32_bf16 v[152:155], v[188:191], a[200:203], v[152:155]
ds_read_b64_tr_b16 v[162:163], v248 offset:17408
v_cvt_pk_bf16_f32 v88, v88, v89
v_mfma_f32_16x16x32_bf16 v[152:155], v[184:187], a[188:191], v[152:155]
ds_read_b64_tr_b16 v[164:165], v248 offset:24576
v_cvt_pk_bf16_f32 v100, v100, v101
v_mfma_f32_16x16x32_bf16 v[156:159], v[184:187], a[192:195], v[156:159]
ds_read_b64_tr_b16 v[166:167], v248 offset:25600
v_cvt_pk_bf16_f32 v89, v90, v91
v_mfma_f32_16x16x32_bf16 v[156:159], v[188:191], a[204:207], v[156:159]
s_waitcnt lgkmcnt(8)
ds_read_b64_tr_b16 v[168:169], v249 offset:16384
v_cvt_pk_bf16_f32 v101, v102, v103
v_mfma_f32_16x16x32_bf16 v[112:115], v[192:195], a[208:211], v[112:115]
ds_read_b64_tr_b16 v[170:171], v249 offset:17408
v_mul_f32 v92, s55, v92
v_mfma_f32_16x16x32_bf16 v[112:115], v[196:199], a[220:223], v[112:115]
ds_read_b64_tr_b16 v[172:173], v249 offset:24576
v_mul_f32 v93, s55, v93
v_mfma_f32_16x16x32_bf16 v[116:119], v[196:199], a[224:227], v[116:119]
ds_read_b64_tr_b16 v[174:175], v249 offset:25600
v_mul_f32 v94, s55, v94
v_mfma_f32_16x16x32_bf16 v[116:119], v[192:195], a[212:215], v[116:119]
v_permlane16_swap_b32 v73, v85
v_mfma_f32_16x16x32_bf16 v[120:123], v[192:195], a[216:219], v[120:123]
v_permlane16_swap_b32 v88, v100
v_mfma_f32_16x16x32_bf16 v[120:123], v[196:199], a[228:231], v[120:123]
s_waitcnt lgkmcnt(8)
v_permlane16_swap_b32 v89, v101
v_mfma_f32_16x16x32_bf16 v[124:127], v[200:203], a[208:211], v[124:127]
v_accvgpr_write_b32 a33, v73
v_accvgpr_write_b32 a35, v85
v_mfma_f32_16x16x32_bf16 v[124:127], v[204:207], a[220:223], v[124:127]
v_mul_f32 v95, s55, v95
v_mul_f32 v104, s55, v104
v_mfma_f32_16x16x32_bf16 v[128:131], v[204:207], a[224:227], v[128:131]
v_mul_f32 v105, s55, v105
v_mul_f32 v106, s55, v106
v_mfma_f32_16x16x32_bf16 v[128:131], v[200:203], a[212:215], v[128:131]
v_mul_f32 v107, s55, v107
v_cvt_pk_bf16_f32 v92, v92, v93
v_mfma_f32_16x16x32_bf16 v[132:135], v[200:203], a[216:219], v[132:135]
v_cvt_pk_bf16_f32 v104, v104, v105
v_cvt_pk_bf16_f32 v93, v94, v95
v_mfma_f32_16x16x32_bf16 v[132:135], v[204:207], a[228:231], v[132:135]
s_waitcnt vmcnt(12) lgkmcnt(0)
s_barrier
ds_read_b64_tr_b16 v[176:177], v246 offset:32768
v_mfma_f32_16x16x32_bf16 v[136:139], v[160:163], a[208:211], v[136:139]
buffer_load_dwordx4 v224, s[32:35], s77 offen offset:0 lds
v_mfma_f32_16x16x32_bf16 v[136:139], v[164:167], a[220:223], v[136:139]
ds_read_b64_tr_b16 v[178:179], v246 offset:33792
ds_read_b64_tr_b16 v[180:181], v246 offset:40960
v_mfma_f32_16x16x32_bf16 v[140:143], v[164:167], a[224:227], v[140:143]
ds_read_b64_tr_b16 v[182:183], v246 offset:41984
ds_read_b64_tr_b16 v[184:185], v247 offset:32768
v_mfma_f32_16x16x32_bf16 v[140:143], v[160:163], a[212:215], v[140:143]
buffer_load_dwordx4 v225, s[32:35], s77 offen offset:1024 lds
v_mfma_f32_16x16x32_bf16 v[144:147], v[160:163], a[216:219], v[144:147]
ds_read_b64_tr_b16 v[186:187], v247 offset:33792
v_cvt_pk_bf16_f32 v105, v106, v107
v_mfma_f32_16x16x32_bf16 v[144:147], v[164:167], a[228:231], v[144:147]
ds_read_b64_tr_b16 v[188:189], v247 offset:40960
v_mul_f32 v96, s55, v96
v_mfma_f32_16x16x32_bf16 v[148:151], v[168:171], a[208:211], v[148:151]
buffer_load_dwordx4 v226, s[32:35], s77 offen offset:2048 lds
v_mfma_f32_16x16x32_bf16 v[148:151], v[172:175], a[220:223], v[148:151]
ds_read_b64_tr_b16 v[190:191], v247 offset:41984
v_mul_f32 v97, s55, v97
v_mfma_f32_16x16x32_bf16 v[152:155], v[172:175], a[224:227], v[152:155]
ds_read_b64_tr_b16 v[192:193], v248 offset:32768
v_mul_f32 v98, s55, v98
v_mfma_f32_16x16x32_bf16 v[152:155], v[168:171], a[212:215], v[152:155]
buffer_load_dwordx4 v227, s[32:35], s77 offen offset:3072 lds
v_mfma_f32_16x16x32_bf16 v[156:159], v[168:171], a[216:219], v[156:159]
s_add_u32 s77, s63, 384
ds_read_b64_tr_b16 v[194:195], v248 offset:33792
s_add_u32 m0, s58, 117760
v_mfma_f32_16x16x32_bf16 v[156:159], v[172:175], a[228:231], v[156:159]
s_waitcnt lgkmcnt(6)
ds_read_b64_tr_b16 v[196:197], v248 offset:40960
v_mul_f32 v99, s55, v99
v_mfma_f32_16x16x32_bf16 v[112:115], v[176:179], a[232:235], v[112:115]
buffer_load_dwordx4 v224, s[32:35], s77 offen offset:0 lds
v_mfma_f32_16x16x32_bf16 v[112:115], v[180:183], a[244:247], v[112:115]
ds_read_b64_tr_b16 v[198:199], v248 offset:41984
v_mul_f32 v108, s55, v108
v_mfma_f32_16x16x32_bf16 v[116:119], v[180:183], a[248:251], v[116:119]
ds_read_b64_tr_b16 v[200:201], v249 offset:32768
v_mul_f32 v109, s55, v109
v_mfma_f32_16x16x32_bf16 v[116:119], v[176:179], a[236:239], v[116:119]
buffer_load_dwordx4 v225, s[32:35], s77 offen offset:1024 lds
v_mfma_f32_16x16x32_bf16 v[120:123], v[176:179], a[240:243], v[120:123]
ds_read_b64_tr_b16 v[202:203], v249 offset:33792
v_mul_f32 v110, s55, v110
v_mfma_f32_16x16x32_bf16 v[120:123], v[180:183], a[252:255], v[120:123]
s_waitcnt lgkmcnt(6)
ds_read_b64_tr_b16 v[204:205], v249 offset:40960
v_mul_f32 v111, s55, v111
v_mfma_f32_16x16x32_bf16 v[124:127], v[184:187], a[232:235], v[124:127]
ds_read_b64_tr_b16 v[206:207], v249 offset:41984
v_cvt_pk_bf16_f32 v96, v96, v97
v_mfma_f32_16x16x32_bf16 v[124:127], v[188:191], a[244:247], v[124:127]
buffer_load_dwordx4 v226, s[32:35], s77 offen offset:2048 lds
v_mfma_f32_16x16x32_bf16 v[128:131], v[188:191], a[248:251], v[128:131]
v_permlane16_swap_b32 v92, v104
v_mfma_f32_16x16x32_bf16 v[128:131], v[184:187], a[236:239], v[128:131]
buffer_load_dwordx4 v227, s[32:35], s77 offen offset:3072 lds
v_mfma_f32_16x16x32_bf16 v[132:135], v[184:187], a[240:243], v[132:135]
s_add_u32 s77, s64, 384
s_add_u32 m0, s58, 134144
v_cvt_pk_bf16_f32 v108, v108, v109
v_mfma_f32_16x16x32_bf16 v[132:135], v[188:191], a[252:255], v[132:135]
s_waitcnt vmcnt(16) lgkmcnt(0)
s_barrier
ds_read_b64_tr_b16 v[160:161], v10 offset:0
v_mfma_f32_16x16x32_bf16 v[136:139], v[192:195], a[232:235], v[136:139]
buffer_load_dwordx4 v224, s[32:35], s77 offen offset:0 lds
v_mfma_f32_16x16x32_bf16 v[136:139], v[196:199], a[244:247], v[136:139]
ds_read_b64_tr_b16 v[162:163], v10 offset:1024
v_cvt_pk_bf16_f32 v97, v98, v99
v_mfma_f32_16x16x32_bf16 v[140:143], v[196:199], a[248:251], v[140:143]
ds_read_b64_tr_b16 v[164:165], v10 offset:8192
v_cvt_pk_bf16_f32 v109, v110, v111
v_mfma_f32_16x16x32_bf16 v[140:143], v[192:195], a[236:239], v[140:143]
buffer_load_dwordx4 v225, s[32:35], s77 offen offset:1024 lds
v_mfma_f32_16x16x32_bf16 v[144:147], v[192:195], a[240:243], v[144:147]
ds_read_b64_tr_b16 v[166:167], v10 offset:9216
v_accvgpr_write_b32 a36, v88
v_mfma_f32_16x16x32_bf16 v[144:147], v[196:199], a[252:255], v[144:147]
ds_read_b64_tr_b16 v[168:169], v11 offset:0
v_accvgpr_write_b32 a38, v100
v_mfma_f32_16x16x32_bf16 v[148:151], v[200:203], a[232:235], v[148:151]
buffer_load_dwordx4 v226, s[32:35], s77 offen offset:2048 lds
v_mfma_f32_16x16x32_bf16 v[148:151], v[204:207], a[244:247], v[148:151]
ds_read_b64_tr_b16 v[170:171], v11 offset:1024
v_mul_f32 v112, s55, v112
v_mfma_f32_16x16x32_bf16 v[152:155], v[204:207], a[248:251], v[152:155]
ds_read_b64_tr_b16 v[172:173], v11 offset:8192
v_mul_f32 v113, s55, v113
v_mfma_f32_16x16x32_bf16 v[152:155], v[200:203], a[236:239], v[152:155]
buffer_load_dwordx4 v227, s[32:35], s77 offen offset:3072 lds
v_mfma_f32_16x16x32_bf16 v[156:159], v[200:203], a[240:243], v[156:159]
s_add_u32 s77, s65, 384
ds_read_b64_tr_b16 v[174:175], v11 offset:9216
v_mul_f32 v114, s55, v114
v_mfma_f32_16x16x32_bf16 v[156:159], v[204:207], a[252:255], v[156:159]
s_waitcnt lgkmcnt(4)
ds_read_b64_tr_b16 v[176:177], v12 offset:0
v_mul_f32 v115, s55, v115
v_mfma_f32_16x16x32_bf16 v[16:19], v[160:163], a[88:91], 0
s_add_u32 m0, s58, 0
ds_read_b64_tr_b16 v[178:179], v12 offset:1024
v_mul_f32 v124, s55, v124
v_mfma_f32_16x16x32_bf16 v[16:19], v[164:167], a[100:103], v[16:19]
ds_read_b64_tr_b16 v[180:181], v12 offset:8192
v_mul_f32 v125, s55, v125
v_mfma_f32_16x16x32_bf16 v[20:23], v[164:167], a[104:107], 0
ds_read_b64_tr_b16 v[182:183], v12 offset:9216
v_mul_f32 v126, s55, v126
v_mfma_f32_16x16x32_bf16 v[20:23], v[160:163], a[92:95], v[20:23]
ds_read_b64_tr_b16 v[184:185], v13 offset:0
v_mul_f32 v127, s55, v127
v_mfma_f32_16x16x32_bf16 v[24:27], v[160:163], a[96:99], 0
ds_read_b64_tr_b16 v[186:187], v13 offset:1024
v_cvt_pk_bf16_f32 v112, v112, v113
v_mfma_f32_16x16x32_bf16 v[24:27], v[164:167], a[108:111], v[24:27]
s_waitcnt lgkmcnt(6)
ds_read_b64_tr_b16 v[188:189], v13 offset:8192
v_cvt_pk_bf16_f32 v124, v124, v125
v_mfma_f32_16x16x32_bf16 v[28:31], v[168:171], a[88:91], 0
ds_read_b64_tr_b16 v[190:191], v13 offset:9216
v_cvt_pk_bf16_f32 v113, v114, v115
v_mfma_f32_16x16x32_bf16 v[28:31], v[172:175], a[100:103], v[28:31]
v_permlane16_swap_b32 v93, v105
v_mfma_f32_16x16x32_bf16 v[32:35], v[172:175], a[104:107], 0
v_permlane16_swap_b32 v96, v108
v_mfma_f32_16x16x32_bf16 v[32:35], v[168:171], a[92:95], v[32:35]
v_permlane16_swap_b32 v97, v109
v_mfma_f32_16x16x32_bf16 v[36:39], v[168:171], a[96:99], 0
v_cvt_pk_bf16_f32 v125, v126, v127
v_accvgpr_write_b32 a37, v89
v_mfma_f32_16x16x32_bf16 v[36:39], v[172:175], a[108:111], v[36:39]
s_waitcnt vmcnt(16) lgkmcnt(0)
s_barrier
ds_read_b64_tr_b16 v[192:193], v10 offset:16384
v_mfma_f32_16x16x32_bf16 v[40:43], v[176:179], a[88:91], 0
buffer_load_dwordx4 v224, s[32:35], s77 offen offset:0 lds
v_mfma_f32_16x16x32_bf16 v[40:43], v[180:183], a[100:103], v[40:43]
ds_read_b64_tr_b16 v[194:195], v10 offset:17408
ds_read_b64_tr_b16 v[196:197], v10 offset:24576
v_mfma_f32_16x16x32_bf16 v[44:47], v[180:183], a[104:107], 0
buffer_load_dwordx4 v225, s[32:35], s77 offen offset:1024 lds
v_mfma_f32_16x16x32_bf16 v[44:47], v[176:179], a[92:95], v[44:47]
ds_read_b64_tr_b16 v[198:199], v10 offset:25600
ds_read_b64_tr_b16 v[200:201], v11 offset:16384
v_mfma_f32_16x16x32_bf16 v[48:51], v[176:179], a[96:99], 0
buffer_load_dwordx4 v226, s[32:35], s77 offen offset:2048 lds
v_mfma_f32_16x16x32_bf16 v[48:51], v[180:183], a[108:111], v[48:51]
ds_read_b64_tr_b16 v[202:203], v11 offset:17408
ds_read_b64_tr_b16 v[204:205], v11 offset:24576
v_mfma_f32_16x16x32_bf16 v[52:55], v[184:187], a[88:91], 0
buffer_load_dwordx4 v227, s[32:35], s77 offen offset:3072 lds
v_mfma_f32_16x16x32_bf16 v[52:55], v[188:191], a[100:103], v[52:55]
s_add_u32 s83, s82, 0
s_add_u32 m0, s57, 33792
ds_read_b64_tr_b16 v[206:207], v11 offset:25600
v_mfma_f32_16x16x32_bf16 v[56:59], v[188:191], a[104:107], 0
buffer_load_dwordx4 v5, s[24:27], s83 offen offset:0 nt lds
v_mfma_f32_16x16x32_bf16 v[56:59], v[184:187], a[92:95], v[56:59]
ds_read_b64_tr_b16 v[160:161], v12 offset:16384
v_accvgpr_write_b32 a39, v101
v_mfma_f32_16x16x32_bf16 v[60:63], v[184:187], a[96:99], 0
buffer_load_dwordx4 v6, s[24:27], s83 offen offset:1056 nt lds
v_mfma_f32_16x16x32_bf16 v[60:63], v[188:191], a[108:111], v[60:63]
s_waitcnt lgkmcnt(5)
ds_read_b64_tr_b16 v[162:163], v12 offset:17408
v_accvgpr_write_b32 a40, v92
v_mfma_f32_16x16x32_bf16 v[16:19], v[192:195], a[112:115], v[16:19]
buffer_load_dwordx4 v7, s[24:27], s83 offen offset:2112 nt lds
v_mfma_f32_16x16x32_bf16 v[16:19], v[196:199], a[124:127], v[16:19]
ds_read_b64_tr_b16 v[164:165], v12 offset:24576
v_accvgpr_write_b32 a42, v104
v_mfma_f32_16x16x32_bf16 v[20:23], v[196:199], a[128:131], v[20:23]
buffer_load_dwordx4 v8, s[24:27], s83 offen offset:3168 nt lds
v_mfma_f32_16x16x32_bf16 v[20:23], v[192:195], a[116:119], v[20:23]
s_add_u32 s77, s66, 384
ds_read_b64_tr_b16 v[166:167], v12 offset:25600
v_accvgpr_write_b32 a41, v93
v_mfma_f32_16x16x32_bf16 v[24:27], v[192:195], a[120:123], v[24:27]
s_add_u32 m0, s58, 16384
ds_read_b64_tr_b16 v[168:169], v13 offset:16384
v_accvgpr_write_b32 a43, v105
v_mfma_f32_16x16x32_bf16 v[24:27], v[196:199], a[132:135], v[24:27]
s_waitcnt lgkmcnt(5)
ds_read_b64_tr_b16 v[170:171], v13 offset:17408
v_accvgpr_write_b32 a44, v96
v_mfma_f32_16x16x32_bf16 v[28:31], v[200:203], a[112:115], v[28:31]
ds_read_b64_tr_b16 v[172:173], v13 offset:24576
v_accvgpr_write_b32 a46, v108
v_mfma_f32_16x16x32_bf16 v[28:31], v[204:207], a[124:127], v[28:31]
ds_read_b64_tr_b16 v[174:175], v13 offset:25600
v_accvgpr_write_b32 a45, v97
v_mfma_f32_16x16x32_bf16 v[32:35], v[204:207], a[128:131], v[32:35]
v_permlane16_swap_b32 v112, v124
v_mfma_f32_16x16x32_bf16 v[32:35], v[200:203], a[116:119], v[32:35]
v_permlane16_swap_b32 v113, v125
v_mfma_f32_16x16x32_bf16 v[36:39], v[200:203], a[120:123], v[36:39]
v_accvgpr_write_b32 a47, v109
v_accvgpr_write_b32 a48, v112
v_mfma_f32_16x16x32_bf16 v[36:39], v[204:207], a[132:135], v[36:39]
s_waitcnt vmcnt(16) lgkmcnt(0)
s_barrier
ds_read_b64_tr_b16 v[176:177], v246 offset:0
v_mfma_f32_16x16x32_bf16 v[40:43], v[160:163], a[112:115], v[40:43]
ds_read_b64_tr_b16 v[178:179], v246 offset:1024
v_accvgpr_write_b32 a50, v124
v_mfma_f32_16x16x32_bf16 v[40:43], v[164:167], a[124:127], v[40:43]
ds_read_b64_tr_b16 v[180:181], v246 offset:8192
v_accvgpr_write_b32 a49, v113
v_mfma_f32_16x16x32_bf16 v[44:47], v[164:167], a[128:131], v[44:47]
ds_read_b64_tr_b16 v[182:183], v246 offset:9216
v_accvgpr_write_b32 a51, v125
v_mfma_f32_16x16x32_bf16 v[44:47], v[160:163], a[116:119], v[44:47]
ds_read_b64_tr_b16 v[184:185], v247 offset:0
v_mul_f32 v116, s55, v116
v_mfma_f32_16x16x32_bf16 v[48:51], v[160:163], a[120:123], v[48:51]
ds_read_b64_tr_b16 v[186:187], v247 offset:1024
v_mul_f32 v117, s55, v117
v_mfma_f32_16x16x32_bf16 v[48:51], v[164:167], a[132:135], v[48:51]
ds_read_b64_tr_b16 v[188:189], v247 offset:8192
v_mul_f32 v118, s55, v118
v_mfma_f32_16x16x32_bf16 v[52:55], v[168:171], a[112:115], v[52:55]
ds_read_b64_tr_b16 v[190:191], v247 offset:9216
v_mul_f32 v119, s55, v119
v_mfma_f32_16x16x32_bf16 v[52:55], v[172:175], a[124:127], v[52:55]
ds_read_b64_tr_b16 v[192:193], v248 offset:0
v_mul_f32 v128, s55, v128
v_mfma_f32_16x16x32_bf16 v[56:59], v[172:175], a[128:131], v[56:59]
ds_read_b64_tr_b16 v[194:195], v248 offset:1024
v_mul_f32 v129, s55, v129
v_mfma_f32_16x16x32_bf16 v[56:59], v[168:171], a[116:119], v[56:59]
ds_read_b64_tr_b16 v[196:197], v248 offset:8192
v_mul_f32 v130, s55, v130
v_mfma_f32_16x16x32_bf16 v[60:63], v[168:171], a[120:123], v[60:63]
ds_read_b64_tr_b16 v[198:199], v248 offset:9216
v_mul_f32 v131, s55, v131
v_mfma_f32_16x16x32_bf16 v[60:63], v[172:175], a[132:135], v[60:63]
s_waitcnt lgkmcnt(8)
ds_read_b64_tr_b16 v[200:201], v249 offset:0
v_cvt_pk_bf16_f32 v116, v116, v117
v_mfma_f32_16x16x32_bf16 v[16:19], v[176:179], a[136:139], v[16:19]
ds_read_b64_tr_b16 v[202:203], v249 offset:1024
v_cvt_pk_bf16_f32 v128, v128, v129
v_mfma_f32_16x16x32_bf16 v[16:19], v[180:183], a[148:151], v[16:19]
ds_read_b64_tr_b16 v[204:205], v249 offset:8192
v_cvt_pk_bf16_f32 v117, v118, v119
v_mfma_f32_16x16x32_bf16 v[20:23], v[180:183], a[152:155], v[20:23]
ds_read_b64_tr_b16 v[206:207], v249 offset:9216
v_cvt_pk_bf16_f32 v129, v130, v131
v_mfma_f32_16x16x32_bf16 v[20:23], v[176:179], a[140:143], v[20:23]
v_mul_f32 v120, s55, v120
v_mul_f32 v121, s55, v121
v_mfma_f32_16x16x32_bf16 v[24:27], v[176:179], a[144:147], v[24:27]
v_permlane16_swap_b32 v116, v128
v_mfma_f32_16x16x32_bf16 v[24:27], v[180:183], a[156:159], v[24:27]
s_waitcnt lgkmcnt(8)
v_permlane16_swap_b32 v117, v129
v_mfma_f32_16x16x32_bf16 v[28:31], v[184:187], a[136:139], v[28:31]
v_accvgpr_write_b32 a52, v116
v_accvgpr_write_b32 a54, v128
v_mfma_f32_16x16x32_bf16 v[28:31], v[188:191], a[148:151], v[28:31]
v_accvgpr_write_b32 a53, v117
v_accvgpr_write_b32 a55, v129
v_mfma_f32_16x16x32_bf16 v[32:35], v[188:191], a[152:155], v[32:35]
v_mul_f32 v122, s55, v122
v_mul_f32 v123, s55, v123
v_mfma_f32_16x16x32_bf16 v[32:35], v[184:187], a[140:143], v[32:35]
v_mul_f32 v132, s55, v132
v_mul_f32 v133, s55, v133
v_mfma_f32_16x16x32_bf16 v[36:39], v[184:187], a[144:147], v[36:39]
v_mul_f32 v134, s55, v134
v_mul_f32 v135, s55, v135
v_mfma_f32_16x16x32_bf16 v[36:39], v[188:191], a[156:159], v[36:39]
s_waitcnt vmcnt(12) lgkmcnt(0)
s_barrier
ds_read_b64_tr_b16 v[160:161], v246 offset:16384
v_mfma_f32_16x16x32_bf16 v[40:43], v[192:195], a[136:139], v[40:43]
buffer_load_dwordx4 v224, s[32:35], s77 offen offset:0 lds
v_mfma_f32_16x16x32_bf16 v[40:43], v[196:199], a[148:151], v[40:43]
ds_read_b64_tr_b16 v[162:163], v246 offset:17408
v_cvt_pk_bf16_f32 v120, v120, v121
v_mfma_f32_16x16x32_bf16 v[44:47], v[196:199], a[152:155], v[44:47]
ds_read_b64_tr_b16 v[164:165], v246 offset:24576
v_cvt_pk_bf16_f32 v132, v132, v133
v_mfma_f32_16x16x32_bf16 v[44:47], v[192:195], a[140:143], v[44:47]
buffer_load_dwordx4 v225, s[32:35], s77 offen offset:1024 lds
v_mfma_f32_16x16x32_bf16 v[48:51], v[192:195], a[144:147], v[48:51]
ds_read_b64_tr_b16 v[166:167], v246 offset:25600
v_cvt_pk_bf16_f32 v121, v122, v123
v_mfma_f32_16x16x32_bf16 v[48:51], v[196:199], a[156:159], v[48:51]
ds_read_b64_tr_b16 v[168:169], v247 offset:16384
v_cvt_pk_bf16_f32 v133, v134, v135
v_mfma_f32_16x16x32_bf16 v[52:55], v[200:203], a[136:139], v[52:55]
buffer_load_dwordx4 v226, s[32:35], s77 offen offset:2048 lds
v_mfma_f32_16x16x32_bf16 v[52:55], v[204:207], a[148:151], v[52:55]
ds_read_b64_tr_b16 v[170:171], v247 offset:17408
v_mul_f32 v136, s55, v136
v_mfma_f32_16x16x32_bf16 v[56:59], v[204:207], a[152:155], v[56:59]
ds_read_b64_tr_b16 v[172:173], v247 offset:24576
v_mul_f32 v137, s55, v137
v_mfma_f32_16x16x32_bf16 v[56:59], v[200:203], a[140:143], v[56:59]
buffer_load_dwordx4 v227, s[32:35], s77 offen offset:3072 lds
v_mfma_f32_16x16x32_bf16 v[60:63], v[200:203], a[144:147], v[60:63]
s_add_u32 s83, s82, 65536
ds_read_b64_tr_b16 v[174:175], v247 offset:25600
v_mul_f32 v138, s55, v138
v_mfma_f32_16x16x32_bf16 v[60:63], v[204:207], a[156:159], v[60:63]
s_waitcnt lgkmcnt(4)
ds_read_b64_tr_b16 v[176:177], v248 offset:16384
v_mul_f32 v139, s55, v139
v_mfma_f32_16x16x32_bf16 v[16:19], v[160:163], a[160:163], v[16:19]
s_add_u32 m0, s57, 101376
ds_read_b64_tr_b16 v[178:179], v248 offset:17408
v_mul_f32 v148, s55, v148
v_mfma_f32_16x16x32_bf16 v[16:19], v[164:167], a[172:175], v[16:19]
s_mov_b32 s76, s54
ds_read_b64_tr_b16 v[180:181], v248 offset:24576
v_mul_f32 v149, s55, v149
v_mfma_f32_16x16x32_bf16 v[20:23], v[164:167], a[176:179], v[20:23]
s_lshl_b32 s67, s76, 7
ds_read_b64_tr_b16 v[182:183], v248 offset:25600
v_mul_f32 v150, s55, v150
v_mfma_f32_16x16x32_bf16 v[20:23], v[160:163], a[164:167], v[20:23]
s_add_u32 s60, s67, s79
ds_read_b64_tr_b16 v[184:185], v249 offset:16384
v_mul_f32 v151, s55, v151
v_mfma_f32_16x16x32_bf16 v[24:27], v[160:163], a[168:171], v[24:27]
s_add_u32 s76, s76, 1
ds_read_b64_tr_b16 v[186:187], v249 offset:17408
v_cvt_pk_bf16_f32 v136, v136, v137
v_mfma_f32_16x16x32_bf16 v[24:27], v[164:167], a[180:183], v[24:27]
s_waitcnt lgkmcnt(6)
ds_read_b64_tr_b16 v[188:189], v249 offset:24576
v_cvt_pk_bf16_f32 v148, v148, v149
v_mfma_f32_16x16x32_bf16 v[28:31], v[168:171], a[160:163], v[28:31]
ds_read_b64_tr_b16 v[190:191], v249 offset:25600
v_cvt_pk_bf16_f32 v137, v138, v139
v_mfma_f32_16x16x32_bf16 v[28:31], v[172:175], a[172:175], v[28:31]
v_permlane16_swap_b32 v120, v132
v_mfma_f32_16x16x32_bf16 v[32:35], v[172:175], a[176:179], v[32:35]
v_permlane16_swap_b32 v121, v133
v_mfma_f32_16x16x32_bf16 v[32:35], v[168:171], a[164:167], v[32:35]
v_accvgpr_write_b32 a56, v120
v_accvgpr_write_b32 a58, v132
v_mfma_f32_16x16x32_bf16 v[36:39], v[168:171], a[168:171], v[36:39]
v_accvgpr_write_b32 a57, v121
v_accvgpr_write_b32 a59, v133
v_mfma_f32_16x16x32_bf16 v[36:39], v[172:175], a[180:183], v[36:39]
s_waitcnt vmcnt(12) lgkmcnt(0)
s_barrier
ds_read_b64_tr_b16 v[192:193], v246 offset:32768
v_mfma_f32_16x16x32_bf16 v[40:43], v[176:179], a[160:163], v[40:43]
buffer_load_dwordx4 v5, s[24:27], s83 offen offset:0 nt lds
v_mfma_f32_16x16x32_bf16 v[40:43], v[180:183], a[172:175], v[40:43]
ds_read_b64_tr_b16 v[194:195], v246 offset:33792
v_cvt_pk_bf16_f32 v149, v150, v151
v_mfma_f32_16x16x32_bf16 v[44:47], v[180:183], a[176:179], v[44:47]
buffer_load_dwordx4 v6, s[24:27], s83 offen offset:1056 nt lds
v_mfma_f32_16x16x32_bf16 v[44:47], v[176:179], a[164:167], v[44:47]
ds_read_b64_tr_b16 v[196:197], v246 offset:40960
v_mul_f32 v140, s55, v140
v_mfma_f32_16x16x32_bf16 v[48:51], v[176:179], a[168:171], v[48:51]
ds_read_b64_tr_b16 v[198:199], v246 offset:41984
v_mul_f32 v141, s55, v141
v_mfma_f32_16x16x32_bf16 v[48:51], v[180:183], a[180:183], v[48:51]
buffer_load_dwordx4 v7, s[24:27], s83 offen offset:2112 nt lds
v_mfma_f32_16x16x32_bf16 v[52:55], v[184:187], a[160:163], v[52:55]
s_add_u32 s83, s82, 65536
ds_read_b64_tr_b16 v[200:201], v247 offset:32768
v_mul_f32 v142, s55, v142
v_mfma_f32_16x16x32_bf16 v[52:55], v[188:191], a[172:175], v[52:55]
s_add_u32 m0, s57, 101376
ds_read_b64_tr_b16 v[202:203], v247 offset:33792
v_mul_f32 v143, s55, v143
v_mfma_f32_16x16x32_bf16 v[56:59], v[188:191], a[176:179], v[56:59]
ds_read_b64_tr_b16 v[204:205], v247 offset:40960
v_mul_f32 v152, s55, v152
v_mfma_f32_16x16x32_bf16 v[56:59], v[184:187], a[164:167], v[56:59]
ds_read_b64_tr_b16 v[206:207], v247 offset:41984
v_mul_f32 v153, s55, v153
v_mfma_f32_16x16x32_bf16 v[60:63], v[184:187], a[168:171], v[60:63]
ds_read_b64_tr_b16 v[160:161], v248 offset:32768
v_mul_f32 v154, s55, v154
v_mfma_f32_16x16x32_bf16 v[60:63], v[188:191], a[180:183], v[60:63]
s_waitcnt lgkmcnt(5)
ds_read_b64_tr_b16 v[162:163], v248 offset:33792
v_mul_f32 v155, s55, v155
v_mfma_f32_16x16x32_bf16 v[16:19], v[192:195], a[184:187], v[16:19]
ds_read_b64_tr_b16 v[164:165], v248 offset:40960
v_cvt_pk_bf16_f32 v140, v140, v141
v_mfma_f32_16x16x32_bf16 v[16:19], v[196:199], a[196:199], v[16:19]
ds_read_b64_tr_b16 v[166:167], v248 offset:41984
v_cvt_pk_bf16_f32 v152, v152, v153
v_mfma_f32_16x16x32_bf16 v[20:23], v[196:199], a[200:203], v[20:23]
ds_read_b64_tr_b16 v[168:169], v249 offset:32768
v_cvt_pk_bf16_f32 v141, v142, v143
v_mfma_f32_16x16x32_bf16 v[20:23], v[192:195], a[188:191], v[20:23]
ds_read_b64_tr_b16 v[170:171], v249 offset:33792
v_cvt_pk_bf16_f32 v153, v154, v155
v_mfma_f32_16x16x32_bf16 v[24:27], v[192:195], a[192:195], v[24:27]
ds_read_b64_tr_b16 v[172:173], v249 offset:40960
v_mul_f32 v144, s55, v144
v_mfma_f32_16x16x32_bf16 v[24:27], v[196:199], a[204:207], v[24:27]
s_waitcnt lgkmcnt(7)
ds_read_b64_tr_b16 v[174:175], v249 offset:41984
v_mul_f32 v145, s55, v145
v_mfma_f32_16x16x32_bf16 v[28:31], v[200:203], a[184:187], v[28:31]
v_permlane16_swap_b32 v136, v148
v_mfma_f32_16x16x32_bf16 v[28:31], v[204:207], a[196:199], v[28:31]
v_permlane16_swap_b32 v137, v149
v_mfma_f32_16x16x32_bf16 v[32:35], v[204:207], a[200:203], v[32:35]
v_permlane16_swap_b32 v140, v152
v_mfma_f32_16x16x32_bf16 v[32:35], v[200:203], a[188:191], v[32:35]
v_permlane16_swap_b32 v141, v153
v_mfma_f32_16x16x32_bf16 v[36:39], v[200:203], a[192:195], v[36:39]
v_accvgpr_write_b32 a60, v136
v_accvgpr_write_b32 a62, v148
v_mfma_f32_16x16x32_bf16 v[36:39], v[204:207], a[204:207], v[36:39]
s_waitcnt vmcnt(11) lgkmcnt(0)
s_barrier
ds_read_b64_tr_b16 v[176:177], v10 offset:0
v_mfma_f32_16x16x32_bf16 v[40:43], v[160:163], a[184:187], v[40:43]
buffer_load_dwordx4 v8, s[24:27], s83 offen offset:3168 nt lds
v_mfma_f32_16x16x32_bf16 v[40:43], v[164:167], a[196:199], v[40:43]
s_add_u32 s83, s82, 81920
s_add_u32 m0, s57, 118272
ds_read_b64_tr_b16 v[178:179], v10 offset:1024
v_mfma_f32_16x16x32_bf16 v[44:47], v[164:167], a[200:203], v[44:47]
buffer_load_dwordx4 v5, s[24:27], s83 offen offset:0 nt lds
v_mfma_f32_16x16x32_bf16 v[44:47], v[160:163], a[188:191], v[44:47]
ds_read_b64_tr_b16 v[180:181], v10 offset:8192
v_accvgpr_write_b32 a61, v137
v_mfma_f32_16x16x32_bf16 v[48:51], v[160:163], a[192:195], v[48:51]
ds_read_b64_tr_b16 v[182:183], v10 offset:9216
v_accvgpr_write_b32 a63, v149
v_mfma_f32_16x16x32_bf16 v[48:51], v[164:167], a[204:207], v[48:51]
buffer_load_dwordx4 v6, s[24:27], s83 offen offset:1056 nt lds
v_mfma_f32_16x16x32_bf16 v[52:55], v[168:171], a[184:187], v[52:55]
s_add_u32 s83, s82, 81920
ds_read_b64_tr_b16 v[184:185], v11 offset:0
v_accvgpr_write_b32 a64, v140
v_mfma_f32_16x16x32_bf16 v[52:55], v[172:175], a[196:199], v[52:55]
s_add_u32 m0, s57, 118272
ds_read_b64_tr_b16 v[186:187], v11 offset:1024
v_accvgpr_write_b32 a66, v152
v_mfma_f32_16x16x32_bf16 v[56:59], v[172:175], a[200:203], v[56:59]
ds_read_b64_tr_b16 v[188:189], v11 offset:8192
v_accvgpr_write_b32 a65, v141
v_mfma_f32_16x16x32_bf16 v[56:59], v[168:171], a[188:191], v[56:59]
ds_read_b64_tr_b16 v[190:191], v11 offset:9216
v_accvgpr_write_b32 a67, v153
v_mfma_f32_16x16x32_bf16 v[60:63], v[168:171], a[192:195], v[60:63]
ds_read_b64_tr_b16 v[192:193], v12 offset:0
v_mul_f32 v146, s55, v146
v_mfma_f32_16x16x32_bf16 v[60:63], v[172:175], a[204:207], v[60:63]
s_waitcnt lgkmcnt(5)
ds_read_b64_tr_b16 v[194:195], v12 offset:1024
v_mul_f32 v147, s55, v147
v_mfma_f32_16x16x32_bf16 v[16:19], v[176:179], a[208:211], v[16:19]
ds_read_b64_tr_b16 v[196:197], v12 offset:8192
v_mul_f32 v156, s55, v156
v_mfma_f32_16x16x32_bf16 v[16:19], v[180:183], a[220:223], v[16:19]
ds_read_b64_tr_b16 v[198:199], v12 offset:9216
v_mul_f32 v157, s55, v157
v_mfma_f32_16x16x32_bf16 v[20:23], v[180:183], a[224:227], v[20:23]
ds_read_b64_tr_b16 v[200:201], v13 offset:0
v_mul_f32 v158, s55, v158
v_mfma_f32_16x16x32_bf16 v[20:23], v[176:179], a[212:215], v[20:23]
ds_read_b64_tr_b16 v[202:203], v13 offset:1024
v_mul_f32 v159, s55, v159
v_mfma_f32_16x16x32_bf16 v[24:27], v[176:179], a[216:219], v[24:27]
ds_read_b64_tr_b16 v[204:205], v13 offset:8192
v_cvt_pk_bf16_f32 v144, v144, v145
v_mfma_f32_16x16x32_bf16 v[24:27], v[180:183], a[228:231], v[24:27]
s_waitcnt lgkmcnt(7)
ds_read_b64_tr_b16 v[206:207], v13 offset:9216
v_cvt_pk_bf16_f32 v156, v156, v157
v_mfma_f32_16x16x32_bf16 v[28:31], v[184:187], a[208:211], v[28:31]
v_cvt_pk_bf16_f32 v145, v146, v147
v_cvt_pk_bf16_f32 v157, v158, v159
v_mfma_f32_16x16x32_bf16 v[28:31], v[188:191], a[220:223], v[28:31]
s_cmp_eq_u32 s76, 7
s_cselect_b32 s76, 0, s76
s_lshl_b32 s67, s76, 7
v_mfma_f32_16x16x32_bf16 v[32:35], v[188:191], a[224:227], v[32:35]
s_add_u32 s61, s67, s79
v_permlane16_swap_b32 v144, v156
v_mfma_f32_16x16x32_bf16 v[32:35], v[184:187], a[212:215], v[32:35]
s_add_u32 s76, s76, 1
v_permlane16_swap_b32 v145, v157
v_mfma_f32_16x16x32_bf16 v[36:39], v[184:187], a[216:219], v[36:39]
v_accvgpr_write_b32 a68, v144
v_accvgpr_write_b32 a70, v156
v_mfma_f32_16x16x32_bf16 v[36:39], v[188:191], a[228:231], v[36:39]
s_waitcnt vmcnt(6) lgkmcnt(0)
s_barrier
ds_read_b64_tr_b16 v[160:161], v10 offset:16384
v_mfma_f32_16x16x32_bf16 v[40:43], v[192:195], a[208:211], v[40:43]
buffer_load_dwordx4 v7, s[24:27], s83 offen offset:2112 nt lds
v_mfma_f32_16x16x32_bf16 v[40:43], v[196:199], a[220:223], v[40:43]
ds_read_b64_tr_b16 v[162:163], v10 offset:17408
v_accvgpr_write_b32 a69, v145
v_mfma_f32_16x16x32_bf16 v[44:47], v[196:199], a[224:227], v[44:47]
buffer_load_dwordx4 v8, s[24:27], s83 offen offset:3168 nt lds
v_mfma_f32_16x16x32_bf16 v[44:47], v[192:195], a[212:215], v[44:47]
s_add_u32 s83, s82, 98304
s_add_u32 m0, s57, 135168
ds_read_b64_tr_b16 v[164:165], v10 offset:24576
v_mfma_f32_16x16x32_bf16 v[48:51], v[192:195], a[216:219], v[48:51]
ds_read_b64_tr_b16 v[166:167], v10 offset:25600
v_accvgpr_write_b32 a71, v157
v_mfma_f32_16x16x32_bf16 v[48:51], v[196:199], a[228:231], v[48:51]
buffer_load_dwordx4 v5, s[24:27], s83 offen offset:0 nt lds
v_mfma_f32_16x16x32_bf16 v[52:55], v[200:203], a[208:211], v[52:55]
s_add_u32 s83, s82, 98304
ds_read_b64_tr_b16 v[168:169], v11 offset:16384
s_add_u32 m0, s57, 135168
v_mfma_f32_16x16x32_bf16 v[52:55], v[204:207], a[220:223], v[52:55]
s_cmp_eq_u32 s76, 7
s_cselect_b32 s76, 0, s76
ds_read_b64_tr_b16 v[170:171], v11 offset:17408
v_mfma_f32_16x16x32_bf16 v[56:59], v[204:207], a[224:227], v[56:59]
s_lshl_b32 s67, s76, 7
ds_read_b64_tr_b16 v[172:173], v11 offset:24576
s_add_u32 s62, s67, s79
v_mfma_f32_16x16x32_bf16 v[56:59], v[200:203], a[212:215], v[56:59]
s_add_u32 s76, s76, 1
ds_read_b64_tr_b16 v[174:175], v11 offset:25600
v_mfma_f32_16x16x32_bf16 v[60:63], v[200:203], a[216:219], v[60:63]
s_cmp_eq_u32 s76, 7
s_cselect_b32 s76, 0, s76
ds_read_b64_tr_b16 v[176:177], v12 offset:16384
v_mfma_f32_16x16x32_bf16 v[60:63], v[204:207], a[228:231], v[60:63]
s_waitcnt lgkmcnt(5)
ds_read_b64_tr_b16 v[178:179], v12 offset:17408
s_lshl_b32 s67, s76, 7
v_mfma_f32_16x16x32_bf16 v[16:19], v[160:163], a[232:235], v[16:19]
s_add_u32 s63, s67, s79
ds_read_b64_tr_b16 v[180:181], v12 offset:24576
s_add_u32 s76, s76, 1
v_mfma_f32_16x16x32_bf16 v[16:19], v[164:167], a[244:247], v[16:19]
s_cmp_eq_u32 s76, 7
s_cselect_b32 s76, 0, s76
ds_read_b64_tr_b16 v[182:183], v12 offset:25600
v_mfma_f32_16x16x32_bf16 v[20:23], v[164:167], a[248:251], v[20:23]
s_lshl_b32 s67, s76, 7
ds_read_b64_tr_b16 v[184:185], v13 offset:16384
s_add_u32 s64, s67, s79
v_mfma_f32_16x16x32_bf16 v[20:23], v[160:163], a[236:239], v[20:23]
s_add_u32 s76, s76, 1
ds_read_b64_tr_b16 v[186:187], v13 offset:17408
v_mfma_f32_16x16x32_bf16 v[24:27], v[160:163], a[240:243], v[24:27]
s_cmp_eq_u32 s76, 7
s_cselect_b32 s76, 0, s76
ds_read_b64_tr_b16 v[188:189], v13 offset:24576
v_mfma_f32_16x16x32_bf16 v[24:27], v[164:167], a[252:255], v[24:27]
s_waitcnt lgkmcnt(7)
ds_read_b64_tr_b16 v[190:191], v13 offset:25600
s_lshl_b32 s67, s76, 7
v_mfma_f32_16x16x32_bf16 v[28:31], v[168:171], a[232:235], v[28:31]
s_add_u32 s65, s67, s79
s_add_u32 s76, s76, 1
v_mfma_f32_16x16x32_bf16 v[28:31], v[172:175], a[244:247], v[28:31]
s_cmp_eq_u32 s76, 7
s_cselect_b32 s76, 0, s76
s_lshl_b32 s67, s76, 7
v_mfma_f32_16x16x32_bf16 v[32:35], v[172:175], a[248:251], v[32:35]
s_add_u32 s66, s67, s79
s_add_u32 s76, s76, 1
v_mfma_f32_16x16x32_bf16 v[32:35], v[168:171], a[236:239], v[32:35]
s_cmp_eq_u32 s76, 7
s_cselect_b32 s76, 0, s76
v_mfma_f32_16x16x32_bf16 v[36:39], v[168:171], a[240:243], v[36:39]
v_mfma_f32_16x16x32_bf16 v[36:39], v[172:175], a[252:255], v[36:39]
s_waitcnt vmcnt(13) lgkmcnt(0)
s_barrier
v_mfma_f32_16x16x32_bf16 v[40:43], v[176:179], a[232:235], v[40:43]
ds_read_b128 a[168:171], v1 offset:0
v_mfma_f32_16x16x32_bf16 v[40:43], v[180:183], a[244:247], v[40:43]
buffer_load_dwordx4 v6, s[24:27], s83 offen offset:1056 nt lds
v_mfma_f32_16x16x32_bf16 v[44:47], v[180:183], a[248:251], v[44:47]
ds_read_b128 a[172:175], v1 offset:64
v_mfma_f32_16x16x32_bf16 v[44:47], v[176:179], a[236:239], v[44:47]
ds_read_b128 a[176:179], v1 offset:8448
v_mfma_f32_16x16x32_bf16 v[48:51], v[176:179], a[240:243], v[48:51]
buffer_load_dwordx4 v7, s[24:27], s83 offen offset:2112 nt lds
v_mfma_f32_16x16x32_bf16 v[48:51], v[180:183], a[252:255], v[48:51]
v_mfma_f32_16x16x32_bf16 v[52:55], v[184:187], a[232:235], v[52:55]
ds_read_b128 a[180:183], v1 offset:8512
v_mul_f32 v16, s55, v16
v_mfma_f32_16x16x32_bf16 v[52:55], v[188:191], a[244:247], v[52:55]
buffer_load_dwordx4 v8, s[24:27], s83 offen offset:3168 nt lds
v_mfma_f32_16x16x32_bf16 v[56:59], v[188:191], a[248:251], v[56:59]
v_mul_f32 v17, s55, v17
v_mul_f32 v18, s55, v18
v_mfma_f32_16x16x32_bf16 v[56:59], v[184:187], a[236:239], v[56:59]
ds_read_b128 a[184:187], v1 offset:128
v_mul_f32 v19, s55, v19
v_mfma_f32_16x16x32_bf16 v[60:63], v[184:187], a[240:243], v[60:63]
v_mul_f32 v28, s55, v28
v_mul_f32 v29, s55, v29
v_mfma_f32_16x16x32_bf16 v[60:63], v[188:191], a[252:255], v[60:63]
s_waitcnt lgkmcnt(3)
v_mul_f32 v30, s55, v30
v_mul_f32 v31, s55, v31
v_mfma_f32_16x16x32_bf16 v[88:91], a[168:171], a[0:3], 0
ds_read_b128 a[188:191], v1 offset:192
v_cvt_pk_bf16_f32 v16, v16, v17
v_mfma_f32_16x16x32_bf16 v[88:91], a[172:175], a[12:15], v[88:91]
v_cvt_pk_bf16_f32 v28, v28, v29
v_cvt_pk_bf16_f32 v17, v18, v19
v_mfma_f32_16x16x32_bf16 v[96:99], a[172:175], a[16:19], 0
v_cvt_pk_bf16_f32 v29, v30, v31
v_mul_f32 v20, s55, v20
v_mfma_f32_16x16x32_bf16 v[96:99], a[168:171], a[4:7], v[96:99]
ds_read_b128 a[192:195], v1 offset:8576
v_mul_f32 v21, s55, v21
v_mfma_f32_16x16x32_bf16 v[104:107], a[168:171], a[8:11], 0
v_permlane16_swap_b32 v16, v28
v_mfma_f32_16x16x32_bf16 v[104:107], a[172:175], a[20:23], v[104:107]
s_waitcnt lgkmcnt(3)
v_permlane16_swap_b32 v17, v29
v_mfma_f32_16x16x32_bf16 v[92:95], a[176:179], a[0:3], 0
ds_read_b128 a[196:199], v1 offset:8640
v_mul_f32 v22, s55, v22
v_mfma_f32_16x16x32_bf16 v[92:95], a[180:183], a[12:15], v[92:95]
v_mul_f32 v23, s55, v23
v_mul_f32 v32, s55, v32
v_mfma_f32_16x16x32_bf16 v[100:103], a[180:183], a[16:19], 0
v_mul_f32 v33, s55, v33
v_mul_f32 v34, s55, v34
v_mfma_f32_16x16x32_bf16 v[100:103], a[176:179], a[4:7], v[100:103]
ds_read_b128 a[200:203], v1 offset:256
v_mul_f32 v35, s55, v35
v_mfma_f32_16x16x32_bf16 v[108:111], a[176:179], a[8:11], 0
v_cvt_pk_bf16_f32 v20, v20, v21
v_cvt_pk_bf16_f32 v32, v32, v33
v_mfma_f32_16x16x32_bf16 v[108:111], a[180:183], a[20:23], v[108:111]
s_waitcnt lgkmcnt(3)
v_cvt_pk_bf16_f32 v21, v22, v23
v_cvt_pk_bf16_f32 v33, v34, v35
v_mfma_f32_16x16x32_bf16 v[88:91], a[184:187], a[24:27], v[88:91]
ds_read_b128 a[204:207], v1 offset:320
v_accvgpr_write_b32 a72, v16
v_mfma_f32_16x16x32_bf16 v[88:91], a[188:191], a[36:39], v[88:91]
v_permlane16_swap_b32 v20, v32
v_mfma_f32_16x16x32_bf16 v[96:99], a[188:191], a[40:43], v[96:99]
v_permlane16_swap_b32 v21, v33
v_mfma_f32_16x16x32_bf16 v[96:99], a[184:187], a[28:31], v[96:99]
ds_read_b128 a[208:211], v1 offset:8704
v_accvgpr_write_b32 a74, v28
v_mfma_f32_16x16x32_bf16 v[104:107], a[184:187], a[32:35], v[104:107]
v_accvgpr_write_b32 a73, v17
v_accvgpr_write_b32 a75, v29
v_mfma_f32_16x16x32_bf16 v[104:107], a[188:191], a[44:47], v[104:107]
s_waitcnt lgkmcnt(3)
v_mul_f32 v24, s55, v24
v_mul_f32 v25, s55, v25
v_mfma_f32_16x16x32_bf16 v[92:95], a[192:195], a[24:27], v[92:95]
ds_read_b128 a[212:215], v1 offset:8768
v_mul_f32 v26, s55, v26
v_mfma_f32_16x16x32_bf16 v[92:95], a[196:199], a[36:39], v[92:95]
v_mul_f32 v27, s55, v27
v_mul_f32 v36, s55, v36
v_mfma_f32_16x16x32_bf16 v[100:103], a[196:199], a[40:43], v[100:103]
v_mul_f32 v37, s55, v37
v_mul_f32 v38, s55, v38
v_mfma_f32_16x16x32_bf16 v[100:103], a[192:195], a[28:31], v[100:103]
ds_read_b128 a[216:219], v1 offset:384
v_mul_f32 v39, s55, v39
v_mfma_f32_16x16x32_bf16 v[108:111], a[192:195], a[32:35], v[108:111]
v_cvt_pk_bf16_f32 v24, v24, v25
v_cvt_pk_bf16_f32 v36, v36, v37
v_mfma_f32_16x16x32_bf16 v[108:111], a[196:199], a[44:47], v[108:111]
s_waitcnt lgkmcnt(3)
v_cvt_pk_bf16_f32 v25, v26, v27
v_cvt_pk_bf16_f32 v37, v38, v39
v_mfma_f32_16x16x32_bf16 v[88:91], a[200:203], a[48:51], v[88:91]
ds_read_b128 a[220:223], v1 offset:448
v_accvgpr_write_b32 a76, v20
v_mfma_f32_16x16x32_bf16 v[88:91], a[204:207], a[60:63], v[88:91]
v_accvgpr_write_b32 a78, v32
v_accvgpr_write_b32 a77, v21
v_accvgpr_write_b32 a79, v33
v_mul_f32 v40, s55, v40
v_mul_f32 v41, s55, v41
v_mul_f32 v42, s55, v42
v_mul_f32 v43, s55, v43
v_mul_f32 v52, s55, v52
v_mul_f32 v53, s55, v53
v_mul_f32 v54, s55, v54
v_mul_f32 v55, s55, v55
v_mfma_f32_16x16x32_bf16 v[96:99], a[204:207], a[64:67], v[96:99]
v_permlane16_swap_b32 v24, v36
v_permlane16_swap_b32 v25, v37
v_cvt_pk_bf16_f32 v40, v40, v41
v_cvt_pk_bf16_f32 v52, v52, v53
v_cvt_pk_bf16_f32 v41, v42, v43
v_cvt_pk_bf16_f32 v53, v54, v55
v_mfma_f32_16x16x32_bf16 v[96:99], a[200:203], a[52:55], v[96:99]
v_accvgpr_write_b32 a80, v24
v_accvgpr_write_b32 a82, v36
v_accvgpr_write_b32 a81, v25
v_accvgpr_write_b32 a83, v37
v_mul_f32 v44, s55, v44
v_mul_f32 v45, s55, v45
v_mul_f32 v46, s55, v46
v_mul_f32 v47, s55, v47
v_mul_f32 v56, s55, v56
v_mul_f32 v57, s55, v57
v_mul_f32 v58, s55, v58
v_mul_f32 v59, s55, v59
v_mfma_f32_16x16x32_bf16 v[104:107], a[200:203], a[56:59], v[104:107]
v_permlane16_swap_b32 v40, v52
v_permlane16_swap_b32 v41, v53
v_cvt_pk_bf16_f32 v44, v44, v45
v_cvt_pk_bf16_f32 v56, v56, v57
v_cvt_pk_bf16_f32 v45, v46, v47
v_cvt_pk_bf16_f32 v57, v58, v59
v_mfma_f32_16x16x32_bf16 v[104:107], a[204:207], a[68:71], v[104:107]
s_waitcnt lgkmcnt(2)
v_accvgpr_write_b32 a84, v40
v_accvgpr_write_b32 a86, v52
v_accvgpr_write_b32 a85, v41
v_accvgpr_write_b32 a87, v53
v_mul_f32 v48, s55, v48
v_mul_f32 v49, s55, v49
v_mul_f32 v50, s55, v50
v_mul_f32 v51, s55, v51
v_mul_f32 v60, s55, v60
v_mul_f32 v61, s55, v61
v_mul_f32 v62, s55, v62
v_mul_f32 v63, s55, v63
v_mfma_f32_16x16x32_bf16 v[92:95], a[208:211], a[48:51], v[92:95]
v_permlane16_swap_b32 v44, v56
v_permlane16_swap_b32 v45, v57
v_cvt_pk_bf16_f32 v48, v48, v49
v_cvt_pk_bf16_f32 v60, v60, v61
v_cvt_pk_bf16_f32 v49, v50, v51
v_cvt_pk_bf16_f32 v61, v62, v63
v_mfma_f32_16x16x32_bf16 v[92:95], a[212:215], a[60:63], v[92:95]
v_accvgpr_write_b32 a88, v44
v_accvgpr_write_b32 a90, v56
v_accvgpr_write_b32 a89, v45
v_accvgpr_write_b32 a91, v57
v_mfma_f32_16x16x32_bf16 v[100:103], a[212:215], a[64:67], v[100:103]
v_permlane16_swap_b32 v48, v60
v_permlane16_swap_b32 v49, v61
v_mfma_f32_16x16x32_bf16 v[100:103], a[208:211], a[52:55], v[100:103]
v_accvgpr_write_b32 a92, v48
v_accvgpr_write_b32 a94, v60
v_accvgpr_write_b32 a93, v49
v_accvgpr_write_b32 a95, v61
v_mfma_f32_16x16x32_bf16 v[108:111], a[208:211], a[56:59], v[108:111]
ds_read_b128 a[224:227], v1 offset:8832
v_mov_b32 v244, 0x3f803f80
v_mfma_f32_16x16x32_bf16 v[108:111], a[212:215], a[68:71], v[108:111]
s_waitcnt lgkmcnt(1)
ds_read_b128 a[228:231], v1 offset:8896
v_accvgpr_write_b32 a244, v244
v_mfma_f32_16x16x32_bf16 v[88:91], a[216:219], a[72:75], v[88:91]
v_accvgpr_write_b32 a245, v244
v_accvgpr_write_b32 a246, v244
v_mfma_f32_16x16x32_bf16 v[88:91], a[220:223], a[84:87], v[88:91]
v_accvgpr_write_b32 a247, v244
v_mfma_f32_16x16x32_bf16 v[96:99], a[220:223], a[88:91], v[96:99]
v_mfma_f32_16x16x32_bf16 v[96:99], a[216:219], a[76:79], v[96:99]
v_mfma_f32_16x16x32_bf16 v[104:107], a[216:219], a[80:83], v[104:107]
v_mfma_f32_16x16x32_bf16 v[104:107], a[220:223], a[92:95], v[104:107]
s_waitcnt lgkmcnt(0)
v_mfma_f32_16x16x32_bf16 v[92:95], a[224:227], a[72:75], v[92:95]
v_mfma_f32_16x16x32_bf16 v[92:95], a[228:231], a[84:87], v[92:95]
v_add_u32 v1, 16896, v1
v_mfma_f32_16x16x32_bf16 v[100:103], a[228:231], a[88:91], v[100:103]
v_mfma_f32_16x16x32_bf16 v[100:103], a[224:227], a[76:79], v[100:103]
v_mfma_f32_16x16x32_bf16 v[108:111], a[224:227], a[80:83], v[108:111]
v_mfma_f32_16x16x32_bf16 v[108:111], a[228:231], a[92:95], v[108:111]
ds_read_b128 a[168:171], v1 offset:0
ds_read_b128 a[172:175], v1 offset:64
ds_read_b128 a[176:179], v1 offset:128
ds_read_b128 a[180:183], v1 offset:192
s_waitcnt vmcnt(56)
s_barrier
s_nop 1
v_max3_f32 v76, v88, v89, v90
v_max3_f32 v76, v76, v91, v92
v_max3_f32 v76, v76, v93, v94
v_max_f32 v76, v76, v95
v_max3_f32 v77, v96, v97, v98
v_max3_f32 v77, v77, v99, v100
v_max3_f32 v77, v77, v101, v102
v_max_f32 v77, v77, v103
v_max3_f32 v78, v104, v105, v106
v_max3_f32 v78, v78, v107, v108
v_max3_f32 v78, v78, v109, v110
v_max_f32 v78, v78, v111
v_mov_b32 v79, v76
v_mov_b32 v80, v77
v_mov_b32 v81, v78
v_permlane32_swap_b32 v76, v79
v_permlane32_swap_b32 v77, v80
v_permlane32_swap_b32 v78, v81
v_max_f32 v76, v76, v79
v_max_f32 v77, v77, v80
v_max_f32 v78, v78, v81
v_mov_b32 v79, v76
v_mov_b32 v80, v77
v_mov_b32 v81, v78
v_permlane16_swap_b32 v76, v79
v_permlane16_swap_b32 v77, v80
v_permlane16_swap_b32 v78, v81
v_max_f32 v76, v76, v79
v_max_f32 v77, v77, v80
v_max_f32 v78, v78, v81
v_sub_f32 v64, 0, v76
v_sub_f32 v65, 0, v76
v_sub_f32 v66, 0, v76
v_sub_f32 v67, 0, v76
v_sub_f32 v68, 0, v77
v_sub_f32 v69, 0, v77
v_sub_f32 v70, 0, v77
v_sub_f32 v71, 0, v77
v_sub_f32 v72, 0, v78
v_sub_f32 v73, 0, v78
v_sub_f32 v74, 0, v78
v_sub_f32 v75, 0, v78
s_nop 0
v_sub_f32 v16, v88, v76
v_sub_f32 v17, v89, v76
v_sub_f32 v18, v90, v76
v_sub_f32 v19, v91, v76
s_waitcnt lgkmcnt(2)
v_mfma_f32_16x16x32_bf16 v[40:43], a[168:171], a[0:3], v[64:67]
s_add_u32 s83, s82, 114688
ds_read_b128 a[184:187], v1 offset:256
v_sub_f32 v20, v92, v76
v_mfma_f32_16x16x32_bf16 v[40:43], a[172:175], a[12:15], v[40:43]
s_add_u32 m0, s57, 0
ds_read_b128 a[188:191], v1 offset:320
v_sub_f32 v21, v93, v76
v_mfma_f32_16x16x32_bf16 v[48:51], a[172:175], a[16:19], v[68:71]
ds_read_b128 a[192:195], v1 offset:384
v_sub_f32 v22, v94, v76
v_mfma_f32_16x16x32_bf16 v[48:51], a[168:171], a[4:7], v[48:51]
ds_read_b128 a[196:199], v1 offset:448
v_sub_f32 v23, v95, v76
v_mfma_f32_16x16x32_bf16 v[56:59], a[168:171], a[8:11], v[72:75]
v_sub_f32 v24, v96, v77
v_sub_f32 v25, v97, v77
v_mfma_f32_16x16x32_bf16 v[56:59], a[172:175], a[20:23], v[56:59]
s_waitcnt lgkmcnt(4)
v_sub_f32 v26, v98, v77
v_sub_f32 v27, v99, v77
v_mfma_f32_16x16x32_bf16 v[40:43], a[176:179], a[24:27], v[40:43]
ds_read_b128 a[200:203], v1 offset:8448
v_sub_f32 v28, v100, v77
v_mfma_f32_16x16x32_bf16 v[40:43], a[180:183], a[36:39], v[40:43]
v_sub_f32 v29, v101, v77
v_sub_f32 v30, v102, v77
v_mfma_f32_16x16x32_bf16 v[48:51], a[180:183], a[40:43], v[48:51]
buffer_load_dwordx4 v5, s[24:27], s83 offen offset:0 nt lds
v_mfma_f32_16x16x32_bf16 v[48:51], a[176:179], a[28:31], v[48:51]
ds_read_b128 a[204:207], v1 offset:8512
v_sub_f32 v31, v103, v77
v_mfma_f32_16x16x32_bf16 v[56:59], a[176:179], a[32:35], v[56:59]
v_sub_f32 v32, v104, v78
v_sub_f32 v33, v105, v78
v_mfma_f32_16x16x32_bf16 v[56:59], a[180:183], a[44:47], v[56:59]
s_waitcnt lgkmcnt(4)
v_sub_f32 v34, v106, v78
v_sub_f32 v35, v107, v78
v_mfma_f32_16x16x32_bf16 v[40:43], a[184:187], a[48:51], v[40:43]
ds_read_b128 a[208:211], v1 offset:8576
v_sub_f32 v36, v108, v78
v_mfma_f32_16x16x32_bf16 v[40:43], a[188:191], a[60:63], v[40:43]
v_sub_f32 v37, v109, v78
v_sub_f32 v38, v110, v78
v_mfma_f32_16x16x32_bf16 v[48:51], a[188:191], a[64:67], v[48:51]
v_sub_f32 v39, v111, v78
v_mfma_f32_16x16x32_bf16 v[48:51], a[184:187], a[52:55], v[48:51]
ds_read_b128 a[212:215], v1 offset:8640
v_mfma_f32_16x16x32_bf16 v[56:59], a[184:187], a[56:59], v[56:59]
v_exp_f32 v16, v16
v_mfma_f32_16x16x32_bf16 v[56:59], a[188:191], a[68:71], v[56:59]
s_waitcnt lgkmcnt(4)
v_exp_f32 v17, v17
v_mfma_f32_16x16x32_bf16 v[40:43], a[192:195], a[72:75], v[40:43]
buffer_load_dwordx4 v6, s[24:27], s83 offen offset:1056 nt lds
v_mfma_f32_16x16x32_bf16 v[40:43], a[196:199], a[84:87], v[40:43]
ds_read_b128 a[216:219], v1 offset:8704
v_cvt_pk_bf16_f32 v88, v16, v17
v_mfma_f32_16x16x32_bf16 v[48:51], a[196:199], a[88:91], v[48:51]
v_exp_f32 v18, v18
v_mfma_f32_16x16x32_bf16 v[48:51], a[192:195], a[76:79], v[48:51]
ds_read_b128 a[220:223], v1 offset:8768
v_mfma_f32_16x16x32_bf16 v[56:59], a[192:195], a[80:83], v[56:59]
v_exp_f32 v19, v19
v_mfma_f32_16x16x32_bf16 v[56:59], a[196:199], a[92:95], v[56:59]
s_waitcnt lgkmcnt(4)
v_exp_f32 v20, v20
v_mfma_f32_16x16x32_bf16 v[44:47], a[200:203], a[0:3], v[64:67]
ds_read_b128 a[224:227], v1 offset:8832
v_cvt_pk_bf16_f32 v89, v18, v19
v_mfma_f32_16x16x32_bf16 v[44:47], a[204:207], a[12:15], v[44:47]
v_exp_f32 v21, v21
v_mfma_f32_16x16x32_bf16 v[52:55], a[204:207], a[16:19], v[68:71]
v_exp_f32 v22, v22
v_mfma_f32_16x16x32_bf16 v[52:55], a[200:203], a[4:7], v[52:55]
ds_read_b128 a[228:231], v1 offset:8896
v_cvt_pk_bf16_f32 v90, v20, v21
v_mfma_f32_16x16x32_bf16 v[60:63], a[200:203], a[8:11], v[72:75]
buffer_load_dwordx4 v7, s[24:27], s83 offen offset:2112 nt lds
v_mfma_f32_16x16x32_bf16 v[60:63], a[204:207], a[20:23], v[60:63]
s_waitcnt lgkmcnt(4)
v_exp_f32 v23, v23
v_mfma_f32_16x16x32_bf16 v[44:47], a[208:211], a[24:27], v[44:47]
v_exp_f32 v24, v24
v_mfma_f32_16x16x32_bf16 v[44:47], a[212:215], a[36:39], v[44:47]
v_exp_f32 v25, v25
v_mfma_f32_16x16x32_bf16 v[52:55], a[212:215], a[40:43], v[52:55]
v_exp_f32 v26, v26
v_mfma_f32_16x16x32_bf16 v[52:55], a[208:211], a[28:31], v[52:55]
v_exp_f32 v27, v27
v_mfma_f32_16x16x32_bf16 v[60:63], a[208:211], a[32:35], v[60:63]
v_add_u32 v1, 16896, v1
v_cvt_pk_bf16_f32 v91, v22, v23
v_mfma_f32_16x16x32_bf16 v[60:63], a[212:215], a[44:47], v[60:63]
s_waitcnt lgkmcnt(2)
v_exp_f32 v28, v28
v_mfma_f32_16x16x32_bf16 v[44:47], a[216:219], a[48:51], v[44:47]
v_exp_f32 v29, v29
v_mfma_f32_16x16x32_bf16 v[44:47], a[220:223], a[60:63], v[44:47]
v_exp_f32 v30, v30
v_mfma_f32_16x16x32_bf16 v[52:55], a[220:223], a[64:67], v[52:55]
buffer_load_dwordx4 v8, s[24:27], s83 offen offset:3168 nt lds
v_mfma_f32_16x16x32_bf16 v[52:55], a[216:219], a[52:55], v[52:55]
ds_read_b128 a[168:171], v1 offset:0
v_cvt_pk_bf16_f32 v92, v24, v25
v_mfma_f32_16x16x32_bf16 v[60:63], a[216:219], a[56:59], v[60:63]
ds_read_b128 a[172:175], v1 offset:64
v_cvt_pk_bf16_f32 v93, v26, v27
v_mfma_f32_16x16x32_bf16 v[60:63], a[220:223], a[68:71], v[60:63]
s_waitcnt lgkmcnt(2)
ds_read_b128 a[176:179], v1 offset:128
v_cvt_pk_bf16_f32 v94, v28, v29
v_mfma_f32_16x16x32_bf16 v[44:47], a[224:227], a[72:75], v[44:47]
ds_read_b128 a[180:183], v1 offset:192
v_max3_f32 v2, v40, v41, v42
v_mfma_f32_16x16x32_bf16 v[44:47], a[228:231], a[84:87], v[44:47]
v_exp_f32 v31, v31
v_mfma_f32_16x16x32_bf16 v[52:55], a[228:231], a[88:91], v[52:55]
v_exp_f32 v32, v32
v_mfma_f32_16x16x32_bf16 v[52:55], a[224:227], a[76:79], v[52:55]
v_exp_f32 v33, v33
v_exp_f32 v34, v34
v_exp_f32 v35, v35
v_exp_f32 v36, v36
v_exp_f32 v37, v37
v_exp_f32 v38, v38
v_exp_f32 v39, v39
v_mfma_f32_16x16x32_bf16 v[60:63], a[224:227], a[80:83], v[60:63]
v_cvt_pk_bf16_f32 v95, v30, v31
v_cvt_pk_bf16_f32 v96, v32, v33
v_cvt_pk_bf16_f32 v97, v34, v35
v_cvt_pk_bf16_f32 v98, v36, v37
v_cvt_pk_bf16_f32 v99, v38, v39
v_mfma_f32_16x16x32_bf16 v[60:63], a[228:231], a[92:95], v[60:63]
v_max3_f32 v2, v2, v43, v48
v_max3_f32 v2, v2, v49, v50
v_max3_f32 v2, v2, v51, v56
v_max3_f32 v2, v2, v57, v58
v_max_f32 v2, v2, v59
v_mfma_f32_16x16x32_bf16 a[232:235], a[244:247], v[88:91], 0
s_waitcnt vmcnt(12)
s_barrier
ds_read_b128 a[184:187], v1 offset:256
v_mfma_f32_16x16x32_bf16 a[236:239], a[244:247], v[92:95], 0
s_add_u32 s83, s82, 131072
ds_read_b128 a[188:191], v1 offset:320
v_max3_f32 v2, v2, v44, v45
v_mfma_f32_16x16x32_bf16 a[240:243], a[244:247], v[96:99], 0
s_waitcnt lgkmcnt(4)
v_max3_f32 v2, v2, v46, v47
v_max3_f32 v2, v2, v52, v53
v_mfma_f32_16x16x32_bf16 v[16:19], a[168:171], a[0:3], v[64:67]
s_add_u32 m0, s57, 16896
ds_read_b128 a[192:195], v1 offset:384
v_max3_f32 v2, v2, v54, v55
v_mfma_f32_16x16x32_bf16 v[16:19], a[172:175], a[12:15], v[16:19]
v_max3_f32 v2, v2, v60, v61
v_max3_f32 v2, v2, v62, v63
v_mfma_f32_16x16x32_bf16 v[24:27], a[172:175], a[16:19], v[68:71]
v_mfma_f32_16x16x32_bf16 v[24:27], a[168:171], a[4:7], v[24:27]
ds_read_b128 a[196:199], v1 offset:448
v_cmp_lt_f32 vcc, s56, v2
v_mfma_f32_16x16x32_bf16 v[32:35], a[168:171], a[8:11], v[72:75]
v_mfma_f32_16x16x32_bf16 v[32:35], a[172:175], a[20:23], v[32:35]
s_waitcnt lgkmcnt(4)
buffer_load_dwordx4 v5, s[24:27], s83 offen offset:0 nt lds
v_mfma_f32_16x16x32_bf16 v[16:19], a[176:179], a[24:27], v[16:19]
ds_read_b128 a[200:203], v1 offset:8448
s_cbranch_vccnz L_rare_1
L_ret_1:
v_mfma_f32_16x16x32_bf16 v[16:19], a[180:183], a[36:39], v[16:19]
v_exp_f32 v40, v40
v_mfma_f32_16x16x32_bf16 v[24:27], a[180:183], a[40:43], v[24:27]
v_exp_f32 v41, v41
v_mfma_f32_16x16x32_bf16 v[24:27], a[176:179], a[28:31], v[24:27]
ds_read_b128 a[204:207], v1 offset:8512
v_cvt_pk_bf16_f32 v100, v40, v41
v_mfma_f32_16x16x32_bf16 v[32:35], a[176:179], a[32:35], v[32:35]
v_exp_f32 v42, v42
v_mfma_f32_16x16x32_bf16 v[32:35], a[180:183], a[44:47], v[32:35]
s_waitcnt lgkmcnt(4)
v_exp_f32 v43, v43
v_mfma_f32_16x16x32_bf16 v[16:19], a[184:187], a[48:51], v[16:19]
ds_read_b128 a[208:211], v1 offset:8576
v_cvt_pk_bf16_f32 v101, v42, v43
v_mfma_f32_16x16x32_bf16 v[16:19], a[188:191], a[60:63], v[16:19]
v_exp_f32 v44, v44
v_mfma_f32_16x16x32_bf16 v[24:27], a[188:191], a[64:67], v[24:27]
v_exp_f32 v45, v45
v_mfma_f32_16x16x32_bf16 v[24:27], a[184:187], a[52:55], v[24:27]
buffer_load_dwordx4 v6, s[24:27], s83 offen offset:1056 nt lds
v_mfma_f32_16x16x32_bf16 v[32:35], a[184:187], a[56:59], v[32:35]
ds_read_b128 a[212:215], v1 offset:8640
v_cvt_pk_bf16_f32 v102, v44, v45
v_mfma_f32_16x16x32_bf16 v[32:35], a[188:191], a[68:71], v[32:35]
s_waitcnt lgkmcnt(4)
v_exp_f32 v46, v46
v_mfma_f32_16x16x32_bf16 v[16:19], a[192:195], a[72:75], v[16:19]
ds_read_b128 a[216:219], v1 offset:8704
v_mfma_f32_16x16x32_bf16 v[16:19], a[196:199], a[84:87], v[16:19]
v_exp_f32 v47, v47
v_mfma_f32_16x16x32_bf16 v[24:27], a[196:199], a[88:91], v[24:27]
v_exp_f32 v48, v48
v_mfma_f32_16x16x32_bf16 v[24:27], a[192:195], a[76:79], v[24:27]
ds_read_b128 a[220:223], v1 offset:8768
v_cvt_pk_bf16_f32 v103, v46, v47
v_mfma_f32_16x16x32_bf16 v[32:35], a[192:195], a[80:83], v[32:35]
v_exp_f32 v49, v49
v_mfma_f32_16x16x32_bf16 v[32:35], a[196:199], a[92:95], v[32:35]
s_waitcnt lgkmcnt(4)
v_exp_f32 v50, v50
v_mfma_f32_16x16x32_bf16 v[20:23], a[200:203], a[0:3], v[64:67]
ds_read_b128 a[224:227], v1 offset:8832
v_cvt_pk_bf16_f32 v104, v48, v49
v_mfma_f32_16x16x32_bf16 v[20:23], a[204:207], a[12:15], v[20:23]
buffer_load_dwordx4 v7, s[24:27], s83 offen offset:2112 nt lds
v_mfma_f32_16x16x32_bf16 v[28:31], a[204:207], a[16:19], v[68:71]
v_exp_f32 v51, v51
v_mfma_f32_16x16x32_bf16 v[28:31], a[200:203], a[4:7], v[28:31]
ds_read_b128 a[228:231], v1 offset:8896
v_cvt_pk_bf16_f32 v105, v50, v51
v_mfma_f32_16x16x32_bf16 v[36:39], a[200:203], a[8:11], v[72:75]
v_exp_f32 v52, v52
v_mfma_f32_16x16x32_bf16 v[36:39], a[204:207], a[20:23], v[36:39]
s_waitcnt lgkmcnt(4)
v_exp_f32 v53, v53
v_mfma_f32_16x16x32_bf16 v[20:23], a[208:211], a[24:27], v[20:23]
v_exp_f32 v54, v54
v_mfma_f32_16x16x32_bf16 v[20:23], a[212:215], a[36:39], v[20:23]
v_exp_f32 v55, v55
v_mfma_f32_16x16x32_bf16 v[28:31], a[212:215], a[40:43], v[28:31]
v_exp_f32 v56, v56
v_mfma_f32_16x16x32_bf16 v[28:31], a[208:211], a[28:31], v[28:31]
v_exp_f32 v57, v57
v_mfma_f32_16x16x32_bf16 v[36:39], a[208:211], a[32:35], v[36:39]
v_add_u32 v1, 16896, v1
v_cvt_pk_bf16_f32 v106, v52, v53
v_mfma_f32_16x16x32_bf16 v[36:39], a[212:215], a[44:47], v[36:39]
s_waitcnt lgkmcnt(2)
buffer_load_dwordx4 v8, s[24:27], s83 offen offset:3168 nt lds
v_mfma_f32_16x16x32_bf16 v[20:23], a[216:219], a[48:51], v[20:23]
s_lshl_b32 s77, s3, 12
v_exp_f32 v58, v58
v_mfma_f32_16x16x32_bf16 v[20:23], a[220:223], a[60:63], v[20:23]
s_lshl_b32 s67, s52, 3
v_exp_f32 v59, v59
v_mfma_f32_16x16x32_bf16 v[28:31], a[220:223], a[64:67], v[28:31]
s_add_u32 s77, s77, s67
ds_read_b128 a[168:171], v1 offset:0
v_cvt_pk_bf16_f32 v107, v54, v55
v_mfma_f32_16x16x32_bf16 v[28:31], a[216:219], a[52:55], v[28:31]
ds_read_b128 a[172:175], v1 offset:64
v_cvt_pk_bf16_f32 v108, v56, v57
v_mfma_f32_16x16x32_bf16 v[36:39], a[216:219], a[56:59], v[36:39]
ds_read_b128 a[176:179], v1 offset:128
v_cvt_pk_bf16_f32 v109, v58, v59
v_mfma_f32_16x16x32_bf16 v[36:39], a[220:223], a[68:71], v[36:39]
s_waitcnt lgkmcnt(3)
ds_read_b128 a[180:183], v1 offset:192
v_lshlrev_b32 v80, 12, v0
v_mfma_f32_16x16x32_bf16 v[20:23], a[224:227], a[72:75], v[20:23]
v_exp_f32 v60, v60
v_mfma_f32_16x16x32_bf16 v[20:23], a[228:231], a[84:87], v[20:23]
v_exp_f32 v61, v61
v_mfma_f32_16x16x32_bf16 v[28:31], a[228:231], a[88:91], v[28:31]
v_exp_f32 v62, v62
v_mfma_f32_16x16x32_bf16 v[28:31], a[224:227], a[76:79], v[28:31]
v_exp_f32 v63, v63
v_mfma_f32_16x16x32_bf16 v[36:39], a[224:227], a[80:83], v[36:39]
v_cvt_pk_bf16_f32 v110, v60, v61
v_cvt_pk_bf16_f32 v111, v62, v63
v_mfma_f32_16x16x32_bf16 v[36:39], a[228:231], a[92:95], v[36:39]
v_add_u32 v80, s77, v80
v_mov_b32 v81, 1
buffer_atomic_add v81, v80, s[44:47], 0 offen sc1
v_max3_f32 v2, v16, v17, v18
v_max3_f32 v2, v2, v19, v24
v_max3_f32 v2, v2, v25, v26
v_max3_f32 v2, v2, v27, v32
v_max3_f32 v2, v2, v33, v34
v_max_f32 v2, v2, v35
v_mfma_f32_16x16x32_bf16 a[232:235], a[244:247], v[100:103], a[232:235]
s_add_u32 s83, s82, 147456
ds_read_b128 a[184:187], v1 offset:256
v_max3_f32 v2, v2, v20, v21
v_mfma_f32_16x16x32_bf16 a[236:239], a[244:247], v[104:107], a[236:239]
s_add_u32 m0, s57, 33792
ds_read_b128 a[188:191], v1 offset:320
v_max3_f32 v2, v2, v22, v23
v_mfma_f32_16x16x32_bf16 a[240:243], a[244:247], v[108:111], a[240:243]
s_waitcnt lgkmcnt(4)
v_max3_f32 v2, v2, v28, v29
v_max3_f32 v2, v2, v30, v31
v_mfma_f32_16x16x32_bf16 v[40:43], a[168:171], a[0:3], v[64:67]
ds_read_b128 a[192:195], v1 offset:384
v_mfma_f32_16x16x32_bf16 v[40:43], a[172:175], a[12:15], v[40:43]
v_max3_f32 v2, v2, v36, v37
v_max3_f32 v2, v2, v38, v39
v_mfma_f32_16x16x32_bf16 v[48:51], a[172:175], a[16:19], v[68:71]
v_mfma_f32_16x16x32_bf16 v[48:51], a[168:171], a[4:7], v[48:51]
ds_read_b128 a[196:199], v1 offset:448
v_cmp_lt_f32 vcc, s56, v2
v_mfma_f32_16x16x32_bf16 v[56:59], a[168:171], a[8:11], v[72:75]
v_mfma_f32_16x16x32_bf16 v[56:59], a[172:175], a[20:23], v[56:59]
s_waitcnt lgkmcnt(4)
buffer_load_dwordx4 v5, s[24:27], s83 offen offset:0 nt lds
v_mfma_f32_16x16x32_bf16 v[40:43], a[176:179], a[24:27], v[40:43]
ds_read_b128 a[200:203], v1 offset:8448
s_cbranch_vccnz L_rare_2
L_ret_2:
v_mfma_f32_16x16x32_bf16 v[40:43], a[180:183], a[36:39], v[40:43]
v_exp_f32 v16, v16
v_mfma_f32_16x16x32_bf16 v[48:51], a[180:183], a[40:43], v[48:51]
v_exp_f32 v17, v17
v_mfma_f32_16x16x32_bf16 v[48:51], a[176:179], a[28:31], v[48:51]
ds_read_b128 a[204:207], v1 offset:8512
v_cvt_pk_bf16_f32 v112, v16, v17
v_mfma_f32_16x16x32_bf16 v[56:59], a[176:179], a[32:35], v[56:59]
v_exp_f32 v18, v18
v_mfma_f32_16x16x32_bf16 v[56:59], a[180:183], a[44:47], v[56:59]
s_waitcnt lgkmcnt(4)
v_exp_f32 v19, v19
v_mfma_f32_16x16x32_bf16 v[40:43], a[184:187], a[48:51], v[40:43]
ds_read_b128 a[208:211], v1 offset:8576
v_cvt_pk_bf16_f32 v113, v18, v19
v_mfma_f32_16x16x32_bf16 v[40:43], a[188:191], a[60:63], v[40:43]
v_exp_f32 v20, v20
v_mfma_f32_16x16x32_bf16 v[48:51], a[188:191], a[64:67], v[48:51]
v_exp_f32 v21, v21
v_mfma_f32_16x16x32_bf16 v[48:51], a[184:187], a[52:55], v[48:51]
buffer_load_dwordx4 v6, s[24:27], s83 offen offset:1056 nt lds
v_mfma_f32_16x16x32_bf16 v[56:59], a[184:187], a[56:59], v[56:59]
ds_read_b128 a[212:215], v1 offset:8640
v_cvt_pk_bf16_f32 v114, v20, v21
v_mfma_f32_16x16x32_bf16 v[56:59], a[188:191], a[68:71], v[56:59]
s_waitcnt lgkmcnt(4)
v_exp_f32 v22, v22
v_mfma_f32_16x16x32_bf16 v[40:43], a[192:195], a[72:75], v[40:43]
ds_read_b128 a[216:219], v1 offset:8704
v_mfma_f32_16x16x32_bf16 v[40:43], a[196:199], a[84:87], v[40:43]
v_exp_f32 v23, v23
v_mfma_f32_16x16x32_bf16 v[48:51], a[196:199], a[88:91], v[48:51]
v_exp_f32 v24, v24
v_mfma_f32_16x16x32_bf16 v[48:51], a[192:195], a[76:79], v[48:51]
ds_read_b128 a[220:223], v1 offset:8768
v_cvt_pk_bf16_f32 v115, v22, v23
v_mfma_f32_16x16x32_bf16 v[56:59], a[192:195], a[80:83], v[56:59]
v_exp_f32 v25, v25
v_mfma_f32_16x16x32_bf16 v[56:59], a[196:199], a[92:95], v[56:59]
s_waitcnt lgkmcnt(4)
v_exp_f32 v26, v26
v_mfma_f32_16x16x32_bf16 v[44:47], a[200:203], a[0:3], v[64:67]
ds_read_b128 a[224:227], v1 offset:8832
v_cvt_pk_bf16_f32 v116, v24, v25
v_mfma_f32_16x16x32_bf16 v[44:47], a[204:207], a[12:15], v[44:47]
buffer_load_dwordx4 v7, s[24:27], s83 offen offset:2112 nt lds
v_mfma_f32_16x16x32_bf16 v[52:55], a[204:207], a[16:19], v[68:71]
v_exp_f32 v27, v27
v_mfma_f32_16x16x32_bf16 v[52:55], a[200:203], a[4:7], v[52:55]
ds_read_b128 a[228:231], v1 offset:8896
v_cvt_pk_bf16_f32 v117, v26, v27
v_mfma_f32_16x16x32_bf16 v[60:63], a[200:203], a[8:11], v[72:75]
v_exp_f32 v28, v28
v_mfma_f32_16x16x32_bf16 v[60:63], a[204:207], a[20:23], v[60:63]
s_waitcnt lgkmcnt(4)
v_exp_f32 v29, v29
v_mfma_f32_16x16x32_bf16 v[44:47], a[208:211], a[24:27], v[44:47]
v_exp_f32 v30, v30
v_mfma_f32_16x16x32_bf16 v[44:47], a[212:215], a[36:39], v[44:47]
v_exp_f32 v31, v31
v_mfma_f32_16x16x32_bf16 v[52:55], a[212:215], a[40:43], v[52:55]
v_exp_f32 v32, v32
v_mfma_f32_16x16x32_bf16 v[52:55], a[208:211], a[28:31], v[52:55]
v_exp_f32 v33, v33
v_mfma_f32_16x16x32_bf16 v[60:63], a[208:211], a[32:35], v[60:63]
v_add_u32 v1, 16896, v1
v_cvt_pk_bf16_f32 v118, v28, v29
v_mfma_f32_16x16x32_bf16 v[60:63], a[212:215], a[44:47], v[60:63]
s_waitcnt lgkmcnt(2)
buffer_load_dwordx4 v8, s[24:27], s83 offen offset:3168 nt lds
v_mfma_f32_16x16x32_bf16 v[44:47], a[216:219], a[48:51], v[44:47]
v_exp_f32 v34, v34
v_mfma_f32_16x16x32_bf16 v[44:47], a[220:223], a[60:63], v[44:47]
v_exp_f32 v35, v35
v_mfma_f32_16x16x32_bf16 v[52:55], a[220:223], a[64:67], v[52:55]
ds_read_b128 a[168:171], v1 offset:0
v_cvt_pk_bf16_f32 v119, v30, v31
v_mfma_f32_16x16x32_bf16 v[52:55], a[216:219], a[52:55], v[52:55]
ds_read_b128 a[172:175], v1 offset:64
v_cvt_pk_bf16_f32 v120, v32, v33
v_mfma_f32_16x16x32_bf16 v[60:63], a[216:219], a[56:59], v[60:63]
ds_read_b128 a[176:179], v1 offset:128
v_cvt_pk_bf16_f32 v121, v34, v35
v_mfma_f32_16x16x32_bf16 v[60:63], a[220:223], a[68:71], v[60:63]
s_waitcnt lgkmcnt(3)
ds_read_b128 a[180:183], v1 offset:192
v_max3_f32 v2, v40, v41, v42
v_mfma_f32_16x16x32_bf16 v[44:47], a[224:227], a[72:75], v[44:47]
v_exp_f32 v36, v36
v_mfma_f32_16x16x32_bf16 v[44:47], a[228:231], a[84:87], v[44:47]
v_exp_f32 v37, v37
v_mfma_f32_16x16x32_bf16 v[52:55], a[228:231], a[88:91], v[52:55]
v_exp_f32 v38, v38
v_mfma_f32_16x16x32_bf16 v[52:55], a[224:227], a[76:79], v[52:55]
v_exp_f32 v39, v39
v_mfma_f32_16x16x32_bf16 v[60:63], a[224:227], a[80:83], v[60:63]
v_cvt_pk_bf16_f32 v122, v36, v37
v_cvt_pk_bf16_f32 v123, v38, v39
v_mfma_f32_16x16x32_bf16 v[60:63], a[228:231], a[92:95], v[60:63]
v_max3_f32 v2, v2, v43, v48
v_max3_f32 v2, v2, v49, v50
v_max3_f32 v2, v2, v51, v56
v_max3_f32 v2, v2, v57, v58
v_max_f32 v2, v2, v59
v_mfma_f32_16x16x32_bf16 a[232:235], a[244:247], v[112:115], a[232:235]
s_waitcnt vmcnt(13)
s_barrier
ds_read_b128 a[184:187], v1 offset:256
v_mfma_f32_16x16x32_bf16 a[236:239], a[244:247], v[116:119], a[236:239]
s_add_u32 s83, s82, 163840
ds_read_b128 a[188:191], v1 offset:320
v_max3_f32 v2, v2, v44, v45
v_mfma_f32_16x16x32_bf16 a[240:243], a[244:247], v[120:123], a[240:243]
s_waitcnt lgkmcnt(4)
v_max3_f32 v2, v2, v46, v47
v_max3_f32 v2, v2, v52, v53
v_mfma_f32_16x16x32_bf16 v[16:19], a[168:171], a[0:3], v[64:67]
s_add_u32 m0, s57, 50688
ds_read_b128 a[192:195], v1 offset:384
v_max3_f32 v2, v2, v54, v55
v_mfma_f32_16x16x32_bf16 v[16:19], a[172:175], a[12:15], v[16:19]
v_max3_f32 v2, v2, v60, v61
v_max3_f32 v2, v2, v62, v63
v_mfma_f32_16x16x32_bf16 v[24:27], a[172:175], a[16:19], v[68:71]
v_mfma_f32_16x16x32_bf16 v[24:27], a[168:171], a[4:7], v[24:27]
ds_read_b128 a[196:199], v1 offset:448
v_cmp_lt_f32 vcc, s56, v2
v_mfma_f32_16x16x32_bf16 v[32:35], a[168:171], a[8:11], v[72:75]
v_mfma_f32_16x16x32_bf16 v[32:35], a[172:175], a[20:23], v[32:35]
s_waitcnt lgkmcnt(4)
buffer_load_dwordx4 v5, s[24:27], s83 offen offset:0 nt lds
v_mfma_f32_16x16x32_bf16 v[16:19], a[176:179], a[24:27], v[16:19]
ds_read_b128 a[200:203], v1 offset:8448
s_cbranch_vccnz L_rare_3
L_ret_3:
v_mfma_f32_16x16x32_bf16 v[16:19], a[180:183], a[36:39], v[16:19]
v_exp_f32 v40, v40
v_mfma_f32_16x16x32_bf16 v[24:27], a[180:183], a[40:43], v[24:27]
v_exp_f32 v41, v41
v_mfma_f32_16x16x32_bf16 v[24:27], a[176:179], a[28:31], v[24:27]
ds_read_b128 a[204:207], v1 offset:8512
v_cvt_pk_bf16_f32 v124, v40, v41
v_mfma_f32_16x16x32_bf16 v[32:35], a[176:179], a[32:35], v[32:35]
v_exp_f32 v42, v42
v_mfma_f32_16x16x32_bf16 v[32:35], a[180:183], a[44:47], v[32:35]
s_waitcnt lgkmcnt(4)
v_exp_f32 v43, v43
v_mfma_f32_16x16x32_bf16 v[16:19], a[184:187], a[48:51], v[16:19]
ds_read_b128 a[208:211], v1 offset:8576
v_cvt_pk_bf16_f32 v125, v42, v43
v_mfma_f32_16x16x32_bf16 v[16:19], a[188:191], a[60:63], v[16:19]
v_exp_f32 v44, v44
v_mfma_f32_16x16x32_bf16 v[24:27], a[188:191], a[64:67], v[24:27]
v_exp_f32 v45, v45
v_mfma_f32_16x16x32_bf16 v[24:27], a[184:187], a[52:55], v[24:27]
ds_read_b128 a[212:215], v1 offset:8640
v_cvt_pk_bf16_f32 v126, v44, v45
v_mfma_f32_16x16x32_bf16 v[32:35], a[184:187], a[56:59], v[32:35]
v_exp_f32 v46, v46
v_mfma_f32_16x16x32_bf16 v[32:35], a[188:191], a[68:71], v[32:35]
s_waitcnt lgkmcnt(4)
v_exp_f32 v47, v47
v_mfma_f32_16x16x32_bf16 v[16:19], a[192:195], a[72:75], v[16:19]
buffer_load_dwordx4 v6, s[24:27], s83 offen offset:1056 nt lds
v_mfma_f32_16x16x32_bf16 v[16:19], a[196:199], a[84:87], v[16:19]
ds_read_b128 a[216:219], v1 offset:8704
v_cvt_pk_bf16_f32 v127, v46, v47
v_mfma_f32_16x16x32_bf16 v[24:27], a[196:199], a[88:91], v[24:27]
v_exp_f32 v48, v48
v_mfma_f32_16x16x32_bf16 v[24:27], a[192:195], a[76:79], v[24:27]
ds_read_b128 a[220:223], v1 offset:8768
v_mfma_f32_16x16x32_bf16 v[32:35], a[192:195], a[80:83], v[32:35]
v_exp_f32 v49, v49
v_mfma_f32_16x16x32_bf16 v[32:35], a[196:199], a[92:95], v[32:35]
s_waitcnt lgkmcnt(4)
v_exp_f32 v50, v50
v_mfma_f32_16x16x32_bf16 v[20:23], a[200:203], a[0:3], v[64:67]
ds_read_b128 a[224:227], v1 offset:8832
v_cvt_pk_bf16_f32 v128, v48, v49
v_mfma_f32_16x16x32_bf16 v[20:23], a[204:207], a[12:15], v[20:23]
v_exp_f32 v51, v51
v_mfma_f32_16x16x32_bf16 v[28:31], a[204:207], a[16:19], v[68:71]
v_exp_f32 v52, v52
v_mfma_f32_16x16x32_bf16 v[28:31], a[200:203], a[4:7], v[28:31]
ds_read_b128 a[228:231], v1 offset:8896
v_cvt_pk_bf16_f32 v129, v50, v51
v_mfma_f32_16x16x32_bf16 v[36:39], a[200:203], a[8:11], v[72:75]
v_exp_f32 v53, v53
v_mfma_f32_16x16x32_bf16 v[36:39], a[204:207], a[20:23], v[36:39]
s_waitcnt lgkmcnt(4)
v_exp_f32 v54, v54
v_mfma_f32_16x16x32_bf16 v[20:23], a[208:211], a[24:27], v[20:23]
v_exp_f32 v55, v55
v_mfma_f32_16x16x32_bf16 v[20:23], a[212:215], a[36:39], v[20:23]
buffer_load_dwordx4 v7, s[24:27], s83 offen offset:2112 nt lds
v_mfma_f32_16x16x32_bf16 v[28:31], a[212:215], a[40:43], v[28:31]
v_exp_f32 v56, v56
v_mfma_f32_16x16x32_bf16 v[28:31], a[208:211], a[28:31], v[28:31]
v_exp_f32 v57, v57
v_mfma_f32_16x16x32_bf16 v[36:39], a[208:211], a[32:35], v[36:39]
v_add_u32 v1, 16896, v1
v_cvt_pk_bf16_f32 v130, v52, v53
v_mfma_f32_16x16x32_bf16 v[36:39], a[212:215], a[44:47], v[36:39]
s_waitcnt lgkmcnt(2)
v_exp_f32 v58, v58
v_mfma_f32_16x16x32_bf16 v[20:23], a[216:219], a[48:51], v[20:23]
v_exp_f32 v59, v59
v_mfma_f32_16x16x32_bf16 v[20:23], a[220:223], a[60:63], v[20:23]
v_exp_f32 v60, v60
v_mfma_f32_16x16x32_bf16 v[28:31], a[220:223], a[64:67], v[28:31]
ds_read_b128 a[168:171], v1 offset:0
v_cvt_pk_bf16_f32 v131, v54, v55
v_mfma_f32_16x16x32_bf16 v[28:31], a[216:219], a[52:55], v[28:31]
ds_read_b128 a[172:175], v1 offset:64
v_cvt_pk_bf16_f32 v132, v56, v57
v_mfma_f32_16x16x32_bf16 v[36:39], a[216:219], a[56:59], v[36:39]
ds_read_b128 a[176:179], v1 offset:128
v_cvt_pk_bf16_f32 v133, v58, v59
v_mfma_f32_16x16x32_bf16 v[36:39], a[220:223], a[68:71], v[36:39]
s_waitcnt lgkmcnt(3)
ds_read_b128 a[180:183], v1 offset:192
v_max3_f32 v2, v16, v17, v18
v_mfma_f32_16x16x32_bf16 v[20:23], a[224:227], a[72:75], v[20:23]
v_exp_f32 v61, v61
v_mfma_f32_16x16x32_bf16 v[20:23], a[228:231], a[84:87], v[20:23]
v_exp_f32 v62, v62
v_mfma_f32_16x16x32_bf16 v[28:31], a[228:231], a[88:91], v[28:31]
v_exp_f32 v63, v63
v_mfma_f32_16x16x32_bf16 v[28:31], a[224:227], a[76:79], v[28:31]
v_cvt_pk_bf16_f32 v134, v60, v61
v_cvt_pk_bf16_f32 v135, v62, v63
v_mfma_f32_16x16x32_bf16 v[36:39], a[224:227], a[80:83], v[36:39]
v_max3_f32 v2, v2, v19, v24
v_max3_f32 v2, v2, v25, v26
v_mfma_f32_16x16x32_bf16 v[36:39], a[228:231], a[92:95], v[36:39]
v_max3_f32 v2, v2, v27, v32
v_max3_f32 v2, v2, v33, v34
v_max_f32 v2, v2, v35
v_mfma_f32_16x16x32_bf16 a[232:235], a[244:247], v[124:127], a[232:235]
s_add_u32 s83, s82, 163840
ds_read_b128 a[184:187], v1 offset:256
v_max3_f32 v2, v2, v20, v21
v_mfma_f32_16x16x32_bf16 a[236:239], a[244:247], v[128:131], a[236:239]
s_add_u32 m0, s57, 50688
ds_read_b128 a[188:191], v1 offset:320
v_max3_f32 v2, v2, v22, v23
v_mfma_f32_16x16x32_bf16 a[240:243], a[244:247], v[132:135], a[240:243]
s_waitcnt lgkmcnt(4)
v_max3_f32 v2, v2, v28, v29
v_max3_f32 v2, v2, v30, v31
v_mfma_f32_16x16x32_bf16 v[40:43], a[168:171], a[0:3], v[64:67]
ds_read_b128 a[192:195], v1 offset:384
v_mfma_f32_16x16x32_bf16 v[40:43], a[172:175], a[12:15], v[40:43]
v_max3_f32 v2, v2, v36, v37
v_max3_f32 v2, v2, v38, v39
v_mfma_f32_16x16x32_bf16 v[48:51], a[172:175], a[16:19], v[68:71]
v_mfma_f32_16x16x32_bf16 v[48:51], a[168:171], a[4:7], v[48:51]
ds_read_b128 a[196:199], v1 offset:448
v_cmp_lt_f32 vcc, s56, v2
v_mfma_f32_16x16x32_bf16 v[56:59], a[168:171], a[8:11], v[72:75]
v_mfma_f32_16x16x32_bf16 v[56:59], a[172:175], a[20:23], v[56:59]
s_waitcnt lgkmcnt(4)
buffer_load_dwordx4 v8, s[24:27], s83 offen offset:3168 nt lds
v_mfma_f32_16x16x32_bf16 v[40:43], a[176:179], a[24:27], v[40:43]
ds_read_b128 a[200:203], v1 offset:8448
s_cbranch_vccnz L_rare_4
L_ret_4:
v_mfma_f32_16x16x32_bf16 v[40:43], a[180:183], a[36:39], v[40:43]
s_add_u32 s83, s82, 180224
v_exp_f32 v16, v16
v_mfma_f32_16x16x32_bf16 v[48:51], a[180:183], a[40:43], v[48:51]
s_add_u32 m0, s57, 67584
v_exp_f32 v17, v17
v_mfma_f32_16x16x32_bf16 v[48:51], a[176:179], a[28:31], v[48:51]
ds_read_b128 a[204:207], v1 offset:8512
v_cvt_pk_bf16_f32 v136, v16, v17
v_mfma_f32_16x16x32_bf16 v[56:59], a[176:179], a[32:35], v[56:59]
v_exp_f32 v18, v18
v_mfma_f32_16x16x32_bf16 v[56:59], a[180:183], a[44:47], v[56:59]
s_waitcnt lgkmcnt(4)
v_exp_f32 v19, v19
v_mfma_f32_16x16x32_bf16 v[40:43], a[184:187], a[48:51], v[40:43]
ds_read_b128 a[208:211], v1 offset:8576
v_cvt_pk_bf16_f32 v137, v18, v19
v_mfma_f32_16x16x32_bf16 v[40:43], a[188:191], a[60:63], v[40:43]
v_exp_f32 v20, v20
v_mfma_f32_16x16x32_bf16 v[48:51], a[188:191], a[64:67], v[48:51]
v_exp_f32 v21, v21
v_mfma_f32_16x16x32_bf16 v[48:51], a[184:187], a[52:55], v[48:51]
ds_read_b128 a[212:215], v1 offset:8640
v_cvt_pk_bf16_f32 v138, v20, v21
v_mfma_f32_16x16x32_bf16 v[56:59], a[184:187], a[56:59], v[56:59]
v_exp_f32 v22, v22
v_mfma_f32_16x16x32_bf16 v[56:59], a[188:191], a[68:71], v[56:59]
s_waitcnt lgkmcnt(4)
v_exp_f32 v23, v23
v_mfma_f32_16x16x32_bf16 v[40:43], a[192:195], a[72:75], v[40:43]
buffer_load_dwordx4 v5, s[24:27], s83 offen offset:0 nt lds
v_mfma_f32_16x16x32_bf16 v[40:43], a[196:199], a[84:87], v[40:43]
ds_read_b128 a[216:219], v1 offset:8704
v_cvt_pk_bf16_f32 v139, v22, v23
v_mfma_f32_16x16x32_bf16 v[48:51], a[196:199], a[88:91], v[48:51]
v_exp_f32 v24, v24
v_mfma_f32_16x16x32_bf16 v[48:51], a[192:195], a[76:79], v[48:51]
ds_read_b128 a[220:223], v1 offset:8768
v_mfma_f32_16x16x32_bf16 v[56:59], a[192:195], a[80:83], v[56:59]
v_exp_f32 v25, v25
v_mfma_f32_16x16x32_bf16 v[56:59], a[196:199], a[92:95], v[56:59]
s_waitcnt lgkmcnt(4)
v_exp_f32 v26, v26
v_mfma_f32_16x16x32_bf16 v[44:47], a[200:203], a[0:3], v[64:67]
ds_read_b128 a[224:227], v1 offset:8832
v_cvt_pk_bf16_f32 v140, v24, v25
v_mfma_f32_16x16x32_bf16 v[44:47], a[204:207], a[12:15], v[44:47]
v_exp_f32 v27, v27
v_mfma_f32_16x16x32_bf16 v[52:55], a[204:207], a[16:19], v[68:71]
v_exp_f32 v28, v28
v_mfma_f32_16x16x32_bf16 v[52:55], a[200:203], a[4:7], v[52:55]
ds_read_b128 a[228:231], v1 offset:8896
v_cvt_pk_bf16_f32 v141, v26, v27
v_mfma_f32_16x16x32_bf16 v[60:63], a[200:203], a[8:11], v[72:75]
v_exp_f32 v29, v29
v_mfma_f32_16x16x32_bf16 v[60:63], a[204:207], a[20:23], v[60:63]
s_waitcnt lgkmcnt(4)
v_exp_f32 v30, v30
v_mfma_f32_16x16x32_bf16 v[44:47], a[208:211], a[24:27], v[44:47]
v_exp_f32 v31, v31
v_mfma_f32_16x16x32_bf16 v[44:47], a[212:215], a[36:39], v[44:47]
buffer_load_dwordx4 v6, s[24:27], s83 offen offset:1056 nt lds
v_mfma_f32_16x16x32_bf16 v[52:55], a[212:215], a[40:43], v[52:55]
v_exp_f32 v32, v32
v_mfma_f32_16x16x32_bf16 v[52:55], a[208:211], a[28:31], v[52:55]
v_exp_f32 v33, v33
v_mfma_f32_16x16x32_bf16 v[60:63], a[208:211], a[32:35], v[60:63]
v_add_u32 v1, 16896, v1
v_cvt_pk_bf16_f32 v142, v28, v29
v_mfma_f32_16x16x32_bf16 v[60:63], a[212:215], a[44:47], v[60:63]
s_waitcnt lgkmcnt(2)
v_exp_f32 v34, v34
v_mfma_f32_16x16x32_bf16 v[44:47], a[216:219], a[48:51], v[44:47]
v_exp_f32 v35, v35
v_mfma_f32_16x16x32_bf16 v[44:47], a[220:223], a[60:63], v[44:47]
v_exp_f32 v36, v36
v_mfma_f32_16x16x32_bf16 v[52:55], a[220:223], a[64:67], v[52:55]
ds_read_b128 a[168:171], v1 offset:0
v_cvt_pk_bf16_f32 v143, v30, v31
v_mfma_f32_16x16x32_bf16 v[52:55], a[216:219], a[52:55], v[52:55]
ds_read_b128 a[172:175], v1 offset:64
v_cvt_pk_bf16_f32 v144, v32, v33
v_mfma_f32_16x16x32_bf16 v[60:63], a[216:219], a[56:59], v[60:63]
ds_read_b128 a[176:179], v1 offset:128
v_cvt_pk_bf16_f32 v145, v34, v35
v_mfma_f32_16x16x32_bf16 v[60:63], a[220:223], a[68:71], v[60:63]
s_waitcnt lgkmcnt(3)
ds_read_b128 a[180:183], v1 offset:192
v_max3_f32 v2, v40, v41, v42
v_mfma_f32_16x16x32_bf16 v[44:47], a[224:227], a[72:75], v[44:47]
v_exp_f32 v37, v37
v_mfma_f32_16x16x32_bf16 v[44:47], a[228:231], a[84:87], v[44:47]
v_exp_f32 v38, v38
v_mfma_f32_16x16x32_bf16 v[52:55], a[228:231], a[88:91], v[52:55]
v_exp_f32 v39, v39
v_mfma_f32_16x16x32_bf16 v[52:55], a[224:227], a[76:79], v[52:55]
v_cvt_pk_bf16_f32 v146, v36, v37
v_cvt_pk_bf16_f32 v147, v38, v39
v_mfma_f32_16x16x32_bf16 v[60:63], a[224:227], a[80:83], v[60:63]
v_max3_f32 v2, v2, v43, v48
v_max3_f32 v2, v2, v49, v50
v_mfma_f32_16x16x32_bf16 v[60:63], a[228:231], a[92:95], v[60:63]
v_max3_f32 v2, v2, v51, v56
v_max3_f32 v2, v2, v57, v58
v_max_f32 v2, v2, v59
v_mfma_f32_16x16x32_bf16 a[232:235], a[244:247], v[136:139], a[232:235]
s_waitcnt vmcnt(11)
s_barrier
ds_read_b128 a[184:187], v1 offset:256
v_mfma_f32_16x16x32_bf16 a[236:239], a[244:247], v[140:143], a[236:239]
s_add_u32 s83, s82, 180224
ds_read_b128 a[188:191], v1 offset:320
v_max3_f32 v2, v2, v44, v45
v_mfma_f32_16x16x32_bf16 a[240:243], a[244:247], v[144:147], a[240:243]
s_waitcnt lgkmcnt(4)
v_max3_f32 v2, v2, v46, v47
v_max3_f32 v2, v2, v52, v53
v_mfma_f32_16x16x32_bf16 v[16:19], a[168:171], a[0:3], v[64:67]
s_add_u32 m0, s57, 67584
ds_read_b128 a[192:195], v1 offset:384
v_max3_f32 v2, v2, v54, v55
v_mfma_f32_16x16x32_bf16 v[16:19], a[172:175], a[12:15], v[16:19]
v_max3_f32 v2, v2, v60, v61
v_max3_f32 v2, v2, v62, v63
v_mfma_f32_16x16x32_bf16 v[24:27], a[172:175], a[16:19], v[68:71]
v_mfma_f32_16x16x32_bf16 v[24:27], a[168:171], a[4:7], v[24:27]
ds_read_b128 a[196:199], v1 offset:448
v_cmp_lt_f32 vcc, s56, v2
v_mfma_f32_16x16x32_bf16 v[32:35], a[168:171], a[8:11], v[72:75]
v_mfma_f32_16x16x32_bf16 v[32:35], a[172:175], a[20:23], v[32:35]
s_waitcnt lgkmcnt(4)
buffer_load_dwordx4 v7, s[24:27], s83 offen offset:2112 nt lds
v_mfma_f32_16x16x32_bf16 v[16:19], a[176:179], a[24:27], v[16:19]
ds_read_b128 a[200:203], v1 offset:8448
s_cbranch_vccnz L_rare_5
L_ret_5:
v_mfma_f32_16x16x32_bf16 v[16:19], a[180:183], a[36:39], v[16:19]
v_exp_f32 v40, v40
v_mfma_f32_16x16x32_bf16 v[24:27], a[180:183], a[40:43], v[24:27]
v_exp_f32 v41, v41
v_mfma_f32_16x16x32_bf16 v[24:27], a[176:179], a[28:31], v[24:27]
ds_read_b128 a[204:207], v1 offset:8512
v_cvt_pk_bf16_f32 v148, v40, v41
v_mfma_f32_16x16x32_bf16 v[32:35], a[176:179], a[32:35], v[32:35]
v_exp_f32 v42, v42
v_mfma_f32_16x16x32_bf16 v[32:35], a[180:183], a[44:47], v[32:35]
s_waitcnt lgkmcnt(4)
v_exp_f32 v43, v43
v_mfma_f32_16x16x32_bf16 v[16:19], a[184:187], a[48:51], v[16:19]
ds_read_b128 a[208:211], v1 offset:8576
v_cvt_pk_bf16_f32 v149, v42, v43
v_mfma_f32_16x16x32_bf16 v[16:19], a[188:191], a[60:63], v[16:19]
v_exp_f32 v44, v44
v_mfma_f32_16x16x32_bf16 v[24:27], a[188:191], a[64:67], v[24:27]
v_exp_f32 v45, v45
v_mfma_f32_16x16x32_bf16 v[24:27], a[184:187], a[52:55], v[24:27]
ds_read_b128 a[212:215], v1 offset:8640
v_cvt_pk_bf16_f32 v150, v44, v45
v_mfma_f32_16x16x32_bf16 v[32:35], a[184:187], a[56:59], v[32:35]
v_exp_f32 v46, v46
v_mfma_f32_16x16x32_bf16 v[32:35], a[188:191], a[68:71], v[32:35]
s_waitcnt lgkmcnt(4)
v_exp_f32 v47, v47
v_mfma_f32_16x16x32_bf16 v[16:19], a[192:195], a[72:75], v[16:19]
buffer_load_dwordx4 v8, s[24:27], s83 offen offset:3168 nt lds
v_mfma_f32_16x16x32_bf16 v[16:19], a[196:199], a[84:87], v[16:19]
s_add_u32 s83, s82, 196608
ds_read_b128 a[216:219], v1 offset:8704
v_cvt_pk_bf16_f32 v151, v46, v47
v_mfma_f32_16x16x32_bf16 v[24:27], a[196:199], a[88:91], v[24:27]
s_add_u32 m0, s57, 84480
v_exp_f32 v48, v48
v_mfma_f32_16x16x32_bf16 v[24:27], a[192:195], a[76:79], v[24:27]
ds_read_b128 a[220:223], v1 offset:8768
v_mfma_f32_16x16x32_bf16 v[32:35], a[192:195], a[80:83], v[32:35]
v_exp_f32 v49, v49
v_mfma_f32_16x16x32_bf16 v[32:35], a[196:199], a[92:95], v[32:35]
s_waitcnt lgkmcnt(4)
v_exp_f32 v50, v50
v_mfma_f32_16x16x32_bf16 v[20:23], a[200:203], a[0:3], v[64:67]
ds_read_b128 a[224:227], v1 offset:8832
v_cvt_pk_bf16_f32 v152, v48, v49
v_mfma_f32_16x16x32_bf16 v[20:23], a[204:207], a[12:15], v[20:23]
v_exp_f32 v51, v51
v_mfma_f32_16x16x32_bf16 v[28:31], a[204:207], a[16:19], v[68:71]
v_exp_f32 v52, v52
v_mfma_f32_16x16x32_bf16 v[28:31], a[200:203], a[4:7], v[28:31]
ds_read_b128 a[228:231], v1 offset:8896
v_cvt_pk_bf16_f32 v153, v50, v51
v_mfma_f32_16x16x32_bf16 v[36:39], a[200:203], a[8:11], v[72:75]
v_exp_f32 v53, v53
v_mfma_f32_16x16x32_bf16 v[36:39], a[204:207], a[20:23], v[36:39]
s_waitcnt lgkmcnt(4)
v_exp_f32 v54, v54
v_mfma_f32_16x16x32_bf16 v[20:23], a[208:211], a[24:27], v[20:23]
v_exp_f32 v55, v55
v_mfma_f32_16x16x32_bf16 v[20:23], a[212:215], a[36:39], v[20:23]
buffer_load_dwordx4 v5, s[24:27], s83 offen offset:0 nt lds
v_mfma_f32_16x16x32_bf16 v[28:31], a[212:215], a[40:43], v[28:31]
v_exp_f32 v56, v56
v_mfma_f32_16x16x32_bf16 v[28:31], a[208:211], a[28:31], v[28:31]
v_exp_f32 v57, v57
v_mfma_f32_16x16x32_bf16 v[36:39], a[208:211], a[32:35], v[36:39]
v_subrev_u32 v1, 135168, v1
v_cvt_pk_bf16_f32 v154, v52, v53
v_mfma_f32_16x16x32_bf16 v[36:39], a[212:215], a[44:47], v[36:39]
s_waitcnt lgkmcnt(2)
v_exp_f32 v58, v58
v_mfma_f32_16x16x32_bf16 v[20:23], a[216:219], a[48:51], v[20:23]
v_exp_f32 v59, v59
v_mfma_f32_16x16x32_bf16 v[20:23], a[220:223], a[60:63], v[20:23]
v_exp_f32 v60, v60
v_mfma_f32_16x16x32_bf16 v[28:31], a[220:223], a[64:67], v[28:31]
ds_read_b128 a[168:171], v1 offset:0
v_cvt_pk_bf16_f32 v155, v54, v55
v_mfma_f32_16x16x32_bf16 v[28:31], a[216:219], a[52:55], v[28:31]
ds_read_b128 a[172:175], v1 offset:64
v_cvt_pk_bf16_f32 v156, v56, v57
v_mfma_f32_16x16x32_bf16 v[36:39], a[216:219], a[56:59], v[36:39]
ds_read_b128 a[176:179], v1 offset:128
v_cvt_pk_bf16_f32 v157, v58, v59
v_mfma_f32_16x16x32_bf16 v[36:39], a[220:223], a[68:71], v[36:39]
s_waitcnt lgkmcnt(3)
ds_read_b128 a[180:183], v1 offset:192
v_max3_f32 v2, v16, v17, v18
v_mfma_f32_16x16x32_bf16 v[20:23], a[224:227], a[72:75], v[20:23]
v_exp_f32 v61, v61
v_mfma_f32_16x16x32_bf16 v[20:23], a[228:231], a[84:87], v[20:23]
v_exp_f32 v62, v62
v_mfma_f32_16x16x32_bf16 v[28:31], a[228:231], a[88:91], v[28:31]
v_exp_f32 v63, v63
v_mfma_f32_16x16x32_bf16 v[28:31], a[224:227], a[76:79], v[28:31]
v_cvt_pk_bf16_f32 v158, v60, v61
v_cvt_pk_bf16_f32 v159, v62, v63
v_mfma_f32_16x16x32_bf16 v[36:39], a[224:227], a[80:83], v[36:39]
v_max3_f32 v2, v2, v19, v24
v_max3_f32 v2, v2, v25, v26
v_mfma_f32_16x16x32_bf16 v[36:39], a[228:231], a[92:95], v[36:39]
v_max3_f32 v2, v2, v27, v32
v_max3_f32 v2, v2, v33, v34
v_max_f32 v2, v2, v35
v_mfma_f32_16x16x32_bf16 a[232:235], a[244:247], v[148:151], a[232:235]
s_add_u32 s83, s82, 196608
ds_read_b128 a[184:187], v1 offset:256
v_max3_f32 v2, v2, v20, v21
v_mfma_f32_16x16x32_bf16 a[236:239], a[244:247], v[152:155], a[236:239]
s_add_u32 m0, s57, 84480
ds_read_b128 a[188:191], v1 offset:320
v_max3_f32 v2, v2, v22, v23
v_mfma_f32_16x16x32_bf16 a[240:243], a[244:247], v[156:159], a[240:243]
s_waitcnt lgkmcnt(4)
v_max3_f32 v2, v2, v28, v29
v_max3_f32 v2, v2, v30, v31
v_mfma_f32_16x16x32_bf16 v[40:43], a[168:171], a[0:3], v[64:67]
ds_read_b128 a[192:195], v1 offset:384
v_mfma_f32_16x16x32_bf16 v[40:43], a[172:175], a[12:15], v[40:43]
v_max3_f32 v2, v2, v36, v37
v_max3_f32 v2, v2, v38, v39
v_mfma_f32_16x16x32_bf16 v[48:51], a[172:175], a[16:19], v[68:71]
v_mfma_f32_16x16x32_bf16 v[48:51], a[168:171], a[4:7], v[48:51]
ds_read_b128 a[196:199], v1 offset:448
v_cmp_lt_f32 vcc, s56, v2
v_mfma_f32_16x16x32_bf16 v[56:59], a[168:171], a[8:11], v[72:75]
v_mfma_f32_16x16x32_bf16 v[56:59], a[172:175], a[20:23], v[56:59]
s_waitcnt lgkmcnt(4)
buffer_load_dwordx4 v6, s[24:27], s83 offen offset:1056 nt lds
v_mfma_f32_16x16x32_bf16 v[40:43], a[176:179], a[24:27], v[40:43]
ds_read_b128 a[200:203], v1 offset:8448
s_cbranch_vccnz L_rare_6
L_ret_6:
v_mfma_f32_16x16x32_bf16 v[40:43], a[180:183], a[36:39], v[40:43]
v_exp_f32 v16, v16
v_mfma_f32_16x16x32_bf16 v[48:51], a[180:183], a[40:43], v[48:51]
v_exp_f32 v17, v17
v_mfma_f32_16x16x32_bf16 v[48:51], a[176:179], a[28:31], v[48:51]
ds_read_b128 a[204:207], v1 offset:8512
v_cvt_pk_bf16_f32 v160, v16, v17
v_mfma_f32_16x16x32_bf16 v[56:59], a[176:179], a[32:35], v[56:59]
s_lshl_b32 s67, s52, 3
v_exp_f32 v18, v18
v_mfma_f32_16x16x32_bf16 v[56:59], a[180:183], a[44:47], v[56:59]
s_waitcnt lgkmcnt(4)
v_exp_f32 v19, v19
v_mfma_f32_16x16x32_bf16 v[40:43], a[184:187], a[48:51], v[40:43]
ds_read_b128 a[208:211], v1 offset:8576
v_cvt_pk_bf16_f32 v161, v18, v19
v_mfma_f32_16x16x32_bf16 v[40:43], a[188:191], a[60:63], v[40:43]
v_exp_f32 v20, v20
v_mfma_f32_16x16x32_bf16 v[48:51], a[188:191], a[64:67], v[48:51]
v_exp_f32 v21, v21
v_mfma_f32_16x16x32_bf16 v[48:51], a[184:187], a[52:55], v[48:51]
ds_read_b128 a[212:215], v1 offset:8640
v_cvt_pk_bf16_f32 v162, v20, v21
v_mfma_f32_16x16x32_bf16 v[56:59], a[184:187], a[56:59], v[56:59]
v_exp_f32 v22, v22
v_mfma_f32_16x16x32_bf16 v[56:59], a[188:191], a[68:71], v[56:59]
s_waitcnt lgkmcnt(4)
v_exp_f32 v23, v23
v_mfma_f32_16x16x32_bf16 v[40:43], a[192:195], a[72:75], v[40:43]
buffer_load_dwordx4 v7, s[24:27], s83 offen offset:2112 nt lds
v_mfma_f32_16x16x32_bf16 v[40:43], a[196:199], a[84:87], v[40:43]
ds_read_b128 a[216:219], v1 offset:8704
v_cvt_pk_bf16_f32 v163, v22, v23
v_mfma_f32_16x16x32_bf16 v[48:51], a[196:199], a[88:91], v[48:51]
v_exp_f32 v24, v24
v_mfma_f32_16x16x32_bf16 v[48:51], a[192:195], a[76:79], v[48:51]
ds_read_b128 a[220:223], v1 offset:8768
v_lshlrev_b32 v86, 12, v0
v_mfma_f32_16x16x32_bf16 v[56:59], a[192:195], a[80:83], v[56:59]
v_exp_f32 v25, v25
v_mfma_f32_16x16x32_bf16 v[56:59], a[196:199], a[92:95], v[56:59]
s_waitcnt lgkmcnt(4)
v_exp_f32 v26, v26
v_mfma_f32_16x16x32_bf16 v[44:47], a[200:203], a[0:3], v[64:67]
ds_read_b128 a[224:227], v1 offset:8832
v_cvt_pk_bf16_f32 v164, v24, v25
v_mfma_f32_16x16x32_bf16 v[44:47], a[204:207], a[12:15], v[44:47]
v_exp_f32 v27, v27
v_mfma_f32_16x16x32_bf16 v[52:55], a[204:207], a[16:19], v[68:71]
v_exp_f32 v28, v28
v_mfma_f32_16x16x32_bf16 v[52:55], a[200:203], a[4:7], v[52:55]
ds_read_b128 a[228:231], v1 offset:8896
v_cvt_pk_bf16_f32 v165, v26, v27
v_mfma_f32_16x16x32_bf16 v[60:63], a[200:203], a[8:11], v[72:75]
v_exp_f32 v29, v29
v_mfma_f32_16x16x32_bf16 v[60:63], a[204:207], a[20:23], v[60:63]
s_waitcnt lgkmcnt(4)
v_exp_f32 v30, v30
v_mfma_f32_16x16x32_bf16 v[44:47], a[208:211], a[24:27], v[44:47]
v_exp_f32 v31, v31
v_mfma_f32_16x16x32_bf16 v[44:47], a[212:215], a[36:39], v[44:47]
buffer_load_dwordx4 v8, s[24:27], s83 offen offset:3168 nt lds
v_mfma_f32_16x16x32_bf16 v[52:55], a[212:215], a[40:43], v[52:55]
v_exp_f32 v32, v32
v_mfma_f32_16x16x32_bf16 v[52:55], a[208:211], a[28:31], v[52:55]
v_exp_f32 v33, v33
v_mfma_f32_16x16x32_bf16 v[60:63], a[208:211], a[32:35], v[60:63]
v_add_u32 v1, 16896, v1
v_cvt_pk_bf16_f32 v166, v28, v29
v_mfma_f32_16x16x32_bf16 v[60:63], a[212:215], a[44:47], v[60:63]
s_waitcnt lgkmcnt(2)
v_exp_f32 v34, v34
v_mfma_f32_16x16x32_bf16 v[44:47], a[216:219], a[48:51], v[44:47]
v_exp_f32 v35, v35
v_mfma_f32_16x16x32_bf16 v[44:47], a[220:223], a[60:63], v[44:47]
v_exp_f32 v36, v36
v_mfma_f32_16x16x32_bf16 v[52:55], a[220:223], a[64:67], v[52:55]
ds_read_b128 a[168:171], v1 offset:0
v_cvt_pk_bf16_f32 v167, v30, v31
v_mfma_f32_16x16x32_bf16 v[52:55], a[216:219], a[52:55], v[52:55]
ds_read_b128 a[172:175], v1 offset:64
v_cvt_pk_bf16_f32 v168, v32, v33
v_mfma_f32_16x16x32_bf16 v[60:63], a[216:219], a[56:59], v[60:63]
ds_read_b128 a[176:179], v1 offset:128
v_cvt_pk_bf16_f32 v169, v34, v35
v_mfma_f32_16x16x32_bf16 v[60:63], a[220:223], a[68:71], v[60:63]
s_waitcnt lgkmcnt(3)
ds_read_b128 a[180:183], v1 offset:192
v_max3_f32 v2, v40, v41, v42
v_mfma_f32_16x16x32_bf16 v[44:47], a[224:227], a[72:75], v[44:47]
v_exp_f32 v37, v37
v_mfma_f32_16x16x32_bf16 v[44:47], a[228:231], a[84:87], v[44:47]
v_exp_f32 v38, v38
v_mfma_f32_16x16x32_bf16 v[52:55], a[228:231], a[88:91], v[52:55]
v_exp_f32 v39, v39
v_mfma_f32_16x16x32_bf16 v[52:55], a[224:227], a[76:79], v[52:55]
v_cvt_pk_bf16_f32 v170, v36, v37
v_cvt_pk_bf16_f32 v171, v38, v39
v_mfma_f32_16x16x32_bf16 v[60:63], a[224:227], a[80:83], v[60:63]
v_max3_f32 v2, v2, v43, v48
v_max3_f32 v2, v2, v49, v50
v_mfma_f32_16x16x32_bf16 v[60:63], a[228:231], a[92:95], v[60:63]
v_max3_f32 v2, v2, v51, v56
v_max3_f32 v2, v2, v57, v58
v_max_f32 v2, v2, v59
v_add_u32 v86, s67, v86
buffer_load_dword v87, v86, s[44:47], 0 offen sc1
v_mfma_f32_16x16x32_bf16 a[232:235], a[244:247], v[160:163], a[232:235]
s_waitcnt vmcnt(9)
s_barrier
ds_read_b128 a[184:187], v1 offset:256
v_mfma_f32_16x16x32_bf16 a[236:239], a[244:247], v[164:167], a[236:239]
s_add_u32 s83, s82, 212992
ds_read_b128 a[188:191], v1 offset:320
v_max3_f32 v2, v2, v44, v45
v_mfma_f32_16x16x32_bf16 a[240:243], a[244:247], v[168:171], a[240:243]
s_waitcnt lgkmcnt(4)
v_max3_f32 v2, v2, v46, v47
v_max3_f32 v2, v2, v52, v53
v_mfma_f32_16x16x32_bf16 v[16:19], a[168:171], a[0:3], v[64:67]
s_add_u32 m0, s57, 101376
ds_read_b128 a[192:195], v1 offset:384
v_max3_f32 v2, v2, v54, v55
v_mfma_f32_16x16x32_bf16 v[16:19], a[172:175], a[12:15], v[16:19]
v_max3_f32 v2, v2, v60, v61
v_max3_f32 v2, v2, v62, v63
v_mfma_f32_16x16x32_bf16 v[24:27], a[172:175], a[16:19], v[68:71]
v_mfma_f32_16x16x32_bf16 v[24:27], a[168:171], a[4:7], v[24:27]
ds_read_b128 a[196:199], v1 offset:448
v_cmp_lt_f32 vcc, s56, v2
v_mfma_f32_16x16x32_bf16 v[32:35], a[168:171], a[8:11], v[72:75]
v_mfma_f32_16x16x32_bf16 v[32:35], a[172:175], a[20:23], v[32:35]
s_waitcnt lgkmcnt(4)
buffer_load_dwordx4 v5, s[24:27], s83 offen offset:0 nt lds
v_mfma_f32_16x16x32_bf16 v[16:19], a[176:179], a[24:27], v[16:19]
ds_read_b128 a[200:203], v1 offset:8448
s_cbranch_vccnz L_rare_7
L_ret_7:
v_mfma_f32_16x16x32_bf16 v[16:19], a[180:183], a[36:39], v[16:19]
v_exp_f32 v40, v40
v_mfma_f32_16x16x32_bf16 v[24:27], a[180:183], a[40:43], v[24:27]
v_exp_f32 v41, v41
v_mfma_f32_16x16x32_bf16 v[24:27], a[176:179], a[28:31], v[24:27]
ds_read_b128 a[204:207], v1 offset:8512
v_cvt_pk_bf16_f32 v172, v40, v41
v_mfma_f32_16x16x32_bf16 v[32:35], a[176:179], a[32:35], v[32:35]
v_exp_f32 v42, v42
v_mfma_f32_16x16x32_bf16 v[32:35], a[180:183], a[44:47], v[32:35]
s_waitcnt lgkmcnt(4)
v_exp_f32 v43, v43
v_mfma_f32_16x16x32_bf16 v[16:19], a[184:187], a[48:51], v[16:19]
ds_read_b128 a[208:211], v1 offset:8576
v_cvt_pk_bf16_f32 v173, v42, v43
v_mfma_f32_16x16x32_bf16 v[16:19], a[188:191], a[60:63], v[16:19]
v_exp_f32 v44, v44
v_mfma_f32_16x16x32_bf16 v[24:27], a[188:191], a[64:67], v[24:27]
v_exp_f32 v45, v45
v_mfma_f32_16x16x32_bf16 v[24:27], a[184:187], a[52:55], v[24:27]
ds_read_b128 a[212:215], v1 offset:8640
v_cvt_pk_bf16_f32 v174, v44, v45
v_mfma_f32_16x16x32_bf16 v[32:35], a[184:187], a[56:59], v[32:35]
v_exp_f32 v46, v46
v_mfma_f32_16x16x32_bf16 v[32:35], a[188:191], a[68:71], v[32:35]
s_waitcnt lgkmcnt(4)
v_exp_f32 v47, v47
v_mfma_f32_16x16x32_bf16 v[16:19], a[192:195], a[72:75], v[16:19]
buffer_load_dwordx4 v6, s[24:27], s83 offen offset:1056 nt lds
v_mfma_f32_16x16x32_bf16 v[16:19], a[196:199], a[84:87], v[16:19]
ds_read_b128 a[216:219], v1 offset:8704
v_cvt_pk_bf16_f32 v175, v46, v47
v_mfma_f32_16x16x32_bf16 v[24:27], a[196:199], a[88:91], v[24:27]
v_exp_f32 v48, v48
v_mfma_f32_16x16x32_bf16 v[24:27], a[192:195], a[76:79], v[24:27]
ds_read_b128 a[220:223], v1 offset:8768
v_mfma_f32_16x16x32_bf16 v[32:35], a[192:195], a[80:83], v[32:35]
v_exp_f32 v49, v49
v_mfma_f32_16x16x32_bf16 v[32:35], a[196:199], a[92:95], v[32:35]
s_waitcnt lgkmcnt(4)
v_exp_f32 v50, v50
v_mfma_f32_16x16x32_bf16 v[20:23], a[200:203], a[0:3], v[64:67]
ds_read_b128 a[224:227], v1 offset:8832
v_cvt_pk_bf16_f32 v176, v48, v49
v_mfma_f32_16x16x32_bf16 v[20:23], a[204:207], a[12:15], v[20:23]
v_exp_f32 v51, v51
v_mfma_f32_16x16x32_bf16 v[28:31], a[204:207], a[16:19], v[68:71]
v_exp_f32 v52, v52
v_mfma_f32_16x16x32_bf16 v[28:31], a[200:203], a[4:7], v[28:31]
ds_read_b128 a[228:231], v1 offset:8896
v_cvt_pk_bf16_f32 v177, v50, v51
v_mfma_f32_16x16x32_bf16 v[36:39], a[200:203], a[8:11], v[72:75]
v_exp_f32 v53, v53
v_mfma_f32_16x16x32_bf16 v[36:39], a[204:207], a[20:23], v[36:39]
s_waitcnt lgkmcnt(4)
v_exp_f32 v54, v54
v_mfma_f32_16x16x32_bf16 v[20:23], a[208:211], a[24:27], v[20:23]
v_exp_f32 v55, v55
v_mfma_f32_16x16x32_bf16 v[20:23], a[212:215], a[36:39], v[20:23]
buffer_load_dwordx4 v7, s[24:27], s83 offen offset:2112 nt lds
v_mfma_f32_16x16x32_bf16 v[28:31], a[212:215], a[40:43], v[28:31]
v_exp_f32 v56, v56
v_mfma_f32_16x16x32_bf16 v[28:31], a[208:211], a[28:31], v[28:31]
v_exp_f32 v57, v57
v_mfma_f32_16x16x32_bf16 v[36:39], a[208:211], a[32:35], v[36:39]
v_add_u32 v1, 16896, v1
v_cvt_pk_bf16_f32 v178, v52, v53
v_mfma_f32_16x16x32_bf16 v[36:39], a[212:215], a[44:47], v[36:39]
s_waitcnt lgkmcnt(2)
v_exp_f32 v58, v58
v_mfma_f32_16x16x32_bf16 v[20:23], a[216:219], a[48:51], v[20:23]
v_exp_f32 v59, v59
v_mfma_f32_16x16x32_bf16 v[20:23], a[220:223], a[60:63], v[20:23]
v_exp_f32 v60, v60
v_mfma_f32_16x16x32_bf16 v[28:31], a[220:223], a[64:67], v[28:31]
ds_read_b128 a[168:171], v1 offset:0
v_cvt_pk_bf16_f32 v179, v54, v55
v_mfma_f32_16x16x32_bf16 v[28:31], a[216:219], a[52:55], v[28:31]
ds_read_b128 a[172:175], v1 offset:64
v_cvt_pk_bf16_f32 v180, v56, v57
v_mfma_f32_16x16x32_bf16 v[36:39], a[216:219], a[56:59], v[36:39]
ds_read_b128 a[176:179], v1 offset:128
v_cvt_pk_bf16_f32 v181, v58, v59
v_mfma_f32_16x16x32_bf16 v[36:39], a[220:223], a[68:71], v[36:39]
s_waitcnt lgkmcnt(3)
ds_read_b128 a[180:183], v1 offset:192
v_max3_f32 v2, v16, v17, v18
v_mfma_f32_16x16x32_bf16 v[20:23], a[224:227], a[72:75], v[20:23]
v_exp_f32 v61, v61
v_mfma_f32_16x16x32_bf16 v[20:23], a[228:231], a[84:87], v[20:23]
v_exp_f32 v62, v62
v_mfma_f32_16x16x32_bf16 v[28:31], a[228:231], a[88:91], v[28:31]
v_exp_f32 v63, v63
v_mfma_f32_16x16x32_bf16 v[28:31], a[224:227], a[76:79], v[28:31]
v_cvt_pk_bf16_f32 v182, v60, v61
v_cvt_pk_bf16_f32 v183, v62, v63
v_mfma_f32_16x16x32_bf16 v[36:39], a[224:227], a[80:83], v[36:39]
v_max3_f32 v2, v2, v19, v24
v_max3_f32 v2, v2, v25, v26
v_mfma_f32_16x16x32_bf16 v[36:39], a[228:231], a[92:95], v[36:39]
v_max3_f32 v2, v2, v27, v32
v_max3_f32 v2, v2, v33, v34
v_max_f32 v2, v2, v35
v_mfma_f32_16x16x32_bf16 a[232:235], a[244:247], v[172:175], a[232:235]
s_add_u32 s83, s82, 212992
ds_read_b128 a[184:187], v1 offset:256
v_max3_f32 v2, v2, v20, v21
v_mfma_f32_16x16x32_bf16 a[236:239], a[244:247], v[176:179], a[236:239]
s_add_u32 m0, s57, 101376
ds_read_b128 a[188:191], v1 offset:320
v_max3_f32 v2, v2, v22, v23
v_mfma_f32_16x16x32_bf16 a[240:243], a[244:247], v[180:183], a[240:243]
s_waitcnt lgkmcnt(4)
v_max3_f32 v2, v2, v28, v29
v_max3_f32 v2, v2, v30, v31
v_mfma_f32_16x16x32_bf16 v[40:43], a[168:171], a[0:3], v[64:67]
ds_read_b128 a[192:195], v1 offset:384
v_mfma_f32_16x16x32_bf16 v[40:43], a[172:175], a[12:15], v[40:43]
v_max3_f32 v2, v2, v36, v37
v_max3_f32 v2, v2, v38, v39
v_mfma_f32_16x16x32_bf16 v[48:51], a[172:175], a[16:19], v[68:71]
v_mfma_f32_16x16x32_bf16 v[48:51], a[168:171], a[4:7], v[48:51]
ds_read_b128 a[196:199], v1 offset:448
v_cmp_lt_f32 vcc, s56, v2
v_mfma_f32_16x16x32_bf16 v[56:59], a[168:171], a[8:11], v[72:75]
v_mfma_f32_16x16x32_bf16 v[56:59], a[172:175], a[20:23], v[56:59]
s_waitcnt lgkmcnt(4)
buffer_load_dwordx4 v8, s[24:27], s83 offen offset:3168 nt lds
v_mfma_f32_16x16x32_bf16 v[40:43], a[176:179], a[24:27], v[40:43]
ds_read_b128 a[200:203], v1 offset:8448
s_cbranch_vccnz L_rare_8
L_ret_8:
v_mfma_f32_16x16x32_bf16 v[40:43], a[180:183], a[36:39], v[40:43]
s_add_u32 s83, s82, 229376
v_exp_f32 v16, v16
v_mfma_f32_16x16x32_bf16 v[48:51], a[180:183], a[40:43], v[48:51]
s_add_u32 m0, s57, 118272
v_exp_f32 v17, v17
v_mfma_f32_16x16x32_bf16 v[48:51], a[176:179], a[28:31], v[48:51]
ds_read_b128 a[204:207], v1 offset:8512
v_cvt_pk_bf16_f32 v184, v16, v17
v_mfma_f32_16x16x32_bf16 v[56:59], a[176:179], a[32:35], v[56:59]
v_exp_f32 v18, v18
v_mfma_f32_16x16x32_bf16 v[56:59], a[180:183], a[44:47], v[56:59]
s_waitcnt lgkmcnt(4)
v_exp_f32 v19, v19
v_mfma_f32_16x16x32_bf16 v[40:43], a[184:187], a[48:51], v[40:43]
ds_read_b128 a[208:211], v1 offset:8576
v_cvt_pk_bf16_f32 v185, v18, v19
v_mfma_f32_16x16x32_bf16 v[40:43], a[188:191], a[60:63], v[40:43]
v_exp_f32 v20, v20
v_mfma_f32_16x16x32_bf16 v[48:51], a[188:191], a[64:67], v[48:51]
v_exp_f32 v21, v21
v_mfma_f32_16x16x32_bf16 v[48:51], a[184:187], a[52:55], v[48:51]
ds_read_b128 a[212:215], v1 offset:8640
v_cvt_pk_bf16_f32 v186, v20, v21
v_mfma_f32_16x16x32_bf16 v[56:59], a[184:187], a[56:59], v[56:59]
v_exp_f32 v22, v22
v_mfma_f32_16x16x32_bf16 v[56:59], a[188:191], a[68:71], v[56:59]
s_waitcnt lgkmcnt(4)
v_exp_f32 v23, v23
v_mfma_f32_16x16x32_bf16 v[40:43], a[192:195], a[72:75], v[40:43]
buffer_load_dwordx4 v5, s[24:27], s83 offen offset:0 nt lds
v_mfma_f32_16x16x32_bf16 v[40:43], a[196:199], a[84:87], v[40:43]
ds_read_b128 a[216:219], v1 offset:8704
v_cvt_pk_bf16_f32 v187, v22, v23
v_mfma_f32_16x16x32_bf16 v[48:51], a[196:199], a[88:91], v[48:51]
v_exp_f32 v24, v24
v_mfma_f32_16x16x32_bf16 v[48:51], a[192:195], a[76:79], v[48:51]
ds_read_b128 a[220:223], v1 offset:8768
v_mfma_f32_16x16x32_bf16 v[56:59], a[192:195], a[80:83], v[56:59]
v_exp_f32 v25, v25
v_mfma_f32_16x16x32_bf16 v[56:59], a[196:199], a[92:95], v[56:59]
s_waitcnt lgkmcnt(4)
v_exp_f32 v26, v26
v_mfma_f32_16x16x32_bf16 v[44:47], a[200:203], a[0:3], v[64:67]
ds_read_b128 a[224:227], v1 offset:8832
v_cvt_pk_bf16_f32 v188, v24, v25
v_mfma_f32_16x16x32_bf16 v[44:47], a[204:207], a[12:15], v[44:47]
v_exp_f32 v27, v27
v_mfma_f32_16x16x32_bf16 v[52:55], a[204:207], a[16:19], v[68:71]
v_exp_f32 v28, v28
v_mfma_f32_16x16x32_bf16 v[52:55], a[200:203], a[4:7], v[52:55]
ds_read_b128 a[228:231], v1 offset:8896
v_cvt_pk_bf16_f32 v189, v26, v27
v_mfma_f32_16x16x32_bf16 v[60:63], a[200:203], a[8:11], v[72:75]
v_exp_f32 v29, v29
v_mfma_f32_16x16x32_bf16 v[60:63], a[204:207], a[20:23], v[60:63]
s_waitcnt lgkmcnt(4)
v_exp_f32 v30, v30
v_mfma_f32_16x16x32_bf16 v[44:47], a[208:211], a[24:27], v[44:47]
v_exp_f32 v31, v31
v_mfma_f32_16x16x32_bf16 v[44:47], a[212:215], a[36:39], v[44:47]
buffer_load_dwordx4 v6, s[24:27], s83 offen offset:1056 nt lds
v_mfma_f32_16x16x32_bf16 v[52:55], a[212:215], a[40:43], v[52:55]
v_exp_f32 v32, v32
v_mfma_f32_16x16x32_bf16 v[52:55], a[208:211], a[28:31], v[52:55]
v_exp_f32 v33, v33
v_mfma_f32_16x16x32_bf16 v[60:63], a[208:211], a[32:35], v[60:63]
v_add_u32 v1, 16896, v1
v_cvt_pk_bf16_f32 v190, v28, v29
v_mfma_f32_16x16x32_bf16 v[60:63], a[212:215], a[44:47], v[60:63]
s_waitcnt lgkmcnt(2)
v_exp_f32 v34, v34
v_mfma_f32_16x16x32_bf16 v[44:47], a[216:219], a[48:51], v[44:47]
v_exp_f32 v35, v35
v_mfma_f32_16x16x32_bf16 v[44:47], a[220:223], a[60:63], v[44:47]
v_exp_f32 v36, v36
v_mfma_f32_16x16x32_bf16 v[52:55], a[220:223], a[64:67], v[52:55]
ds_read_b128 a[168:171], v1 offset:0
v_cvt_pk_bf16_f32 v191, v30, v31
v_mfma_f32_16x16x32_bf16 v[52:55], a[216:219], a[52:55], v[52:55]
ds_read_b128 a[172:175], v1 offset:64
v_cvt_pk_bf16_f32 v192, v32, v33
v_mfma_f32_16x16x32_bf16 v[60:63], a[216:219], a[56:59], v[60:63]
ds_read_b128 a[176:179], v1 offset:128
v_cvt_pk_bf16_f32 v193, v34, v35
v_mfma_f32_16x16x32_bf16 v[60:63], a[220:223], a[68:71], v[60:63]
s_waitcnt lgkmcnt(3)
ds_read_b128 a[180:183], v1 offset:192
v_max3_f32 v2, v40, v41, v42
v_mfma_f32_16x16x32_bf16 v[44:47], a[224:227], a[72:75], v[44:47]
v_exp_f32 v37, v37
v_mfma_f32_16x16x32_bf16 v[44:47], a[228:231], a[84:87], v[44:47]
v_exp_f32 v38, v38
v_mfma_f32_16x16x32_bf16 v[52:55], a[228:231], a[88:91], v[52:55]
v_exp_f32 v39, v39
v_mfma_f32_16x16x32_bf16 v[52:55], a[224:227], a[76:79], v[52:55]
v_cvt_pk_bf16_f32 v194, v36, v37
v_cvt_pk_bf16_f32 v195, v38, v39
v_mfma_f32_16x16x32_bf16 v[60:63], a[224:227], a[80:83], v[60:63]
v_max3_f32 v2, v2, v43, v48
v_max3_f32 v2, v2, v49, v50
v_mfma_f32_16x16x32_bf16 v[60:63], a[228:231], a[92:95], v[60:63]
v_max3_f32 v2, v2, v51, v56
v_max3_f32 v2, v2, v57, v58
v_max_f32 v2, v2, v59
v_mfma_f32_16x16x32_bf16 a[232:235], a[244:247], v[184:187], a[232:235]
s_waitcnt vmcnt(7)
s_barrier
ds_read_b128 a[184:187], v1 offset:256
v_mfma_f32_16x16x32_bf16 a[236:239], a[244:247], v[188:191], a[236:239]
s_add_u32 s83, s82, 229376
ds_read_b128 a[188:191], v1 offset:320
v_max3_f32 v2, v2, v44, v45
v_mfma_f32_16x16x32_bf16 a[240:243], a[244:247], v[192:195], a[240:243]
s_waitcnt lgkmcnt(4)
v_max3_f32 v2, v2, v46, v47
v_max3_f32 v2, v2, v52, v53
v_mfma_f32_16x16x32_bf16 v[16:19], a[168:171], a[0:3], v[64:67]
s_add_u32 m0, s57, 118272
ds_read_b128 a[192:195], v1 offset:384
v_max3_f32 v2, v2, v54, v55
v_mfma_f32_16x16x32_bf16 v[16:19], a[172:175], a[12:15], v[16:19]
v_max3_f32 v2, v2, v60, v61
v_max3_f32 v2, v2, v62, v63
v_mfma_f32_16x16x32_bf16 v[24:27], a[172:175], a[16:19], v[68:71]
v_mfma_f32_16x16x32_bf16 v[24:27], a[168:171], a[4:7], v[24:27]
ds_read_b128 a[196:199], v1 offset:448
v_cmp_lt_f32 vcc, s56, v2
v_mfma_f32_16x16x32_bf16 v[32:35], a[168:171], a[8:11], v[72:75]
v_mfma_f32_16x16x32_bf16 v[32:35], a[172:175], a[20:23], v[32:35]
s_waitcnt lgkmcnt(4)
buffer_load_dwordx4 v7, s[24:27], s83 offen offset:2112 nt lds
v_mfma_f32_16x16x32_bf16 v[16:19], a[176:179], a[24:27], v[16:19]
ds_read_b128 a[200:203], v1 offset:8448
s_cbranch_vccnz L_rare_9
L_ret_9:
v_mfma_f32_16x16x32_bf16 v[16:19], a[180:183], a[36:39], v[16:19]
v_exp_f32 v40, v40
v_mfma_f32_16x16x32_bf16 v[24:27], a[180:183], a[40:43], v[24:27]
v_exp_f32 v41, v41
v_mfma_f32_16x16x32_bf16 v[24:27], a[176:179], a[28:31], v[24:27]
ds_read_b128 a[204:207], v1 offset:8512
v_cvt_pk_bf16_f32 v196, v40, v41
v_mfma_f32_16x16x32_bf16 v[32:35], a[176:179], a[32:35], v[32:35]
v_exp_f32 v42, v42
v_mfma_f32_16x16x32_bf16 v[32:35], a[180:183], a[44:47], v[32:35]
s_waitcnt lgkmcnt(4)
v_exp_f32 v43, v43
v_mfma_f32_16x16x32_bf16 v[16:19], a[184:187], a[48:51], v[16:19]
ds_read_b128 a[208:211], v1 offset:8576
v_cvt_pk_bf16_f32 v197, v42, v43
v_mfma_f32_16x16x32_bf16 v[16:19], a[188:191], a[60:63], v[16:19]
v_exp_f32 v44, v44
v_mfma_f32_16x16x32_bf16 v[24:27], a[188:191], a[64:67], v[24:27]
v_exp_f32 v45, v45
v_mfma_f32_16x16x32_bf16 v[24:27], a[184:187], a[52:55], v[24:27]
ds_read_b128 a[212:215], v1 offset:8640
v_cvt_pk_bf16_f32 v198, v44, v45
v_mfma_f32_16x16x32_bf16 v[32:35], a[184:187], a[56:59], v[32:35]
v_exp_f32 v46, v46
v_mfma_f32_16x16x32_bf16 v[32:35], a[188:191], a[68:71], v[32:35]
s_waitcnt lgkmcnt(4)
v_exp_f32 v47, v47
v_mfma_f32_16x16x32_bf16 v[16:19], a[192:195], a[72:75], v[16:19]
buffer_load_dwordx4 v8, s[24:27], s83 offen offset:3168 nt lds
v_mfma_f32_16x16x32_bf16 v[16:19], a[196:199], a[84:87], v[16:19]
s_add_u32 s83, s82, 245760
ds_read_b128 a[216:219], v1 offset:8704
v_cvt_pk_bf16_f32 v199, v46, v47
v_mfma_f32_16x16x32_bf16 v[24:27], a[196:199], a[88:91], v[24:27]
s_add_u32 m0, s57, 135168
v_exp_f32 v48, v48
v_mfma_f32_16x16x32_bf16 v[24:27], a[192:195], a[76:79], v[24:27]
ds_read_b128 a[220:223], v1 offset:8768
v_mfma_f32_16x16x32_bf16 v[32:35], a[192:195], a[80:83], v[32:35]
v_exp_f32 v49, v49
v_mfma_f32_16x16x32_bf16 v[32:35], a[196:199], a[92:95], v[32:35]
s_waitcnt lgkmcnt(4)
v_exp_f32 v50, v50
v_mfma_f32_16x16x32_bf16 v[20:23], a[200:203], a[0:3], v[64:67]
ds_read_b128 a[224:227], v1 offset:8832
v_cvt_pk_bf16_f32 v200, v48, v49
v_mfma_f32_16x16x32_bf16 v[20:23], a[204:207], a[12:15], v[20:23]
v_exp_f32 v51, v51
v_mfma_f32_16x16x32_bf16 v[28:31], a[204:207], a[16:19], v[68:71]
v_exp_f32 v52, v52
v_mfma_f32_16x16x32_bf16 v[28:31], a[200:203], a[4:7], v[28:31]
ds_read_b128 a[228:231], v1 offset:8896
v_cvt_pk_bf16_f32 v201, v50, v51
v_mfma_f32_16x16x32_bf16 v[36:39], a[200:203], a[8:11], v[72:75]
v_exp_f32 v53, v53
v_mfma_f32_16x16x32_bf16 v[36:39], a[204:207], a[20:23], v[36:39]
s_waitcnt lgkmcnt(4)
v_exp_f32 v54, v54
v_mfma_f32_16x16x32_bf16 v[20:23], a[208:211], a[24:27], v[20:23]
v_exp_f32 v55, v55
v_mfma_f32_16x16x32_bf16 v[20:23], a[212:215], a[36:39], v[20:23]
buffer_load_dwordx4 v5, s[24:27], s83 offen offset:0 nt lds
v_mfma_f32_16x16x32_bf16 v[28:31], a[212:215], a[40:43], v[28:31]
v_exp_f32 v56, v56
v_mfma_f32_16x16x32_bf16 v[28:31], a[208:211], a[28:31], v[28:31]
v_exp_f32 v57, v57
v_mfma_f32_16x16x32_bf16 v[36:39], a[208:211], a[32:35], v[36:39]
v_add_u32 v1, 16896, v1
v_cvt_pk_bf16_f32 v202, v52, v53
v_mfma_f32_16x16x32_bf16 v[36:39], a[212:215], a[44:47], v[36:39]
s_waitcnt lgkmcnt(2)
v_exp_f32 v58, v58
v_mfma_f32_16x16x32_bf16 v[20:23], a[216:219], a[48:51], v[20:23]
v_exp_f32 v59, v59
v_mfma_f32_16x16x32_bf16 v[20:23], a[220:223], a[60:63], v[20:23]
v_exp_f32 v60, v60
v_mfma_f32_16x16x32_bf16 v[28:31], a[220:223], a[64:67], v[28:31]
ds_read_b128 a[168:171], v1 offset:0
v_cvt_pk_bf16_f32 v203, v54, v55
v_mfma_f32_16x16x32_bf16 v[28:31], a[216:219], a[52:55], v[28:31]
ds_read_b128 a[172:175], v1 offset:64
v_cvt_pk_bf16_f32 v204, v56, v57
v_mfma_f32_16x16x32_bf16 v[36:39], a[216:219], a[56:59], v[36:39]
ds_read_b128 a[176:179], v1 offset:128
v_cvt_pk_bf16_f32 v205, v58, v59
v_mfma_f32_16x16x32_bf16 v[36:39], a[220:223], a[68:71], v[36:39]
s_waitcnt lgkmcnt(3)
ds_read_b128 a[180:183], v1 offset:192
v_max3_f32 v2, v16, v17, v18
v_mfma_f32_16x16x32_bf16 v[20:23], a[224:227], a[72:75], v[20:23]
v_exp_f32 v61, v61
v_mfma_f32_16x16x32_bf16 v[20:23], a[228:231], a[84:87], v[20:23]
v_exp_f32 v62, v62
v_mfma_f32_16x16x32_bf16 v[28:31], a[228:231], a[88:91], v[28:31]
v_exp_f32 v63, v63
v_mfma_f32_16x16x32_bf16 v[28:31], a[224:227], a[76:79], v[28:31]
v_cvt_pk_bf16_f32 v206, v60, v61
v_cvt_pk_bf16_f32 v207, v62, v63
v_mfma_f32_16x16x32_bf16 v[36:39], a[224:227], a[80:83], v[36:39]
v_max3_f32 v2, v2, v19, v24
v_max3_f32 v2, v2, v25, v26
v_mfma_f32_16x16x32_bf16 v[36:39], a[228:231], a[92:95], v[36:39]
v_max3_f32 v2, v2, v27, v32
v_max3_f32 v2, v2, v33, v34
v_max_f32 v2, v2, v35
v_mfma_f32_16x16x32_bf16 a[232:235], a[244:247], v[196:199], a[232:235]
s_add_u32 s83, s82, 245760
ds_read_b128 a[184:187], v1 offset:256
v_max3_f32 v2, v2, v20, v21
v_mfma_f32_16x16x32_bf16 a[236:239], a[244:247], v[200:203], a[236:239]
s_add_u32 m0, s57, 135168
ds_read_b128 a[188:191], v1 offset:320
v_max3_f32 v2, v2, v22, v23
v_mfma_f32_16x16x32_bf16 a[240:243], a[244:247], v[204:207], a[240:243]
s_waitcnt lgkmcnt(4)
v_max3_f32 v2, v2, v28, v29
v_max3_f32 v2, v2, v30, v31
v_mfma_f32_16x16x32_bf16 v[40:43], a[168:171], a[0:3], v[64:67]
ds_read_b128 a[192:195], v1 offset:384
v_mfma_f32_16x16x32_bf16 v[40:43], a[172:175], a[12:15], v[40:43]
v_max3_f32 v2, v2, v36, v37
v_max3_f32 v2, v2, v38, v39
v_mfma_f32_16x16x32_bf16 v[48:51], a[172:175], a[16:19], v[68:71]
v_mfma_f32_16x16x32_bf16 v[48:51], a[168:171], a[4:7], v[48:51]
ds_read_b128 a[196:199], v1 offset:448
v_cmp_lt_f32 vcc, s56, v2
v_mfma_f32_16x16x32_bf16 v[56:59], a[168:171], a[8:11], v[72:75]
v_mfma_f32_16x16x32_bf16 v[56:59], a[172:175], a[20:23], v[56:59]
s_waitcnt lgkmcnt(4)
buffer_load_dwordx4 v6, s[24:27], s83 offen offset:1056 nt lds
v_mfma_f32_16x16x32_bf16 v[40:43], a[176:179], a[24:27], v[40:43]
ds_read_b128 a[200:203], v1 offset:8448
s_cbranch_vccnz L_rare_10
L_ret_10:
v_mfma_f32_16x16x32_bf16 v[40:43], a[180:183], a[36:39], v[40:43]
v_exp_f32 v16, v16
v_mfma_f32_16x16x32_bf16 v[48:51], a[180:183], a[40:43], v[48:51]
v_exp_f32 v17, v17
v_mfma_f32_16x16x32_bf16 v[48:51], a[176:179], a[28:31], v[48:51]
ds_read_b128 a[204:207], v1 offset:8512
v_cvt_pk_bf16_f32 v208, v16, v17
v_mfma_f32_16x16x32_bf16 v[56:59], a[176:179], a[32:35], v[56:59]
v_exp_f32 v18, v18
v_mfma_f32_16x16x32_bf16 v[56:59], a[180:183], a[44:47], v[56:59]
s_waitcnt lgkmcnt(4)
v_exp_f32 v19, v19
v_mfma_f32_16x16x32_bf16 v[40:43], a[184:187], a[48:51], v[40:43]
ds_read_b128 a[208:211], v1 offset:8576
v_cvt_pk_bf16_f32 v209, v18, v19
v_mfma_f32_16x16x32_bf16 v[40:43], a[188:191], a[60:63], v[40:43]
v_exp_f32 v20, v20
v_mfma_f32_16x16x32_bf16 v[48:51], a[188:191], a[64:67], v[48:51]
v_exp_f32 v21, v21
v_mfma_f32_16x16x32_bf16 v[48:51], a[184:187], a[52:55], v[48:51]
ds_read_b128 a[212:215], v1 offset:8640
v_cvt_pk_bf16_f32 v210, v20, v21
v_mfma_f32_16x16x32_bf16 v[56:59], a[184:187], a[56:59], v[56:59]
v_exp_f32 v22, v22
v_mfma_f32_16x16x32_bf16 v[56:59], a[188:191], a[68:71], v[56:59]
s_waitcnt lgkmcnt(4)
v_exp_f32 v23, v23
v_mfma_f32_16x16x32_bf16 v[40:43], a[192:195], a[72:75], v[40:43]
buffer_load_dwordx4 v7, s[24:27], s83 offen offset:2112 nt lds
v_mfma_f32_16x16x32_bf16 v[40:43], a[196:199], a[84:87], v[40:43]
ds_read_b128 a[216:219], v1 offset:8704
v_cvt_pk_bf16_f32 v211, v22, v23
v_mfma_f32_16x16x32_bf16 v[48:51], a[196:199], a[88:91], v[48:51]
v_exp_f32 v24, v24
v_mfma_f32_16x16x32_bf16 v[48:51], a[192:195], a[76:79], v[48:51]
ds_read_b128 a[220:223], v1 offset:8768
v_mfma_f32_16x16x32_bf16 v[56:59], a[192:195], a[80:83], v[56:59]
v_exp_f32 v25, v25
v_mfma_f32_16x16x32_bf16 v[56:59], a[196:199], a[92:95], v[56:59]
s_waitcnt lgkmcnt(4)
v_exp_f32 v26, v26
v_mfma_f32_16x16x32_bf16 v[44:47], a[200:203], a[0:3], v[64:67]
ds_read_b128 a[224:227], v1 offset:8832
v_cvt_pk_bf16_f32 v212, v24, v25
v_mfma_f32_16x16x32_bf16 v[44:47], a[204:207], a[12:15], v[44:47]
v_exp_f32 v27, v27
v_mfma_f32_16x16x32_bf16 v[52:55], a[204:207], a[16:19], v[68:71]
v_exp_f32 v28, v28
v_mfma_f32_16x16x32_bf16 v[52:55], a[200:203], a[4:7], v[52:55]
ds_read_b128 a[228:231], v1 offset:8896
v_cvt_pk_bf16_f32 v213, v26, v27
v_mfma_f32_16x16x32_bf16 v[60:63], a[200:203], a[8:11], v[72:75]
v_exp_f32 v29, v29
v_mfma_f32_16x16x32_bf16 v[60:63], a[204:207], a[20:23], v[60:63]
s_waitcnt lgkmcnt(4)
v_exp_f32 v30, v30
v_mfma_f32_16x16x32_bf16 v[44:47], a[208:211], a[24:27], v[44:47]
v_exp_f32 v31, v31
v_mfma_f32_16x16x32_bf16 v[44:47], a[212:215], a[36:39], v[44:47]
buffer_load_dwordx4 v8, s[24:27], s83 offen offset:3168 nt lds
v_mfma_f32_16x16x32_bf16 v[52:55], a[212:215], a[40:43], v[52:55]
v_exp_f32 v32, v32
v_mfma_f32_16x16x32_bf16 v[52:55], a[208:211], a[28:31], v[52:55]
v_exp_f32 v33, v33
v_mfma_f32_16x16x32_bf16 v[60:63], a[208:211], a[32:35], v[60:63]
v_add_u32 v1, 16896, v1
v_cvt_pk_bf16_f32 v214, v28, v29
v_mfma_f32_16x16x32_bf16 v[60:63], a[212:215], a[44:47], v[60:63]
s_waitcnt lgkmcnt(2)
v_exp_f32 v34, v34
v_mfma_f32_16x16x32_bf16 v[44:47], a[216:219], a[48:51], v[44:47]
v_exp_f32 v35, v35
v_mfma_f32_16x16x32_bf16 v[44:47], a[220:223], a[60:63], v[44:47]
v_exp_f32 v36, v36
v_mfma_f32_16x16x32_bf16 v[52:55], a[220:223], a[64:67], v[52:55]
ds_read_b128 a[168:171], v1 offset:0
v_cvt_pk_bf16_f32 v215, v30, v31
v_mfma_f32_16x16x32_bf16 v[52:55], a[216:219], a[52:55], v[52:55]
ds_read_b128 a[172:175], v1 offset:64
v_cvt_pk_bf16_f32 v216, v32, v33
v_mfma_f32_16x16x32_bf16 v[60:63], a[216:219], a[56:59], v[60:63]
ds_read_b128 a[176:179], v1 offset:128
v_cvt_pk_bf16_f32 v217, v34, v35
v_mfma_f32_16x16x32_bf16 v[60:63], a[220:223], a[68:71], v[60:63]
s_waitcnt lgkmcnt(3)
ds_read_b128 a[180:183], v1 offset:192
v_max3_f32 v2, v40, v41, v42
v_mfma_f32_16x16x32_bf16 v[44:47], a[224:227], a[72:75], v[44:47]
v_exp_f32 v37, v37
v_mfma_f32_16x16x32_bf16 v[44:47], a[228:231], a[84:87], v[44:47]
v_exp_f32 v38, v38
v_mfma_f32_16x16x32_bf16 v[52:55], a[228:231], a[88:91], v[52:55]
v_exp_f32 v39, v39
v_mfma_f32_16x16x32_bf16 v[52:55], a[224:227], a[76:79], v[52:55]
v_cvt_pk_bf16_f32 v218, v36, v37
v_cvt_pk_bf16_f32 v219, v38, v39
v_mfma_f32_16x16x32_bf16 v[60:63], a[224:227], a[80:83], v[60:63]
v_max3_f32 v2, v2, v43, v48
v_max3_f32 v2, v2, v49, v50
v_mfma_f32_16x16x32_bf16 v[60:63], a[228:231], a[92:95], v[60:63]
v_max3_f32 v2, v2, v51, v56
v_max3_f32 v2, v2, v57, v58
v_max_f32 v2, v2, v59
v_mfma_f32_16x16x32_bf16 a[232:235], a[244:247], v[208:211], a[232:235]
s_waitcnt vmcnt(4)
s_barrier
ds_read_b128 a[184:187], v1 offset:256
v_mfma_f32_16x16x32_bf16 a[236:239], a[244:247], v[212:215], a[236:239]
s_add_u32 s70, s68, 512
ds_read_b128 a[188:191], v1 offset:320
v_max3_f32 v2, v2, v44, v45
v_mfma_f32_16x16x32_bf16 a[240:243], a[244:247], v[216:219], a[240:243]
s_waitcnt lgkmcnt(4)
v_max3_f32 v2, v2, v46, v47
v_max3_f32 v2, v2, v52, v53
v_mfma_f32_16x16x32_bf16 v[16:19], a[168:171], a[0:3], v[64:67]
s_add_u32 s71, s68, 0
ds_read_b128 a[192:195], v1 offset:384
v_max3_f32 v2, v2, v54, v55
v_mfma_f32_16x16x32_bf16 v[16:19], a[172:175], a[12:15], v[16:19]
s_add_u32 s72, s68, 6656
s_add_u32 s73, s68, 6144
s_add_u32 m0, s58, 0
v_mfma_f32_16x16x32_bf16 v[24:27], a[172:175], a[16:19], v[68:71]
v_max3_f32 v2, v2, v60, v61
v_max3_f32 v2, v2, v62, v63
v_mfma_f32_16x16x32_bf16 v[24:27], a[168:171], a[4:7], v[24:27]
ds_read_b128 a[196:199], v1 offset:448
v_cmp_lt_f32 vcc, s56, v2
v_mfma_f32_16x16x32_bf16 v[32:35], a[168:171], a[8:11], v[72:75]
v_mfma_f32_16x16x32_bf16 v[32:35], a[172:175], a[20:23], v[32:35]
s_waitcnt lgkmcnt(4)
buffer_load_dwordx4 v3, s[28:31], s70 offen offset:0 nt lds
v_mfma_f32_16x16x32_bf16 v[16:19], a[176:179], a[24:27], v[16:19]
ds_read_b128 a[200:203], v1 offset:8448
s_cbranch_vccnz L_rare_11
L_ret_11:
v_mfma_f32_16x16x32_bf16 v[16:19], a[180:183], a[36:39], v[16:19]
v_exp_f32 v40, v40
v_mfma_f32_16x16x32_bf16 v[24:27], a[180:183], a[40:43], v[24:27]
v_exp_f32 v41, v41
v_mfma_f32_16x16x32_bf16 v[24:27], a[176:179], a[28:31], v[24:27]
ds_read_b128 a[204:207], v1 offset:8512
v_cvt_pk_bf16_f32 v220, v40, v41
v_mfma_f32_16x16x32_bf16 v[32:35], a[176:179], a[32:35], v[32:35]
v_exp_f32 v42, v42
v_mfma_f32_16x16x32_bf16 v[32:35], a[180:183], a[44:47], v[32:35]
s_waitcnt lgkmcnt(4)
v_exp_f32 v43, v43
v_mfma_f32_16x16x32_bf16 v[16:19], a[184:187], a[48:51], v[16:19]
ds_read_b128 a[208:211], v1 offset:8576
v_cvt_pk_bf16_f32 v221, v42, v43
v_mfma_f32_16x16x32_bf16 v[16:19], a[188:191], a[60:63], v[16:19]
v_exp_f32 v44, v44
v_mfma_f32_16x16x32_bf16 v[24:27], a[188:191], a[64:67], v[24:27]
v_exp_f32 v45, v45
v_mfma_f32_16x16x32_bf16 v[24:27], a[184:187], a[52:55], v[24:27]
ds_read_b128 a[212:215], v1 offset:8640
v_cvt_pk_bf16_f32 v222, v44, v45
v_mfma_f32_16x16x32_bf16 v[32:35], a[184:187], a[56:59], v[32:35]
v_exp_f32 v46, v46
v_mfma_f32_16x16x32_bf16 v[32:35], a[188:191], a[68:71], v[32:35]
s_waitcnt lgkmcnt(4)
v_exp_f32 v47, v47
v_mfma_f32_16x16x32_bf16 v[16:19], a[192:195], a[72:75], v[16:19]
buffer_load_dwordx4 v3, s[28:31], s71 offen offset:1024 nt lds
v_mfma_f32_16x16x32_bf16 v[16:19], a[196:199], a[84:87], v[16:19]
ds_read_b128 a[216:219], v1 offset:8704
v_cvt_pk_bf16_f32 v223, v46, v47
v_mfma_f32_16x16x32_bf16 v[24:27], a[196:199], a[88:91], v[24:27]
v_exp_f32 v48, v48
v_mfma_f32_16x16x32_bf16 v[24:27], a[192:195], a[76:79], v[24:27]
ds_read_b128 a[220:223], v1 offset:8768
v_mfma_f32_16x16x32_bf16 v[32:35], a[192:195], a[80:83], v[32:35]
v_exp_f32 v49, v49
v_mfma_f32_16x16x32_bf16 v[32:35], a[196:199], a[92:95], v[32:35]
s_waitcnt lgkmcnt(4)
v_exp_f32 v50, v50
v_mfma_f32_16x16x32_bf16 v[20:23], a[200:203], a[0:3], v[64:67]
ds_read_b128 a[224:227], v1 offset:8832
v_cvt_pk_bf16_f32 v224, v48, v49
v_mfma_f32_16x16x32_bf16 v[20:23], a[204:207], a[12:15], v[20:23]
v_exp_f32 v51, v51
v_mfma_f32_16x16x32_bf16 v[28:31], a[204:207], a[16:19], v[68:71]
v_exp_f32 v52, v52
v_mfma_f32_16x16x32_bf16 v[28:31], a[200:203], a[4:7], v[28:31]
ds_read_b128 a[228:231], v1 offset:8896
v_cvt_pk_bf16_f32 v225, v50, v51
v_mfma_f32_16x16x32_bf16 v[36:39], a[200:203], a[8:11], v[72:75]
v_exp_f32 v53, v53
v_mfma_f32_16x16x32_bf16 v[36:39], a[204:207], a[20:23], v[36:39]
s_waitcnt lgkmcnt(4)
v_exp_f32 v54, v54
v_mfma_f32_16x16x32_bf16 v[20:23], a[208:211], a[24:27], v[20:23]
v_exp_f32 v55, v55
v_mfma_f32_16x16x32_bf16 v[20:23], a[212:215], a[36:39], v[20:23]
buffer_load_dwordx4 v3, s[28:31], s72 offen offset:2048 nt lds
v_mfma_f32_16x16x32_bf16 v[28:31], a[212:215], a[40:43], v[28:31]
v_exp_f32 v56, v56
v_mfma_f32_16x16x32_bf16 v[28:31], a[208:211], a[28:31], v[28:31]
v_exp_f32 v57, v57
v_mfma_f32_16x16x32_bf16 v[36:39], a[208:211], a[32:35], v[36:39]
v_add_u32 v1, 16896, v1
v_cvt_pk_bf16_f32 v226, v52, v53
v_mfma_f32_16x16x32_bf16 v[36:39], a[212:215], a[44:47], v[36:39]
s_waitcnt lgkmcnt(2)
v_exp_f32 v58, v58
v_mfma_f32_16x16x32_bf16 v[20:23], a[216:219], a[48:51], v[20:23]
v_exp_f32 v59, v59
v_mfma_f32_16x16x32_bf16 v[20:23], a[220:223], a[60:63], v[20:23]
v_exp_f32 v60, v60
v_mfma_f32_16x16x32_bf16 v[28:31], a[220:223], a[64:67], v[28:31]
ds_read_b128 a[168:171], v1 offset:0
v_cvt_pk_bf16_f32 v227, v54, v55
v_mfma_f32_16x16x32_bf16 v[28:31], a[216:219], a[52:55], v[28:31]
ds_read_b128 a[172:175], v1 offset:64
v_cvt_pk_bf16_f32 v228, v56, v57
v_mfma_f32_16x16x32_bf16 v[36:39], a[216:219], a[56:59], v[36:39]
ds_read_b128 a[176:179], v1 offset:128
v_cvt_pk_bf16_f32 v229, v58, v59
v_mfma_f32_16x16x32_bf16 v[36:39], a[220:223], a[68:71], v[36:39]
s_waitcnt lgkmcnt(3)
ds_read_b128 a[180:183], v1 offset:192
v_max3_f32 v2, v16, v17, v18
v_mfma_f32_16x16x32_bf16 v[20:23], a[224:227], a[72:75], v[20:23]
v_exp_f32 v61, v61
v_mfma_f32_16x16x32_bf16 v[20:23], a[228:231], a[84:87], v[20:23]
v_exp_f32 v62, v62
v_mfma_f32_16x16x32_bf16 v[28:31], a[228:231], a[88:91], v[28:31]
v_exp_f32 v63, v63
v_mfma_f32_16x16x32_bf16 v[28:31], a[224:227], a[76:79], v[28:31]
v_cvt_pk_bf16_f32 v230, v60, v61
v_cvt_pk_bf16_f32 v231, v62, v63
v_mfma_f32_16x16x32_bf16 v[36:39], a[224:227], a[80:83], v[36:39]
v_max3_f32 v2, v2, v19, v24
v_max3_f32 v2, v2, v25, v26
v_mfma_f32_16x16x32_bf16 v[36:39], a[228:231], a[92:95], v[36:39]
v_max3_f32 v2, v2, v27, v32
v_max3_f32 v2, v2, v33, v34
v_max_f32 v2, v2, v35
v_mfma_f32_16x16x32_bf16 a[232:235], a[244:247], v[220:223], a[232:235]
s_add_u32 m0, s58, 0
ds_read_b128 a[184:187], v1 offset:256
v_max3_f32 v2, v2, v20, v21
v_mfma_f32_16x16x32_bf16 a[236:239], a[244:247], v[224:227], a[236:239]
ds_read_b128 a[188:191], v1 offset:320
v_max3_f32 v2, v2, v22, v23
v_mfma_f32_16x16x32_bf16 a[240:243], a[244:247], v[228:231], a[240:243]
s_waitcnt lgkmcnt(4)
v_max3_f32 v2, v2, v28, v29
v_max3_f32 v2, v2, v30, v31
v_mfma_f32_16x16x32_bf16 v[40:43], a[168:171], a[0:3], v[64:67]
ds_read_b128 a[192:195], v1 offset:384
v_mfma_f32_16x16x32_bf16 v[40:43], a[172:175], a[12:15], v[40:43]
v_max3_f32 v2, v2, v36, v37
v_max3_f32 v2, v2, v38, v39
v_mfma_f32_16x16x32_bf16 v[48:51], a[172:175], a[16:19], v[68:71]
v_mfma_f32_16x16x32_bf16 v[48:51], a[168:171], a[4:7], v[48:51]
ds_read_b128 a[196:199], v1 offset:448
v_cmp_lt_f32 vcc, s56, v2
v_mfma_f32_16x16x32_bf16 v[56:59], a[168:171], a[8:11], v[72:75]
v_mfma_f32_16x16x32_bf16 v[56:59], a[172:175], a[20:23], v[56:59]
s_waitcnt lgkmcnt(4)
buffer_load_dwordx4 v3, s[28:31], s73 offen offset:3072 nt lds
v_mfma_f32_16x16x32_bf16 v[40:43], a[176:179], a[24:27], v[40:43]
ds_read_b128 a[200:203], v1 offset:8448
s_cbranch_vccnz L_rare_12
L_ret_12:
v_mfma_f32_16x16x32_bf16 v[40:43], a[180:183], a[36:39], v[40:43]
s_add_u32 s70, s68, 66048
v_exp_f32 v16, v16
v_mfma_f32_16x16x32_bf16 v[48:51], a[180:183], a[40:43], v[48:51]
s_add_u32 s71, s68, 65536
v_exp_f32 v17, v17
v_mfma_f32_16x16x32_bf16 v[48:51], a[176:179], a[28:31], v[48:51]
s_add_u32 s72, s68, 72192
ds_read_b128 a[204:207], v1 offset:8512
v_cvt_pk_bf16_f32 v232, v16, v17
v_mfma_f32_16x16x32_bf16 v[56:59], a[176:179], a[32:35], v[56:59]
s_add_u32 s73, s68, 71680
v_exp_f32 v18, v18
v_mfma_f32_16x16x32_bf16 v[56:59], a[180:183], a[44:47], v[56:59]
s_waitcnt lgkmcnt(4)
v_exp_f32 v19, v19
v_mfma_f32_16x16x32_bf16 v[40:43], a[184:187], a[48:51], v[40:43]
s_add_u32 m0, s58, 16384
ds_read_b128 a[208:211], v1 offset:8576
v_cvt_pk_bf16_f32 v233, v18, v19
v_mfma_f32_16x16x32_bf16 v[40:43], a[188:191], a[60:63], v[40:43]
v_exp_f32 v20, v20
v_mfma_f32_16x16x32_bf16 v[48:51], a[188:191], a[64:67], v[48:51]
v_exp_f32 v21, v21
v_mfma_f32_16x16x32_bf16 v[48:51], a[184:187], a[52:55], v[48:51]
ds_read_b128 a[212:215], v1 offset:8640
v_cvt_pk_bf16_f32 v234, v20, v21
v_mfma_f32_16x16x32_bf16 v[56:59], a[184:187], a[56:59], v[56:59]
v_exp_f32 v22, v22
v_mfma_f32_16x16x32_bf16 v[56:59], a[188:191], a[68:71], v[56:59]
s_waitcnt lgkmcnt(4)
v_exp_f32 v23, v23
v_mfma_f32_16x16x32_bf16 v[40:43], a[192:195], a[72:75], v[40:43]
buffer_load_dwordx4 v3, s[28:31], s70 offen offset:0 nt lds
v_mfma_f32_16x16x32_bf16 v[40:43], a[196:199], a[84:87], v[40:43]
ds_read_b128 a[216:219], v1 offset:8704
v_cvt_pk_bf16_f32 v235, v22, v23
v_mfma_f32_16x16x32_bf16 v[48:51], a[196:199], a[88:91], v[48:51]
v_exp_f32 v24, v24
v_mfma_f32_16x16x32_bf16 v[48:51], a[192:195], a[76:79], v[48:51]
ds_read_b128 a[220:223], v1 offset:8768
v_mfma_f32_16x16x32_bf16 v[56:59], a[192:195], a[80:83], v[56:59]
v_exp_f32 v25, v25
v_mfma_f32_16x16x32_bf16 v[56:59], a[196:199], a[92:95], v[56:59]
s_waitcnt lgkmcnt(4)
v_exp_f32 v26, v26
v_mfma_f32_16x16x32_bf16 v[44:47], a[200:203], a[0:3], v[64:67]
ds_read_b128 a[224:227], v1 offset:8832
v_cvt_pk_bf16_f32 v236, v24, v25
v_mfma_f32_16x16x32_bf16 v[44:47], a[204:207], a[12:15], v[44:47]
v_exp_f32 v27, v27
v_mfma_f32_16x16x32_bf16 v[52:55], a[204:207], a[16:19], v[68:71]
v_exp_f32 v28, v28
v_mfma_f32_16x16x32_bf16 v[52:55], a[200:203], a[4:7], v[52:55]
ds_read_b128 a[228:231], v1 offset:8896
v_cvt_pk_bf16_f32 v237, v26, v27
v_mfma_f32_16x16x32_bf16 v[60:63], a[200:203], a[8:11], v[72:75]
v_exp_f32 v29, v29
v_mfma_f32_16x16x32_bf16 v[60:63], a[204:207], a[20:23], v[60:63]
s_waitcnt lgkmcnt(4)
v_exp_f32 v30, v30
v_mfma_f32_16x16x32_bf16 v[44:47], a[208:211], a[24:27], v[44:47]
v_exp_f32 v31, v31
v_mfma_f32_16x16x32_bf16 v[44:47], a[212:215], a[36:39], v[44:47]
buffer_load_dwordx4 v3, s[28:31], s71 offen offset:1024 nt lds
v_mfma_f32_16x16x32_bf16 v[52:55], a[212:215], a[40:43], v[52:55]
v_exp_f32 v32, v32
v_mfma_f32_16x16x32_bf16 v[52:55], a[208:211], a[28:31], v[52:55]
v_exp_f32 v33, v33
v_mfma_f32_16x16x32_bf16 v[60:63], a[208:211], a[32:35], v[60:63]
v_add_u32 v1, 16896, v1
v_cvt_pk_bf16_f32 v238, v28, v29
v_mfma_f32_16x16x32_bf16 v[60:63], a[212:215], a[44:47], v[60:63]
s_waitcnt lgkmcnt(2)
v_exp_f32 v34, v34
v_mfma_f32_16x16x32_bf16 v[44:47], a[216:219], a[48:51], v[44:47]
v_exp_f32 v35, v35
v_mfma_f32_16x16x32_bf16 v[44:47], a[220:223], a[60:63], v[44:47]
v_exp_f32 v36, v36
v_mfma_f32_16x16x32_bf16 v[52:55], a[220:223], a[64:67], v[52:55]
ds_read_b128 a[168:171], v1 offset:0
v_cvt_pk_bf16_f32 v239, v30, v31
v_mfma_f32_16x16x32_bf16 v[52:55], a[216:219], a[52:55], v[52:55]
ds_read_b128 a[172:175], v1 offset:64
v_cvt_pk_bf16_f32 v240, v32, v33
v_mfma_f32_16x16x32_bf16 v[60:63], a[216:219], a[56:59], v[60:63]
ds_read_b128 a[176:179], v1 offset:128
v_cvt_pk_bf16_f32 v241, v34, v35
v_mfma_f32_16x16x32_bf16 v[60:63], a[220:223], a[68:71], v[60:63]
s_waitcnt lgkmcnt(3)
ds_read_b128 a[180:183], v1 offset:192
v_max3_f32 v2, v40, v41, v42
v_mfma_f32_16x16x32_bf16 v[44:47], a[224:227], a[72:75], v[44:47]
v_exp_f32 v37, v37
v_mfma_f32_16x16x32_bf16 v[44:47], a[228:231], a[84:87], v[44:47]
v_exp_f32 v38, v38
v_mfma_f32_16x16x32_bf16 v[52:55], a[228:231], a[88:91], v[52:55]
v_exp_f32 v39, v39
v_mfma_f32_16x16x32_bf16 v[52:55], a[224:227], a[76:79], v[52:55]
v_cvt_pk_bf16_f32 v242, v36, v37
v_cvt_pk_bf16_f32 v243, v38, v39
v_mfma_f32_16x16x32_bf16 v[60:63], a[224:227], a[80:83], v[60:63]
v_max3_f32 v2, v2, v43, v48
v_max3_f32 v2, v2, v49, v50
v_mfma_f32_16x16x32_bf16 v[60:63], a[228:231], a[92:95], v[60:63]
v_max3_f32 v2, v2, v51, v56
v_max3_f32 v2, v2, v57, v58
v_max_f32 v2, v2, v59
v_mfma_f32_16x16x32_bf16 a[232:235], a[244:247], v[232:235], a[232:235]
s_waitcnt vmcnt(6)
s_barrier
ds_read_b128 a[184:187], v1 offset:256
v_mfma_f32_16x16x32_bf16 a[236:239], a[244:247], v[236:239], a[236:239]
s_add_u32 m0, s58, 16384
ds_read_b128 a[188:191], v1 offset:320
v_max3_f32 v2, v2, v44, v45
v_mfma_f32_16x16x32_bf16 a[240:243], a[244:247], v[240:243], a[240:243]
s_waitcnt lgkmcnt(4)
v_max3_f32 v2, v2, v46, v47
v_max3_f32 v2, v2, v52, v53
v_mfma_f32_16x16x32_bf16 v[16:19], a[168:171], a[0:3], v[64:67]
ds_read_b128 a[192:195], v1 offset:384
v_max3_f32 v2, v2, v54, v55
v_mfma_f32_16x16x32_bf16 v[16:19], a[172:175], a[12:15], v[16:19]
v_max3_f32 v2, v2, v60, v61
v_max3_f32 v2, v2, v62, v63
v_mfma_f32_16x16x32_bf16 v[24:27], a[172:175], a[16:19], v[68:71]
v_mfma_f32_16x16x32_bf16 v[24:27], a[168:171], a[4:7], v[24:27]
ds_read_b128 a[196:199], v1 offset:448
v_cmp_lt_f32 vcc, s56, v2
v_mfma_f32_16x16x32_bf16 v[32:35], a[168:171], a[8:11], v[72:75]
v_mfma_f32_16x16x32_bf16 v[32:35], a[172:175], a[20:23], v[32:35]
s_waitcnt lgkmcnt(4)
buffer_load_dwordx4 v3, s[28:31], s72 offen offset:2048 nt lds
v_mfma_f32_16x16x32_bf16 v[16:19], a[176:179], a[24:27], v[16:19]
ds_read_b128 a[200:203], v1 offset:8448
s_cbranch_vccnz L_rare_13
L_ret_13:
v_mfma_f32_16x16x32_bf16 v[16:19], a[180:183], a[36:39], v[16:19]
v_exp_f32 v40, v40
v_mfma_f32_16x16x32_bf16 v[24:27], a[180:183], a[40:43], v[24:27]
v_exp_f32 v41, v41
v_mfma_f32_16x16x32_bf16 v[24:27], a[176:179], a[28:31], v[24:27]
ds_read_b128 a[204:207], v1 offset:8512
v_cvt_pk_bf16_f32 v244, v40, v41
v_mfma_f32_16x16x32_bf16 v[32:35], a[176:179], a[32:35], v[32:35]
s_mul_i32 s78, s3, 21504
v_exp_f32 v42, v42
v_mfma_f32_16x16x32_bf16 v[32:35], a[180:183], a[44:47], v[32:35]
s_waitcnt lgkmcnt(4)
v_exp_f32 v43, v43
v_mfma_f32_16x16x32_bf16 v[16:19], a[184:187], a[48:51], v[16:19]
s_mul_i32 s77, s53, 1024
ds_read_b128 a[208:211], v1 offset:8576
v_cvt_pk_bf16_f32 v245, v42, v43
v_mfma_f32_16x16x32_bf16 v[16:19], a[188:191], a[60:63], v[16:19]
s_add_u32 s82, s78, s77
v_exp_f32 v44, v44
v_mfma_f32_16x16x32_bf16 v[24:27], a[188:191], a[64:67], v[24:27]
s_mul_i32 s77, s53, 86016
v_exp_f32 v45, v45
v_mfma_f32_16x16x32_bf16 v[24:27], a[184:187], a[52:55], v[24:27]
s_add_u32 s78, s78, s77
ds_read_b128 a[212:215], v1 offset:8640
v_cvt_pk_bf16_f32 v246, v44, v45
v_mfma_f32_16x16x32_bf16 v[32:35], a[184:187], a[56:59], v[32:35]
s_mov_b32 s77, s53
v_exp_f32 v46, v46
v_mfma_f32_16x16x32_bf16 v[32:35], a[188:191], a[68:71], v[32:35]
s_waitcnt lgkmcnt(4)
v_exp_f32 v47, v47
v_mfma_f32_16x16x32_bf16 v[16:19], a[192:195], a[72:75], v[16:19]
buffer_load_dwordx4 v3, s[28:31], s73 offen offset:3072 nt lds
v_mfma_f32_16x16x32_bf16 v[16:19], a[196:199], a[84:87], v[16:19]
s_add_u32 s70, s68, 131584
ds_read_b128 a[216:219], v1 offset:8704
v_cvt_pk_bf16_f32 v247, v46, v47
v_mfma_f32_16x16x32_bf16 v[24:27], a[196:199], a[88:91], v[24:27]
s_add_u32 s71, s68, 131072
v_exp_f32 v48, v48
v_mfma_f32_16x16x32_bf16 v[24:27], a[192:195], a[76:79], v[24:27]
s_add_u32 s72, s68, 137728
ds_read_b128 a[220:223], v1 offset:8768
s_add_u32 s73, s68, 137216
v_mfma_f32_16x16x32_bf16 v[32:35], a[192:195], a[80:83], v[32:35]
s_add_u32 m0, s58, 32768
v_exp_f32 v49, v49
v_mfma_f32_16x16x32_bf16 v[32:35], a[196:199], a[92:95], v[32:35]
s_waitcnt lgkmcnt(4)
v_exp_f32 v50, v50
v_mfma_f32_16x16x32_bf16 v[20:23], a[200:203], a[0:3], v[64:67]
s_add_u32 s77, s77, 1
ds_read_b128 a[224:227], v1 offset:8832
v_cvt_pk_bf16_f32 v248, v48, v49
v_mfma_f32_16x16x32_bf16 v[20:23], a[204:207], a[12:15], v[20:23]
s_and_b32 s77, s77, 7
v_exp_f32 v51, v51
v_mfma_f32_16x16x32_bf16 v[28:31], a[204:207], a[16:19], v[68:71]
s_mul_i32 s84, s77, 86016
v_exp_f32 v52, v52
v_mfma_f32_16x16x32_bf16 v[28:31], a[200:203], a[4:7], v[28:31]
s_add_u32 s84, s84, s82
ds_read_b128 a[228:231], v1 offset:8896
v_cvt_pk_bf16_f32 v249, v50, v51
v_mfma_f32_16x16x32_bf16 v[36:39], a[200:203], a[8:11], v[72:75]
s_add_u32 s77, s77, 1
v_exp_f32 v53, v53
v_mfma_f32_16x16x32_bf16 v[36:39], a[204:207], a[20:23], v[36:39]
s_waitcnt lgkmcnt(4)
v_exp_f32 v54, v54
v_mfma_f32_16x16x32_bf16 v[20:23], a[208:211], a[24:27], v[20:23]
s_and_b32 s77, s77, 7
v_exp_f32 v55, v55
v_mfma_f32_16x16x32_bf16 v[20:23], a[212:215], a[36:39], v[20:23]
buffer_load_dwordx4 v3, s[28:31], s70 offen offset:0 nt lds
v_mfma_f32_16x16x32_bf16 v[28:31], a[212:215], a[40:43], v[28:31]
s_mul_i32 s85, s77, 86016
v_exp_f32 v56, v56
v_mfma_f32_16x16x32_bf16 v[28:31], a[208:211], a[28:31], v[28:31]
s_add_u32 s85, s85, s82
v_exp_f32 v57, v57
v_mfma_f32_16x16x32_bf16 v[36:39], a[208:211], a[32:35], v[36:39]
s_add_u32 s77, s77, 1
v_add_u32 v1, 16896, v1
v_cvt_pk_bf16_f32 v250, v52, v53
v_mfma_f32_16x16x32_bf16 v[36:39], a[212:215], a[44:47], v[36:39]
s_waitcnt lgkmcnt(2)
v_exp_f32 v58, v58
v_mfma_f32_16x16x32_bf16 v[20:23], a[216:219], a[48:51], v[20:23]
s_and_b32 s77, s77, 7
v_exp_f32 v59, v59
v_mfma_f32_16x16x32_bf16 v[20:23], a[220:223], a[60:63], v[20:23]
s_mul_i32 s86, s77, 86016
v_exp_f32 v60, v60
v_mfma_f32_16x16x32_bf16 v[28:31], a[220:223], a[64:67], v[28:31]
s_add_u32 s86, s86, s82
ds_read_b128 a[168:171], v1 offset:0
v_cvt_pk_bf16_f32 v251, v54, v55
v_mfma_f32_16x16x32_bf16 v[28:31], a[216:219], a[52:55], v[28:31]
s_add_u32 s77, s77, 1
ds_read_b128 a[172:175], v1 offset:64
v_cvt_pk_bf16_f32 v252, v56, v57
v_mfma_f32_16x16x32_bf16 v[36:39], a[216:219], a[56:59], v[36:39]
s_and_b32 s77, s77, 7
ds_read_b128 a[176:179], v1 offset:128
v_cvt_pk_bf16_f32 v253, v58, v59
v_mfma_f32_16x16x32_bf16 v[36:39], a[220:223], a[68:71], v[36:39]
s_waitcnt lgkmcnt(3)
ds_read_b128 a[180:183], v1 offset:192
v_max3_f32 v2, v16, v17, v18
v_mfma_f32_16x16x32_bf16 v[20:23], a[224:227], a[72:75], v[20:23]
s_mul_i32 s87, s77, 86016
v_exp_f32 v61, v61
v_mfma_f32_16x16x32_bf16 v[20:23], a[228:231], a[84:87], v[20:23]
s_add_u32 s87, s87, s82
v_exp_f32 v62, v62
v_mfma_f32_16x16x32_bf16 v[28:31], a[228:231], a[88:91], v[28:31]
s_add_u32 s77, s77, 1
s_and_b32 s77, s77, 7
s_mul_i32 s88, s77, 86016
v_mfma_f32_16x16x32_bf16 v[28:31], a[224:227], a[76:79], v[28:31]
s_add_u32 s88, s88, s82
v_exp_f32 v63, v63
v_mfma_f32_16x16x32_bf16 v[36:39], a[224:227], a[80:83], v[36:39]
s_add_u32 s77, s77, 1
v_cvt_pk_bf16_f32 v254, v60, v61
v_cvt_pk_bf16_f32 v255, v62, v63
v_mfma_f32_16x16x32_bf16 v[36:39], a[228:231], a[92:95], v[36:39]
s_and_b32 s77, s77, 7
s_mul_i32 s89, s77, 86016
s_add_u32 s89, s89, s82
s_add_u32 s77, s77, 1
s_and_b32 s77, s77, 7
s_mul_i32 s90, s77, 86016
s_add_u32 s90, s90, s82
v_max3_f32 v2, v2, v19, v24
v_max3_f32 v2, v2, v25, v26
v_max3_f32 v2, v2, v27, v32
v_max3_f32 v2, v2, v33, v34
v_max_f32 v2, v2, v35
v_mfma_f32_16x16x32_bf16 a[232:235], a[244:247], v[244:247], a[232:235]
s_add_u32 m0, s58, 32768
ds_read_b128 a[184:187], v1 offset:256
v_max3_f32 v2, v2, v20, v21
v_mfma_f32_16x16x32_bf16 a[236:239], a[244:247], v[248:251], a[236:239]
ds_read_b128 a[188:191], v1 offset:320
v_max3_f32 v2, v2, v22, v23
v_mfma_f32_16x16x32_bf16 a[240:243], a[244:247], v[252:255], a[240:243]
s_waitcnt lgkmcnt(4)
v_max3_f32 v2, v2, v28, v29
v_max3_f32 v2, v2, v30, v31
v_mfma_f32_16x16x32_bf16 v[40:43], a[168:171], a[0:3], v[64:67]
ds_read_b128 a[192:195], v1 offset:384
v_mfma_f32_16x16x32_bf16 v[40:43], a[172:175], a[12:15], v[40:43]
v_max3_f32 v2, v2, v36, v37
v_max3_f32 v2, v2, v38, v39
v_mfma_f32_16x16x32_bf16 v[48:51], a[172:175], a[16:19], v[68:71]
v_mfma_f32_16x16x32_bf16 v[48:51], a[168:171], a[4:7], v[48:51]
ds_read_b128 a[196:199], v1 offset:448
v_cmp_lt_f32 vcc, s56, v2
v_mfma_f32_16x16x32_bf16 v[56:59], a[168:171], a[8:11], v[72:75]
v_mfma_f32_16x16x32_bf16 v[56:59], a[172:175], a[20:23], v[56:59]
s_waitcnt lgkmcnt(4)
buffer_load_dwordx4 v3, s[28:31], s71 offen offset:1024 nt lds
v_mfma_f32_16x16x32_bf16 v[40:43], a[176:179], a[24:27], v[40:43]
ds_read_b128 a[200:203], v1 offset:8448
s_cbranch_vccnz L_rare_14
L_ret_14:
v_mfma_f32_16x16x32_bf16 v[40:43], a[180:183], a[36:39], v[40:43]
v_exp_f32 v16, v16
v_mfma_f32_16x16x32_bf16 v[48:51], a[180:183], a[40:43], v[48:51]
v_exp_f32 v17, v17
v_mfma_f32_16x16x32_bf16 v[48:51], a[176:179], a[28:31], v[48:51]
ds_read_b128 a[204:207], v1 offset:8512
v_cvt_pk_bf16_f32 v16, v16, v17
v_mfma_f32_16x16x32_bf16 v[56:59], a[176:179], a[32:35], v[56:59]
s_lshl_b32 s67, s80, 12
v_exp_f32 v18, v18
v_mfma_f32_16x16x32_bf16 v[56:59], a[180:183], a[44:47], v[56:59]
s_waitcnt lgkmcnt(4)
v_exp_f32 v19, v19
v_mfma_f32_16x16x32_bf16 v[40:43], a[184:187], a[48:51], v[40:43]
ds_read_b128 a[208:211], v1 offset:8576
v_cvt_pk_bf16_f32 v17, v18, v19
v_mfma_f32_16x16x32_bf16 v[40:43], a[188:191], a[60:63], v[40:43]
v_exp_f32 v20, v20
v_mfma_f32_16x16x32_bf16 v[48:51], a[188:191], a[64:67], v[48:51]
v_exp_f32 v21, v21
v_mfma_f32_16x16x32_bf16 v[48:51], a[184:187], a[52:55], v[48:51]
ds_read_b128 a[212:215], v1 offset:8640
v_cvt_pk_bf16_f32 v18, v20, v21
v_mfma_f32_16x16x32_bf16 v[56:59], a[184:187], a[56:59], v[56:59]
v_exp_f32 v22, v22
v_mfma_f32_16x16x32_bf16 v[56:59], a[188:191], a[68:71], v[56:59]
s_waitcnt lgkmcnt(4)
v_exp_f32 v23, v23
v_mfma_f32_16x16x32_bf16 v[40:43], a[192:195], a[72:75], v[40:43]
buffer_load_dwordx4 v3, s[28:31], s72 offen offset:2048 nt lds
v_mfma_f32_16x16x32_bf16 v[40:43], a[196:199], a[84:87], v[40:43]
ds_read_b128 a[216:219], v1 offset:8704
v_cvt_pk_bf16_f32 v19, v22, v23
v_mfma_f32_16x16x32_bf16 v[48:51], a[196:199], a[88:91], v[48:51]
v_exp_f32 v24, v24
v_mfma_f32_16x16x32_bf16 v[48:51], a[192:195], a[76:79], v[48:51]
ds_read_b128 a[220:223], v1 offset:8768
v_subrev_u32 v80, s67, v10
v_mfma_f32_16x16x32_bf16 v[56:59], a[192:195], a[80:83], v[56:59]
v_exp_f32 v25, v25
v_mfma_f32_16x16x32_bf16 v[56:59], a[196:199], a[92:95], v[56:59]
s_waitcnt lgkmcnt(4)
v_exp_f32 v26, v26
v_mfma_f32_16x16x32_bf16 v[44:47], a[200:203], a[0:3], v[64:67]
ds_read_b128 a[224:227], v1 offset:8832
v_cvt_pk_bf16_f32 v24, v24, v25
v_mfma_f32_16x16x32_bf16 v[44:47], a[204:207], a[12:15], v[44:47]
v_exp_f32 v27, v27
v_mfma_f32_16x16x32_bf16 v[52:55], a[204:207], a[16:19], v[68:71]
v_exp_f32 v28, v28
v_mfma_f32_16x16x32_bf16 v[52:55], a[200:203], a[4:7], v[52:55]
ds_read_b128 a[228:231], v1 offset:8896
v_cvt_pk_bf16_f32 v25, v26, v27
v_mfma_f32_16x16x32_bf16 v[60:63], a[200:203], a[8:11], v[72:75]
v_exp_f32 v29, v29
v_mfma_f32_16x16x32_bf16 v[60:63], a[204:207], a[20:23], v[60:63]
s_waitcnt lgkmcnt(4)
v_exp_f32 v30, v30
v_mfma_f32_16x16x32_bf16 v[44:47], a[208:211], a[24:27], v[44:47]
v_exp_f32 v31, v31
v_mfma_f32_16x16x32_bf16 v[44:47], a[212:215], a[36:39], v[44:47]
buffer_load_dwordx4 v3, s[28:31], s73 offen offset:3072 nt lds
v_mfma_f32_16x16x32_bf16 v[52:55], a[212:215], a[40:43], v[52:55]
v_exp_f32 v32, v32
v_mfma_f32_16x16x32_bf16 v[52:55], a[208:211], a[28:31], v[52:55]
v_exp_f32 v33, v33
v_mfma_f32_16x16x32_bf16 v[60:63], a[208:211], a[32:35], v[60:63]
v_exp_f32 v34, v34
v_mfma_f32_16x16x32_bf16 v[60:63], a[212:215], a[44:47], v[60:63]
s_waitcnt lgkmcnt(2)
v_exp_f32 v35, v35
v_mfma_f32_16x16x32_bf16 v[44:47], a[216:219], a[48:51], v[44:47]
v_exp_f32 v36, v36
v_mfma_f32_16x16x32_bf16 v[44:47], a[220:223], a[60:63], v[44:47]
v_exp_f32 v37, v37
v_mfma_f32_16x16x32_bf16 v[52:55], a[220:223], a[64:67], v[52:55]
v_exp_f32 v38, v38
v_mfma_f32_16x16x32_bf16 v[52:55], a[216:219], a[52:55], v[52:55]
v_exp_f32 v39, v39
v_mfma_f32_16x16x32_bf16 v[60:63], a[216:219], a[56:59], v[60:63]
v_cvt_pk_bf16_f32 v26, v28, v29
v_cvt_pk_bf16_f32 v27, v30, v31
v_mfma_f32_16x16x32_bf16 v[60:63], a[220:223], a[68:71], v[60:63]
s_waitcnt lgkmcnt(0)
v_cvt_pk_bf16_f32 v32, v32, v33
v_cvt_pk_bf16_f32 v33, v34, v35
v_mfma_f32_16x16x32_bf16 v[44:47], a[224:227], a[72:75], v[44:47]
v_cvt_pk_bf16_f32 v34, v36, v37
v_cvt_pk_bf16_f32 v35, v38, v39
v_mfma_f32_16x16x32_bf16 v[44:47], a[228:231], a[84:87], v[44:47]
v_max3_f32 v2, v40, v41, v42
v_max3_f32 v2, v2, v43, v48
v_mfma_f32_16x16x32_bf16 v[52:55], a[228:231], a[88:91], v[52:55]
v_max3_f32 v2, v2, v49, v50
v_max3_f32 v2, v2, v51, v56
v_mfma_f32_16x16x32_bf16 v[52:55], a[224:227], a[76:79], v[52:55]
v_max3_f32 v2, v2, v57, v58
v_max_f32 v2, v2, v59
v_mfma_f32_16x16x32_bf16 v[60:63], a[224:227], a[80:83], v[60:63]
v_lshrrev_b32 v81, 5, v0
v_lshlrev_b32 v81, 10, v81
v_mfma_f32_16x16x32_bf16 v[60:63], a[228:231], a[92:95], v[60:63]
v_sub_u32 v10, v80, v81
v_xor_b32 v11, 32, v10
v_xor_b32 v12, 64, v10
v_xor_b32 v13, 0x60, v10
s_lshl_b32 s67, s80, 6
v_xor_b32 v9, s67, v10
v_xor_b32 v15, s67, v11
v_mfma_f32_16x16x32_bf16 a[232:235], a[244:247], v[16:19], a[232:235]
v_mfma_f32_16x16x32_bf16 a[236:239], a[244:247], v[24:27], a[236:239]
v_mfma_f32_16x16x32_bf16 a[240:243], a[244:247], v[32:35], a[240:243]
s_waitcnt vmcnt(24)
v_readfirstlane_b32 s69, v87
s_nop 3
v_max3_f32 v2, v2, v44, v45
v_max3_f32 v2, v2, v46, v47
v_max3_f32 v2, v2, v52, v53
v_max3_f32 v2, v2, v54, v55
v_max3_f32 v2, v2, v60, v61
v_max3_f32 v2, v2, v62, v63
v_cmp_lt_f32 vcc, s56, v2
s_cmp_lt_u32 s69, 8
s_cbranch_scc1 L_clr_wait
L_clr_ok:
s_cbranch_vccnz L_rare_15
L_ret_15:
s_waitcnt vmcnt(8)
s_barrier
ds_read_b64_tr_b16 a[168:169], v10 offset:0
ds_read_b64_tr_b16 a[170:171], v10 offset:2048
ds_read_b64_tr_b16 a[172:173], v10 offset:4096
ds_read_b64_tr_b16 a[174:175], v10 offset:6144
ds_read_b64_tr_b16 a[176:177], v11 offset:0
ds_read_b64_tr_b16 a[178:179], v11 offset:2048
ds_read_b64_tr_b16 a[180:181], v11 offset:4096
ds_read_b64_tr_b16 a[182:183], v11 offset:6144
s_waitcnt lgkmcnt(4)
v_mfma_f32_16x16x32_bf16 v[64:67], a[168:171], v[88:91], 0
s_add_u32 s70, s68, 197120
s_add_u32 s71, s68, 196608
s_add_u32 s72, s68, 203264
s_add_u32 s73, s68, 202752
s_add_u32 m0, s58, 49152
v_mfma_f32_16x16x32_bf16 v[64:67], a[172:175], v[100:103], v[64:67]
buffer_load_dwordx4 v3, s[28:31], s70 offen offset:0 nt lds
v_mfma_f32_16x16x32_bf16 v[68:71], a[172:175], v[104:107], 0
ds_read_b64_tr_b16 a[184:185], v12 offset:0
v_mfma_f32_16x16x32_bf16 v[68:71], a[168:171], v[92:95], v[68:71]
ds_read_b64_tr_b16 a[186:187], v12 offset:2048
v_mfma_f32_16x16x32_bf16 v[72:75], a[168:171], v[96:99], 0
ds_read_b64_tr_b16 a[188:189], v12 offset:4096
v_mfma_f32_16x16x32_bf16 v[72:75], a[172:175], v[108:111], v[72:75]
s_waitcnt lgkmcnt(3)
ds_read_b64_tr_b16 a[190:191], v12 offset:6144
v_mfma_f32_16x16x32_bf16 v[76:79], a[176:179], v[88:91], 0
ds_read_b64_tr_b16 a[192:193], v13 offset:0
v_mfma_f32_16x16x32_bf16 v[76:79], a[180:183], v[100:103], v[76:79]
buffer_load_dwordx4 v3, s[28:31], s71 offen offset:1024 nt lds
v_mfma_f32_16x16x32_bf16 v[80:83], a[180:183], v[104:107], 0
ds_read_b64_tr_b16 a[194:195], v13 offset:2048
v_mfma_f32_16x16x32_bf16 v[80:83], a[176:179], v[92:95], v[80:83]
ds_read_b64_tr_b16 a[196:197], v13 offset:4096
v_mfma_f32_16x16x32_bf16 v[84:87], a[176:179], v[96:99], 0
ds_read_b64_tr_b16 a[198:199], v13 offset:6144
v_mfma_f32_16x16x32_bf16 v[84:87], a[180:183], v[108:111], v[84:87]
s_waitcnt lgkmcnt(4)
ds_read_b64_tr_b16 a[200:201], v10 offset:8192
v_mfma_f32_16x16x32_bf16 v[20:23], a[184:187], v[88:91], 0
ds_read_b64_tr_b16 a[202:203], v10 offset:10240
v_mfma_f32_16x16x32_bf16 v[20:23], a[188:191], v[100:103], v[20:23]
buffer_load_dwordx4 v3, s[28:31], s72 offen offset:2048 nt lds
v_mfma_f32_16x16x32_bf16 v[28:31], a[188:191], v[104:107], 0
ds_read_b64_tr_b16 a[204:205], v10 offset:12288
v_mfma_f32_16x16x32_bf16 v[28:31], a[184:187], v[92:95], v[28:31]
ds_read_b64_tr_b16 a[206:207], v10 offset:14336
v_mfma_f32_16x16x32_bf16 v[36:39], a[184:187], v[96:99], 0
ds_read_b64_tr_b16 a[168:169], v11 offset:8192
v_mfma_f32_16x16x32_bf16 v[36:39], a[188:191], v[108:111], v[36:39]
s_waitcnt lgkmcnt(5)
ds_read_b64_tr_b16 a[170:171], v11 offset:10240
v_mfma_f32_16x16x32_bf16 a[96:99], a[192:195], v[88:91], 0
ds_read_b64_tr_b16 a[172:173], v11 offset:12288
v_mfma_f32_16x16x32_bf16 a[96:99], a[196:199], v[100:103], a[96:99]
buffer_load_dwordx4 v3, s[28:31], s73 offen offset:3072 nt lds
v_mfma_f32_16x16x32_bf16 a[100:103], a[196:199], v[104:107], 0
ds_read_b64_tr_b16 a[174:175], v11 offset:14336
v_mfma_f32_16x16x32_bf16 a[100:103], a[192:195], v[92:95], a[100:103]
ds_read_b64_tr_b16 a[176:177], v12 offset:8192
v_mfma_f32_16x16x32_bf16 a[104:107], a[192:195], v[96:99], 0
ds_read_b64_tr_b16 a[178:179], v12 offset:10240
v_mfma_f32_16x16x32_bf16 a[104:107], a[196:199], v[108:111], a[104:107]
s_waitcnt lgkmcnt(6)
ds_read_b64_tr_b16 a[180:181], v12 offset:12288
v_mfma_f32_16x16x32_bf16 v[64:67], a[200:203], v[112:115], v[64:67]
ds_read_b64_tr_b16 a[182:183], v12 offset:14336
v_mfma_f32_16x16x32_bf16 v[64:67], a[204:207], v[124:127], v[64:67]
ds_read_b64_tr_b16 a[184:185], v13 offset:8192
v_mfma_f32_16x16x32_bf16 v[68:71], a[204:207], v[128:131], v[68:71]
ds_read_b64_tr_b16 a[186:187], v13 offset:10240
v_mfma_f32_16x16x32_bf16 v[68:71], a[200:203], v[116:119], v[68:71]
ds_read_b64_tr_b16 a[188:189], v13 offset:12288
v_mfma_f32_16x16x32_bf16 v[72:75], a[200:203], v[120:123], v[72:75]
ds_read_b64_tr_b16 a[190:191], v13 offset:14336
v_mfma_f32_16x16x32_bf16 v[72:75], a[204:207], v[132:135], v[72:75]
s_waitcnt lgkmcnt(8)
v_exp_f32 v40, v40
v_mfma_f32_16x16x32_bf16 v[76:79], a[168:171], v[112:115], v[76:79]
v_exp_f32 v41, v41
v_mfma_f32_16x16x32_bf16 v[76:79], a[172:175], v[124:127], v[76:79]
v_exp_f32 v42, v42
v_mfma_f32_16x16x32_bf16 v[80:83], a[172:175], v[128:131], v[80:83]
v_exp_f32 v43, v43
v_mfma_f32_16x16x32_bf16 v[80:83], a[168:171], v[116:119], v[80:83]
v_exp_f32 v44, v44
v_mfma_f32_16x16x32_bf16 v[84:87], a[168:171], v[120:123], v[84:87]
v_exp_f32 v45, v45
v_mfma_f32_16x16x32_bf16 v[84:87], a[172:175], v[132:135], v[84:87]
s_waitcnt vmcnt(8) lgkmcnt(0)
s_barrier
ds_read_b64_tr_b16 a[192:193], v10 offset:16384
v_mfma_f32_16x16x32_bf16 v[20:23], a[176:179], v[112:115], v[20:23]
ds_read_b64_tr_b16 a[194:195], v10 offset:18432
v_cvt_pk_bf16_f32 v40, v40, v41
v_mfma_f32_16x16x32_bf16 v[20:23], a[180:183], v[124:127], v[20:23]
ds_read_b64_tr_b16 a[196:197], v10 offset:20480
v_cvt_pk_bf16_f32 v41, v42, v43
v_mfma_f32_16x16x32_bf16 v[28:31], a[180:183], v[128:131], v[28:31]
ds_read_b64_tr_b16 a[198:199], v10 offset:22528
v_cvt_pk_bf16_f32 v42, v44, v45
v_mfma_f32_16x16x32_bf16 v[28:31], a[176:179], v[116:119], v[28:31]
ds_read_b64_tr_b16 a[200:201], v11 offset:16384
v_mfma_f32_16x16x32_bf16 v[36:39], a[176:179], v[120:123], v[36:39]
ds_read_b64_tr_b16 a[202:203], v11 offset:18432
v_mfma_f32_16x16x32_bf16 v[36:39], a[180:183], v[132:135], v[36:39]
s_waitcnt lgkmcnt(6)
ds_read_b64_tr_b16 a[204:205], v11 offset:20480
v_mfma_f32_16x16x32_bf16 a[96:99], a[184:187], v[112:115], a[96:99]
ds_read_b64_tr_b16 a[206:207], v11 offset:22528
v_mfma_f32_16x16x32_bf16 a[96:99], a[188:191], v[124:127], a[96:99]
ds_read_b64_tr_b16 a[168:169], v12 offset:16384
v_mfma_f32_16x16x32_bf16 a[100:103], a[188:191], v[128:131], a[100:103]
s_add_u32 s20, s60, 0
ds_read_b64_tr_b16 a[170:171], v12 offset:18432
s_add_u32 s21, s60, 6144
v_mfma_f32_16x16x32_bf16 a[100:103], a[184:187], v[116:119], a[100:103]
s_add_u32 s22, s60, 12288
ds_read_b64_tr_b16 a[172:173], v12 offset:20480
s_add_u32 s23, s60, 18432
v_mfma_f32_16x16x32_bf16 a[104:107], a[184:187], v[120:123], a[104:107]
s_add_u32 m0, s59, 81920
ds_read_b64_tr_b16 a[174:175], v12 offset:22528
v_mfma_f32_16x16x32_bf16 a[104:107], a[188:191], v[132:135], a[104:107]
s_waitcnt lgkmcnt(8)
ds_read_b64_tr_b16 a[176:177], v13 offset:16384
v_mfma_f32_16x16x32_bf16 v[64:67], a[192:195], v[136:139], v[64:67]
ds_read_b64_tr_b16 a[178:179], v13 offset:18432
v_mfma_f32_16x16x32_bf16 v[64:67], a[196:199], v[148:151], v[64:67]
ds_read_b64_tr_b16 a[180:181], v13 offset:20480
v_mfma_f32_16x16x32_bf16 v[68:71], a[196:199], v[152:155], v[68:71]
ds_read_b64_tr_b16 a[182:183], v13 offset:22528
v_mfma_f32_16x16x32_bf16 v[68:71], a[192:195], v[140:143], v[68:71]
ds_read_b64_tr_b16 a[184:185], v10 offset:24576
v_mfma_f32_16x16x32_bf16 v[72:75], a[192:195], v[144:147], v[72:75]
ds_read_b64_tr_b16 a[186:187], v10 offset:26624
v_mfma_f32_16x16x32_bf16 v[72:75], a[196:199], v[156:159], v[72:75]
s_waitcnt lgkmcnt(10)
ds_read_b64_tr_b16 a[188:189], v10 offset:28672
v_mfma_f32_16x16x32_bf16 v[76:79], a[200:203], v[136:139], v[76:79]
ds_read_b64_tr_b16 a[190:191], v10 offset:30720
v_mfma_f32_16x16x32_bf16 v[76:79], a[204:207], v[148:151], v[76:79]
ds_read_b64_tr_b16 a[192:193], v11 offset:24576
v_mfma_f32_16x16x32_bf16 v[80:83], a[204:207], v[152:155], v[80:83]
ds_read_b64_tr_b16 a[194:195], v11 offset:26624
v_mfma_f32_16x16x32_bf16 v[80:83], a[200:203], v[140:143], v[80:83]
ds_read_b64_tr_b16 a[196:197], v11 offset:28672
v_mfma_f32_16x16x32_bf16 v[84:87], a[200:203], v[144:147], v[84:87]
ds_read_b64_tr_b16 a[198:199], v11 offset:30720
v_mfma_f32_16x16x32_bf16 v[84:87], a[204:207], v[156:159], v[84:87]
s_waitcnt lgkmcnt(12)
ds_read_b64_tr_b16 a[200:201], v12 offset:24576
v_mfma_f32_16x16x32_bf16 v[20:23], a[168:171], v[136:139], v[20:23]
ds_read_b64_tr_b16 a[202:203], v12 offset:26624
v_mfma_f32_16x16x32_bf16 v[20:23], a[172:175], v[148:151], v[20:23]
ds_read_b64_tr_b16 a[204:205], v12 offset:28672
v_mfma_f32_16x16x32_bf16 v[28:31], a[172:175], v[152:155], v[28:31]
ds_read_b64_tr_b16 a[206:207], v12 offset:30720
v_mfma_f32_16x16x32_bf16 v[28:31], a[168:171], v[140:143], v[28:31]
v_exp_f32 v46, v46
v_mfma_f32_16x16x32_bf16 v[36:39], a[168:171], v[144:147], v[36:39]
buffer_load_dwordx4 v4, s[36:39], s20 offen offset:0 lds
v_mfma_f32_16x16x32_bf16 v[36:39], a[172:175], v[156:159], v[36:39]
s_waitcnt lgkmcnt(12)
ds_read_b64_tr_b16 a[168:169], v13 offset:24576
v_mfma_f32_16x16x32_bf16 a[96:99], a[176:179], v[136:139], a[96:99]
ds_read_b64_tr_b16 a[170:171], v13 offset:26624
v_mfma_f32_16x16x32_bf16 a[96:99], a[180:183], v[148:151], a[96:99]
ds_read_b64_tr_b16 a[172:173], v13 offset:28672
v_mfma_f32_16x16x32_bf16 a[100:103], a[180:183], v[152:155], a[100:103]
buffer_load_dwordx4 v4, s[36:39], s21 offen offset:1024 lds
v_mfma_f32_16x16x32_bf16 a[100:103], a[176:179], v[140:143], a[100:103]
ds_read_b64_tr_b16 a[174:175], v13 offset:30720
v_mfma_f32_16x16x32_bf16 a[104:107], a[176:179], v[144:147], a[104:107]
v_exp_f32 v47, v47
v_mfma_f32_16x16x32_bf16 a[104:107], a[180:183], v[156:159], a[104:107]
s_waitcnt lgkmcnt(12)
v_exp_f32 v48, v48
v_mfma_f32_16x16x32_bf16 v[64:67], a[184:187], v[160:163], v[64:67]
buffer_load_dwordx4 v4, s[36:39], s22 offen offset:2048 lds
v_mfma_f32_16x16x32_bf16 v[64:67], a[188:191], v[172:175], v[64:67]
v_exp_f32 v49, v49
v_mfma_f32_16x16x32_bf16 v[68:71], a[188:191], v[176:179], v[68:71]
v_exp_f32 v50, v50
v_mfma_f32_16x16x32_bf16 v[68:71], a[184:187], v[164:167], v[68:71]
v_exp_f32 v51, v51
v_mfma_f32_16x16x32_bf16 v[72:75], a[184:187], v[168:171], v[72:75]
buffer_load_dwordx4 v4, s[36:39], s23 offen offset:3072 lds
v_mfma_f32_16x16x32_bf16 v[72:75], a[188:191], v[180:183], v[72:75]
s_waitcnt lgkmcnt(8)
s_add_u32 s70, s68, 640
s_add_u32 s71, s68, 128
v_mfma_f32_16x16x32_bf16 v[76:79], a[192:195], v[160:163], v[76:79]
s_add_u32 s72, s68, 6784
s_add_u32 s73, s68, 6272
s_add_u32 m0, s58, 65536
v_mfma_f32_16x16x32_bf16 v[76:79], a[196:199], v[172:175], v[76:79]
buffer_load_dwordx4 v3, s[28:31], s70 offen offset:0 nt lds
v_mfma_f32_16x16x32_bf16 v[80:83], a[196:199], v[176:179], v[80:83]
v_exp_f32 v52, v52
v_mfma_f32_16x16x32_bf16 v[80:83], a[192:195], v[164:167], v[80:83]
v_exp_f32 v53, v53
v_mfma_f32_16x16x32_bf16 v[84:87], a[192:195], v[168:171], v[84:87]
v_exp_f32 v54, v54
v_mfma_f32_16x16x32_bf16 v[84:87], a[196:199], v[180:183], v[84:87]
s_waitcnt vmcnt(9) lgkmcnt(0)
s_barrier
ds_read_b64_tr_b16 a[176:177], v10 offset:32768
v_mfma_f32_16x16x32_bf16 v[20:23], a[200:203], v[160:163], v[20:23]
ds_read_b64_tr_b16 a[178:179], v10 offset:34816
v_cvt_pk_bf16_f32 v43, v46, v47
v_mfma_f32_16x16x32_bf16 v[20:23], a[204:207], v[172:175], v[20:23]
buffer_load_dwordx4 v3, s[28:31], s71 offen offset:1024 nt lds
v_mfma_f32_16x16x32_bf16 v[28:31], a[204:207], v[176:179], v[28:31]
ds_read_b64_tr_b16 a[180:181], v10 offset:36864
v_cvt_pk_bf16_f32 v48, v48, v49
v_mfma_f32_16x16x32_bf16 v[28:31], a[200:203], v[164:167], v[28:31]
ds_read_b64_tr_b16 a[182:183], v10 offset:38912
v_cvt_pk_bf16_f32 v49, v50, v51
v_mfma_f32_16x16x32_bf16 v[36:39], a[200:203], v[168:171], v[36:39]
ds_read_b64_tr_b16 a[184:185], v11 offset:32768
v_cvt_pk_bf16_f32 v50, v52, v53
v_mfma_f32_16x16x32_bf16 v[36:39], a[204:207], v[180:183], v[36:39]
s_waitcnt lgkmcnt(5)
ds_read_b64_tr_b16 a[186:187], v11 offset:34816
v_mfma_f32_16x16x32_bf16 a[96:99], a[168:171], v[160:163], a[96:99]
ds_read_b64_tr_b16 a[188:189], v11 offset:36864
v_mfma_f32_16x16x32_bf16 a[96:99], a[172:175], v[172:175], a[96:99]
buffer_load_dwordx4 v3, s[28:31], s72 offen offset:2048 nt lds
v_mfma_f32_16x16x32_bf16 a[100:103], a[172:175], v[176:179], a[100:103]
ds_read_b64_tr_b16 a[190:191], v11 offset:38912
v_mfma_f32_16x16x32_bf16 a[100:103], a[168:171], v[164:167], a[100:103]
ds_read_b64_tr_b16 a[192:193], v12 offset:32768
v_mfma_f32_16x16x32_bf16 a[104:107], a[168:171], v[168:171], a[104:107]
ds_read_b64_tr_b16 a[194:195], v12 offset:34816
v_mfma_f32_16x16x32_bf16 a[104:107], a[172:175], v[180:183], a[104:107]
s_waitcnt lgkmcnt(6)
ds_read_b64_tr_b16 a[196:197], v12 offset:36864
v_mfma_f32_16x16x32_bf16 v[64:67], a[176:179], v[184:187], v[64:67]
ds_read_b64_tr_b16 a[198:199], v12 offset:38912
v_mfma_f32_16x16x32_bf16 v[64:67], a[180:183], v[196:199], v[64:67]
buffer_load_dwordx4 v3, s[28:31], s73 offen offset:3072 nt lds
v_mfma_f32_16x16x32_bf16 v[68:71], a[180:183], v[200:203], v[68:71]
ds_read_b64_tr_b16 a[200:201], v13 offset:32768
v_mfma_f32_16x16x32_bf16 v[68:71], a[176:179], v[188:191], v[68:71]
ds_read_b64_tr_b16 a[202:203], v13 offset:34816
v_mfma_f32_16x16x32_bf16 v[72:75], a[176:179], v[192:195], v[72:75]
ds_read_b64_tr_b16 a[204:205], v13 offset:36864
v_mfma_f32_16x16x32_bf16 v[72:75], a[180:183], v[204:207], v[72:75]
s_waitcnt lgkmcnt(7)
ds_read_b64_tr_b16 a[206:207], v13 offset:38912
v_mfma_f32_16x16x32_bf16 v[76:79], a[184:187], v[184:187], v[76:79]
ds_read_b64_tr_b16 a[168:169], v10 offset:40960
v_mfma_f32_16x16x32_bf16 v[76:79], a[188:191], v[196:199], v[76:79]
ds_read_b64_tr_b16 a[170:171], v10 offset:43008
v_mfma_f32_16x16x32_bf16 v[80:83], a[188:191], v[200:203], v[80:83]
s_mul_i32 s67, s81, 12288
ds_read_b64_tr_b16 a[172:173], v10 offset:45056
s_add_u32 s67, s67, 131072
v_mfma_f32_16x16x32_bf16 v[80:83], a[184:187], v[188:191], v[80:83]
ds_read_b64_tr_b16 a[174:175], v10 offset:47104
v_add_u32 v2, s67, v14
v_mfma_f32_16x16x32_bf16 v[84:87], a[184:187], v[192:195], v[84:87]
s_mul_i32 s67, s80, 6144
ds_read_b64_tr_b16 a[176:177], v11 offset:40960
v_add_u32 v1, s67, v2
v_mfma_f32_16x16x32_bf16 v[84:87], a[188:191], v[204:207], v[84:87]
s_waitcnt lgkmcnt(9)
ds_read_b64_tr_b16 a[178:179], v11 offset:43008
v_mfma_f32_16x16x32_bf16 v[20:23], a[192:195], v[184:187], v[20:23]
ds_read_b64_tr_b16 a[180:181], v11 offset:45056
v_mfma_f32_16x16x32_bf16 v[20:23], a[196:199], v[196:199], v[20:23]
ds_read_b64_tr_b16 a[182:183], v11 offset:47104
v_mfma_f32_16x16x32_bf16 v[28:31], a[196:199], v[200:203], v[28:31]
ds_read_b64_tr_b16 a[184:185], v12 offset:40960
v_mfma_f32_16x16x32_bf16 v[28:31], a[192:195], v[188:191], v[28:31]
ds_read_b64_tr_b16 a[186:187], v12 offset:43008
v_mfma_f32_16x16x32_bf16 v[36:39], a[192:195], v[192:195], v[36:39]
ds_read_b64_tr_b16 a[188:189], v12 offset:45056
v_mfma_f32_16x16x32_bf16 v[36:39], a[196:199], v[204:207], v[36:39]
s_waitcnt lgkmcnt(11)
ds_read_b64_tr_b16 a[190:191], v12 offset:47104
v_mfma_f32_16x16x32_bf16 a[96:99], a[200:203], v[184:187], a[96:99]
ds_read_b64_tr_b16 a[192:193], v13 offset:40960
v_mfma_f32_16x16x32_bf16 a[96:99], a[204:207], v[196:199], a[96:99]
ds_read_b64_tr_b16 a[194:195], v13 offset:43008
v_mfma_f32_16x16x32_bf16 a[100:103], a[204:207], v[200:203], a[100:103]
ds_read_b64_tr_b16 a[196:197], v13 offset:45056
v_mfma_f32_16x16x32_bf16 a[100:103], a[200:203], v[188:191], a[100:103]
ds_read_b64_tr_b16 a[198:199], v13 offset:47104
v_mfma_f32_16x16x32_bf16 a[104:107], a[200:203], v[192:195], a[104:107]
v_exp_f32 v55, v55
v_mfma_f32_16x16x32_bf16 a[104:107], a[204:207], v[204:207], a[104:107]
s_waitcnt lgkmcnt(12)
v_exp_f32 v56, v56
v_mfma_f32_16x16x32_bf16 v[64:67], a[168:171], v[208:211], v[64:67]
v_exp_f32 v57, v57
v_mfma_f32_16x16x32_bf16 v[64:67], a[172:175], v[220:223], v[64:67]
v_exp_f32 v58, v58
v_mfma_f32_16x16x32_bf16 v[68:71], a[172:175], v[224:227], v[68:71]
v_exp_f32 v59, v59
v_mfma_f32_16x16x32_bf16 v[68:71], a[168:171], v[212:215], v[68:71]
s_add_u32 s20, s61, 0
v_exp_f32 v60, v60
v_mfma_f32_16x16x32_bf16 v[72:75], a[168:171], v[216:219], v[72:75]
s_add_u32 s21, s61, 6144
v_exp_f32 v61, v61
v_mfma_f32_16x16x32_bf16 v[72:75], a[172:175], v[228:231], v[72:75]
s_waitcnt lgkmcnt(8)
v_exp_f32 v62, v62
v_mfma_f32_16x16x32_bf16 v[76:79], a[176:179], v[208:211], v[76:79]
s_add_u32 s22, s61, 12288
v_exp_f32 v63, v63
v_mfma_f32_16x16x32_bf16 v[76:79], a[180:183], v[220:223], v[76:79]
s_add_u32 s23, s61, 18432
v_cvt_pk_bf16_f32 v51, v54, v55
v_cvt_pk_bf16_f32 v56, v56, v57
v_mfma_f32_16x16x32_bf16 v[80:83], a[180:183], v[224:227], v[80:83]
s_add_u32 m0, s59, 114688
v_cvt_pk_bf16_f32 v57, v58, v59
v_cvt_pk_bf16_f32 v58, v60, v61
v_mfma_f32_16x16x32_bf16 v[80:83], a[176:179], v[212:215], v[80:83]
v_cvt_pk_bf16_f32 v59, v62, v63
v_mfma_f32_16x16x32_bf16 v[84:87], a[176:179], v[216:219], v[84:87]
v_mfma_f32_16x16x32_bf16 v[84:87], a[180:183], v[228:231], v[84:87]
s_waitcnt lgkmcnt(4)
v_mfma_f32_16x16x32_bf16 v[20:23], a[184:187], v[208:211], v[20:23]
v_mfma_f32_16x16x32_bf16 v[20:23], a[188:191], v[220:223], v[20:23]
v_mfma_f32_16x16x32_bf16 v[28:31], a[188:191], v[224:227], v[28:31]
s_waitcnt vmcnt(8) lgkmcnt(0)
s_barrier
ds_read_b64_tr_b16 a[200:201], v10 offset:49152
v_mfma_f32_16x16x32_bf16 v[28:31], a[184:187], v[212:215], v[28:31]
ds_read_b64_tr_b16 a[202:203], v10 offset:51200
v_mfma_f32_16x16x32_bf16 v[36:39], a[184:187], v[216:219], v[36:39]
ds_read_b64_tr_b16 a[204:205], v10 offset:53248
v_mfma_f32_16x16x32_bf16 v[36:39], a[188:191], v[228:231], v[36:39]
s_waitcnt lgkmcnt(3)
ds_read_b64_tr_b16 a[206:207], v10 offset:55296
v_mfma_f32_16x16x32_bf16 a[96:99], a[192:195], v[208:211], a[96:99]
ds_read_b64_tr_b16 a[168:169], v10 offset:57344
v_mfma_f32_16x16x32_bf16 a[96:99], a[196:199], v[220:223], a[96:99]
ds_read_b64_tr_b16 a[170:171], v10 offset:59392
v_mfma_f32_16x16x32_bf16 a[100:103], a[196:199], v[224:227], a[100:103]
ds_read_b64_tr_b16 a[172:173], v10 offset:61440
v_mfma_f32_16x16x32_bf16 a[100:103], a[192:195], v[212:215], a[100:103]
ds_read_b64_tr_b16 a[174:175], v10 offset:63488
v_mfma_f32_16x16x32_bf16 a[104:107], a[192:195], v[216:219], a[104:107]
ds_read_b64_tr_b16 a[176:177], v11 offset:49152
v_mfma_f32_16x16x32_bf16 a[104:107], a[196:199], v[228:231], a[104:107]
buffer_load_dwordx4 v4, s[36:39], s20 offen offset:0 lds
v_mfma_f32_16x16x32_bf16 a[232:235], a[244:247], v[40:43], a[232:235]
ds_read_b64_tr_b16 a[178:179], v11 offset:51200
v_mfma_f32_16x16x32_bf16 a[236:239], a[244:247], v[48:51], a[236:239]
ds_read_b64_tr_b16 a[180:181], v11 offset:53248
v_mfma_f32_16x16x32_bf16 a[240:243], a[244:247], v[56:59], a[240:243]
s_waitcnt lgkmcnt(7)
ds_read_b64_tr_b16 a[182:183], v11 offset:55296
v_mfma_f32_16x16x32_bf16 v[64:67], a[200:203], v[232:235], v[64:67]
buffer_load_dwordx4 v4, s[36:39], s21 offen offset:1024 lds
v_mfma_f32_16x16x32_bf16 v[64:67], a[204:207], v[244:247], v[64:67]
ds_read_b64_tr_b16 a[184:185], v11 offset:57344
v_mfma_f32_16x16x32_bf16 v[68:71], a[204:207], v[248:251], v[68:71]
ds_read_b64_tr_b16 a[186:187], v11 offset:59392
v_mfma_f32_16x16x32_bf16 v[68:71], a[200:203], v[236:239], v[68:71]
ds_read_b64_tr_b16 a[188:189], v11 offset:61440
v_mfma_f32_16x16x32_bf16 v[72:75], a[200:203], v[240:243], v[72:75]
buffer_load_dwordx4 v4, s[36:39], s22 offen offset:2048 lds
v_mfma_f32_16x16x32_bf16 v[72:75], a[204:207], v[252:255], v[72:75]
s_waitcnt lgkmcnt(7)
ds_read_b64_tr_b16 a[190:191], v11 offset:63488
v_mfma_f32_16x16x32_bf16 v[64:67], a[168:171], v[16:19], v[64:67]
ds_read_b64_tr_b16 a[192:193], v12 offset:49152
v_accvgpr_read_b32 v5, a232
v_mfma_f32_16x16x32_bf16 v[64:67], a[172:175], v[40:43], v[64:67]
ds_read_b64_tr_b16 a[194:195], v12 offset:51200
v_mfma_f32_16x16x32_bf16 v[68:71], a[172:175], v[48:51], v[68:71]
buffer_load_dwordx4 v4, s[36:39], s23 offen offset:3072 lds
v_mfma_f32_16x16x32_bf16 v[68:71], a[168:171], v[24:27], v[68:71]
s_add_u32 s70, s68, 66176
ds_read_b64_tr_b16 a[196:197], v12 offset:53248
s_add_u32 s71, s68, 65664
v_mfma_f32_16x16x32_bf16 v[72:75], a[168:171], v[32:35], v[72:75]
s_add_u32 s72, s68, 72320
s_add_u32 s73, s68, 71808
s_add_u32 m0, s58, 98304
v_mfma_f32_16x16x32_bf16 v[72:75], a[172:175], v[56:59], v[72:75]
s_waitcnt lgkmcnt(7)
buffer_load_dwordx4 v3, s[28:31], s70 offen offset:0 nt lds
v_mfma_f32_16x16x32_bf16 v[76:79], a[176:179], v[232:235], v[76:79]
ds_read_b64_tr_b16 a[198:199], v12 offset:55296
v_mfma_f32_16x16x32_bf16 v[76:79], a[180:183], v[244:247], v[76:79]
ds_read_b64_tr_b16 a[200:201], v12 offset:57344
v_mfma_f32_16x16x32_bf16 v[80:83], a[180:183], v[248:251], v[80:83]
ds_read_b64_tr_b16 a[202:203], v12 offset:59392
v_mfma_f32_16x16x32_bf16 v[80:83], a[176:179], v[236:239], v[80:83]
ds_read_b64_tr_b16 a[204:205], v12 offset:61440
v_mfma_f32_16x16x32_bf16 v[84:87], a[176:179], v[240:243], v[84:87]
ds_read_b64_tr_b16 a[206:207], v12 offset:63488
v_mfma_f32_16x16x32_bf16 v[84:87], a[180:183], v[252:255], v[84:87]
s_waitcnt lgkmcnt(8)
buffer_load_dwordx4 v3, s[28:31], s71 offen offset:1024 nt lds
v_mfma_f32_16x16x32_bf16 v[76:79], a[184:187], v[16:19], v[76:79]
ds_read_b64_tr_b16 a[168:169], v13 offset:49152
v_mfma_f32_16x16x32_bf16 v[76:79], a[188:191], v[40:43], v[76:79]
ds_read_b64_tr_b16 a[170:171], v13 offset:51200
v_mfma_f32_16x16x32_bf16 v[80:83], a[188:191], v[48:51], v[80:83]
ds_read_b64_tr_b16 a[172:173], v13 offset:53248
v_mfma_f32_16x16x32_bf16 v[80:83], a[184:187], v[24:27], v[80:83]
ds_read_b64_tr_b16 a[174:175], v13 offset:55296
v_mfma_f32_16x16x32_bf16 v[84:87], a[184:187], v[32:35], v[84:87]
ds_read_b64_tr_b16 a[176:177], v13 offset:57344
v_mfma_f32_16x16x32_bf16 v[84:87], a[188:191], v[56:59], v[84:87]
s_waitcnt lgkmcnt(9)
buffer_load_dwordx4 v3, s[28:31], s72 offen offset:2048 nt lds
v_mfma_f32_16x16x32_bf16 v[20:23], a[192:195], v[232:235], v[20:23]
v_rcp_f32 v5, v5
v_accvgpr_read_b32 v6, a236
v_rcp_f32 v6, v6
v_accvgpr_read_b32 v7, a240
v_mfma_f32_16x16x32_bf16 v[20:23], a[196:199], v[244:247], v[20:23]
ds_read_b64_tr_b16 a[178:179], v13 offset:59392
v_mfma_f32_16x16x32_bf16 v[28:31], a[196:199], v[248:251], v[28:31]
v_rcp_f32 v7, v7
v_mfma_f32_16x16x32_bf16 v[28:31], a[192:195], v[236:239], v[28:31]
ds_read_b64_tr_b16 a[180:181], v13 offset:61440
v_mfma_f32_16x16x32_bf16 v[36:39], a[192:195], v[240:243], v[36:39]
ds_read_b64_tr_b16 a[182:183], v13 offset:63488
v_mfma_f32_16x16x32_bf16 v[36:39], a[196:199], v[252:255], v[36:39]
s_waitcnt lgkmcnt(8)
buffer_load_dwordx4 v3, s[28:31], s73 offen offset:3072 nt lds
v_mfma_f32_16x16x32_bf16 v[20:23], a[200:203], v[16:19], v[20:23]
v_add_u32 v10, 0x10000, v10
v_add_u32 v11, 0x10000, v11
v_mfma_f32_16x16x32_bf16 v[20:23], a[204:207], v[40:43], v[20:23]
v_add_u32 v12, 0x10000, v12
v_add_u32 v13, 0x10000, v13
v_mfma_f32_16x16x32_bf16 v[28:31], a[204:207], v[48:51], v[28:31]
v_mul_f32 v64, v64, v5
v_mul_f32 v65, v65, v5
v_mfma_f32_16x16x32_bf16 v[28:31], a[200:203], v[24:27], v[28:31]
v_mul_f32 v66, v66, v5
v_mul_f32 v67, v67, v5
v_mfma_f32_16x16x32_bf16 v[36:39], a[200:203], v[32:35], v[36:39]
v_mul_f32 v76, v76, v5
v_mul_f32 v77, v77, v5
v_mfma_f32_16x16x32_bf16 v[36:39], a[204:207], v[56:59], v[36:39]
s_waitcnt vmcnt(8) lgkmcnt(0)
s_barrier
ds_read_b64_tr_b16 a[184:185], v10 offset:0
v_mfma_f32_16x16x32_bf16 a[96:99], a[168:171], v[232:235], a[96:99]
ds_read_b64_tr_b16 a[186:187], v10 offset:2048
v_mul_f32 v78, v78, v5
v_mfma_f32_16x16x32_bf16 a[96:99], a[172:175], v[244:247], a[96:99]
ds_read_b64_tr_b16 a[188:189], v10 offset:4096
v_mul_f32 v79, v79, v5
v_mfma_f32_16x16x32_bf16 a[100:103], a[172:175], v[248:251], a[100:103]
ds_read_b64_tr_b16 a[190:191], v10 offset:6144
v_cvt_pk_bf16_f32 v64, v64, v65
v_mfma_f32_16x16x32_bf16 a[100:103], a[168:171], v[236:239], a[100:103]
ds_read_b64_tr_b16 a[192:193], v10 offset:8192
v_cvt_pk_bf16_f32 v65, v66, v67
v_mfma_f32_16x16x32_bf16 a[104:107], a[168:171], v[240:243], a[104:107]
ds_read_b64_tr_b16 a[194:195], v10 offset:10240
v_cvt_pk_bf16_f32 v66, v76, v77
v_mfma_f32_16x16x32_bf16 a[104:107], a[172:175], v[252:255], a[104:107]
s_waitcnt lgkmcnt(6)
ds_read_b64_tr_b16 a[196:197], v10 offset:12288
v_cvt_pk_bf16_f32 v67, v78, v79
v_mfma_f32_16x16x32_bf16 a[96:99], a[176:179], v[16:19], a[96:99]
ds_write_b128 v1, v[64:67] offset:0
v_mfma_f32_16x16x32_bf16 a[96:99], a[180:183], v[40:43], a[96:99]
ds_read_b64_tr_b16 a[198:199], v10 offset:14336
v_mul_f32 v68, v68, v6
v_mfma_f32_16x16x32_bf16 a[100:103], a[180:183], v[48:51], a[100:103]
ds_read_b64_tr_b16 a[200:201], v11 offset:0
v_mul_f32 v69, v69, v6
v_mfma_f32_16x16x32_bf16 a[100:103], a[176:179], v[24:27], a[100:103]
v_mul_f32 v70, v70, v6
v_mul_f32 v71, v71, v6
v_mul_f32 v80, v80, v6
v_mul_f32 v81, v81, v6
v_mul_f32 v82, v82, v6
v_mul_f32 v83, v83, v6
v_cvt_pk_bf16_f32 v68, v68, v69
v_cvt_pk_bf16_f32 v69, v70, v71
v_cvt_pk_bf16_f32 v70, v80, v81
v_cvt_pk_bf16_f32 v71, v82, v83
v_mfma_f32_16x16x32_bf16 a[104:107], a[176:179], v[32:35], a[104:107]
ds_write_b128 v1, v[68:71] offset:1024
v_mul_f32 v72, v72, v7
v_mul_f32 v73, v73, v7
v_mul_f32 v74, v74, v7
v_mul_f32 v75, v75, v7
v_mul_f32 v84, v84, v7
v_mul_f32 v85, v85, v7
v_mul_f32 v86, v86, v7
v_mul_f32 v87, v87, v7
v_cvt_pk_bf16_f32 v72, v72, v73
v_cvt_pk_bf16_f32 v73, v74, v75
v_cvt_pk_bf16_f32 v74, v84, v85
v_cvt_pk_bf16_f32 v75, v86, v87
v_mfma_f32_16x16x32_bf16 a[104:107], a[180:183], v[56:59], a[104:107]
s_waitcnt lgkmcnt(7)
ds_write_b128 v1, v[72:75] offset:2048
v_mfma_f32_16x16x32_bf16 v[64:67], a[184:187], v[88:91], 0
ds_read_b64_tr_b16 a[202:203], v11 offset:2048
v_mfma_f32_16x16x32_bf16 v[64:67], a[188:191], v[100:103], v[64:67]
s_add_u32 s20, s62, 0
ds_read_b64_tr_b16 a[204:205], v11 offset:4096
s_add_u32 s21, s62, 6144
v_mfma_f32_16x16x32_bf16 v[68:71], a[188:191], v[104:107], 0
s_add_u32 s22, s62, 12288
ds_read_b64_tr_b16 a[206:207], v11 offset:6144
s_add_u32 s23, s62, 18432
v_mfma_f32_16x16x32_bf16 v[68:71], a[184:187], v[92:95], v[68:71]
s_add_u32 m0, s59, 16384
ds_read_b64_tr_b16 a[168:169], v11 offset:8192
v_mfma_f32_16x16x32_bf16 v[72:75], a[184:187], v[96:99], 0
ds_read_b64_tr_b16 a[170:171], v11 offset:10240
v_mfma_f32_16x16x32_bf16 v[72:75], a[188:191], v[108:111], v[72:75]
s_waitcnt lgkmcnt(8)
ds_read_b64_tr_b16 a[172:173], v11 offset:12288
v_mfma_f32_16x16x32_bf16 v[64:67], a[192:195], v[112:115], v[64:67]
ds_read_b64_tr_b16 a[174:175], v11 offset:14336
v_accvgpr_read_b32 v44, a96
v_mfma_f32_16x16x32_bf16 v[64:67], a[196:199], v[124:127], v[64:67]
ds_read_b64_tr_b16 a[176:177], v12 offset:0
v_accvgpr_read_b32 v45, a97
v_mfma_f32_16x16x32_bf16 v[68:71], a[196:199], v[128:131], v[68:71]
ds_read_b64_tr_b16 a[178:179], v12 offset:2048
v_accvgpr_read_b32 v46, a98
v_mfma_f32_16x16x32_bf16 v[68:71], a[192:195], v[116:119], v[68:71]
ds_read_b64_tr_b16 a[180:181], v12 offset:4096
v_accvgpr_read_b32 v47, a99
v_mfma_f32_16x16x32_bf16 v[72:75], a[192:195], v[120:123], v[72:75]
ds_read_b64_tr_b16 a[182:183], v12 offset:6144
v_mul_f32 v20, v20, v5
v_mfma_f32_16x16x32_bf16 v[72:75], a[196:199], v[132:135], v[72:75]
s_waitcnt lgkmcnt(8)
ds_read_b64_tr_b16 a[184:185], v12 offset:8192
v_mul_f32 v21, v21, v5
v_mfma_f32_16x16x32_bf16 v[76:79], a[200:203], v[88:91], 0
ds_read_b64_tr_b16 a[186:187], v12 offset:10240
v_mul_f32 v22, v22, v5
v_mfma_f32_16x16x32_bf16 v[76:79], a[204:207], v[100:103], v[76:79]
ds_read_b64_tr_b16 a[188:189], v12 offset:12288
v_mul_f32 v23, v23, v5
v_mfma_f32_16x16x32_bf16 v[80:83], a[204:207], v[104:107], 0
ds_read_b64_tr_b16 a[190:191], v12 offset:14336
v_mul_f32 v44, v44, v5
v_mfma_f32_16x16x32_bf16 v[80:83], a[200:203], v[92:95], v[80:83]
ds_read_b64_tr_b16 a[192:193], v13 offset:0
v_mul_f32 v45, v45, v5
v_mfma_f32_16x16x32_bf16 v[84:87], a[200:203], v[96:99], 0
ds_read_b64_tr_b16 a[194:195], v13 offset:2048
v_mul_f32 v46, v46, v5
v_mfma_f32_16x16x32_bf16 v[84:87], a[204:207], v[108:111], v[84:87]
s_waitcnt lgkmcnt(10)
ds_read_b64_tr_b16 a[196:197], v13 offset:4096
v_mul_f32 v47, v47, v5
v_mfma_f32_16x16x32_bf16 v[76:79], a[168:171], v[112:115], v[76:79]
ds_read_b64_tr_b16 a[198:199], v13 offset:6144
v_cvt_pk_bf16_f32 v20, v20, v21
v_mfma_f32_16x16x32_bf16 v[76:79], a[172:175], v[124:127], v[76:79]
ds_read_b64_tr_b16 a[200:201], v13 offset:8192
v_cvt_pk_bf16_f32 v21, v22, v23
v_mfma_f32_16x16x32_bf16 v[80:83], a[172:175], v[128:131], v[80:83]
v_cvt_pk_bf16_f32 v22, v44, v45
v_cvt_pk_bf16_f32 v23, v46, v47
v_mfma_f32_16x16x32_bf16 v[80:83], a[168:171], v[116:119], v[80:83]
ds_write_b128 v1, v[20:23] offset:3072
v_accvgpr_read_b32 v52, a100
v_accvgpr_read_b32 v53, a101
v_accvgpr_read_b32 v54, a102
v_accvgpr_read_b32 v55, a103
v_mul_f32 v28, v28, v6
v_mul_f32 v29, v29, v6
v_mul_f32 v30, v30, v6
v_mul_f32 v31, v31, v6
v_mul_f32 v52, v52, v6
v_mul_f32 v53, v53, v6
v_mul_f32 v54, v54, v6
v_mul_f32 v55, v55, v6
v_cvt_pk_bf16_f32 v28, v28, v29
v_cvt_pk_bf16_f32 v29, v30, v31
v_cvt_pk_bf16_f32 v30, v52, v53
v_cvt_pk_bf16_f32 v31, v54, v55
v_mfma_f32_16x16x32_bf16 v[84:87], a[168:171], v[120:123], v[84:87]
buffer_load_dwordx4 v4, s[36:39], s20 offen offset:0 lds
ds_write_b128 v1, v[28:31] offset:4096
v_accvgpr_read_b32 v60, a104
v_accvgpr_read_b32 v61, a105
v_accvgpr_read_b32 v62, a106
v_accvgpr_read_b32 v63, a107
v_mul_f32 v36, v36, v7
v_mul_f32 v37, v37, v7
v_mul_f32 v38, v38, v7
v_mul_f32 v39, v39, v7
v_mul_f32 v60, v60, v7
v_mul_f32 v61, v61, v7
v_mul_f32 v62, v62, v7
v_mul_f32 v63, v63, v7
v_cvt_pk_bf16_f32 v36, v36, v37
v_cvt_pk_bf16_f32 v37, v38, v39
v_cvt_pk_bf16_f32 v38, v60, v61
v_cvt_pk_bf16_f32 v39, v62, v63
v_mfma_f32_16x16x32_bf16 v[84:87], a[172:175], v[132:135], v[84:87]
s_waitcnt lgkmcnt(11)
ds_write_b128 v1, v[36:39] offset:5120
v_mfma_f32_16x16x32_bf16 v[20:23], a[176:179], v[88:91], 0
ds_read_b64_tr_b16 a[202:203], v13 offset:10240
v_mfma_f32_16x16x32_bf16 v[20:23], a[180:183], v[100:103], v[20:23]
buffer_load_dwordx4 v4, s[36:39], s21 offen offset:1024 lds
v_mfma_f32_16x16x32_bf16 v[28:31], a[180:183], v[104:107], 0
ds_read_b64_tr_b16 a[204:205], v13 offset:12288
ds_read_b64_tr_b16 a[206:207], v13 offset:14336
v_mfma_f32_16x16x32_bf16 v[28:31], a[176:179], v[92:95], v[28:31]
v_mfma_f32_16x16x32_bf16 v[36:39], a[176:179], v[96:99], 0
v_mfma_f32_16x16x32_bf16 v[36:39], a[180:183], v[108:111], v[36:39]
s_waitcnt lgkmcnt(11)
buffer_load_dwordx4 v4, s[36:39], s22 offen offset:2048 lds
v_mfma_f32_16x16x32_bf16 v[20:23], a[184:187], v[112:115], v[20:23]
v_add_u32 v9, 0x10000, v9
v_add_u32 v15, 0x10000, v15
v_mfma_f32_16x16x32_bf16 v[20:23], a[188:191], v[124:127], v[20:23]
v_mfma_f32_16x16x32_bf16 v[28:31], a[188:191], v[128:131], v[28:31]
v_mfma_f32_16x16x32_bf16 v[28:31], a[184:187], v[116:119], v[28:31]
s_waitcnt lgkmcnt(3)
s_barrier
ds_read_b128 a[208:211], v2 offset:0
v_mfma_f32_16x16x32_bf16 v[36:39], a[184:187], v[120:123], v[36:39]
buffer_load_dwordx4 v4, s[36:39], s23 offen offset:3072 lds
v_mfma_f32_16x16x32_bf16 v[36:39], a[188:191], v[132:135], v[36:39]
s_waitcnt lgkmcnt(8)
s_add_u32 s70, s68, 131712
s_add_u32 s71, s68, 131200
s_add_u32 s72, s68, 137856
s_add_u32 s73, s68, 137344
s_add_u32 m0, s58, 0
v_mfma_f32_16x16x32_bf16 v[44:47], a[192:195], v[88:91], 0
buffer_load_dwordx4 v3, s[28:31], s70 offen offset:0 nt lds
v_mfma_f32_16x16x32_bf16 v[44:47], a[196:199], v[100:103], v[44:47]
ds_read_b128 a[212:215], v2 offset:1024
v_mfma_f32_16x16x32_bf16 v[52:55], a[196:199], v[104:107], 0
ds_read_b128 a[216:219], v2 offset:2048
v_mfma_f32_16x16x32_bf16 v[52:55], a[192:195], v[92:95], v[52:55]
ds_read_b128 a[220:223], v2 offset:3072
v_mfma_f32_16x16x32_bf16 v[60:63], a[192:195], v[96:99], 0
ds_read_b128 a[224:227], v2 offset:4096
ds_read_b128 a[228:231], v2 offset:5120
v_mfma_f32_16x16x32_bf16 v[60:63], a[196:199], v[108:111], v[60:63]
s_waitcnt lgkmcnt(6)
ds_read_b64_tr_b16 a[168:169], v9 offset:16384
ds_read_b64_tr_b16 a[170:171], v9 offset:18432
ds_read_b64_tr_b16 a[172:173], v9 offset:20480
ds_read_b64_tr_b16 a[174:175], v9 offset:22528
v_mfma_f32_16x16x32_bf16 v[44:47], a[200:203], v[112:115], v[44:47]
buffer_load_dwordx4 v3, s[28:31], s71 offen offset:1024 nt lds
v_mfma_f32_16x16x32_bf16 v[44:47], a[204:207], v[124:127], v[44:47]
ds_read_b64_tr_b16 a[176:177], v15 offset:16384
ds_read_b64_tr_b16 a[178:179], v15 offset:18432
v_mfma_f32_16x16x32_bf16 v[52:55], a[204:207], v[128:131], v[52:55]
ds_read_b64_tr_b16 a[180:181], v15 offset:20480
ds_read_b64_tr_b16 a[182:183], v15 offset:22528
v_mfma_f32_16x16x32_bf16 v[52:55], a[200:203], v[116:119], v[52:55]
ds_read_b128 a[232:235], v2 offset:6144
v_mfma_f32_16x16x32_bf16 v[60:63], a[200:203], v[120:123], v[60:63]
s_waitcnt lgkmcnt(9)
ds_read_b128 a[236:239], v2 offset:7168
v_mfma_f32_16x16x32_bf16 v[60:63], a[204:207], v[132:135], v[60:63]
s_waitcnt lgkmcnt(6)
ds_read_b128 a[240:243], v2 offset:8192
v_mfma_f32_16x16x32_bf16 a[0:3], a[168:171], a[208:211], 0
buffer_load_dwordx4 v3, s[28:31], s72 offen offset:2048 nt lds
v_mfma_f32_16x16x32_bf16 a[0:3], a[172:175], a[220:223], a[0:3]
ds_read_b128 a[244:247], v2 offset:9216
v_mfma_f32_16x16x32_bf16 a[8:11], a[172:175], a[224:227], 0
ds_read_b128 a[248:251], v2 offset:10240
v_mfma_f32_16x16x32_bf16 a[8:11], a[168:171], a[212:215], a[8:11]
ds_read_b128 a[252:255], v2 offset:11264
v_mfma_f32_16x16x32_bf16 a[16:19], a[168:171], a[216:219], 0
ds_read_b64_tr_b16 a[184:185], v9 offset:24576
ds_read_b64_tr_b16 a[186:187], v9 offset:26624
v_mfma_f32_16x16x32_bf16 a[16:19], a[172:175], a[228:231], a[16:19]
s_waitcnt lgkmcnt(8)
ds_read_b64_tr_b16 a[188:189], v9 offset:28672
ds_read_b64_tr_b16 a[190:191], v9 offset:30720
v_mfma_f32_16x16x32_bf16 a[4:7], a[176:179], a[208:211], 0
ds_read_b64_tr_b16 a[192:193], v15 offset:24576
ds_read_b64_tr_b16 a[194:195], v15 offset:26624
v_mfma_f32_16x16x32_bf16 a[4:7], a[180:183], a[220:223], a[4:7]
ds_read_b64_tr_b16 a[196:197], v15 offset:28672
ds_read_b64_tr_b16 a[198:199], v15 offset:30720
buffer_load_dwordx4 v3, s[28:31], s73 offen offset:3072 nt lds
v_mfma_f32_16x16x32_bf16 a[12:15], a[180:183], a[224:227], 0
v_mfma_f32_16x16x32_bf16 a[12:15], a[176:179], a[212:215], a[12:15]
v_mfma_f32_16x16x32_bf16 a[20:23], a[176:179], a[216:219], 0
s_waitcnt lgkmcnt(8)
v_mfma_f32_16x16x32_bf16 a[20:23], a[180:183], a[228:231], a[20:23]
s_waitcnt vmcnt(8) lgkmcnt(0)
s_barrier
ds_read_b64_tr_b16 a[200:201], v9 offset:49152
v_mfma_f32_16x16x32_bf16 a[0:3], a[184:187], a[232:235], a[0:3]
ds_read_b64_tr_b16 a[202:203], v9 offset:51200
v_mfma_f32_16x16x32_bf16 a[0:3], a[188:191], a[244:247], a[0:3]
ds_read_b64_tr_b16 a[204:205], v9 offset:53248
v_mfma_f32_16x16x32_bf16 a[8:11], a[188:191], a[248:251], a[8:11]
ds_read_b64_tr_b16 a[206:207], v9 offset:55296
v_mfma_f32_16x16x32_bf16 a[8:11], a[184:187], a[236:239], a[8:11]
ds_read_b64_tr_b16 a[168:169], v15 offset:49152
v_mfma_f32_16x16x32_bf16 a[16:19], a[184:187], a[240:243], a[16:19]
ds_read_b64_tr_b16 a[170:171], v15 offset:51200
v_mfma_f32_16x16x32_bf16 a[16:19], a[188:191], a[252:255], a[16:19]
s_waitcnt lgkmcnt(6)
ds_read_b64_tr_b16 a[172:173], v15 offset:53248
v_mfma_f32_16x16x32_bf16 a[4:7], a[192:195], a[232:235], a[4:7]
ds_read_b64_tr_b16 a[174:175], v15 offset:55296
v_mfma_f32_16x16x32_bf16 a[4:7], a[196:199], a[244:247], a[4:7]
ds_read_b64_tr_b16 a[176:177], v9 offset:57344
v_mfma_f32_16x16x32_bf16 a[12:15], a[196:199], a[248:251], a[12:15]
ds_read_b64_tr_b16 a[178:179], v9 offset:59392
v_mfma_f32_16x16x32_bf16 a[12:15], a[192:195], a[236:239], a[12:15]
ds_read_b64_tr_b16 a[180:181], v9 offset:61440
v_mfma_f32_16x16x32_bf16 a[20:23], a[192:195], a[240:243], a[20:23]
ds_read_b64_tr_b16 a[182:183], v9 offset:63488
v_mfma_f32_16x16x32_bf16 a[20:23], a[196:199], a[252:255], a[20:23]
s_waitcnt lgkmcnt(8)
ds_read_b64_tr_b16 a[184:185], v15 offset:57344
v_mfma_f32_16x16x32_bf16 a[24:27], a[200:203], a[208:211], 0
ds_read_b64_tr_b16 a[186:187], v15 offset:59392
v_mfma_f32_16x16x32_bf16 a[24:27], a[204:207], a[220:223], a[24:27]
s_add_u32 s20, s63, 0
ds_read_b64_tr_b16 a[188:189], v15 offset:61440
s_add_u32 s21, s63, 6144
v_mfma_f32_16x16x32_bf16 a[32:35], a[204:207], a[224:227], 0
s_add_u32 s22, s63, 12288
ds_read_b64_tr_b16 a[190:191], v15 offset:63488
s_add_u32 s23, s63, 18432
v_mfma_f32_16x16x32_bf16 a[32:35], a[200:203], a[212:215], a[32:35]
s_add_u32 m0, s59, 49152
v_mfma_f32_16x16x32_bf16 a[40:43], a[200:203], a[216:219], 0
v_mfma_f32_16x16x32_bf16 a[40:43], a[204:207], a[228:231], a[40:43]
s_waitcnt lgkmcnt(8)
v_mfma_f32_16x16x32_bf16 a[28:31], a[168:171], a[208:211], 0
v_mfma_f32_16x16x32_bf16 a[28:31], a[172:175], a[220:223], a[28:31]
v_mfma_f32_16x16x32_bf16 a[36:39], a[172:175], a[224:227], 0
v_mfma_f32_16x16x32_bf16 a[36:39], a[168:171], a[212:215], a[36:39]
v_mfma_f32_16x16x32_bf16 a[44:47], a[168:171], a[216:219], 0
v_mfma_f32_16x16x32_bf16 a[44:47], a[172:175], a[228:231], a[44:47]
s_waitcnt lgkmcnt(4)
ds_read_b64_tr_b16 a[192:193], v10 offset:32768
v_mfma_f32_16x16x32_bf16 a[24:27], a[176:179], a[232:235], a[24:27]
ds_read_b64_tr_b16 a[194:195], v10 offset:34816
v_mfma_f32_16x16x32_bf16 a[24:27], a[180:183], a[244:247], a[24:27]
ds_read_b64_tr_b16 a[196:197], v10 offset:36864
v_mfma_f32_16x16x32_bf16 a[32:35], a[180:183], a[248:251], a[32:35]
ds_read_b64_tr_b16 a[198:199], v10 offset:38912
v_mfma_f32_16x16x32_bf16 a[32:35], a[176:179], a[236:239], a[32:35]
ds_read_b64_tr_b16 a[200:201], v11 offset:32768
v_mfma_f32_16x16x32_bf16 a[40:43], a[176:179], a[240:243], a[40:43]
ds_read_b64_tr_b16 a[202:203], v11 offset:34816
v_mfma_f32_16x16x32_bf16 a[40:43], a[180:183], a[252:255], a[40:43]
s_waitcnt lgkmcnt(6)
ds_read_b64_tr_b16 a[204:205], v11 offset:36864
v_mfma_f32_16x16x32_bf16 a[28:31], a[184:187], a[232:235], a[28:31]
ds_read_b64_tr_b16 a[206:207], v11 offset:38912
v_mfma_f32_16x16x32_bf16 a[28:31], a[188:191], a[244:247], a[28:31]
ds_read_b64_tr_b16 a[168:169], v12 offset:32768
v_mfma_f32_16x16x32_bf16 a[36:39], a[188:191], a[248:251], a[36:39]
ds_read_b64_tr_b16 a[170:171], v12 offset:34816
v_mfma_f32_16x16x32_bf16 a[36:39], a[184:187], a[236:239], a[36:39]
buffer_load_dwordx4 v4, s[36:39], s20 offen offset:0 lds
v_mfma_f32_16x16x32_bf16 a[44:47], a[184:187], a[240:243], a[44:47]
ds_read_b64_tr_b16 a[172:173], v12 offset:36864
v_mfma_f32_16x16x32_bf16 a[44:47], a[188:191], a[252:255], a[44:47]
s_waitcnt lgkmcnt(7)
ds_read_b64_tr_b16 a[174:175], v12 offset:38912
v_mfma_f32_16x16x32_bf16 v[64:67], a[192:195], v[136:139], v[64:67]
ds_read_b64_tr_b16 a[176:177], v13 offset:32768
v_mfma_f32_16x16x32_bf16 v[64:67], a[196:199], v[148:151], v[64:67]
buffer_load_dwordx4 v4, s[36:39], s21 offen offset:1024 lds
v_mfma_f32_16x16x32_bf16 v[68:71], a[196:199], v[152:155], v[68:71]
ds_read_b64_tr_b16 a[178:179], v13 offset:34816
v_mfma_f32_16x16x32_bf16 v[68:71], a[192:195], v[140:143], v[68:71]
ds_read_b64_tr_b16 a[180:181], v13 offset:36864
v_mfma_f32_16x16x32_bf16 v[72:75], a[192:195], v[144:147], v[72:75]
ds_read_b64_tr_b16 a[182:183], v13 offset:38912
v_mfma_f32_16x16x32_bf16 v[72:75], a[196:199], v[156:159], v[72:75]
s_waitcnt lgkmcnt(8)
buffer_load_dwordx4 v4, s[36:39], s22 offen offset:2048 lds
v_mfma_f32_16x16x32_bf16 v[76:79], a[200:203], v[136:139], v[76:79]
ds_read_b64_tr_b16 a[184:185], v10 offset:40960
v_mfma_f32_16x16x32_bf16 v[76:79], a[204:207], v[148:151], v[76:79]
ds_read_b64_tr_b16 a[186:187], v10 offset:43008
v_mfma_f32_16x16x32_bf16 v[80:83], a[204:207], v[152:155], v[80:83]
ds_read_b64_tr_b16 a[188:189], v10 offset:45056
v_mfma_f32_16x16x32_bf16 v[80:83], a[200:203], v[140:143], v[80:83]
buffer_load_dwordx4 v4, s[36:39], s23 offen offset:3072 lds
v_mfma_f32_16x16x32_bf16 v[84:87], a[200:203], v[144:147], v[84:87]
s_add_u32 s70, s68, 197248
ds_read_b64_tr_b16 a[190:191], v10 offset:47104
s_add_u32 s71, s68, 196736
v_mfma_f32_16x16x32_bf16 v[84:87], a[204:207], v[156:159], v[84:87]
s_waitcnt lgkmcnt(8)
s_add_u32 s72, s68, 203392
s_add_u32 s73, s68, 202880
s_add_u32 m0, s58, 32768
v_mfma_f32_16x16x32_bf16 v[20:23], a[168:171], v[136:139], v[20:23]
buffer_load_dwordx4 v3, s[28:31], s70 offen offset:0 nt lds
v_mfma_f32_16x16x32_bf16 v[20:23], a[172:175], v[148:151], v[20:23]
ds_read_b64_tr_b16 a[192:193], v11 offset:40960
v_mfma_f32_16x16x32_bf16 v[28:31], a[172:175], v[152:155], v[28:31]
ds_read_b64_tr_b16 a[194:195], v11 offset:43008
v_mfma_f32_16x16x32_bf16 v[28:31], a[168:171], v[140:143], v[28:31]
ds_read_b64_tr_b16 a[196:197], v11 offset:45056
v_mfma_f32_16x16x32_bf16 v[36:39], a[168:171], v[144:147], v[36:39]
ds_read_b64_tr_b16 a[198:199], v11 offset:47104
v_mfma_f32_16x16x32_bf16 v[36:39], a[172:175], v[156:159], v[36:39]
s_waitcnt lgkmcnt(8)
ds_read_b64_tr_b16 a[200:201], v12 offset:40960
v_mfma_f32_16x16x32_bf16 v[44:47], a[176:179], v[136:139], v[44:47]
buffer_load_dwordx4 v3, s[28:31], s71 offen offset:1024 nt lds
v_mfma_f32_16x16x32_bf16 v[44:47], a[180:183], v[148:151], v[44:47]
ds_read_b64_tr_b16 a[202:203], v12 offset:43008
v_mfma_f32_16x16x32_bf16 v[52:55], a[180:183], v[152:155], v[52:55]
ds_read_b64_tr_b16 a[204:205], v12 offset:45056
v_mfma_f32_16x16x32_bf16 v[52:55], a[176:179], v[140:143], v[52:55]
ds_read_b64_tr_b16 a[206:207], v12 offset:47104
v_mfma_f32_16x16x32_bf16 v[60:63], a[176:179], v[144:147], v[60:63]
ds_read_b64_tr_b16 a[168:169], v13 offset:40960
v_mfma_f32_16x16x32_bf16 v[60:63], a[180:183], v[156:159], v[60:63]
s_waitcnt lgkmcnt(9)
ds_read_b64_tr_b16 a[170:171], v13 offset:43008
v_mfma_f32_16x16x32_bf16 v[64:67], a[184:187], v[160:163], v[64:67]
buffer_load_dwordx4 v3, s[28:31], s72 offen offset:2048 nt lds
v_mfma_f32_16x16x32_bf16 v[64:67], a[188:191], v[172:175], v[64:67]
ds_read_b64_tr_b16 a[172:173], v13 offset:45056
v_mfma_f32_16x16x32_bf16 v[68:71], a[188:191], v[176:179], v[68:71]
ds_read_b64_tr_b16 a[174:175], v13 offset:47104
v_mfma_f32_16x16x32_bf16 v[68:71], a[184:187], v[164:167], v[68:71]
v_mfma_f32_16x16x32_bf16 v[72:75], a[184:187], v[168:171], v[72:75]
v_mfma_f32_16x16x32_bf16 v[72:75], a[188:191], v[180:183], v[72:75]
s_waitcnt lgkmcnt(8)
v_subrev_u32 v9, 0x10000, v9
v_subrev_u32 v15, 0x10000, v15
v_mfma_f32_16x16x32_bf16 v[76:79], a[192:195], v[160:163], v[76:79]
buffer_load_dwordx4 v3, s[28:31], s73 offen offset:3072 nt lds
v_mfma_f32_16x16x32_bf16 v[76:79], a[196:199], v[172:175], v[76:79]
v_mfma_f32_16x16x32_bf16 v[80:83], a[196:199], v[176:179], v[80:83]
v_mfma_f32_16x16x32_bf16 v[80:83], a[192:195], v[164:167], v[80:83]
v_mfma_f32_16x16x32_bf16 v[84:87], a[192:195], v[168:171], v[84:87]
v_mfma_f32_16x16x32_bf16 v[84:87], a[196:199], v[180:183], v[84:87]
s_waitcnt vmcnt(8) lgkmcnt(0)
s_barrier
ds_read_b64_tr_b16 a[176:177], v9 offset:16384
v_mfma_f32_16x16x32_bf16 v[20:23], a[200:203], v[160:163], v[20:23]
ds_read_b64_tr_b16 a[178:179], v9 offset:18432
v_mfma_f32_16x16x32_bf16 v[20:23], a[204:207], v[172:175], v[20:23]
ds_read_b64_tr_b16 a[180:181], v9 offset:20480
v_mfma_f32_16x16x32_bf16 v[28:31], a[204:207], v[176:179], v[28:31]
s_add_u32 s20, s64, 0
ds_read_b64_tr_b16 a[182:183], v9 offset:22528
s_add_u32 s21, s64, 6144
v_mfma_f32_16x16x32_bf16 v[28:31], a[200:203], v[164:167], v[28:31]
s_add_u32 s22, s64, 12288
ds_read_b64_tr_b16 a[184:185], v15 offset:16384
s_add_u32 s23, s64, 18432
v_mfma_f32_16x16x32_bf16 v[36:39], a[200:203], v[168:171], v[36:39]
s_add_u32 m0, s59, 81920
ds_read_b64_tr_b16 a[186:187], v15 offset:18432
v_mfma_f32_16x16x32_bf16 v[36:39], a[204:207], v[180:183], v[36:39]
s_waitcnt lgkmcnt(6)
ds_read_b64_tr_b16 a[188:189], v15 offset:20480
v_mfma_f32_16x16x32_bf16 v[44:47], a[168:171], v[160:163], v[44:47]
ds_read_b64_tr_b16 a[190:191], v15 offset:22528
v_mfma_f32_16x16x32_bf16 v[44:47], a[172:175], v[172:175], v[44:47]
ds_read_b64_tr_b16 a[192:193], v9 offset:24576
v_mfma_f32_16x16x32_bf16 v[52:55], a[172:175], v[176:179], v[52:55]
ds_read_b64_tr_b16 a[194:195], v9 offset:26624
v_mfma_f32_16x16x32_bf16 v[52:55], a[168:171], v[164:167], v[52:55]
ds_read_b64_tr_b16 a[196:197], v9 offset:28672
v_mfma_f32_16x16x32_bf16 v[60:63], a[168:171], v[168:171], v[60:63]
ds_read_b64_tr_b16 a[198:199], v9 offset:30720
v_mfma_f32_16x16x32_bf16 v[60:63], a[172:175], v[180:183], v[60:63]
s_waitcnt lgkmcnt(8)
ds_read_b64_tr_b16 a[200:201], v15 offset:24576
v_mfma_f32_16x16x32_bf16 a[48:51], a[176:179], a[208:211], 0
ds_read_b64_tr_b16 a[202:203], v15 offset:26624
v_mfma_f32_16x16x32_bf16 a[48:51], a[180:183], a[220:223], a[48:51]
ds_read_b64_tr_b16 a[204:205], v15 offset:28672
v_mfma_f32_16x16x32_bf16 a[56:59], a[180:183], a[224:227], 0
ds_read_b64_tr_b16 a[206:207], v15 offset:30720
v_mfma_f32_16x16x32_bf16 a[56:59], a[176:179], a[212:215], a[56:59]
v_mfma_f32_16x16x32_bf16 a[64:67], a[176:179], a[216:219], 0
v_mfma_f32_16x16x32_bf16 a[64:67], a[180:183], a[228:231], a[64:67]
s_waitcnt lgkmcnt(8)
v_subrev_u32 v10, 0x10000, v10
v_subrev_u32 v11, 0x10000, v11
v_mfma_f32_16x16x32_bf16 a[52:55], a[184:187], a[208:211], 0
v_subrev_u32 v12, 0x10000, v12
v_subrev_u32 v13, 0x10000, v13
v_mfma_f32_16x16x32_bf16 a[52:55], a[188:191], a[220:223], a[52:55]
v_mfma_f32_16x16x32_bf16 a[60:63], a[188:191], a[224:227], 0
v_mfma_f32_16x16x32_bf16 a[60:63], a[184:187], a[212:215], a[60:63]
v_mfma_f32_16x16x32_bf16 a[68:71], a[184:187], a[216:219], 0
buffer_load_dwordx4 v4, s[36:39], s20 offen offset:0 lds
v_mfma_f32_16x16x32_bf16 a[68:71], a[188:191], a[228:231], a[68:71]
s_waitcnt lgkmcnt(4)
ds_read_b64_tr_b16 a[168:169], v10 offset:0
v_mfma_f32_16x16x32_bf16 a[48:51], a[192:195], a[232:235], a[48:51]
ds_read_b64_tr_b16 a[170:171], v10 offset:2048
v_mfma_f32_16x16x32_bf16 a[48:51], a[196:199], a[244:247], a[48:51]
ds_read_b64_tr_b16 a[172:173], v10 offset:4096
v_mfma_f32_16x16x32_bf16 a[56:59], a[196:199], a[248:251], a[56:59]
buffer_load_dwordx4 v4, s[36:39], s21 offen offset:1024 lds
v_mfma_f32_16x16x32_bf16 a[56:59], a[192:195], a[236:239], a[56:59]
ds_read_b64_tr_b16 a[174:175], v10 offset:6144
v_mfma_f32_16x16x32_bf16 a[64:67], a[192:195], a[240:243], a[64:67]
ds_read_b64_tr_b16 a[176:177], v11 offset:0
v_mfma_f32_16x16x32_bf16 a[64:67], a[196:199], a[252:255], a[64:67]
s_waitcnt lgkmcnt(5)
ds_read_b64_tr_b16 a[178:179], v11 offset:2048
v_mfma_f32_16x16x32_bf16 a[52:55], a[200:203], a[232:235], a[52:55]
buffer_load_dwordx4 v4, s[36:39], s22 offen offset:2048 lds
v_mfma_f32_16x16x32_bf16 a[52:55], a[204:207], a[244:247], a[52:55]
ds_read_b64_tr_b16 a[180:181], v11 offset:4096
v_mfma_f32_16x16x32_bf16 a[60:63], a[204:207], a[248:251], a[60:63]
ds_read_b64_tr_b16 a[182:183], v11 offset:6144
v_mfma_f32_16x16x32_bf16 a[60:63], a[200:203], a[236:239], a[60:63]
ds_read_b64_tr_b16 a[184:185], v12 offset:0
v_mfma_f32_16x16x32_bf16 a[68:71], a[200:203], a[240:243], a[68:71]
buffer_load_dwordx4 v4, s[36:39], s23 offen offset:3072 lds
v_mfma_f32_16x16x32_bf16 a[68:71], a[204:207], a[252:255], a[68:71]
s_waitcnt lgkmcnt(5)
ds_read_b64_tr_b16 a[186:187], v12 offset:2048
s_add_u32 s20, s65, 0
v_mfma_f32_16x16x32_bf16 v[64:67], a[168:171], v[184:187], v[64:67]
s_add_u32 s21, s65, 6144
ds_read_b64_tr_b16 a[188:189], v12 offset:4096
s_add_u32 s22, s65, 12288
v_mfma_f32_16x16x32_bf16 v[64:67], a[172:175], v[196:199], v[64:67]
s_add_u32 s23, s65, 18432
s_add_u32 m0, s59, 114688
ds_read_b64_tr_b16 a[190:191], v12 offset:6144
v_mfma_f32_16x16x32_bf16 v[68:71], a[172:175], v[200:203], v[68:71]
buffer_load_dwordx4 v4, s[36:39], s20 offen offset:0 lds
v_mfma_f32_16x16x32_bf16 v[68:71], a[168:171], v[188:191], v[68:71]
ds_read_b64_tr_b16 a[192:193], v13 offset:0
v_mfma_f32_16x16x32_bf16 v[72:75], a[168:171], v[192:195], v[72:75]
ds_read_b64_tr_b16 a[194:195], v13 offset:2048
v_mfma_f32_16x16x32_bf16 v[72:75], a[172:175], v[204:207], v[72:75]
s_waitcnt lgkmcnt(6)
ds_read_b64_tr_b16 a[196:197], v13 offset:4096
v_mfma_f32_16x16x32_bf16 v[76:79], a[176:179], v[184:187], v[76:79]
buffer_load_dwordx4 v4, s[36:39], s21 offen offset:1024 lds
v_mfma_f32_16x16x32_bf16 v[76:79], a[180:183], v[196:199], v[76:79]
ds_read_b64_tr_b16 a[198:199], v13 offset:6144
v_mfma_f32_16x16x32_bf16 v[80:83], a[180:183], v[200:203], v[80:83]
ds_read_b64_tr_b16 a[200:201], v10 offset:8192
v_mfma_f32_16x16x32_bf16 v[80:83], a[176:179], v[188:191], v[80:83]
ds_read_b64_tr_b16 a[202:203], v10 offset:10240
v_mfma_f32_16x16x32_bf16 v[84:87], a[176:179], v[192:195], v[84:87]
buffer_load_dwordx4 v4, s[36:39], s22 offen offset:2048 lds
v_mfma_f32_16x16x32_bf16 v[84:87], a[180:183], v[204:207], v[84:87]
s_waitcnt lgkmcnt(6)
ds_read_b64_tr_b16 a[204:205], v10 offset:12288
v_mfma_f32_16x16x32_bf16 v[20:23], a[184:187], v[184:187], v[20:23]
ds_read_b64_tr_b16 a[206:207], v10 offset:14336
v_mfma_f32_16x16x32_bf16 v[20:23], a[188:191], v[196:199], v[20:23]
ds_read_b64_tr_b16 a[168:169], v11 offset:8192
v_mfma_f32_16x16x32_bf16 v[28:31], a[188:191], v[200:203], v[28:31]
buffer_load_dwordx4 v4, s[36:39], s23 offen offset:3072 lds
v_mfma_f32_16x16x32_bf16 v[28:31], a[184:187], v[188:191], v[28:31]
s_add_u32 s20, s66, 0
ds_read_b64_tr_b16 a[170:171], v11 offset:10240
s_add_u32 s21, s66, 6144
v_mfma_f32_16x16x32_bf16 v[36:39], a[184:187], v[192:195], v[36:39]
s_add_u32 s22, s66, 12288
ds_read_b64_tr_b16 a[172:173], v11 offset:12288
s_add_u32 s23, s66, 18432
v_mfma_f32_16x16x32_bf16 v[36:39], a[188:191], v[204:207], v[36:39]
s_waitcnt lgkmcnt(7)
s_add_u32 m0, s59, 98304
ds_read_b64_tr_b16 a[174:175], v11 offset:14336
v_mfma_f32_16x16x32_bf16 v[44:47], a[192:195], v[184:187], v[44:47]
buffer_load_dwordx4 v4, s[36:39], s20 offen offset:0 lds
v_mfma_f32_16x16x32_bf16 v[44:47], a[196:199], v[196:199], v[44:47]
ds_read_b64_tr_b16 a[176:177], v12 offset:8192
v_mfma_f32_16x16x32_bf16 v[52:55], a[196:199], v[200:203], v[52:55]
ds_read_b64_tr_b16 a[178:179], v12 offset:10240
v_mfma_f32_16x16x32_bf16 v[52:55], a[192:195], v[188:191], v[52:55]
ds_read_b64_tr_b16 a[180:181], v12 offset:12288
v_mfma_f32_16x16x32_bf16 v[60:63], a[192:195], v[192:195], v[60:63]
buffer_load_dwordx4 v4, s[36:39], s21 offen offset:1024 lds
v_mfma_f32_16x16x32_bf16 v[60:63], a[196:199], v[204:207], v[60:63]
s_waitcnt lgkmcnt(7)
ds_read_b64_tr_b16 a[182:183], v12 offset:14336
v_mfma_f32_16x16x32_bf16 v[64:67], a[200:203], v[208:211], v[64:67]
ds_read_b64_tr_b16 a[184:185], v13 offset:8192
v_mfma_f32_16x16x32_bf16 v[64:67], a[204:207], v[220:223], v[64:67]
ds_read_b64_tr_b16 a[186:187], v13 offset:10240
v_mfma_f32_16x16x32_bf16 v[68:71], a[204:207], v[224:227], v[68:71]
buffer_load_dwordx4 v4, s[36:39], s22 offen offset:2048 lds
v_mfma_f32_16x16x32_bf16 v[68:71], a[200:203], v[212:215], v[68:71]
ds_read_b64_tr_b16 a[188:189], v13 offset:12288
v_mfma_f32_16x16x32_bf16 v[72:75], a[200:203], v[216:219], v[72:75]
ds_read_b64_tr_b16 a[190:191], v13 offset:14336
v_mfma_f32_16x16x32_bf16 v[72:75], a[204:207], v[228:231], v[72:75]
s_waitcnt lgkmcnt(8)
v_mfma_f32_16x16x32_bf16 v[76:79], a[168:171], v[208:211], v[76:79]
buffer_load_dwordx4 v4, s[36:39], s23 offen offset:3072 lds
v_mfma_f32_16x16x32_bf16 v[76:79], a[172:175], v[220:223], v[76:79]
s_add_u32 s70, s68, 768
s_add_u32 s71, s68, 256
s_add_u32 s72, s68, 6912
v_mfma_f32_16x16x32_bf16 v[80:83], a[172:175], v[224:227], v[80:83]
s_add_u32 s73, s68, 6400
s_add_u32 m0, s58, 65536
v_mfma_f32_16x16x32_bf16 v[80:83], a[168:171], v[212:215], v[80:83]
buffer_load_dwordx4 v3, s[28:31], s70 offen offset:0 nt lds
v_mfma_f32_16x16x32_bf16 v[84:87], a[168:171], v[216:219], v[84:87]
v_mfma_f32_16x16x32_bf16 v[84:87], a[172:175], v[228:231], v[84:87]
s_waitcnt vmcnt(13) lgkmcnt(0)
s_barrier
ds_read_b64_tr_b16 a[192:193], v9 offset:49152
v_mfma_f32_16x16x32_bf16 v[20:23], a[176:179], v[208:211], v[20:23]
ds_read_b64_tr_b16 a[194:195], v9 offset:51200
v_mfma_f32_16x16x32_bf16 v[20:23], a[180:183], v[220:223], v[20:23]
ds_read_b64_tr_b16 a[196:197], v9 offset:53248
v_mfma_f32_16x16x32_bf16 v[28:31], a[180:183], v[224:227], v[28:31]
ds_read_b64_tr_b16 a[198:199], v9 offset:55296
v_mfma_f32_16x16x32_bf16 v[28:31], a[176:179], v[212:215], v[28:31]
buffer_load_dwordx4 v3, s[28:31], s71 offen offset:1024 nt lds
v_mfma_f32_16x16x32_bf16 v[36:39], a[176:179], v[216:219], v[36:39]
ds_read_b64_tr_b16 a[200:201], v15 offset:49152
v_mfma_f32_16x16x32_bf16 v[36:39], a[180:183], v[228:231], v[36:39]
s_waitcnt lgkmcnt(5)
ds_read_b64_tr_b16 a[202:203], v15 offset:51200
v_mfma_f32_16x16x32_bf16 v[44:47], a[184:187], v[208:211], v[44:47]
ds_read_b64_tr_b16 a[204:205], v15 offset:53248
v_mfma_f32_16x16x32_bf16 v[44:47], a[188:191], v[220:223], v[44:47]
ds_read_b64_tr_b16 a[206:207], v15 offset:55296
v_mfma_f32_16x16x32_bf16 v[52:55], a[188:191], v[224:227], v[52:55]
ds_read_b64_tr_b16 a[168:169], v9 offset:57344
v_mfma_f32_16x16x32_bf16 v[52:55], a[184:187], v[212:215], v[52:55]
buffer_load_dwordx4 v3, s[28:31], s72 offen offset:2048 nt lds
v_mfma_f32_16x16x32_bf16 v[60:63], a[184:187], v[216:219], v[60:63]
ds_read_b64_tr_b16 a[170:171], v9 offset:59392
v_mfma_f32_16x16x32_bf16 v[60:63], a[188:191], v[228:231], v[60:63]
s_waitcnt lgkmcnt(6)
ds_read_b64_tr_b16 a[172:173], v9 offset:61440
v_mfma_f32_16x16x32_bf16 a[72:75], a[192:195], a[208:211], 0
ds_read_b64_tr_b16 a[174:175], v9 offset:63488
v_mfma_f32_16x16x32_bf16 a[72:75], a[196:199], a[220:223], a[72:75]
ds_read_b64_tr_b16 a[176:177], v15 offset:57344
v_mfma_f32_16x16x32_bf16 a[80:83], a[196:199], a[224:227], 0
ds_read_b64_tr_b16 a[178:179], v15 offset:59392
v_mfma_f32_16x16x32_bf16 a[80:83], a[192:195], a[212:215], a[80:83]
buffer_load_dwordx4 v3, s[28:31], s73 offen offset:3072 nt lds
v_mfma_f32_16x16x32_bf16 a[88:91], a[192:195], a[216:219], 0
ds_read_b64_tr_b16 a[180:181], v15 offset:61440
v_mfma_f32_16x16x32_bf16 a[88:91], a[196:199], a[228:231], a[88:91]
s_waitcnt lgkmcnt(7)
ds_read_b64_tr_b16 a[182:183], v15 offset:63488
v_mfma_f32_16x16x32_bf16 a[76:79], a[200:203], a[208:211], 0
v_mfma_f32_16x16x32_bf16 a[76:79], a[204:207], a[220:223], a[76:79]
v_mfma_f32_16x16x32_bf16 a[84:87], a[204:207], a[224:227], 0
v_mfma_f32_16x16x32_bf16 a[84:87], a[200:203], a[212:215], a[84:87]
v_mfma_f32_16x16x32_bf16 a[92:95], a[200:203], a[216:219], 0
v_mfma_f32_16x16x32_bf16 a[92:95], a[204:207], a[228:231], a[92:95]
s_waitcnt lgkmcnt(4)
ds_read_b64_tr_b16 a[184:185], v10 offset:32768
v_mfma_f32_16x16x32_bf16 a[72:75], a[168:171], a[232:235], a[72:75]
ds_read_b64_tr_b16 a[186:187], v10 offset:34816
v_mfma_f32_16x16x32_bf16 a[72:75], a[172:175], a[244:247], a[72:75]
ds_read_b64_tr_b16 a[188:189], v10 offset:36864
v_mfma_f32_16x16x32_bf16 a[80:83], a[172:175], a[248:251], a[80:83]
ds_read_b64_tr_b16 a[190:191], v10 offset:38912
v_mfma_f32_16x16x32_bf16 a[80:83], a[168:171], a[236:239], a[80:83]
ds_read_b64_tr_b16 a[192:193], v10 offset:40960
v_mfma_f32_16x16x32_bf16 a[88:91], a[168:171], a[240:243], a[88:91]
ds_read_b64_tr_b16 a[194:195], v10 offset:43008
v_mfma_f32_16x16x32_bf16 a[88:91], a[172:175], a[252:255], a[88:91]
s_waitcnt lgkmcnt(6)
ds_read_b64_tr_b16 a[196:197], v10 offset:45056
v_mfma_f32_16x16x32_bf16 a[76:79], a[176:179], a[232:235], a[76:79]
ds_read_b64_tr_b16 a[198:199], v10 offset:47104
v_mfma_f32_16x16x32_bf16 a[76:79], a[180:183], a[244:247], a[76:79]
ds_read_b64_tr_b16 a[200:201], v11 offset:32768
v_mfma_f32_16x16x32_bf16 a[84:87], a[180:183], a[248:251], a[84:87]
ds_read_b64_tr_b16 a[202:203], v11 offset:34816
v_mfma_f32_16x16x32_bf16 a[84:87], a[176:179], a[236:239], a[84:87]
ds_read_b64_tr_b16 a[204:205], v11 offset:36864
v_mfma_f32_16x16x32_bf16 a[92:95], a[176:179], a[240:243], a[92:95]
ds_read_b64_tr_b16 a[206:207], v11 offset:38912
v_mfma_f32_16x16x32_bf16 a[92:95], a[180:183], a[252:255], a[92:95]
s_waitcnt lgkmcnt(8)
ds_read_b64_tr_b16 a[168:169], v11 offset:40960
v_mfma_f32_16x16x32_bf16 v[64:67], a[184:187], v[232:235], v[64:67]
ds_read_b64_tr_b16 a[170:171], v11 offset:43008
v_mfma_f32_16x16x32_bf16 v[64:67], a[188:191], v[244:247], v[64:67]
s_add_u32 s20, s60, 57344
ds_read_b64_tr_b16 a[172:173], v11 offset:45056
s_add_u32 s21, s60, 63488
v_mfma_f32_16x16x32_bf16 v[68:71], a[188:191], v[248:251], v[68:71]
s_add_u32 s22, s60, 69632
ds_read_b64_tr_b16 a[174:175], v11 offset:47104
s_add_u32 s23, s60, 75776
v_mfma_f32_16x16x32_bf16 v[68:71], a[184:187], v[236:239], v[68:71]
s_add_u32 m0, s59, 16384
ds_read_b64_tr_b16 a[176:177], v12 offset:32768
v_mfma_f32_16x16x32_bf16 v[72:75], a[184:187], v[240:243], v[72:75]
ds_read_b64_tr_b16 a[178:179], v12 offset:34816
v_mfma_f32_16x16x32_bf16 v[72:75], a[188:191], v[252:255], v[72:75]
s_waitcnt lgkmcnt(10)
ds_read_b64_tr_b16 a[180:181], v12 offset:36864
v_mfma_f32_16x16x32_bf16 v[64:67], a[192:195], v[16:19], v[64:67]
ds_read_b64_tr_b16 a[182:183], v12 offset:38912
v_mfma_f32_16x16x32_bf16 v[64:67], a[196:199], v[40:43], v[64:67]
ds_read_b64_tr_b16 a[184:185], v12 offset:40960
v_mfma_f32_16x16x32_bf16 v[68:71], a[196:199], v[48:51], v[68:71]
ds_read_b64_tr_b16 a[186:187], v12 offset:43008
v_mfma_f32_16x16x32_bf16 v[68:71], a[192:195], v[24:27], v[68:71]
ds_read_b64_tr_b16 a[188:189], v12 offset:45056
v_mfma_f32_16x16x32_bf16 v[72:75], a[192:195], v[32:35], v[72:75]
ds_read_b64_tr_b16 a[190:191], v12 offset:47104
v_mfma_f32_16x16x32_bf16 v[72:75], a[196:199], v[56:59], v[72:75]
s_waitcnt lgkmcnt(12)
ds_read_b64_tr_b16 a[192:193], v13 offset:32768
v_mfma_f32_16x16x32_bf16 v[76:79], a[200:203], v[232:235], v[76:79]
ds_read_b64_tr_b16 a[194:195], v13 offset:34816
v_mfma_f32_16x16x32_bf16 v[76:79], a[204:207], v[244:247], v[76:79]
ds_read_b64_tr_b16 a[196:197], v13 offset:36864
v_mfma_f32_16x16x32_bf16 v[80:83], a[204:207], v[248:251], v[80:83]
ds_read_b64_tr_b16 a[198:199], v13 offset:38912
v_mfma_f32_16x16x32_bf16 v[80:83], a[200:203], v[236:239], v[80:83]
v_mfma_f32_16x16x32_bf16 v[84:87], a[200:203], v[240:243], v[84:87]
v_mfma_f32_16x16x32_bf16 v[84:87], a[204:207], v[252:255], v[84:87]
s_waitcnt lgkmcnt(12)
ds_read_b64_tr_b16 a[200:201], v13 offset:40960
v_mfma_f32_16x16x32_bf16 v[76:79], a[168:171], v[16:19], v[76:79]
ds_read_b64_tr_b16 a[202:203], v13 offset:43008
v_mfma_f32_16x16x32_bf16 v[76:79], a[172:175], v[40:43], v[76:79]
ds_read_b64_tr_b16 a[204:205], v13 offset:45056
v_mfma_f32_16x16x32_bf16 v[80:83], a[172:175], v[48:51], v[80:83]
ds_read_b64_tr_b16 a[206:207], v13 offset:47104
v_mfma_f32_16x16x32_bf16 v[80:83], a[168:171], v[24:27], v[80:83]
buffer_load_dwordx4 v4, s[36:39], s20 offen offset:0 lds
v_mfma_f32_16x16x32_bf16 v[84:87], a[168:171], v[32:35], v[84:87]
v_mfma_f32_16x16x32_bf16 v[84:87], a[172:175], v[56:59], v[84:87]
s_waitcnt lgkmcnt(12)
v_mfma_f32_16x16x32_bf16 v[20:23], a[176:179], v[232:235], v[20:23]
v_mfma_f32_16x16x32_bf16 v[20:23], a[180:183], v[244:247], v[20:23]
buffer_load_dwordx4 v4, s[36:39], s21 offen offset:1024 lds
v_mfma_f32_16x16x32_bf16 v[28:31], a[180:183], v[248:251], v[28:31]
v_mfma_f32_16x16x32_bf16 v[28:31], a[176:179], v[236:239], v[28:31]
v_mfma_f32_16x16x32_bf16 v[36:39], a[176:179], v[240:243], v[36:39]
v_mfma_f32_16x16x32_bf16 v[36:39], a[180:183], v[252:255], v[36:39]
s_waitcnt lgkmcnt(8)
buffer_load_dwordx4 v4, s[36:39], s22 offen offset:2048 lds
v_mfma_f32_16x16x32_bf16 v[20:23], a[184:187], v[16:19], v[20:23]
v_add_u32 v9, 0x10000, v9
v_add_u32 v15, 0x10000, v15
v_mfma_f32_16x16x32_bf16 v[20:23], a[188:191], v[40:43], v[20:23]
v_mul_f32 v64, v64, v5
v_mul_f32 v65, v65, v5
v_mfma_f32_16x16x32_bf16 v[28:31], a[188:191], v[48:51], v[28:31]
v_mul_f32 v66, v66, v5
v_mul_f32 v67, v67, v5
v_mfma_f32_16x16x32_bf16 v[28:31], a[184:187], v[24:27], v[28:31]
buffer_load_dwordx4 v4, s[36:39], s23 offen offset:3072 lds
v_mfma_f32_16x16x32_bf16 v[36:39], a[184:187], v[32:35], v[36:39]
s_add_u32 s70, s68, 66304
v_mul_f32 v76, v76, v5
v_mul_f32 v77, v77, v5
v_mfma_f32_16x16x32_bf16 v[36:39], a[188:191], v[56:59], v[36:39]
s_waitcnt vmcnt(8) lgkmcnt(0)
s_barrier
ds_read_b64_tr_b16 a[168:169], v9 offset:16384
v_mfma_f32_16x16x32_bf16 v[44:47], a[192:195], v[232:235], v[44:47]
s_add_u32 s71, s68, 65792
ds_read_b64_tr_b16 a[170:171], v9 offset:18432
s_add_u32 s72, s68, 72448
v_mfma_f32_16x16x32_bf16 v[44:47], a[196:199], v[244:247], v[44:47]
s_add_u32 s73, s68, 71936
ds_read_b64_tr_b16 a[172:173], v9 offset:20480
s_add_u32 m0, s58, 0
v_mfma_f32_16x16x32_bf16 v[52:55], a[196:199], v[248:251], v[52:55]
ds_read_b64_tr_b16 a[174:175], v9 offset:22528
v_mul_f32 v78, v78, v5
v_mfma_f32_16x16x32_bf16 v[52:55], a[192:195], v[236:239], v[52:55]
ds_read_b64_tr_b16 a[176:177], v15 offset:16384
v_mul_f32 v79, v79, v5
v_mfma_f32_16x16x32_bf16 v[60:63], a[192:195], v[240:243], v[60:63]
buffer_load_dwordx4 v3, s[28:31], s70 offen offset:0 nt lds
v_mfma_f32_16x16x32_bf16 v[60:63], a[196:199], v[252:255], v[60:63]
s_waitcnt lgkmcnt(5)
ds_read_b64_tr_b16 a[178:179], v15 offset:18432
v_cvt_pk_bf16_f32 v64, v64, v65
v_mfma_f32_16x16x32_bf16 v[44:47], a[200:203], v[16:19], v[44:47]
ds_read_b64_tr_b16 a[180:181], v15 offset:20480
v_cvt_pk_bf16_f32 v65, v66, v67
v_mfma_f32_16x16x32_bf16 v[44:47], a[204:207], v[40:43], v[44:47]
ds_read_b64_tr_b16 a[182:183], v15 offset:22528
v_cvt_pk_bf16_f32 v66, v76, v77
v_mfma_f32_16x16x32_bf16 v[52:55], a[204:207], v[48:51], v[52:55]
ds_read_b64_tr_b16 a[184:185], v9 offset:24576
v_cvt_pk_bf16_f32 v67, v78, v79
v_mfma_f32_16x16x32_bf16 v[52:55], a[200:203], v[24:27], v[52:55]
ds_read_b64_tr_b16 a[186:187], v9 offset:26624
v_mul_f32 v68, v68, v6
v_mfma_f32_16x16x32_bf16 v[60:63], a[200:203], v[32:35], v[60:63]
buffer_load_dwordx4 v3, s[28:31], s71 offen offset:1024 nt lds
v_mfma_f32_16x16x32_bf16 v[60:63], a[204:207], v[56:59], v[60:63]
s_waitcnt lgkmcnt(6)
ds_read_b64_tr_b16 a[188:189], v9 offset:28672
v_mul_f32 v69, v69, v6
v_mfma_f32_16x16x32_bf16 a[96:99], a[168:171], a[208:211], 0
ds_read_b64_tr_b16 a[190:191], v9 offset:30720
v_mul_f32 v70, v70, v6
v_mfma_f32_16x16x32_bf16 a[96:99], a[172:175], a[220:223], a[96:99]
ds_read_b64_tr_b16 a[192:193], v15 offset:24576
v_mul_f32 v71, v71, v6
v_mfma_f32_16x16x32_bf16 a[104:107], a[172:175], a[224:227], 0
ds_read_b64_tr_b16 a[194:195], v15 offset:26624
v_mul_f32 v80, v80, v6
v_mfma_f32_16x16x32_bf16 a[104:107], a[168:171], a[212:215], a[104:107]
ds_read_b64_tr_b16 a[196:197], v15 offset:28672
v_mul_f32 v81, v81, v6
v_mfma_f32_16x16x32_bf16 a[112:115], a[168:171], a[216:219], 0
buffer_load_dwordx4 v3, s[28:31], s72 offen offset:2048 nt lds
v_mfma_f32_16x16x32_bf16 a[112:115], a[172:175], a[228:231], a[112:115]
s_waitcnt lgkmcnt(7)
ds_read_b64_tr_b16 a[198:199], v15 offset:30720
v_mul_f32 v82, v82, v6
v_mfma_f32_16x16x32_bf16 a[100:103], a[176:179], a[208:211], 0
ds_write_b128 v1, v[64:67] offset:0
v_mfma_f32_16x16x32_bf16 a[100:103], a[180:183], a[220:223], a[100:103]
v_mul_f32 v83, v83, v6
v_cvt_pk_bf16_f32 v68, v68, v69
v_mfma_f32_16x16x32_bf16 a[108:111], a[180:183], a[224:227], 0
v_cvt_pk_bf16_f32 v69, v70, v71
v_cvt_pk_bf16_f32 v70, v80, v81
v_mfma_f32_16x16x32_bf16 a[108:111], a[176:179], a[212:215], a[108:111]
v_cvt_pk_bf16_f32 v71, v82, v83
v_mul_f32 v72, v72, v7
v_mfma_f32_16x16x32_bf16 a[116:119], a[176:179], a[216:219], 0
buffer_load_dwordx4 v3, s[28:31], s73 offen offset:3072 nt lds
v_mfma_f32_16x16x32_bf16 a[116:119], a[180:183], a[228:231], a[116:119]
s_waitcnt lgkmcnt(5)
ds_read_b64_tr_b16 a[200:201], v9 offset:49152
v_mul_f32 v73, v73, v7
v_mfma_f32_16x16x32_bf16 a[96:99], a[184:187], a[232:235], a[96:99]
ds_read_b64_tr_b16 a[202:203], v9 offset:51200
v_mul_f32 v74, v74, v7
v_mfma_f32_16x16x32_bf16 a[96:99], a[188:191], a[244:247], a[96:99]
ds_read_b64_tr_b16 a[204:205], v9 offset:53248
v_mul_f32 v75, v75, v7
v_mfma_f32_16x16x32_bf16 a[104:107], a[188:191], a[248:251], a[104:107]
ds_read_b64_tr_b16 a[206:207], v9 offset:55296
v_mul_f32 v84, v84, v7
v_mfma_f32_16x16x32_bf16 a[104:107], a[184:187], a[236:239], a[104:107]
ds_read_b64_tr_b16 a[168:169], v15 offset:49152
v_mul_f32 v85, v85, v7
v_mfma_f32_16x16x32_bf16 a[112:115], a[184:187], a[240:243], a[112:115]
ds_read_b64_tr_b16 a[170:171], v15 offset:51200
v_mul_f32 v86, v86, v7
v_mfma_f32_16x16x32_bf16 a[112:115], a[188:191], a[252:255], a[112:115]
s_waitcnt lgkmcnt(7)
ds_read_b64_tr_b16 a[172:173], v15 offset:53248
v_mul_f32 v87, v87, v7
v_mfma_f32_16x16x32_bf16 a[100:103], a[192:195], a[232:235], a[100:103]
ds_read_b64_tr_b16 a[174:175], v15 offset:55296
v_cvt_pk_bf16_f32 v72, v72, v73
v_mfma_f32_16x16x32_bf16 a[100:103], a[196:199], a[244:247], a[100:103]
ds_read_b64_tr_b16 a[176:177], v9 offset:57344
v_cvt_pk_bf16_f32 v73, v74, v75
v_mfma_f32_16x16x32_bf16 a[108:111], a[196:199], a[248:251], a[108:111]
ds_read_b64_tr_b16 a[178:179], v9 offset:59392
v_cvt_pk_bf16_f32 v74, v84, v85
v_mfma_f32_16x16x32_bf16 a[108:111], a[192:195], a[236:239], a[108:111]
ds_read_b64_tr_b16 a[180:181], v9 offset:61440
v_cvt_pk_bf16_f32 v75, v86, v87
v_mfma_f32_16x16x32_bf16 a[116:119], a[192:195], a[240:243], a[116:119]
ds_read_b64_tr_b16 a[182:183], v9 offset:63488
v_mul_f32 v20, v20, v5
v_mfma_f32_16x16x32_bf16 a[116:119], a[196:199], a[252:255], a[116:119]
s_waitcnt lgkmcnt(8)
ds_read_b64_tr_b16 a[184:185], v15 offset:57344
v_mul_f32 v21, v21, v5
v_mfma_f32_16x16x32_bf16 a[120:123], a[200:203], a[208:211], 0
ds_read_b64_tr_b16 a[186:187], v15 offset:59392
v_mul_f32 v22, v22, v5
v_mfma_f32_16x16x32_bf16 a[120:123], a[204:207], a[220:223], a[120:123]
s_add_u32 s20, s61, 57344
ds_read_b64_tr_b16 a[188:189], v15 offset:61440
v_mul_f32 v23, v23, v5
v_mfma_f32_16x16x32_bf16 a[128:131], a[204:207], a[224:227], 0
s_add_u32 s21, s61, 63488
ds_read_b64_tr_b16 a[190:191], v15 offset:63488
v_mul_f32 v44, v44, v5
v_mfma_f32_16x16x32_bf16 a[128:131], a[200:203], a[212:215], a[128:131]
s_add_u32 s22, s61, 69632
ds_write_b128 v1, v[68:71] offset:1024
v_mfma_f32_16x16x32_bf16 a[136:139], a[200:203], a[216:219], 0
s_add_u32 s23, s61, 75776
ds_write_b128 v1, v[72:75] offset:2048
v_mfma_f32_16x16x32_bf16 a[136:139], a[204:207], a[228:231], a[136:139]
s_waitcnt lgkmcnt(10)
v_mul_f32 v45, v45, v5
v_mul_f32 v46, v46, v5
v_mfma_f32_16x16x32_bf16 a[124:127], a[168:171], a[208:211], 0
s_add_u32 m0, s59, 49152
v_mul_f32 v47, v47, v5
v_cvt_pk_bf16_f32 v20, v20, v21
v_mfma_f32_16x16x32_bf16 a[124:127], a[172:175], a[220:223], a[124:127]
v_cvt_pk_bf16_f32 v21, v22, v23
v_cvt_pk_bf16_f32 v22, v44, v45
v_mfma_f32_16x16x32_bf16 a[132:135], a[172:175], a[224:227], 0
v_cvt_pk_bf16_f32 v23, v46, v47
v_mul_f32 v28, v28, v6
v_mfma_f32_16x16x32_bf16 a[132:135], a[168:171], a[212:215], a[132:135]
ds_write_b128 v1, v[20:23] offset:3072
v_mfma_f32_16x16x32_bf16 a[140:143], a[168:171], a[216:219], 0
v_mul_f32 v29, v29, v6
v_mul_f32 v30, v30, v6
v_mfma_f32_16x16x32_bf16 a[140:143], a[172:175], a[228:231], a[140:143]
s_waitcnt lgkmcnt(7)
ds_read_b64_tr_b16 a[192:193], v9 offset:32768
v_mul_f32 v31, v31, v6
v_mfma_f32_16x16x32_bf16 a[120:123], a[176:179], a[232:235], a[120:123]
ds_read_b64_tr_b16 a[194:195], v9 offset:34816
v_mul_f32 v52, v52, v6
v_mfma_f32_16x16x32_bf16 a[120:123], a[180:183], a[244:247], a[120:123]
ds_read_b64_tr_b16 a[196:197], v9 offset:36864
v_mul_f32 v53, v53, v6
v_mfma_f32_16x16x32_bf16 a[128:131], a[180:183], a[248:251], a[128:131]
ds_read_b64_tr_b16 a[198:199], v9 offset:38912
v_mul_f32 v54, v54, v6
v_mfma_f32_16x16x32_bf16 a[128:131], a[176:179], a[236:239], a[128:131]
ds_read_b64_tr_b16 a[200:201], v15 offset:32768
v_mul_f32 v55, v55, v6
v_mfma_f32_16x16x32_bf16 a[136:139], a[176:179], a[240:243], a[136:139]
ds_read_b64_tr_b16 a[202:203], v15 offset:34816
v_cvt_pk_bf16_f32 v28, v28, v29
v_mfma_f32_16x16x32_bf16 a[136:139], a[180:183], a[252:255], a[136:139]
s_waitcnt lgkmcnt(9)
ds_read_b64_tr_b16 a[204:205], v15 offset:36864
v_cvt_pk_bf16_f32 v29, v30, v31
v_mfma_f32_16x16x32_bf16 a[124:127], a[184:187], a[232:235], a[124:127]
ds_read_b64_tr_b16 a[206:207], v15 offset:38912
v_cvt_pk_bf16_f32 v30, v52, v53
v_mfma_f32_16x16x32_bf16 a[124:127], a[188:191], a[244:247], a[124:127]
ds_read_b64_tr_b16 a[168:169], v9 offset:40960
v_cvt_pk_bf16_f32 v31, v54, v55
v_mfma_f32_16x16x32_bf16 a[132:135], a[188:191], a[248:251], a[132:135]
ds_read_b64_tr_b16 a[170:171], v9 offset:43008
v_mul_f32 v36, v36, v7
v_mfma_f32_16x16x32_bf16 a[132:135], a[184:187], a[236:239], a[132:135]
buffer_load_dwordx4 v4, s[36:39], s20 offen offset:0 lds
v_mfma_f32_16x16x32_bf16 a[140:143], a[184:187], a[240:243], a[140:143]
ds_read_b64_tr_b16 a[172:173], v9 offset:45056
v_mul_f32 v37, v37, v7
v_mfma_f32_16x16x32_bf16 a[140:143], a[188:191], a[252:255], a[140:143]
s_waitcnt lgkmcnt(7)
ds_read_b64_tr_b16 a[174:175], v9 offset:47104
v_mul_f32 v38, v38, v7
v_mfma_f32_16x16x32_bf16 a[144:147], a[192:195], a[208:211], 0
ds_read_b64_tr_b16 a[176:177], v15 offset:40960
v_mul_f32 v39, v39, v7
v_mfma_f32_16x16x32_bf16 a[144:147], a[196:199], a[220:223], a[144:147]
buffer_load_dwordx4 v4, s[36:39], s21 offen offset:1024 lds
v_mfma_f32_16x16x32_bf16 a[152:155], a[196:199], a[224:227], 0
ds_read_b64_tr_b16 a[178:179], v15 offset:43008
v_mul_f32 v60, v60, v7
v_mfma_f32_16x16x32_bf16 a[152:155], a[192:195], a[212:215], a[152:155]
ds_read_b64_tr_b16 a[180:181], v15 offset:45056
v_mul_f32 v61, v61, v7
v_mfma_f32_16x16x32_bf16 a[160:163], a[192:195], a[216:219], 0
ds_read_b64_tr_b16 a[182:183], v15 offset:47104
v_mul_f32 v62, v62, v7
v_mfma_f32_16x16x32_bf16 a[160:163], a[196:199], a[228:231], a[160:163]
s_waitcnt lgkmcnt(8)
buffer_load_dwordx4 v4, s[36:39], s22 offen offset:2048 lds
v_mfma_f32_16x16x32_bf16 a[148:151], a[200:203], a[208:211], 0
ds_write_b128 v1, v[28:31] offset:4096
v_mfma_f32_16x16x32_bf16 a[148:151], a[204:207], a[220:223], a[148:151]
v_mul_f32 v63, v63, v7
v_cvt_pk_bf16_f32 v36, v36, v37
v_mfma_f32_16x16x32_bf16 a[156:159], a[204:207], a[224:227], 0
v_cvt_pk_bf16_f32 v37, v38, v39
v_cvt_pk_bf16_f32 v38, v60, v61
v_mfma_f32_16x16x32_bf16 a[156:159], a[200:203], a[212:215], a[156:159]
v_cvt_pk_bf16_f32 v39, v62, v63
v_add_u32 v10, 0x10000, v10
v_mfma_f32_16x16x32_bf16 a[164:167], a[200:203], a[216:219], 0
buffer_load_dwordx4 v4, s[36:39], s23 offen offset:3072 lds
v_add_u32 v11, 0x10000, v11
v_add_u32 v12, 0x10000, v12
v_add_u32 v13, 0x10000, v13
v_mfma_f32_16x16x32_bf16 a[164:167], a[204:207], a[228:231], a[164:167]
s_waitcnt vmcnt(8) lgkmcnt(1)
s_barrier
ds_read_b64_tr_b16 a[184:185], v10 offset:0
v_mfma_f32_16x16x32_bf16 a[144:147], a[168:171], a[232:235], a[144:147]
s_add_u32 s20, s62, 57344
ds_write_b128 v1, v[36:39] offset:5120
v_mfma_f32_16x16x32_bf16 a[144:147], a[172:175], a[244:247], a[144:147]
s_add_u32 s21, s62, 63488
ds_read_b64_tr_b16 a[186:187], v10 offset:2048
s_add_u32 s22, s62, 69632
v_mfma_f32_16x16x32_bf16 a[152:155], a[172:175], a[248:251], a[152:155]
s_add_u32 s23, s62, 75776
ds_read_b64_tr_b16 a[188:189], v10 offset:4096
s_add_u32 m0, s59, 81920
v_mfma_f32_16x16x32_bf16 a[152:155], a[168:171], a[236:239], a[152:155]
ds_read_b64_tr_b16 a[190:191], v10 offset:6144
v_mfma_f32_16x16x32_bf16 a[160:163], a[168:171], a[240:243], a[160:163]
buffer_load_dwordx4 v4, s[36:39], s20 offen offset:0 lds
v_mfma_f32_16x16x32_bf16 a[160:163], a[172:175], a[252:255], a[160:163]
s_waitcnt lgkmcnt(6)
ds_read_b64_tr_b16 a[192:193], v11 offset:0
v_mfma_f32_16x16x32_bf16 a[148:151], a[176:179], a[232:235], a[148:151]
ds_read_b64_tr_b16 a[194:195], v11 offset:2048
v_mfma_f32_16x16x32_bf16 a[148:151], a[180:183], a[244:247], a[148:151]
ds_read_b64_tr_b16 a[196:197], v11 offset:4096
v_mfma_f32_16x16x32_bf16 a[156:159], a[180:183], a[248:251], a[156:159]
buffer_load_dwordx4 v4, s[36:39], s21 offen offset:1024 lds
v_mfma_f32_16x16x32_bf16 a[156:159], a[176:179], a[236:239], a[156:159]
s_add_u32 s70, s68, 131840
ds_read_b64_tr_b16 a[198:199], v11 offset:6144
s_add_u32 s71, s68, 131328
v_mfma_f32_16x16x32_bf16 a[164:167], a[176:179], a[240:243], a[164:167]
s_add_u32 s72, s68, 137984
s_add_u32 s73, s68, 137472
s_add_u32 m0, s58, 32768
v_mfma_f32_16x16x32_bf16 a[164:167], a[180:183], a[252:255], a[164:167]
s_waitcnt lgkmcnt(4)
s_waitcnt lgkmcnt(7)
s_barrier
v_mfma_f32_16x16x32_bf16 v[64:67], a[184:187], v[88:91], 0
buffer_load_dwordx4 v3, s[28:31], s70 offen offset:0 nt lds
v_mfma_f32_16x16x32_bf16 v[64:67], a[188:191], v[100:103], v[64:67]
ds_read_b64_tr_b16 a[200:201], v12 offset:0
v_mfma_f32_16x16x32_bf16 v[68:71], a[188:191], v[104:107], 0
ds_read_b64_tr_b16 a[202:203], v12 offset:2048
v_mfma_f32_16x16x32_bf16 v[68:71], a[184:187], v[92:95], v[68:71]
ds_read_b64_tr_b16 a[204:205], v12 offset:4096
v_mfma_f32_16x16x32_bf16 v[72:75], a[184:187], v[96:99], 0
ds_read_b64_tr_b16 a[206:207], v12 offset:6144
v_mfma_f32_16x16x32_bf16 v[72:75], a[188:191], v[108:111], v[72:75]
s_waitcnt lgkmcnt(4)
buffer_load_dwordx4 v3, s[28:31], s71 offen offset:1024 nt lds
v_mfma_f32_16x16x32_bf16 v[76:79], a[192:195], v[88:91], 0
ds_read_b64_tr_b16 a[168:169], v13 offset:0
v_mfma_f32_16x16x32_bf16 v[76:79], a[196:199], v[100:103], v[76:79]
ds_read_b64_tr_b16 a[170:171], v13 offset:2048
v_mfma_f32_16x16x32_bf16 v[80:83], a[196:199], v[104:107], 0
ds_read_b64_tr_b16 a[172:173], v13 offset:4096
v_mfma_f32_16x16x32_bf16 v[80:83], a[192:195], v[92:95], v[80:83]
ds_read_b64_tr_b16 a[174:175], v13 offset:6144
v_mfma_f32_16x16x32_bf16 v[84:87], a[192:195], v[96:99], 0
ds_read_b64_tr_b16 a[176:177], v10 offset:8192
v_mfma_f32_16x16x32_bf16 v[84:87], a[196:199], v[108:111], v[84:87]
s_waitcnt lgkmcnt(5)
buffer_load_dwordx4 v3, s[28:31], s72 offen offset:2048 nt lds
v_mfma_f32_16x16x32_bf16 v[20:23], a[200:203], v[88:91], 0
ds_read_b64_tr_b16 a[178:179], v10 offset:10240
v_mfma_f32_16x16x32_bf16 v[20:23], a[204:207], v[100:103], v[20:23]
ds_read_b64_tr_b16 a[180:181], v10 offset:12288
v_mfma_f32_16x16x32_bf16 v[28:31], a[204:207], v[104:107], 0
ds_read_b64_tr_b16 a[182:183], v10 offset:14336
v_mfma_f32_16x16x32_bf16 v[28:31], a[200:203], v[92:95], v[28:31]
ds_read_b64_tr_b16 a[184:185], v11 offset:8192
v_mfma_f32_16x16x32_bf16 v[36:39], a[200:203], v[96:99], 0
ds_read_b64_tr_b16 a[186:187], v11 offset:10240
v_mfma_f32_16x16x32_bf16 v[36:39], a[204:207], v[108:111], v[36:39]
s_waitcnt lgkmcnt(6)
buffer_load_dwordx4 v3, s[28:31], s73 offen offset:3072 nt lds
v_mfma_f32_16x16x32_bf16 v[44:47], a[168:171], v[88:91], 0
ds_read_b64_tr_b16 a[188:189], v11 offset:12288
v_mfma_f32_16x16x32_bf16 v[44:47], a[172:175], v[100:103], v[44:47]
ds_read_b64_tr_b16 a[190:191], v11 offset:14336
v_mfma_f32_16x16x32_bf16 v[52:55], a[172:175], v[104:107], 0
ds_read_b64_tr_b16 a[192:193], v12 offset:8192
v_mfma_f32_16x16x32_bf16 v[52:55], a[168:171], v[92:95], v[52:55]
ds_read_b64_tr_b16 a[194:195], v12 offset:10240
v_mfma_f32_16x16x32_bf16 v[60:63], a[168:171], v[96:99], 0
ds_read_b64_tr_b16 a[196:197], v12 offset:12288
v_mfma_f32_16x16x32_bf16 v[60:63], a[172:175], v[108:111], v[60:63]
s_waitcnt lgkmcnt(7)
ds_read_b64_tr_b16 a[198:199], v12 offset:14336
v_mfma_f32_16x16x32_bf16 v[64:67], a[176:179], v[112:115], v[64:67]
ds_read_b64_tr_b16 a[200:201], v13 offset:8192
v_mfma_f32_16x16x32_bf16 v[64:67], a[180:183], v[124:127], v[64:67]
ds_read_b64_tr_b16 a[202:203], v13 offset:10240
ds_read_b64_tr_b16 a[204:205], v13 offset:12288
v_mfma_f32_16x16x32_bf16 v[68:71], a[180:183], v[128:131], v[68:71]
ds_read_b64_tr_b16 a[206:207], v13 offset:14336
v_mfma_f32_16x16x32_bf16 v[68:71], a[176:179], v[116:119], v[68:71]
ds_read_b128 a[208:211], v2 offset:0
v_mfma_f32_16x16x32_bf16 v[72:75], a[176:179], v[120:123], v[72:75]
ds_read_b128 a[212:215], v2 offset:1024
v_mfma_f32_16x16x32_bf16 v[72:75], a[180:183], v[132:135], v[72:75]
s_waitcnt lgkmcnt(10)
ds_read_b128 a[216:219], v2 offset:2048
v_subrev_u32 v9, 0x10000, v9
v_mfma_f32_16x16x32_bf16 v[76:79], a[184:187], v[112:115], v[76:79]
ds_read_b128 a[220:223], v2 offset:3072
v_subrev_u32 v15, 0x10000, v15
v_mfma_f32_16x16x32_bf16 v[76:79], a[188:191], v[124:127], v[76:79]
ds_read_b128 a[224:227], v2 offset:4096
v_mfma_f32_16x16x32_bf16 v[80:83], a[188:191], v[128:131], v[80:83]
ds_read_b128 a[228:231], v2 offset:5120
v_mfma_f32_16x16x32_bf16 v[80:83], a[184:187], v[116:119], v[80:83]
s_add_u32 m0, s59, 81920
ds_read_b128 a[232:235], v2 offset:6144
v_mfma_f32_16x16x32_bf16 v[84:87], a[184:187], v[120:123], v[84:87]
ds_read_b128 a[236:239], v2 offset:7168
v_mfma_f32_16x16x32_bf16 v[84:87], a[188:191], v[132:135], v[84:87]
s_waitcnt lgkmcnt(12)
ds_read_b64_tr_b16 a[168:169], v9 offset:16384
v_mfma_f32_16x16x32_bf16 v[20:23], a[192:195], v[112:115], v[20:23]
ds_read_b64_tr_b16 a[170:171], v9 offset:18432
v_mfma_f32_16x16x32_bf16 v[20:23], a[196:199], v[124:127], v[20:23]
ds_read_b64_tr_b16 a[172:173], v9 offset:20480
v_mfma_f32_16x16x32_bf16 v[28:31], a[196:199], v[128:131], v[28:31]
ds_read_b64_tr_b16 a[174:175], v9 offset:22528
v_mfma_f32_16x16x32_bf16 v[28:31], a[192:195], v[116:119], v[28:31]
ds_read_b64_tr_b16 a[176:177], v15 offset:16384
v_mfma_f32_16x16x32_bf16 v[36:39], a[192:195], v[120:123], v[36:39]
ds_read_b64_tr_b16 a[178:179], v15 offset:18432
v_mfma_f32_16x16x32_bf16 v[36:39], a[196:199], v[132:135], v[36:39]
s_waitcnt lgkmcnt(14)
ds_read_b64_tr_b16 a[180:181], v15 offset:20480
v_mfma_f32_16x16x32_bf16 v[44:47], a[200:203], v[112:115], v[44:47]
ds_read_b64_tr_b16 a[182:183], v15 offset:22528
v_mfma_f32_16x16x32_bf16 v[44:47], a[204:207], v[124:127], v[44:47]
ds_read_b128 a[240:243], v2 offset:8192
v_mfma_f32_16x16x32_bf16 v[52:55], a[204:207], v[128:131], v[52:55]
ds_read_b128 a[244:247], v2 offset:9216
v_mfma_f32_16x16x32_bf16 v[52:55], a[200:203], v[116:119], v[52:55]
ds_read_b128 a[248:251], v2 offset:10240
v_mfma_f32_16x16x32_bf16 v[60:63], a[200:203], v[120:123], v[60:63]
s_waitcnt lgkmcnt(13)
ds_read_b128 a[252:255], v2 offset:11264
v_mfma_f32_16x16x32_bf16 v[60:63], a[204:207], v[132:135], v[60:63]
s_waitcnt lgkmcnt(8)
ds_read_b64_tr_b16 a[184:185], v9 offset:24576
v_mfma_f32_16x16x32_bf16 a[0:3], a[168:171], a[208:211], a[0:3]
ds_read_b64_tr_b16 a[186:187], v9 offset:26624
v_mfma_f32_16x16x32_bf16 a[0:3], a[172:175], a[220:223], a[0:3]
ds_read_b64_tr_b16 a[188:189], v9 offset:28672
v_mfma_f32_16x16x32_bf16 a[8:11], a[172:175], a[224:227], a[8:11]
ds_read_b64_tr_b16 a[190:191], v9 offset:30720
v_mfma_f32_16x16x32_bf16 a[8:11], a[168:171], a[212:215], a[8:11]
ds_read_b64_tr_b16 a[192:193], v15 offset:24576
v_mfma_f32_16x16x32_bf16 a[16:19], a[168:171], a[216:219], a[16:19]
ds_read_b64_tr_b16 a[194:195], v15 offset:26624
v_mfma_f32_16x16x32_bf16 a[16:19], a[172:175], a[228:231], a[16:19]
s_waitcnt lgkmcnt(10)
buffer_load_dwordx4 v4, s[36:39], s22 offen offset:2048 lds
v_mfma_f32_16x16x32_bf16 a[4:7], a[176:179], a[208:211], a[4:7]
ds_read_b64_tr_b16 a[196:197], v15 offset:28672
v_mfma_f32_16x16x32_bf16 a[4:7], a[180:183], a[220:223], a[4:7]
ds_read_b64_tr_b16 a[198:199], v15 offset:30720
v_mfma_f32_16x16x32_bf16 a[12:15], a[180:183], a[224:227], a[12:15]
v_mfma_f32_16x16x32_bf16 a[12:15], a[176:179], a[212:215], a[12:15]
buffer_load_dwordx4 v4, s[36:39], s23 offen offset:3072 lds
v_mfma_f32_16x16x32_bf16 a[20:23], a[176:179], a[216:219], a[20:23]
s_waitcnt lgkmcnt(8)
s_add_u32 s20, s63, 57344
s_add_u32 s21, s63, 63488
v_mfma_f32_16x16x32_bf16 a[20:23], a[180:183], a[228:231], a[20:23]
s_waitcnt vmcnt(8) lgkmcnt(0)
s_barrier
ds_read_b64_tr_b16 a[200:201], v9 offset:49152
v_mfma_f32_16x16x32_bf16 a[0:3], a[184:187], a[232:235], a[0:3]
s_add_u32 s22, s63, 69632
ds_read_b64_tr_b16 a[202:203], v9 offset:51200
s_add_u32 s23, s63, 75776
v_mfma_f32_16x16x32_bf16 a[0:3], a[188:191], a[244:247], a[0:3]
s_add_u32 m0, s59, 98304
ds_read_b64_tr_b16 a[204:205], v9 offset:53248
v_mfma_f32_16x16x32_bf16 a[8:11], a[188:191], a[248:251], a[8:11]
ds_read_b64_tr_b16 a[206:207], v9 offset:55296
v_mfma_f32_16x16x32_bf16 a[8:11], a[184:187], a[236:239], a[8:11]
ds_read_b64_tr_b16 a[168:169], v15 offset:49152
v_mfma_f32_16x16x32_bf16 a[16:19], a[184:187], a[240:243], a[16:19]
buffer_load_dwordx4 v4, s[36:39], s20 offen offset:0 lds
v_mfma_f32_16x16x32_bf16 a[16:19], a[188:191], a[252:255], a[16:19]
s_waitcnt lgkmcnt(5)
ds_read_b64_tr_b16 a[170:171], v15 offset:51200
v_mfma_f32_16x16x32_bf16 a[4:7], a[192:195], a[232:235], a[4:7]
ds_read_b64_tr_b16 a[172:173], v15 offset:53248
v_mfma_f32_16x16x32_bf16 a[4:7], a[196:199], a[244:247], a[4:7]
ds_read_b64_tr_b16 a[174:175], v15 offset:55296
v_mfma_f32_16x16x32_bf16 a[12:15], a[196:199], a[248:251], a[12:15]
buffer_load_dwordx4 v4, s[36:39], s21 offen offset:1024 lds
v_mfma_f32_16x16x32_bf16 a[12:15], a[192:195], a[236:239], a[12:15]
ds_read_b64_tr_b16 a[176:177], v9 offset:57344
v_mfma_f32_16x16x32_bf16 a[20:23], a[192:195], a[240:243], a[20:23]
ds_read_b64_tr_b16 a[178:179], v9 offset:59392
v_mfma_f32_16x16x32_bf16 a[20:23], a[196:199], a[252:255], a[20:23]
s_waitcnt lgkmcnt(6)
ds_read_b64_tr_b16 a[180:181], v9 offset:61440
v_mfma_f32_16x16x32_bf16 a[24:27], a[200:203], a[208:211], a[24:27]
buffer_load_dwordx4 v4, s[36:39], s22 offen offset:2048 lds
v_mfma_f32_16x16x32_bf16 a[24:27], a[204:207], a[220:223], a[24:27]
ds_read_b64_tr_b16 a[182:183], v9 offset:63488
v_mfma_f32_16x16x32_bf16 a[32:35], a[204:207], a[224:227], a[32:35]
ds_read_b64_tr_b16 a[184:185], v15 offset:57344
v_mfma_f32_16x16x32_bf16 a[32:35], a[200:203], a[212:215], a[32:35]
ds_read_b64_tr_b16 a[186:187], v15 offset:59392
v_mfma_f32_16x16x32_bf16 a[40:43], a[200:203], a[216:219], a[40:43]
buffer_load_dwordx4 v4, s[36:39], s23 offen offset:3072 lds
v_mfma_f32_16x16x32_bf16 a[40:43], a[204:207], a[228:231], a[40:43]
s_waitcnt lgkmcnt(6)
ds_read_b64_tr_b16 a[188:189], v15 offset:61440
s_add_u32 s70, s68, 197376
v_mfma_f32_16x16x32_bf16 a[28:31], a[168:171], a[208:211], a[28:31]
s_add_u32 s71, s68, 196864
s_add_u32 s72, s68, 203520
s_add_u32 s73, s68, 203008
s_add_u32 m0, s58, 114688
v_mfma_f32_16x16x32_bf16 a[28:31], a[172:175], a[220:223], a[28:31]
ds_read_b64_tr_b16 a[190:191], v15 offset:63488
v_subrev_u32 v10, 0x10000, v10
v_mfma_f32_16x16x32_bf16 a[36:39], a[172:175], a[224:227], a[36:39]
buffer_load_dwordx4 v3, s[28:31], s70 offen offset:0 nt lds
v_mfma_f32_16x16x32_bf16 a[36:39], a[168:171], a[212:215], a[36:39]
v_subrev_u32 v11, 0x10000, v11
v_subrev_u32 v12, 0x10000, v12
v_mfma_f32_16x16x32_bf16 a[44:47], a[168:171], a[216:219], a[44:47]
v_subrev_u32 v13, 0x10000, v13
v_mfma_f32_16x16x32_bf16 a[44:47], a[172:175], a[228:231], a[44:47]
s_waitcnt lgkmcnt(4)
ds_read_b64_tr_b16 a[192:193], v10 offset:0
v_mfma_f32_16x16x32_bf16 a[24:27], a[176:179], a[232:235], a[24:27]
ds_read_b64_tr_b16 a[194:195], v10 offset:2048
v_mfma_f32_16x16x32_bf16 a[24:27], a[180:183], a[244:247], a[24:27]
buffer_load_dwordx4 v3, s[28:31], s71 offen offset:1024 nt lds
v_mfma_f32_16x16x32_bf16 a[32:35], a[180:183], a[248:251], a[32:35]
ds_read_b64_tr_b16 a[196:197], v10 offset:4096
v_mfma_f32_16x16x32_bf16 a[32:35], a[176:179], a[236:239], a[32:35]
ds_read_b64_tr_b16 a[198:199], v10 offset:6144
v_mfma_f32_16x16x32_bf16 a[40:43], a[176:179], a[240:243], a[40:43]
ds_read_b64_tr_b16 a[200:201], v11 offset:0
v_mfma_f32_16x16x32_bf16 a[40:43], a[180:183], a[252:255], a[40:43]
s_waitcnt lgkmcnt(5)
ds_read_b64_tr_b16 a[202:203], v11 offset:2048
v_mfma_f32_16x16x32_bf16 a[28:31], a[184:187], a[232:235], a[28:31]
ds_read_b64_tr_b16 a[204:205], v11 offset:4096
v_mfma_f32_16x16x32_bf16 a[28:31], a[188:191], a[244:247], a[28:31]
buffer_load_dwordx4 v3, s[28:31], s72 offen offset:2048 nt lds
v_mfma_f32_16x16x32_bf16 a[36:39], a[188:191], a[248:251], a[36:39]
ds_read_b64_tr_b16 a[206:207], v11 offset:6144
v_mfma_f32_16x16x32_bf16 a[36:39], a[184:187], a[236:239], a[36:39]
ds_read_b64_tr_b16 a[168:169], v12 offset:0
v_mfma_f32_16x16x32_bf16 a[44:47], a[184:187], a[240:243], a[44:47]
ds_read_b64_tr_b16 a[170:171], v12 offset:2048
v_mfma_f32_16x16x32_bf16 a[44:47], a[188:191], a[252:255], a[44:47]
s_waitcnt lgkmcnt(6)
ds_read_b64_tr_b16 a[172:173], v12 offset:4096
v_mfma_f32_16x16x32_bf16 v[64:67], a[192:195], v[136:139], v[64:67]
ds_read_b64_tr_b16 a[174:175], v12 offset:6144
v_mfma_f32_16x16x32_bf16 v[64:67], a[196:199], v[148:151], v[64:67]
buffer_load_dwordx4 v3, s[28:31], s73 offen offset:3072 nt lds
v_mfma_f32_16x16x32_bf16 v[68:71], a[196:199], v[152:155], v[68:71]
s_add_u32 s20, s60, 114688
ds_read_b64_tr_b16 a[176:177], v13 offset:0
s_add_u32 s21, s60, 120832
v_mfma_f32_16x16x32_bf16 v[68:71], a[192:195], v[140:143], v[68:71]
s_add_u32 s22, s60, 126976
ds_read_b64_tr_b16 a[178:179], v13 offset:2048
s_add_u32 s23, s60, 133120
v_mfma_f32_16x16x32_bf16 v[72:75], a[192:195], v[144:147], v[72:75]
s_add_u32 m0, s59, 65536
ds_read_b64_tr_b16 a[180:181], v13 offset:4096
v_mfma_f32_16x16x32_bf16 v[72:75], a[196:199], v[156:159], v[72:75]
s_waitcnt lgkmcnt(7)
ds_read_b64_tr_b16 a[182:183], v13 offset:6144
v_mfma_f32_16x16x32_bf16 v[76:79], a[200:203], v[136:139], v[76:79]
ds_read_b64_tr_b16 a[184:185], v10 offset:8192
v_mfma_f32_16x16x32_bf16 v[76:79], a[204:207], v[148:151], v[76:79]
ds_read_b64_tr_b16 a[186:187], v10 offset:10240
v_mfma_f32_16x16x32_bf16 v[80:83], a[204:207], v[152:155], v[80:83]
ds_read_b64_tr_b16 a[188:189], v10 offset:12288
v_mfma_f32_16x16x32_bf16 v[80:83], a[200:203], v[140:143], v[80:83]
ds_read_b64_tr_b16 a[190:191], v10 offset:14336
v_mfma_f32_16x16x32_bf16 v[84:87], a[200:203], v[144:147], v[84:87]
ds_read_b64_tr_b16 a[192:193], v11 offset:8192
v_mfma_f32_16x16x32_bf16 v[84:87], a[204:207], v[156:159], v[84:87]
s_waitcnt lgkmcnt(9)
ds_read_b64_tr_b16 a[194:195], v11 offset:10240
v_mfma_f32_16x16x32_bf16 v[20:23], a[168:171], v[136:139], v[20:23]
ds_read_b64_tr_b16 a[196:197], v11 offset:12288
v_mfma_f32_16x16x32_bf16 v[20:23], a[172:175], v[148:151], v[20:23]
ds_read_b64_tr_b16 a[198:199], v11 offset:14336
v_mfma_f32_16x16x32_bf16 v[28:31], a[172:175], v[152:155], v[28:31]
ds_read_b64_tr_b16 a[200:201], v12 offset:8192
v_mfma_f32_16x16x32_bf16 v[28:31], a[168:171], v[140:143], v[28:31]
ds_read_b64_tr_b16 a[202:203], v12 offset:10240
v_mfma_f32_16x16x32_bf16 v[36:39], a[168:171], v[144:147], v[36:39]
ds_read_b64_tr_b16 a[204:205], v12 offset:12288
v_mfma_f32_16x16x32_bf16 v[36:39], a[172:175], v[156:159], v[36:39]
s_waitcnt lgkmcnt(11)
ds_read_b64_tr_b16 a[206:207], v12 offset:14336
v_mfma_f32_16x16x32_bf16 v[44:47], a[176:179], v[136:139], v[44:47]
ds_read_b64_tr_b16 a[168:169], v13 offset:8192
v_mfma_f32_16x16x32_bf16 v[44:47], a[180:183], v[148:151], v[44:47]
ds_read_b64_tr_b16 a[170:171], v13 offset:10240
v_mfma_f32_16x16x32_bf16 v[52:55], a[180:183], v[152:155], v[52:55]
ds_read_b64_tr_b16 a[172:173], v13 offset:12288
v_mfma_f32_16x16x32_bf16 v[52:55], a[176:179], v[140:143], v[52:55]
buffer_load_dwordx4 v4, s[36:39], s20 offen offset:0 lds
v_mfma_f32_16x16x32_bf16 v[60:63], a[176:179], v[144:147], v[60:63]
ds_read_b64_tr_b16 a[174:175], v13 offset:14336
v_mfma_f32_16x16x32_bf16 v[60:63], a[180:183], v[156:159], v[60:63]
s_waitcnt lgkmcnt(12)
v_mfma_f32_16x16x32_bf16 v[64:67], a[184:187], v[160:163], v[64:67]
v_mfma_f32_16x16x32_bf16 v[64:67], a[188:191], v[172:175], v[64:67]
buffer_load_dwordx4 v4, s[36:39], s21 offen offset:1024 lds
v_mfma_f32_16x16x32_bf16 v[68:71], a[188:191], v[176:179], v[68:71]
v_mfma_f32_16x16x32_bf16 v[68:71], a[184:187], v[164:167], v[68:71]
v_mfma_f32_16x16x32_bf16 v[72:75], a[184:187], v[168:171], v[72:75]
v_mfma_f32_16x16x32_bf16 v[72:75], a[188:191], v[180:183], v[72:75]
s_waitcnt lgkmcnt(8)
buffer_load_dwordx4 v4, s[36:39], s22 offen offset:2048 lds
v_mfma_f32_16x16x32_bf16 v[76:79], a[192:195], v[160:163], v[76:79]
v_add_u32 v9, 0x10000, v9
v_add_u32 v15, 0x10000, v15
v_mfma_f32_16x16x32_bf16 v[76:79], a[196:199], v[172:175], v[76:79]
v_mfma_f32_16x16x32_bf16 v[80:83], a[196:199], v[176:179], v[80:83]
v_mfma_f32_16x16x32_bf16 v[80:83], a[192:195], v[164:167], v[80:83]
buffer_load_dwordx4 v4, s[36:39], s23 offen offset:3072 lds
v_mfma_f32_16x16x32_bf16 v[84:87], a[192:195], v[168:171], v[84:87]
v_mfma_f32_16x16x32_bf16 v[84:87], a[196:199], v[180:183], v[84:87]
s_waitcnt vmcnt(12) lgkmcnt(0)
s_barrier
ds_read_b64_tr_b16 a[176:177], v9 offset:16384
v_mfma_f32_16x16x32_bf16 v[20:23], a[200:203], v[160:163], v[20:23]
ds_read_b64_tr_b16 a[178:179], v9 offset:18432
v_mfma_f32_16x16x32_bf16 v[20:23], a[204:207], v[172:175], v[20:23]
ds_read_b64_tr_b16 a[180:181], v9 offset:20480
v_mfma_f32_16x16x32_bf16 v[28:31], a[204:207], v[176:179], v[28:31]
ds_read_b64_tr_b16 a[182:183], v9 offset:22528
v_mfma_f32_16x16x32_bf16 v[28:31], a[200:203], v[164:167], v[28:31]
ds_read_b64_tr_b16 a[184:185], v15 offset:16384
v_mfma_f32_16x16x32_bf16 v[36:39], a[200:203], v[168:171], v[36:39]
ds_read_b64_tr_b16 a[186:187], v15 offset:18432
v_mfma_f32_16x16x32_bf16 v[36:39], a[204:207], v[180:183], v[36:39]
s_waitcnt lgkmcnt(6)
ds_read_b64_tr_b16 a[188:189], v15 offset:20480
s_add_u32 s20, s64, 57344
v_mfma_f32_16x16x32_bf16 v[44:47], a[168:171], v[160:163], v[44:47]
s_add_u32 s21, s64, 63488
ds_read_b64_tr_b16 a[190:191], v15 offset:22528
s_add_u32 s22, s64, 69632
v_mfma_f32_16x16x32_bf16 v[44:47], a[172:175], v[172:175], v[44:47]
s_add_u32 s23, s64, 75776
ds_read_b64_tr_b16 a[192:193], v9 offset:24576
s_add_u32 m0, s59, 16384
v_mfma_f32_16x16x32_bf16 v[52:55], a[172:175], v[176:179], v[52:55]
ds_read_b64_tr_b16 a[194:195], v9 offset:26624
v_mfma_f32_16x16x32_bf16 v[52:55], a[168:171], v[164:167], v[52:55]
ds_read_b64_tr_b16 a[196:197], v9 offset:28672
v_mfma_f32_16x16x32_bf16 v[60:63], a[168:171], v[168:171], v[60:63]
ds_read_b64_tr_b16 a[198:199], v9 offset:30720
v_mfma_f32_16x16x32_bf16 v[60:63], a[172:175], v[180:183], v[60:63]
s_waitcnt lgkmcnt(8)
ds_read_b64_tr_b16 a[200:201], v15 offset:24576
v_mfma_f32_16x16x32_bf16 a[48:51], a[176:179], a[208:211], a[48:51]
ds_read_b64_tr_b16 a[202:203], v15 offset:26624
v_mfma_f32_16x16x32_bf16 a[48:51], a[180:183], a[220:223], a[48:51]
ds_read_b64_tr_b16 a[204:205], v15 offset:28672
v_mfma_f32_16x16x32_bf16 a[56:59], a[180:183], a[224:227], a[56:59]
ds_read_b64_tr_b16 a[206:207], v15 offset:30720
v_mfma_f32_16x16x32_bf16 a[56:59], a[176:179], a[212:215], a[56:59]
v_mfma_f32_16x16x32_bf16 a[64:67], a[176:179], a[216:219], a[64:67]
v_mfma_f32_16x16x32_bf16 a[64:67], a[180:183], a[228:231], a[64:67]
s_waitcnt lgkmcnt(8)
v_mfma_f32_16x16x32_bf16 a[52:55], a[184:187], a[208:211], a[52:55]
v_mfma_f32_16x16x32_bf16 a[52:55], a[188:191], a[220:223], a[52:55]
v_mfma_f32_16x16x32_bf16 a[60:63], a[188:191], a[224:227], a[60:63]
v_mfma_f32_16x16x32_bf16 a[60:63], a[184:187], a[212:215], a[60:63]
v_mfma_f32_16x16x32_bf16 a[68:71], a[184:187], a[216:219], a[68:71]
v_mfma_f32_16x16x32_bf16 a[68:71], a[188:191], a[228:231], a[68:71]
s_waitcnt lgkmcnt(4)
ds_read_b64_tr_b16 a[168:169], v10 offset:32768
v_mfma_f32_16x16x32_bf16 a[48:51], a[192:195], a[232:235], a[48:51]
ds_read_b64_tr_b16 a[170:171], v10 offset:34816
v_mfma_f32_16x16x32_bf16 a[48:51], a[196:199], a[244:247], a[48:51]
buffer_load_dwordx4 v4, s[36:39], s20 offen offset:0 lds
v_mfma_f32_16x16x32_bf16 a[56:59], a[196:199], a[248:251], a[56:59]
ds_read_b64_tr_b16 a[172:173], v10 offset:36864
v_mfma_f32_16x16x32_bf16 a[56:59], a[192:195], a[236:239], a[56:59]
ds_read_b64_tr_b16 a[174:175], v10 offset:38912
v_mfma_f32_16x16x32_bf16 a[64:67], a[192:195], a[240:243], a[64:67]
ds_read_b64_tr_b16 a[176:177], v11 offset:32768
v_mfma_f32_16x16x32_bf16 a[64:67], a[196:199], a[252:255], a[64:67]
s_waitcnt lgkmcnt(5)
buffer_load_dwordx4 v4, s[36:39], s21 offen offset:1024 lds
v_mfma_f32_16x16x32_bf16 a[52:55], a[200:203], a[232:235], a[52:55]
ds_read_b64_tr_b16 a[178:179], v11 offset:34816
v_mfma_f32_16x16x32_bf16 a[52:55], a[204:207], a[244:247], a[52:55]
ds_read_b64_tr_b16 a[180:181], v11 offset:36864
v_mfma_f32_16x16x32_bf16 a[60:63], a[204:207], a[248:251], a[60:63]
ds_read_b64_tr_b16 a[182:183], v11 offset:38912
v_mfma_f32_16x16x32_bf16 a[60:63], a[200:203], a[236:239], a[60:63]
buffer_load_dwordx4 v4, s[36:39], s22 offen offset:2048 lds
v_mfma_f32_16x16x32_bf16 a[68:71], a[200:203], a[240:243], a[68:71]
ds_read_b64_tr_b16 a[184:185], v12 offset:32768
v_mfma_f32_16x16x32_bf16 a[68:71], a[204:207], a[252:255], a[68:71]
s_waitcnt lgkmcnt(5)
ds_read_b64_tr_b16 a[186:187], v12 offset:34816
v_mfma_f32_16x16x32_bf16 v[64:67], a[168:171], v[184:187], v[64:67]
ds_read_b64_tr_b16 a[188:189], v12 offset:36864
v_mfma_f32_16x16x32_bf16 v[64:67], a[172:175], v[196:199], v[64:67]
buffer_load_dwordx4 v4, s[36:39], s23 offen offset:3072 lds
v_mfma_f32_16x16x32_bf16 v[68:71], a[172:175], v[200:203], v[68:71]
s_add_u32 s20, s65, 57344
ds_read_b64_tr_b16 a[190:191], v12 offset:38912
s_add_u32 s21, s65, 63488
v_mfma_f32_16x16x32_bf16 v[68:71], a[168:171], v[188:191], v[68:71]
s_add_u32 s22, s65, 69632
ds_read_b64_tr_b16 a[192:193], v13 offset:32768
s_add_u32 s23, s65, 75776
v_mfma_f32_16x16x32_bf16 v[72:75], a[168:171], v[192:195], v[72:75]
s_add_u32 m0, s59, 49152
ds_read_b64_tr_b16 a[194:195], v13 offset:34816
v_mfma_f32_16x16x32_bf16 v[72:75], a[172:175], v[204:207], v[72:75]
s_waitcnt lgkmcnt(6)
buffer_load_dwordx4 v4, s[36:39], s20 offen offset:0 lds
v_mfma_f32_16x16x32_bf16 v[76:79], a[176:179], v[184:187], v[76:79]
ds_read_b64_tr_b16 a[196:197], v13 offset:36864
v_mfma_f32_16x16x32_bf16 v[76:79], a[180:183], v[196:199], v[76:79]
ds_read_b64_tr_b16 a[198:199], v13 offset:38912
v_mfma_f32_16x16x32_bf16 v[80:83], a[180:183], v[200:203], v[80:83]
ds_read_b64_tr_b16 a[200:201], v10 offset:40960
v_mfma_f32_16x16x32_bf16 v[80:83], a[176:179], v[188:191], v[80:83]
buffer_load_dwordx4 v4, s[36:39], s21 offen offset:1024 lds
v_mfma_f32_16x16x32_bf16 v[84:87], a[176:179], v[192:195], v[84:87]
ds_read_b64_tr_b16 a[202:203], v10 offset:43008
v_mfma_f32_16x16x32_bf16 v[84:87], a[180:183], v[204:207], v[84:87]
s_waitcnt lgkmcnt(6)
ds_read_b64_tr_b16 a[204:205], v10 offset:45056
v_mfma_f32_16x16x32_bf16 v[20:23], a[184:187], v[184:187], v[20:23]
ds_read_b64_tr_b16 a[206:207], v10 offset:47104
v_mfma_f32_16x16x32_bf16 v[20:23], a[188:191], v[196:199], v[20:23]
buffer_load_dwordx4 v4, s[36:39], s22 offen offset:2048 lds
v_mfma_f32_16x16x32_bf16 v[28:31], a[188:191], v[200:203], v[28:31]
ds_read_b64_tr_b16 a[168:169], v11 offset:40960
v_mfma_f32_16x16x32_bf16 v[28:31], a[184:187], v[188:191], v[28:31]
ds_read_b64_tr_b16 a[170:171], v11 offset:43008
v_mfma_f32_16x16x32_bf16 v[36:39], a[184:187], v[192:195], v[36:39]
ds_read_b64_tr_b16 a[172:173], v11 offset:45056
v_mfma_f32_16x16x32_bf16 v[36:39], a[188:191], v[204:207], v[36:39]
s_waitcnt lgkmcnt(7)
buffer_load_dwordx4 v4, s[36:39], s23 offen offset:3072 lds
v_mfma_f32_16x16x32_bf16 v[44:47], a[192:195], v[184:187], v[44:47]
s_add_u32 s20, s66, 57344
ds_read_b64_tr_b16 a[174:175], v11 offset:47104
s_add_u32 s21, s66, 63488
v_mfma_f32_16x16x32_bf16 v[44:47], a[196:199], v[196:199], v[44:47]
s_add_u32 s22, s66, 69632
ds_read_b64_tr_b16 a[176:177], v12 offset:40960
s_add_u32 s23, s66, 75776
v_mfma_f32_16x16x32_bf16 v[52:55], a[196:199], v[200:203], v[52:55]
s_add_u32 m0, s59, 0
ds_read_b64_tr_b16 a[178:179], v12 offset:43008
v_mfma_f32_16x16x32_bf16 v[52:55], a[192:195], v[188:191], v[52:55]
buffer_load_dwordx4 v4, s[36:39], s20 offen offset:0 lds
v_mfma_f32_16x16x32_bf16 v[60:63], a[192:195], v[192:195], v[60:63]
ds_read_b64_tr_b16 a[180:181], v12 offset:45056
v_mfma_f32_16x16x32_bf16 v[60:63], a[196:199], v[204:207], v[60:63]
s_waitcnt lgkmcnt(7)
ds_read_b64_tr_b16 a[182:183], v12 offset:47104
v_mfma_f32_16x16x32_bf16 v[64:67], a[200:203], v[208:211], v[64:67]
ds_read_b64_tr_b16 a[184:185], v13 offset:40960
v_mfma_f32_16x16x32_bf16 v[64:67], a[204:207], v[220:223], v[64:67]
buffer_load_dwordx4 v4, s[36:39], s21 offen offset:1024 lds
v_mfma_f32_16x16x32_bf16 v[68:71], a[204:207], v[224:227], v[68:71]
ds_read_b64_tr_b16 a[186:187], v13 offset:43008
v_mfma_f32_16x16x32_bf16 v[68:71], a[200:203], v[212:215], v[68:71]
ds_read_b64_tr_b16 a[188:189], v13 offset:45056
v_mfma_f32_16x16x32_bf16 v[72:75], a[200:203], v[216:219], v[72:75]
ds_read_b64_tr_b16 a[190:191], v13 offset:47104
v_mfma_f32_16x16x32_bf16 v[72:75], a[204:207], v[228:231], v[72:75]
s_waitcnt lgkmcnt(8)
buffer_load_dwordx4 v4, s[36:39], s22 offen offset:2048 lds
v_mfma_f32_16x16x32_bf16 v[76:79], a[168:171], v[208:211], v[76:79]
v_mfma_f32_16x16x32_bf16 v[76:79], a[172:175], v[220:223], v[76:79]
v_mfma_f32_16x16x32_bf16 v[80:83], a[172:175], v[224:227], v[80:83]
v_mfma_f32_16x16x32_bf16 v[80:83], a[168:171], v[212:215], v[80:83]
buffer_load_dwordx4 v4, s[36:39], s23 offen offset:3072 lds
v_mfma_f32_16x16x32_bf16 v[84:87], a[168:171], v[216:219], v[84:87]
s_add_u32 s70, s68, 896
s_add_u32 s71, s68, 384
s_add_u32 s72, s68, 7040
v_mfma_f32_16x16x32_bf16 v[84:87], a[172:175], v[228:231], v[84:87]
s_waitcnt vmcnt(16) lgkmcnt(0)
s_barrier
ds_read_b64_tr_b16 a[192:193], v9 offset:32768
v_mfma_f32_16x16x32_bf16 v[20:23], a[176:179], v[208:211], v[20:23]
s_add_u32 s73, s68, 6528
s_add_u32 m0, s58, 81920
ds_read_b64_tr_b16 a[194:195], v9 offset:34816
v_mfma_f32_16x16x32_bf16 v[20:23], a[180:183], v[220:223], v[20:23]
buffer_load_dwordx4 v3, s[28:31], s70 offen offset:0 nt lds
v_mfma_f32_16x16x32_bf16 v[28:31], a[180:183], v[224:227], v[28:31]
ds_read_b64_tr_b16 a[196:197], v9 offset:36864
v_mfma_f32_16x16x32_bf16 v[28:31], a[176:179], v[212:215], v[28:31]
ds_read_b64_tr_b16 a[198:199], v9 offset:38912
v_mfma_f32_16x16x32_bf16 v[36:39], a[176:179], v[216:219], v[36:39]
ds_read_b64_tr_b16 a[200:201], v15 offset:32768
v_mfma_f32_16x16x32_bf16 v[36:39], a[180:183], v[228:231], v[36:39]
s_waitcnt lgkmcnt(5)
ds_read_b64_tr_b16 a[202:203], v15 offset:34816
v_mfma_f32_16x16x32_bf16 v[44:47], a[184:187], v[208:211], v[44:47]
ds_read_b64_tr_b16 a[204:205], v15 offset:36864
v_mfma_f32_16x16x32_bf16 v[44:47], a[188:191], v[220:223], v[44:47]
buffer_load_dwordx4 v3, s[28:31], s71 offen offset:1024 nt lds
v_mfma_f32_16x16x32_bf16 v[52:55], a[188:191], v[224:227], v[52:55]
ds_read_b64_tr_b16 a[206:207], v15 offset:38912
v_mfma_f32_16x16x32_bf16 v[52:55], a[184:187], v[212:215], v[52:55]
ds_read_b64_tr_b16 a[168:169], v9 offset:40960
v_mfma_f32_16x16x32_bf16 v[60:63], a[184:187], v[216:219], v[60:63]
ds_read_b64_tr_b16 a[170:171], v9 offset:43008
v_mfma_f32_16x16x32_bf16 v[60:63], a[188:191], v[228:231], v[60:63]
s_waitcnt lgkmcnt(6)
ds_read_b64_tr_b16 a[172:173], v9 offset:45056
v_mfma_f32_16x16x32_bf16 a[72:75], a[192:195], a[208:211], a[72:75]
ds_read_b64_tr_b16 a[174:175], v9 offset:47104
v_mfma_f32_16x16x32_bf16 a[72:75], a[196:199], a[220:223], a[72:75]
buffer_load_dwordx4 v3, s[28:31], s72 offen offset:2048 nt lds
v_mfma_f32_16x16x32_bf16 a[80:83], a[196:199], a[224:227], a[80:83]
ds_read_b64_tr_b16 a[176:177], v15 offset:40960
v_mfma_f32_16x16x32_bf16 a[80:83], a[192:195], a[212:215], a[80:83]
ds_read_b64_tr_b16 a[178:179], v15 offset:43008
v_mfma_f32_16x16x32_bf16 a[88:91], a[192:195], a[216:219], a[88:91]
ds_read_b64_tr_b16 a[180:181], v15 offset:45056
v_mfma_f32_16x16x32_bf16 a[88:91], a[196:199], a[228:231], a[88:91]
s_waitcnt lgkmcnt(7)
ds_read_b64_tr_b16 a[182:183], v15 offset:47104
v_add_u32 v10, 0x10000, v10
v_mfma_f32_16x16x32_bf16 a[76:79], a[200:203], a[208:211], a[76:79]
v_add_u32 v11, 0x10000, v11
v_add_u32 v12, 0x10000, v12
v_mfma_f32_16x16x32_bf16 a[76:79], a[204:207], a[220:223], a[76:79]
buffer_load_dwordx4 v3, s[28:31], s73 offen offset:3072 nt lds
v_mfma_f32_16x16x32_bf16 a[84:87], a[204:207], a[224:227], a[84:87]
s_add_u32 s70, s68, 66432
v_add_u32 v13, 0x10000, v13
s_add_u32 s71, s68, 65920
v_mfma_f32_16x16x32_bf16 a[84:87], a[200:203], a[212:215], a[84:87]
s_add_u32 s72, s68, 72576
s_add_u32 s73, s68, 72064
s_add_u32 m0, s58, 32768
v_mfma_f32_16x16x32_bf16 a[92:95], a[200:203], a[216:219], a[92:95]
v_mfma_f32_16x16x32_bf16 a[92:95], a[204:207], a[228:231], a[92:95]
s_waitcnt lgkmcnt(4)
ds_read_b64_tr_b16 a[184:185], v10 offset:49152
v_mfma_f32_16x16x32_bf16 a[72:75], a[168:171], a[232:235], a[72:75]
ds_read_b64_tr_b16 a[186:187], v10 offset:51200
v_mfma_f32_16x16x32_bf16 a[72:75], a[172:175], a[244:247], a[72:75]
ds_read_b64_tr_b16 a[188:189], v10 offset:53248
v_mfma_f32_16x16x32_bf16 a[80:83], a[172:175], a[248:251], a[80:83]
ds_read_b64_tr_b16 a[190:191], v10 offset:55296
v_mfma_f32_16x16x32_bf16 a[80:83], a[168:171], a[236:239], a[80:83]
ds_read_b64_tr_b16 a[192:193], v10 offset:57344
v_mfma_f32_16x16x32_bf16 a[88:91], a[168:171], a[240:243], a[88:91]
ds_read_b64_tr_b16 a[194:195], v10 offset:59392
v_mfma_f32_16x16x32_bf16 a[88:91], a[172:175], a[252:255], a[88:91]
s_waitcnt lgkmcnt(6)
ds_read_b64_tr_b16 a[196:197], v10 offset:61440
v_mfma_f32_16x16x32_bf16 a[76:79], a[176:179], a[232:235], a[76:79]
ds_read_b64_tr_b16 a[198:199], v10 offset:63488
v_mfma_f32_16x16x32_bf16 a[76:79], a[180:183], a[244:247], a[76:79]
ds_read_b64_tr_b16 a[200:201], v11 offset:49152
v_mfma_f32_16x16x32_bf16 a[84:87], a[180:183], a[248:251], a[84:87]
ds_read_b64_tr_b16 a[202:203], v11 offset:51200
v_mfma_f32_16x16x32_bf16 a[84:87], a[176:179], a[236:239], a[84:87]
buffer_load_dwordx4 v3, s[28:31], s70 offen offset:0 nt lds
v_mfma_f32_16x16x32_bf16 a[92:95], a[176:179], a[240:243], a[92:95]
ds_read_b64_tr_b16 a[204:205], v11 offset:53248
v_mfma_f32_16x16x32_bf16 a[92:95], a[180:183], a[252:255], a[92:95]
s_waitcnt lgkmcnt(7)
ds_read_b64_tr_b16 a[206:207], v11 offset:55296
v_mfma_f32_16x16x32_bf16 v[64:67], a[184:187], v[232:235], v[64:67]
ds_read_b64_tr_b16 a[168:169], v11 offset:57344
v_mfma_f32_16x16x32_bf16 v[64:67], a[188:191], v[244:247], v[64:67]
ds_read_b64_tr_b16 a[170:171], v11 offset:59392
v_mfma_f32_16x16x32_bf16 v[68:71], a[188:191], v[248:251], v[68:71]
ds_read_b64_tr_b16 a[172:173], v11 offset:61440
v_mfma_f32_16x16x32_bf16 v[68:71], a[184:187], v[236:239], v[68:71]
buffer_load_dwordx4 v3, s[28:31], s71 offen offset:1024 nt lds
v_mfma_f32_16x16x32_bf16 v[72:75], a[184:187], v[240:243], v[72:75]
ds_read_b64_tr_b16 a[174:175], v11 offset:63488
v_mfma_f32_16x16x32_bf16 v[72:75], a[188:191], v[252:255], v[72:75]
s_waitcnt lgkmcnt(8)
ds_read_b64_tr_b16 a[176:177], v12 offset:49152
v_mfma_f32_16x16x32_bf16 v[64:67], a[192:195], v[16:19], v[64:67]
ds_read_b64_tr_b16 a[178:179], v12 offset:51200
v_mfma_f32_16x16x32_bf16 v[64:67], a[196:199], v[40:43], v[64:67]
ds_read_b64_tr_b16 a[180:181], v12 offset:53248
v_mfma_f32_16x16x32_bf16 v[68:71], a[196:199], v[48:51], v[68:71]
ds_read_b64_tr_b16 a[182:183], v12 offset:55296
v_mfma_f32_16x16x32_bf16 v[68:71], a[192:195], v[24:27], v[68:71]
buffer_load_dwordx4 v3, s[28:31], s72 offen offset:2048 nt lds
v_mfma_f32_16x16x32_bf16 v[72:75], a[192:195], v[32:35], v[72:75]
ds_read_b64_tr_b16 a[184:185], v12 offset:57344
v_mfma_f32_16x16x32_bf16 v[72:75], a[196:199], v[56:59], v[72:75]
s_waitcnt lgkmcnt(9)
ds_read_b64_tr_b16 a[186:187], v12 offset:59392
v_mfma_f32_16x16x32_bf16 v[76:79], a[200:203], v[232:235], v[76:79]
ds_read_b64_tr_b16 a[188:189], v12 offset:61440
v_mfma_f32_16x16x32_bf16 v[76:79], a[204:207], v[244:247], v[76:79]
ds_read_b64_tr_b16 a[190:191], v12 offset:63488
v_mfma_f32_16x16x32_bf16 v[80:83], a[204:207], v[248:251], v[80:83]
ds_read_b64_tr_b16 a[192:193], v13 offset:49152
v_mfma_f32_16x16x32_bf16 v[80:83], a[200:203], v[236:239], v[80:83]
buffer_load_dwordx4 v3, s[28:31], s73 offen offset:3072 nt lds
v_mfma_f32_16x16x32_bf16 v[84:87], a[200:203], v[240:243], v[84:87]
ds_read_b64_tr_b16 a[194:195], v13 offset:51200
v_mfma_f32_16x16x32_bf16 v[84:87], a[204:207], v[252:255], v[84:87]
s_waitcnt lgkmcnt(10)
ds_read_b64_tr_b16 a[196:197], v13 offset:53248
v_mfma_f32_16x16x32_bf16 v[76:79], a[168:171], v[16:19], v[76:79]
ds_read_b64_tr_b16 a[198:199], v13 offset:55296
v_mfma_f32_16x16x32_bf16 v[76:79], a[172:175], v[40:43], v[76:79]
ds_read_b64_tr_b16 a[200:201], v13 offset:57344
v_mfma_f32_16x16x32_bf16 v[80:83], a[172:175], v[48:51], v[80:83]
ds_read_b64_tr_b16 a[202:203], v13 offset:59392
v_mfma_f32_16x16x32_bf16 v[80:83], a[168:171], v[24:27], v[80:83]
ds_read_b64_tr_b16 a[204:205], v13 offset:61440
v_mfma_f32_16x16x32_bf16 v[84:87], a[168:171], v[32:35], v[84:87]
ds_read_b64_tr_b16 a[206:207], v13 offset:63488
v_mfma_f32_16x16x32_bf16 v[84:87], a[172:175], v[56:59], v[84:87]
s_waitcnt lgkmcnt(12)
v_mfma_f32_16x16x32_bf16 v[20:23], a[176:179], v[232:235], v[20:23]
v_mfma_f32_16x16x32_bf16 v[20:23], a[180:183], v[244:247], v[20:23]
v_mfma_f32_16x16x32_bf16 v[28:31], a[180:183], v[248:251], v[28:31]
v_mfma_f32_16x16x32_bf16 v[28:31], a[176:179], v[236:239], v[28:31]
v_mfma_f32_16x16x32_bf16 v[36:39], a[176:179], v[240:243], v[36:39]
v_mfma_f32_16x16x32_bf16 v[36:39], a[180:183], v[252:255], v[36:39]
s_waitcnt lgkmcnt(8)
v_subrev_u32 v9, 0x10000, v9
v_subrev_u32 v15, 0x10000, v15
v_mfma_f32_16x16x32_bf16 v[20:23], a[184:187], v[16:19], v[20:23]
v_mul_f32 v64, v64, v5
v_mul_f32 v65, v65, v5
v_mfma_f32_16x16x32_bf16 v[20:23], a[188:191], v[40:43], v[20:23]
v_mul_f32 v66, v66, v5
v_mul_f32 v67, v67, v5
v_mfma_f32_16x16x32_bf16 v[28:31], a[188:191], v[48:51], v[28:31]
v_mul_f32 v76, v76, v5
v_mul_f32 v77, v77, v5
v_mfma_f32_16x16x32_bf16 v[28:31], a[184:187], v[24:27], v[28:31]
v_mul_f32 v78, v78, v5
v_mul_f32 v79, v79, v5
v_mfma_f32_16x16x32_bf16 v[36:39], a[184:187], v[32:35], v[36:39]
v_cvt_pk_bf16_f32 v64, v64, v65
v_cvt_pk_bf16_f32 v65, v66, v67
v_mfma_f32_16x16x32_bf16 v[36:39], a[188:191], v[56:59], v[36:39]
s_waitcnt vmcnt(8) lgkmcnt(0)
s_barrier
ds_read_b64_tr_b16 a[168:169], v9 offset:16384
v_mfma_f32_16x16x32_bf16 v[44:47], a[192:195], v[232:235], v[44:47]
ds_read_b64_tr_b16 a[170:171], v9 offset:18432
v_cvt_pk_bf16_f32 v66, v76, v77
v_mfma_f32_16x16x32_bf16 v[44:47], a[196:199], v[244:247], v[44:47]
ds_read_b64_tr_b16 a[172:173], v9 offset:20480
v_cvt_pk_bf16_f32 v67, v78, v79
v_mfma_f32_16x16x32_bf16 v[52:55], a[196:199], v[248:251], v[52:55]
ds_read_b64_tr_b16 a[174:175], v9 offset:22528
v_mul_f32 v68, v68, v6
v_mfma_f32_16x16x32_bf16 v[52:55], a[192:195], v[236:239], v[52:55]
ds_read_b64_tr_b16 a[176:177], v15 offset:16384
v_mul_f32 v69, v69, v6
v_mfma_f32_16x16x32_bf16 v[60:63], a[192:195], v[240:243], v[60:63]
ds_read_b64_tr_b16 a[178:179], v15 offset:18432
v_mul_f32 v70, v70, v6
v_mfma_f32_16x16x32_bf16 v[60:63], a[196:199], v[252:255], v[60:63]
s_waitcnt lgkmcnt(6)
ds_read_b64_tr_b16 a[180:181], v15 offset:20480
v_mul_f32 v71, v71, v6
v_mfma_f32_16x16x32_bf16 v[44:47], a[200:203], v[16:19], v[44:47]
s_add_u32 s20, s61, 114688
ds_read_b64_tr_b16 a[182:183], v15 offset:22528
v_mul_f32 v80, v80, v6
v_mfma_f32_16x16x32_bf16 v[44:47], a[204:207], v[40:43], v[44:47]
s_add_u32 s21, s61, 120832
ds_read_b64_tr_b16 a[184:185], v9 offset:24576
v_mul_f32 v81, v81, v6
v_mfma_f32_16x16x32_bf16 v[52:55], a[204:207], v[48:51], v[52:55]
s_add_u32 s22, s61, 126976
ds_read_b64_tr_b16 a[186:187], v9 offset:26624
v_mul_f32 v82, v82, v6
v_mfma_f32_16x16x32_bf16 v[52:55], a[200:203], v[24:27], v[52:55]
s_add_u32 s23, s61, 133120
ds_read_b64_tr_b16 a[188:189], v9 offset:28672
v_mul_f32 v83, v83, v6
v_mfma_f32_16x16x32_bf16 v[60:63], a[200:203], v[32:35], v[60:63]
s_add_u32 m0, s59, 114688
ds_read_b64_tr_b16 a[190:191], v9 offset:30720
v_cvt_pk_bf16_f32 v68, v68, v69
v_mfma_f32_16x16x32_bf16 v[60:63], a[204:207], v[56:59], v[60:63]
s_waitcnt lgkmcnt(8)
ds_read_b64_tr_b16 a[192:193], v15 offset:24576
v_cvt_pk_bf16_f32 v69, v70, v71
v_mfma_f32_16x16x32_bf16 a[96:99], a[168:171], a[208:211], a[96:99]
ds_read_b64_tr_b16 a[194:195], v15 offset:26624
v_cvt_pk_bf16_f32 v70, v80, v81
v_mfma_f32_16x16x32_bf16 a[96:99], a[172:175], a[220:223], a[96:99]
ds_read_b64_tr_b16 a[196:197], v15 offset:28672
v_cvt_pk_bf16_f32 v71, v82, v83
v_mfma_f32_16x16x32_bf16 a[104:107], a[172:175], a[224:227], a[104:107]
ds_read_b64_tr_b16 a[198:199], v15 offset:30720
v_mul_f32 v72, v72, v7
v_mfma_f32_16x16x32_bf16 a[104:107], a[168:171], a[212:215], a[104:107]
ds_write_b128 v1, v[64:67] offset:0
v_mfma_f32_16x16x32_bf16 a[112:115], a[168:171], a[216:219], a[112:115]
ds_write_b128 v1, v[68:71] offset:1024
v_mfma_f32_16x16x32_bf16 a[112:115], a[172:175], a[228:231], a[112:115]
s_waitcnt lgkmcnt(10)
v_mul_f32 v73, v73, v7
v_mul_f32 v74, v74, v7
v_mfma_f32_16x16x32_bf16 a[100:103], a[176:179], a[208:211], a[100:103]
v_mul_f32 v75, v75, v7
v_mul_f32 v84, v84, v7
v_mfma_f32_16x16x32_bf16 a[100:103], a[180:183], a[220:223], a[100:103]
v_mul_f32 v85, v85, v7
v_mul_f32 v86, v86, v7
v_mfma_f32_16x16x32_bf16 a[108:111], a[180:183], a[224:227], a[108:111]
v_mul_f32 v87, v87, v7
v_cvt_pk_bf16_f32 v72, v72, v73
v_mfma_f32_16x16x32_bf16 a[108:111], a[176:179], a[212:215], a[108:111]
v_cvt_pk_bf16_f32 v73, v74, v75
v_cvt_pk_bf16_f32 v74, v84, v85
v_mfma_f32_16x16x32_bf16 a[116:119], a[176:179], a[216:219], a[116:119]
v_cvt_pk_bf16_f32 v75, v86, v87
v_mul_f32 v20, v20, v5
v_mfma_f32_16x16x32_bf16 a[116:119], a[180:183], a[228:231], a[116:119]
s_waitcnt lgkmcnt(6)
ds_read_b64_tr_b16 a[200:201], v9 offset:49152
v_mul_f32 v21, v21, v5
v_mfma_f32_16x16x32_bf16 a[96:99], a[184:187], a[232:235], a[96:99]
ds_read_b64_tr_b16 a[202:203], v9 offset:51200
v_mul_f32 v22, v22, v5
v_mfma_f32_16x16x32_bf16 a[96:99], a[188:191], a[244:247], a[96:99]
buffer_load_dwordx4 v4, s[36:39], s20 offen offset:0 lds
v_mfma_f32_16x16x32_bf16 a[104:107], a[188:191], a[248:251], a[104:107]
ds_read_b64_tr_b16 a[204:205], v9 offset:53248
v_mul_f32 v23, v23, v5
v_mfma_f32_16x16x32_bf16 a[104:107], a[184:187], a[236:239], a[104:107]
ds_read_b64_tr_b16 a[206:207], v9 offset:55296
v_mul_f32 v44, v44, v5
v_mfma_f32_16x16x32_bf16 a[112:115], a[184:187], a[240:243], a[112:115]
ds_read_b64_tr_b16 a[168:169], v15 offset:49152
v_mul_f32 v45, v45, v5
v_mfma_f32_16x16x32_bf16 a[112:115], a[188:191], a[252:255], a[112:115]
s_waitcnt lgkmcnt(7)
buffer_load_dwordx4 v4, s[36:39], s21 offen offset:1024 lds
v_mfma_f32_16x16x32_bf16 a[100:103], a[192:195], a[232:235], a[100:103]
ds_read_b64_tr_b16 a[170:171], v15 offset:51200
v_mul_f32 v46, v46, v5
v_mfma_f32_16x16x32_bf16 a[100:103], a[196:199], a[244:247], a[100:103]
ds_read_b64_tr_b16 a[172:173], v15 offset:53248
v_mul_f32 v47, v47, v5
v_mfma_f32_16x16x32_bf16 a[108:111], a[196:199], a[248:251], a[108:111]
ds_read_b64_tr_b16 a[174:175], v15 offset:55296
v_cvt_pk_bf16_f32 v20, v20, v21
v_mfma_f32_16x16x32_bf16 a[108:111], a[192:195], a[236:239], a[108:111]
buffer_load_dwordx4 v4, s[36:39], s22 offen offset:2048 lds
v_mfma_f32_16x16x32_bf16 a[116:119], a[192:195], a[240:243], a[116:119]
ds_read_b64_tr_b16 a[176:177], v9 offset:57344
v_cvt_pk_bf16_f32 v21, v22, v23
v_mfma_f32_16x16x32_bf16 a[116:119], a[196:199], a[252:255], a[116:119]
s_waitcnt lgkmcnt(5)
ds_read_b64_tr_b16 a[178:179], v9 offset:59392
v_cvt_pk_bf16_f32 v22, v44, v45
v_mfma_f32_16x16x32_bf16 a[120:123], a[200:203], a[208:211], a[120:123]
ds_read_b64_tr_b16 a[180:181], v9 offset:61440
v_cvt_pk_bf16_f32 v23, v46, v47
v_mfma_f32_16x16x32_bf16 a[120:123], a[204:207], a[220:223], a[120:123]
buffer_load_dwordx4 v4, s[36:39], s23 offen offset:3072 lds
v_mfma_f32_16x16x32_bf16 a[128:131], a[204:207], a[224:227], a[128:131]
s_add_u32 s70, s68, 131968
ds_read_b64_tr_b16 a[182:183], v9 offset:63488
s_add_u32 s71, s68, 131456
v_mfma_f32_16x16x32_bf16 a[128:131], a[200:203], a[212:215], a[128:131]
s_add_u32 s72, s68, 138112
s_add_u32 s73, s68, 137600
s_add_u32 m0, s58, 98304
v_mfma_f32_16x16x32_bf16 a[136:139], a[200:203], a[216:219], a[136:139]
buffer_load_dwordx4 v3, s[28:31], s70 offen offset:0 nt lds
v_mfma_f32_16x16x32_bf16 a[136:139], a[204:207], a[228:231], a[136:139]
s_waitcnt lgkmcnt(4)
ds_read_b64_tr_b16 a[184:185], v15 offset:57344
ds_read_b64_tr_b16 a[186:187], v15 offset:59392
v_mfma_f32_16x16x32_bf16 a[124:127], a[168:171], a[208:211], a[124:127]
ds_read_b64_tr_b16 a[188:189], v15 offset:61440
v_mul_f32 v28, v28, v6
v_mfma_f32_16x16x32_bf16 a[124:127], a[172:175], a[220:223], a[124:127]
ds_read_b64_tr_b16 a[190:191], v15 offset:63488
v_mul_f32 v29, v29, v6
v_mfma_f32_16x16x32_bf16 a[132:135], a[172:175], a[224:227], a[132:135]
ds_write_b128 v1, v[72:75] offset:2048
v_mfma_f32_16x16x32_bf16 a[132:135], a[168:171], a[212:215], a[132:135]
ds_write_b128 v1, v[20:23] offset:3072
v_mfma_f32_16x16x32_bf16 a[140:143], a[168:171], a[216:219], a[140:143]
buffer_load_dwordx4 v3, s[28:31], s71 offen offset:1024 nt lds
v_mfma_f32_16x16x32_bf16 a[140:143], a[172:175], a[228:231], a[140:143]
s_waitcnt lgkmcnt(6)
ds_read_b64_tr_b16 a[192:193], v9 offset:0
v_mul_f32 v30, v30, v6
v_mfma_f32_16x16x32_bf16 a[120:123], a[176:179], a[232:235], a[120:123]
ds_read_b64_tr_b16 a[194:195], v9 offset:2048
v_mul_f32 v31, v31, v6
v_mfma_f32_16x16x32_bf16 a[120:123], a[180:183], a[244:247], a[120:123]
ds_read_b64_tr_b16 a[196:197], v9 offset:4096
v_mul_f32 v52, v52, v6
v_mfma_f32_16x16x32_bf16 a[128:131], a[180:183], a[248:251], a[128:131]
ds_read_b64_tr_b16 a[198:199], v9 offset:6144
v_mul_f32 v53, v53, v6
v_mfma_f32_16x16x32_bf16 a[128:131], a[176:179], a[236:239], a[128:131]
ds_read_b64_tr_b16 a[200:201], v15 offset:0
v_mul_f32 v54, v54, v6
v_mfma_f32_16x16x32_bf16 a[136:139], a[176:179], a[240:243], a[136:139]
buffer_load_dwordx4 v3, s[28:31], s72 offen offset:2048 nt lds
v_mfma_f32_16x16x32_bf16 a[136:139], a[180:183], a[252:255], a[136:139]
s_waitcnt lgkmcnt(7)
ds_read_b64_tr_b16 a[202:203], v15 offset:2048
v_mul_f32 v55, v55, v6
v_mfma_f32_16x16x32_bf16 a[124:127], a[184:187], a[232:235], a[124:127]
ds_read_b64_tr_b16 a[204:205], v15 offset:4096
v_cvt_pk_bf16_f32 v28, v28, v29
v_mfma_f32_16x16x32_bf16 a[124:127], a[188:191], a[244:247], a[124:127]
ds_read_b64_tr_b16 a[206:207], v15 offset:6144
v_cvt_pk_bf16_f32 v29, v30, v31
v_mfma_f32_16x16x32_bf16 a[132:135], a[188:191], a[248:251], a[132:135]
ds_read_b64_tr_b16 a[168:169], v9 offset:8192
v_cvt_pk_bf16_f32 v30, v52, v53
v_mfma_f32_16x16x32_bf16 a[132:135], a[184:187], a[236:239], a[132:135]
ds_read_b64_tr_b16 a[170:171], v9 offset:10240
v_cvt_pk_bf16_f32 v31, v54, v55
v_mfma_f32_16x16x32_bf16 a[140:143], a[184:187], a[240:243], a[140:143]
buffer_load_dwordx4 v3, s[28:31], s73 offen offset:3072 nt lds
v_mfma_f32_16x16x32_bf16 a[140:143], a[188:191], a[252:255], a[140:143]
s_waitcnt lgkmcnt(6)
ds_read_b64_tr_b16 a[172:173], v9 offset:12288
v_mul_f32 v36, v36, v7
v_mfma_f32_16x16x32_bf16 a[144:147], a[192:195], a[208:211], a[144:147]
s_add_u32 s20, s62, 114688
ds_read_b64_tr_b16 a[174:175], v9 offset:14336
v_mul_f32 v37, v37, v7
v_mfma_f32_16x16x32_bf16 a[144:147], a[196:199], a[220:223], a[144:147]
s_add_u32 s21, s62, 120832
ds_read_b64_tr_b16 a[176:177], v15 offset:8192
v_mul_f32 v38, v38, v7
v_mfma_f32_16x16x32_bf16 a[152:155], a[196:199], a[224:227], a[152:155]
s_add_u32 s22, s62, 126976
ds_read_b64_tr_b16 a[178:179], v15 offset:10240
v_mul_f32 v39, v39, v7
v_mfma_f32_16x16x32_bf16 a[152:155], a[192:195], a[212:215], a[152:155]
s_add_u32 s23, s62, 133120
ds_read_b64_tr_b16 a[180:181], v15 offset:12288
v_mul_f32 v60, v60, v7
v_mfma_f32_16x16x32_bf16 a[160:163], a[192:195], a[216:219], a[160:163]
s_add_u32 m0, s59, 16384
ds_read_b64_tr_b16 a[182:183], v15 offset:14336
v_mul_f32 v61, v61, v7
v_mfma_f32_16x16x32_bf16 a[160:163], a[196:199], a[228:231], a[160:163]
s_waitcnt lgkmcnt(8)
ds_write_b128 v1, v[28:31] offset:4096
v_mfma_f32_16x16x32_bf16 a[148:151], a[200:203], a[208:211], a[148:151]
v_mul_f32 v62, v62, v7
v_mul_f32 v63, v63, v7
v_mfma_f32_16x16x32_bf16 a[148:151], a[204:207], a[220:223], a[148:151]
v_cvt_pk_bf16_f32 v36, v36, v37
v_cvt_pk_bf16_f32 v37, v38, v39
v_mfma_f32_16x16x32_bf16 a[156:159], a[204:207], a[224:227], a[156:159]
v_cvt_pk_bf16_f32 v38, v60, v61
v_cvt_pk_bf16_f32 v39, v62, v63
v_mfma_f32_16x16x32_bf16 a[156:159], a[200:203], a[212:215], a[156:159]
ds_write_b128 v1, v[36:39] offset:5120
v_mfma_f32_16x16x32_bf16 a[164:167], a[200:203], a[216:219], a[164:167]
v_mfma_f32_16x16x32_bf16 a[164:167], a[204:207], a[228:231], a[164:167]
s_waitcnt vmcnt(12) lgkmcnt(2)
s_barrier
ds_read_b64_tr_b16 a[184:185], v10 offset:16384
v_mfma_f32_16x16x32_bf16 a[144:147], a[168:171], a[232:235], a[144:147]
ds_read_b64_tr_b16 a[186:187], v10 offset:18432
v_mfma_f32_16x16x32_bf16 a[144:147], a[172:175], a[244:247], a[144:147]
ds_read_b64_tr_b16 a[188:189], v10 offset:20480
v_mfma_f32_16x16x32_bf16 a[152:155], a[172:175], a[248:251], a[152:155]
buffer_load_dwordx4 v4, s[36:39], s20 offen offset:0 lds
v_mfma_f32_16x16x32_bf16 a[152:155], a[168:171], a[236:239], a[152:155]
ds_read_b64_tr_b16 a[190:191], v10 offset:22528
v_mfma_f32_16x16x32_bf16 a[160:163], a[168:171], a[240:243], a[160:163]
ds_read_b64_tr_b16 a[192:193], v11 offset:16384
v_mfma_f32_16x16x32_bf16 a[160:163], a[172:175], a[252:255], a[160:163]
s_waitcnt lgkmcnt(7)
buffer_load_dwordx4 v4, s[36:39], s21 offen offset:1024 lds
v_mfma_f32_16x16x32_bf16 a[148:151], a[176:179], a[232:235], a[148:151]
ds_read_b64_tr_b16 a[194:195], v11 offset:18432
v_mfma_f32_16x16x32_bf16 a[148:151], a[180:183], a[244:247], a[148:151]
ds_read_b64_tr_b16 a[196:197], v11 offset:20480
v_mfma_f32_16x16x32_bf16 a[156:159], a[180:183], a[248:251], a[156:159]
ds_read_b64_tr_b16 a[198:199], v11 offset:22528
v_mfma_f32_16x16x32_bf16 a[156:159], a[176:179], a[236:239], a[156:159]
buffer_load_dwordx4 v4, s[36:39], s22 offen offset:2048 lds
v_mfma_f32_16x16x32_bf16 a[164:167], a[176:179], a[240:243], a[164:167]
ds_read_b64_tr_b16 a[200:201], v12 offset:16384
v_mfma_f32_16x16x32_bf16 a[164:167], a[180:183], a[252:255], a[164:167]
s_waitcnt lgkmcnt(5)
s_waitcnt lgkmcnt(9)
s_barrier
v_mfma_f32_16x16x32_bf16 v[64:67], a[184:187], v[88:91], 0
buffer_load_dwordx4 v4, s[36:39], s23 offen offset:3072 lds
v_mfma_f32_16x16x32_bf16 v[64:67], a[188:191], v[100:103], v[64:67]
s_add_u32 s20, s63, 114688
ds_read_b64_tr_b16 a[202:203], v12 offset:18432
s_add_u32 s21, s63, 120832
v_mfma_f32_16x16x32_bf16 v[68:71], a[188:191], v[104:107], 0
s_add_u32 s22, s63, 126976
ds_read_b64_tr_b16 a[204:205], v12 offset:20480
s_add_u32 s23, s63, 133120
v_mfma_f32_16x16x32_bf16 v[68:71], a[184:187], v[92:95], v[68:71]
s_add_u32 m0, s59, 49152
ds_read_b64_tr_b16 a[206:207], v12 offset:22528
v_mfma_f32_16x16x32_bf16 v[72:75], a[184:187], v[96:99], 0
buffer_load_dwordx4 v4, s[36:39], s20 offen offset:0 lds
v_mfma_f32_16x16x32_bf16 v[72:75], a[188:191], v[108:111], v[72:75]
s_waitcnt lgkmcnt(4)
ds_read_b64_tr_b16 a[168:169], v13 offset:16384
v_mfma_f32_16x16x32_bf16 v[76:79], a[192:195], v[88:91], 0
ds_read_b64_tr_b16 a[170:171], v13 offset:18432
v_mfma_f32_16x16x32_bf16 v[76:79], a[196:199], v[100:103], v[76:79]
buffer_load_dwordx4 v4, s[36:39], s21 offen offset:1024 lds
v_mfma_f32_16x16x32_bf16 v[80:83], a[196:199], v[104:107], 0
ds_read_b64_tr_b16 a[172:173], v13 offset:20480
v_mfma_f32_16x16x32_bf16 v[80:83], a[192:195], v[92:95], v[80:83]
ds_read_b64_tr_b16 a[174:175], v13 offset:22528
v_mfma_f32_16x16x32_bf16 v[84:87], a[192:195], v[96:99], 0
ds_read_b64_tr_b16 a[176:177], v10 offset:24576
v_mfma_f32_16x16x32_bf16 v[84:87], a[196:199], v[108:111], v[84:87]
s_waitcnt lgkmcnt(5)
buffer_load_dwordx4 v4, s[36:39], s22 offen offset:2048 lds
v_mfma_f32_16x16x32_bf16 v[20:23], a[200:203], v[88:91], 0
ds_read_b64_tr_b16 a[178:179], v10 offset:26624
v_mfma_f32_16x16x32_bf16 v[20:23], a[204:207], v[100:103], v[20:23]
ds_read_b64_tr_b16 a[180:181], v10 offset:28672
v_mfma_f32_16x16x32_bf16 v[28:31], a[204:207], v[104:107], 0
ds_read_b64_tr_b16 a[182:183], v10 offset:30720
v_mfma_f32_16x16x32_bf16 v[28:31], a[200:203], v[92:95], v[28:31]
buffer_load_dwordx4 v4, s[36:39], s23 offen offset:3072 lds
v_mfma_f32_16x16x32_bf16 v[36:39], a[200:203], v[96:99], 0
s_add_u32 s20, s60, 172032
ds_read_b64_tr_b16 a[184:185], v11 offset:24576
s_add_u32 s21, s60, 178176
v_mfma_f32_16x16x32_bf16 v[36:39], a[204:207], v[108:111], v[36:39]
s_waitcnt lgkmcnt(5)
s_add_u32 s22, s60, 184320
s_add_u32 s23, s60, 190464
s_add_u32 m0, s59, 0
v_mfma_f32_16x16x32_bf16 v[44:47], a[168:171], v[88:91], 0
buffer_load_dwordx4 v4, s[36:39], s20 offen offset:0 lds
v_mfma_f32_16x16x32_bf16 v[44:47], a[172:175], v[100:103], v[44:47]
ds_read_b64_tr_b16 a[186:187], v11 offset:26624
ds_read_b64_tr_b16 a[188:189], v11 offset:28672
v_mfma_f32_16x16x32_bf16 v[52:55], a[172:175], v[104:107], 0
ds_read_b64_tr_b16 a[190:191], v11 offset:30720
v_mfma_f32_16x16x32_bf16 v[52:55], a[168:171], v[92:95], v[52:55]
ds_read_b64_tr_b16 a[192:193], v12 offset:24576
v_mfma_f32_16x16x32_bf16 v[60:63], a[168:171], v[96:99], 0
buffer_load_dwordx4 v4, s[36:39], s21 offen offset:1024 lds
v_mfma_f32_16x16x32_bf16 v[60:63], a[172:175], v[108:111], v[60:63]
s_waitcnt lgkmcnt(5)
ds_read_b64_tr_b16 a[194:195], v12 offset:26624
v_mfma_f32_16x16x32_bf16 v[64:67], a[176:179], v[112:115], v[64:67]
ds_read_b64_tr_b16 a[196:197], v12 offset:28672
v_mfma_f32_16x16x32_bf16 v[64:67], a[180:183], v[124:127], v[64:67]
buffer_load_dwordx4 v4, s[36:39], s22 offen offset:2048 lds
v_mfma_f32_16x16x32_bf16 v[68:71], a[180:183], v[128:131], v[68:71]
ds_read_b64_tr_b16 a[198:199], v12 offset:30720
v_mfma_f32_16x16x32_bf16 v[68:71], a[176:179], v[116:119], v[68:71]
ds_read_b64_tr_b16 a[200:201], v13 offset:24576
v_mfma_f32_16x16x32_bf16 v[72:75], a[176:179], v[120:123], v[72:75]
ds_read_b64_tr_b16 a[202:203], v13 offset:26624
v_mfma_f32_16x16x32_bf16 v[72:75], a[180:183], v[132:135], v[72:75]
s_waitcnt lgkmcnt(6)
buffer_load_dwordx4 v4, s[36:39], s23 offen offset:3072 lds
v_mfma_f32_16x16x32_bf16 v[76:79], a[184:187], v[112:115], v[76:79]
s_add_u32 s70, s68, 197504
ds_read_b64_tr_b16 a[204:205], v13 offset:28672
s_add_u32 s71, s68, 196992
v_mfma_f32_16x16x32_bf16 v[76:79], a[188:191], v[124:127], v[76:79]
s_add_u32 s72, s68, 203648
ds_read_b64_tr_b16 a[206:207], v13 offset:30720
v_subrev_u32 v10, 0x10000, v10
v_mfma_f32_16x16x32_bf16 v[80:83], a[188:191], v[128:131], v[80:83]
s_add_u32 s73, s68, 203136
ds_read_b128 a[208:211], v2 offset:0
v_subrev_u32 v11, 0x10000, v11
v_mfma_f32_16x16x32_bf16 v[80:83], a[184:187], v[116:119], v[80:83]
s_add_u32 m0, s58, 81920
ds_read_b128 a[212:215], v2 offset:1024
v_subrev_u32 v12, 0x10000, v12
v_mfma_f32_16x16x32_bf16 v[84:87], a[184:187], v[120:123], v[84:87]
ds_read_b128 a[216:219], v2 offset:2048
v_subrev_u32 v13, 0x10000, v13
v_mfma_f32_16x16x32_bf16 v[84:87], a[188:191], v[132:135], v[84:87]
s_waitcnt vmcnt(20) lgkmcnt(3)
s_barrier
ds_read_b64_tr_b16 a[168:169], v10 offset:32768
v_mfma_f32_16x16x32_bf16 v[20:23], a[192:195], v[112:115], v[20:23]
ds_read_b64_tr_b16 a[170:171], v10 offset:34816
v_mfma_f32_16x16x32_bf16 v[20:23], a[196:199], v[124:127], v[20:23]
buffer_load_dwordx4 v3, s[28:31], s70 offen offset:0 nt lds
v_mfma_f32_16x16x32_bf16 v[28:31], a[196:199], v[128:131], v[28:31]
ds_read_b64_tr_b16 a[172:173], v10 offset:36864
v_mfma_f32_16x16x32_bf16 v[28:31], a[192:195], v[116:119], v[28:31]
ds_read_b64_tr_b16 a[174:175], v10 offset:38912
v_mfma_f32_16x16x32_bf16 v[36:39], a[192:195], v[120:123], v[36:39]
ds_read_b64_tr_b16 a[176:177], v11 offset:32768
v_mfma_f32_16x16x32_bf16 v[36:39], a[196:199], v[132:135], v[36:39]
s_waitcnt lgkmcnt(8)
ds_read_b64_tr_b16 a[178:179], v11 offset:34816
v_mfma_f32_16x16x32_bf16 v[44:47], a[200:203], v[112:115], v[44:47]
ds_read_b64_tr_b16 a[180:181], v11 offset:36864
v_mfma_f32_16x16x32_bf16 v[44:47], a[204:207], v[124:127], v[44:47]
buffer_load_dwordx4 v3, s[28:31], s71 offen offset:1024 nt lds
v_mfma_f32_16x16x32_bf16 v[52:55], a[204:207], v[128:131], v[52:55]
ds_read_b64_tr_b16 a[182:183], v11 offset:38912
v_mfma_f32_16x16x32_bf16 v[52:55], a[200:203], v[116:119], v[52:55]
ds_read_b64_tr_b16 a[184:185], v12 offset:32768
v_mfma_f32_16x16x32_bf16 v[60:63], a[200:203], v[120:123], v[60:63]
ds_read_b64_tr_b16 a[186:187], v12 offset:34816
v_mfma_f32_16x16x32_bf16 v[60:63], a[204:207], v[132:135], v[60:63]
s_waitcnt lgkmcnt(6)
ds_read_b64_tr_b16 a[188:189], v12 offset:36864
v_mfma_f32_16x16x32_bf16 v[64:67], a[168:171], v[136:139], v[64:67]
ds_read_b64_tr_b16 a[190:191], v12 offset:38912
v_accvgpr_read_b32 v88, a0
v_mfma_f32_16x16x32_bf16 v[64:67], a[172:175], v[148:151], v[64:67]
buffer_load_dwordx4 v3, s[28:31], s72 offen offset:2048 nt lds
v_mfma_f32_16x16x32_bf16 v[68:71], a[172:175], v[152:155], v[68:71]
ds_read_b64_tr_b16 a[192:193], v13 offset:32768
v_accvgpr_read_b32 v89, a1
v_mfma_f32_16x16x32_bf16 v[68:71], a[168:171], v[140:143], v[68:71]
ds_read_b64_tr_b16 a[194:195], v13 offset:34816
v_accvgpr_read_b32 v90, a2
v_mfma_f32_16x16x32_bf16 v[72:75], a[168:171], v[144:147], v[72:75]
ds_read_b64_tr_b16 a[196:197], v13 offset:36864
v_accvgpr_read_b32 v91, a3
v_mfma_f32_16x16x32_bf16 v[72:75], a[172:175], v[156:159], v[72:75]
s_waitcnt lgkmcnt(7)
ds_read_b64_tr_b16 a[198:199], v13 offset:38912
v_accvgpr_read_b32 v92, a4
v_mfma_f32_16x16x32_bf16 v[76:79], a[176:179], v[136:139], v[76:79]
ds_read_b64_tr_b16 a[200:201], v10 offset:40960
v_accvgpr_read_b32 v93, a5
v_mfma_f32_16x16x32_bf16 v[76:79], a[180:183], v[148:151], v[76:79]
buffer_load_dwordx4 v3, s[28:31], s73 offen offset:3072 nt lds
v_mfma_f32_16x16x32_bf16 v[80:83], a[180:183], v[152:155], v[80:83]
ds_read_b64_tr_b16 a[202:203], v10 offset:43008
v_accvgpr_read_b32 v94, a6
v_mfma_f32_16x16x32_bf16 v[80:83], a[176:179], v[140:143], v[80:83]
ds_read_b64_tr_b16 a[204:205], v10 offset:45056
v_accvgpr_read_b32 v95, a7
v_mfma_f32_16x16x32_bf16 v[84:87], a[176:179], v[144:147], v[84:87]
ds_read_b64_tr_b16 a[206:207], v10 offset:47104
v_accvgpr_read_b32 v96, a8
v_mfma_f32_16x16x32_bf16 v[84:87], a[180:183], v[156:159], v[84:87]
s_waitcnt lgkmcnt(8)
ds_read_b64_tr_b16 a[168:169], v11 offset:40960
v_accvgpr_read_b32 v97, a9
v_mfma_f32_16x16x32_bf16 v[20:23], a[184:187], v[136:139], v[20:23]
ds_read_b64_tr_b16 a[170:171], v11 offset:43008
v_accvgpr_read_b32 v98, a10
v_mfma_f32_16x16x32_bf16 v[20:23], a[188:191], v[148:151], v[20:23]
ds_read_b64_tr_b16 a[172:173], v11 offset:45056
v_accvgpr_read_b32 v99, a11
v_mfma_f32_16x16x32_bf16 v[28:31], a[188:191], v[152:155], v[28:31]
ds_read_b64_tr_b16 a[174:175], v11 offset:47104
v_accvgpr_read_b32 v100, a12
v_mfma_f32_16x16x32_bf16 v[28:31], a[184:187], v[140:143], v[28:31]
ds_read_b64_tr_b16 a[176:177], v12 offset:40960
v_accvgpr_read_b32 v101, a13
v_mfma_f32_16x16x32_bf16 v[36:39], a[184:187], v[144:147], v[36:39]
ds_read_b64_tr_b16 a[178:179], v12 offset:43008
v_accvgpr_read_b32 v102, a14
v_mfma_f32_16x16x32_bf16 v[36:39], a[188:191], v[156:159], v[36:39]
s_waitcnt lgkmcnt(10)
ds_read_b64_tr_b16 a[180:181], v12 offset:45056
v_accvgpr_read_b32 v103, a15
v_mfma_f32_16x16x32_bf16 v[44:47], a[192:195], v[136:139], v[44:47]
s_add_u32 s20, s61, 172032
ds_read_b64_tr_b16 a[182:183], v12 offset:47104
v_accvgpr_read_b32 v104, a16
v_mfma_f32_16x16x32_bf16 v[44:47], a[196:199], v[148:151], v[44:47]
s_add_u32 s21, s61, 178176
ds_read_b64_tr_b16 a[184:185], v13 offset:40960
v_accvgpr_read_b32 v105, a17
v_mfma_f32_16x16x32_bf16 v[52:55], a[196:199], v[152:155], v[52:55]
s_add_u32 s22, s61, 184320
ds_read_b64_tr_b16 a[186:187], v13 offset:43008
v_accvgpr_read_b32 v106, a18
v_mfma_f32_16x16x32_bf16 v[52:55], a[192:195], v[140:143], v[52:55]
s_add_u32 s23, s61, 190464
ds_read_b64_tr_b16 a[188:189], v13 offset:45056
v_accvgpr_read_b32 v107, a19
v_mfma_f32_16x16x32_bf16 v[60:63], a[192:195], v[144:147], v[60:63]
s_add_u32 m0, s59, 32768
ds_read_b64_tr_b16 a[190:191], v13 offset:47104
v_accvgpr_read_b32 v108, a20
v_mfma_f32_16x16x32_bf16 v[60:63], a[196:199], v[156:159], v[60:63]
s_waitcnt lgkmcnt(12)
ds_read_b128 a[220:223], v2 offset:3072
v_accvgpr_read_b32 v109, a21
v_mfma_f32_16x16x32_bf16 v[64:67], a[200:203], v[160:163], v[64:67]
ds_read_b128 a[224:227], v2 offset:4096
v_accvgpr_read_b32 v110, a22
v_mfma_f32_16x16x32_bf16 v[64:67], a[204:207], v[172:175], v[64:67]
ds_read_b128 a[228:231], v2 offset:5120
v_accvgpr_read_b32 v111, a23
v_mfma_f32_16x16x32_bf16 v[68:71], a[204:207], v[176:179], v[68:71]
ds_read_b128 a[232:235], v2 offset:6144
v_accvgpr_read_b32 v112, a24
v_mfma_f32_16x16x32_bf16 v[68:71], a[200:203], v[164:167], v[68:71]
ds_read_b128 a[236:239], v2 offset:7168
v_accvgpr_read_b32 v113, a25
v_mfma_f32_16x16x32_bf16 v[72:75], a[200:203], v[168:171], v[72:75]
ds_read_b128 a[240:243], v2 offset:8192
v_accvgpr_read_b32 v114, a26
v_mfma_f32_16x16x32_bf16 v[72:75], a[204:207], v[180:183], v[72:75]
s_waitcnt lgkmcnt(14)
ds_read_b128 a[244:247], v2 offset:9216
v_add_u32 v10, 0x10000, v10
v_mfma_f32_16x16x32_bf16 v[76:79], a[168:171], v[160:163], v[76:79]
ds_read_b128 a[248:251], v2 offset:10240
v_add_u32 v11, 0x10000, v11
v_mfma_f32_16x16x32_bf16 v[76:79], a[172:175], v[172:175], v[76:79]
ds_read_b128 a[252:255], v2 offset:11264
v_add_u32 v12, 0x10000, v12
v_mfma_f32_16x16x32_bf16 v[80:83], a[172:175], v[176:179], v[80:83]
v_add_u32 v13, 0x10000, v13
v_accvgpr_read_b32 v115, a27
v_mfma_f32_16x16x32_bf16 v[80:83], a[168:171], v[164:167], v[80:83]
v_accvgpr_read_b32 v116, a28
v_accvgpr_read_b32 v117, a29
v_mfma_f32_16x16x32_bf16 v[84:87], a[168:171], v[168:171], v[84:87]
v_accvgpr_read_b32 v118, a30
v_accvgpr_read_b32 v119, a31
v_mfma_f32_16x16x32_bf16 v[84:87], a[172:175], v[180:183], v[84:87]
s_waitcnt vmcnt(16) lgkmcnt(9)
s_barrier
ds_read_b64_tr_b16 a[192:193], v10 offset:32768
v_mfma_f32_16x16x32_bf16 v[20:23], a[176:179], v[160:163], v[20:23]
ds_read_b64_tr_b16 a[194:195], v10 offset:34816
v_accvgpr_read_b32 v120, a32
v_mfma_f32_16x16x32_bf16 v[20:23], a[180:183], v[172:175], v[20:23]
ds_read_b64_tr_b16 a[196:197], v10 offset:36864
v_accvgpr_read_b32 v121, a33
v_mfma_f32_16x16x32_bf16 v[28:31], a[180:183], v[176:179], v[28:31]
buffer_load_dwordx4 v4, s[36:39], s20 offen offset:0 lds
v_mfma_f32_16x16x32_bf16 v[28:31], a[176:179], v[164:167], v[28:31]
ds_read_b64_tr_b16 a[198:199], v10 offset:38912
v_accvgpr_read_b32 v122, a34
v_mfma_f32_16x16x32_bf16 v[36:39], a[176:179], v[168:171], v[36:39]
ds_read_b64_tr_b16 a[200:201], v11 offset:32768
v_accvgpr_read_b32 v123, a35
v_mfma_f32_16x16x32_bf16 v[36:39], a[180:183], v[180:183], v[36:39]
s_waitcnt lgkmcnt(14)
ds_read_b64_tr_b16 a[202:203], v11 offset:34816
v_accvgpr_read_b32 v124, a36
v_mfma_f32_16x16x32_bf16 v[44:47], a[184:187], v[160:163], v[44:47]
ds_read_b64_tr_b16 a[204:205], v11 offset:36864
v_accvgpr_read_b32 v125, a37
v_mfma_f32_16x16x32_bf16 v[44:47], a[188:191], v[172:175], v[44:47]
ds_read_b64_tr_b16 a[206:207], v11 offset:38912
v_accvgpr_read_b32 v126, a38
v_mfma_f32_16x16x32_bf16 v[52:55], a[188:191], v[176:179], v[52:55]
ds_read_b64_tr_b16 a[168:169], v12 offset:32768
v_accvgpr_read_b32 v127, a39
v_mfma_f32_16x16x32_bf16 v[52:55], a[184:187], v[164:167], v[52:55]
ds_read_b64_tr_b16 a[170:171], v12 offset:34816
v_accvgpr_read_b32 v128, a40
v_mfma_f32_16x16x32_bf16 v[60:63], a[184:187], v[168:171], v[60:63]
buffer_load_dwordx4 v4, s[36:39], s21 offen offset:1024 lds
v_mfma_f32_16x16x32_bf16 v[60:63], a[188:191], v[180:183], v[60:63]
s_waitcnt lgkmcnt(6)
ds_read_b64_tr_b16 a[172:173], v12 offset:36864
v_accvgpr_read_b32 v129, a41
v_mfma_f32_16x16x32_bf16 v[64:67], a[192:195], v[184:187], v[64:67]
ds_read_b64_tr_b16 a[174:175], v12 offset:38912
v_accvgpr_read_b32 v130, a42
v_mfma_f32_16x16x32_bf16 v[64:67], a[196:199], v[196:199], v[64:67]
ds_read_b64_tr_b16 a[176:177], v13 offset:32768
v_accvgpr_read_b32 v131, a43
v_mfma_f32_16x16x32_bf16 v[68:71], a[196:199], v[200:203], v[68:71]
ds_read_b64_tr_b16 a[178:179], v13 offset:34816
v_accvgpr_read_b32 v132, a44
v_mfma_f32_16x16x32_bf16 v[68:71], a[192:195], v[188:191], v[68:71]
ds_read_b64_tr_b16 a[180:181], v13 offset:36864
v_accvgpr_read_b32 v133, a45
v_mfma_f32_16x16x32_bf16 v[72:75], a[192:195], v[192:195], v[72:75]
ds_read_b64_tr_b16 a[182:183], v13 offset:38912
v_accvgpr_read_b32 v134, a46
v_mfma_f32_16x16x32_bf16 v[72:75], a[196:199], v[204:207], v[72:75]
s_waitcnt lgkmcnt(8)
ds_read_b64_tr_b16 a[184:185], v10 offset:40960
v_accvgpr_read_b32 v135, a47
v_mfma_f32_16x16x32_bf16 v[76:79], a[200:203], v[184:187], v[76:79]
buffer_load_dwordx4 v4, s[36:39], s22 offen offset:2048 lds
v_mfma_f32_16x16x32_bf16 v[76:79], a[204:207], v[196:199], v[76:79]
ds_read_b64_tr_b16 a[186:187], v10 offset:43008
v_accvgpr_read_b32 v136, a48
v_mfma_f32_16x16x32_bf16 v[80:83], a[204:207], v[200:203], v[80:83]
ds_read_b64_tr_b16 a[188:189], v10 offset:45056
v_accvgpr_read_b32 v137, a49
v_mfma_f32_16x16x32_bf16 v[80:83], a[200:203], v[188:191], v[80:83]
ds_read_b64_tr_b16 a[190:191], v10 offset:47104
v_accvgpr_read_b32 v138, a50
v_mfma_f32_16x16x32_bf16 v[84:87], a[200:203], v[192:195], v[84:87]
ds_read_b64_tr_b16 a[192:193], v11 offset:40960
v_accvgpr_read_b32 v139, a51
v_mfma_f32_16x16x32_bf16 v[84:87], a[204:207], v[204:207], v[84:87]
s_waitcnt lgkmcnt(9)
ds_read_b64_tr_b16 a[194:195], v11 offset:43008
v_accvgpr_read_b32 v140, a52
v_mfma_f32_16x16x32_bf16 v[20:23], a[168:171], v[184:187], v[20:23]
ds_read_b64_tr_b16 a[196:197], v11 offset:45056
v_accvgpr_read_b32 v141, a53
v_mfma_f32_16x16x32_bf16 v[20:23], a[172:175], v[196:199], v[20:23]
ds_read_b64_tr_b16 a[198:199], v11 offset:47104
v_accvgpr_read_b32 v142, a54
v_mfma_f32_16x16x32_bf16 v[28:31], a[172:175], v[200:203], v[28:31]
buffer_load_dwordx4 v4, s[36:39], s23 offen offset:3072 lds
v_mfma_f32_16x16x32_bf16 v[28:31], a[168:171], v[188:191], v[28:31]
ds_read_b64_tr_b16 a[200:201], v12 offset:40960
v_accvgpr_read_b32 v143, a55
v_mfma_f32_16x16x32_bf16 v[36:39], a[168:171], v[192:195], v[36:39]
ds_read_b64_tr_b16 a[202:203], v12 offset:43008
v_accvgpr_read_b32 v144, a56
v_mfma_f32_16x16x32_bf16 v[36:39], a[172:175], v[204:207], v[36:39]
s_waitcnt lgkmcnt(10)
ds_read_b64_tr_b16 a[204:205], v12 offset:45056
v_accvgpr_read_b32 v145, a57
v_mfma_f32_16x16x32_bf16 v[44:47], a[176:179], v[184:187], v[44:47]
s_add_u32 s20, s62, 172032
ds_read_b64_tr_b16 a[206:207], v12 offset:47104
v_accvgpr_read_b32 v146, a58
v_mfma_f32_16x16x32_bf16 v[44:47], a[180:183], v[196:199], v[44:47]
s_add_u32 s21, s62, 178176
ds_read_b64_tr_b16 a[168:169], v13 offset:40960
v_accvgpr_read_b32 v147, a59
v_mfma_f32_16x16x32_bf16 v[52:55], a[180:183], v[200:203], v[52:55]
s_add_u32 s22, s62, 184320
ds_read_b64_tr_b16 a[170:171], v13 offset:43008
v_accvgpr_read_b32 v148, a60
v_mfma_f32_16x16x32_bf16 v[52:55], a[176:179], v[188:191], v[52:55]
s_add_u32 s23, s62, 190464
ds_read_b64_tr_b16 a[172:173], v13 offset:45056
v_accvgpr_read_b32 v149, a61
v_mfma_f32_16x16x32_bf16 v[60:63], a[176:179], v[192:195], v[60:63]
s_add_u32 m0, s59, 98304
ds_read_b64_tr_b16 a[174:175], v13 offset:47104
v_accvgpr_read_b32 v150, a62
v_mfma_f32_16x16x32_bf16 v[60:63], a[180:183], v[204:207], v[60:63]
s_waitcnt lgkmcnt(12)
v_accvgpr_read_b32 v151, a63
v_accvgpr_read_b32 v152, a64
v_mfma_f32_16x16x32_bf16 v[64:67], a[184:187], v[208:211], v[64:67]
v_accvgpr_read_b32 v153, a65
v_accvgpr_read_b32 v154, a66
v_mfma_f32_16x16x32_bf16 v[64:67], a[188:191], v[220:223], v[64:67]
v_accvgpr_read_b32 v155, a67
v_accvgpr_read_b32 v156, a68
v_mfma_f32_16x16x32_bf16 v[68:71], a[188:191], v[224:227], v[68:71]
v_accvgpr_read_b32 v157, a69
v_accvgpr_read_b32 v158, a70
v_mfma_f32_16x16x32_bf16 v[68:71], a[184:187], v[212:215], v[68:71]
v_accvgpr_read_b32 v159, a71
v_accvgpr_read_b32 v160, a72
v_mfma_f32_16x16x32_bf16 v[72:75], a[184:187], v[216:219], v[72:75]
v_accvgpr_read_b32 v161, a73
v_accvgpr_read_b32 v162, a74
v_mfma_f32_16x16x32_bf16 v[72:75], a[188:191], v[228:231], v[72:75]
s_waitcnt lgkmcnt(8)
v_accvgpr_read_b32 v163, a75
v_accvgpr_read_b32 v164, a76
v_mfma_f32_16x16x32_bf16 v[76:79], a[192:195], v[208:211], v[76:79]
v_accvgpr_read_b32 v165, a77
v_accvgpr_read_b32 v166, a78
v_mfma_f32_16x16x32_bf16 v[76:79], a[196:199], v[220:223], v[76:79]
v_accvgpr_read_b32 v167, a79
v_accvgpr_read_b32 v168, a80
v_mfma_f32_16x16x32_bf16 v[80:83], a[196:199], v[224:227], v[80:83]
v_accvgpr_read_b32 v169, a81
v_accvgpr_read_b32 v170, a82
v_mfma_f32_16x16x32_bf16 v[80:83], a[192:195], v[212:215], v[80:83]
v_accvgpr_read_b32 v171, a83
v_accvgpr_read_b32 v172, a84
v_mfma_f32_16x16x32_bf16 v[84:87], a[192:195], v[216:219], v[84:87]
v_accvgpr_read_b32 v173, a85
v_accvgpr_read_b32 v174, a86
v_mfma_f32_16x16x32_bf16 v[84:87], a[196:199], v[228:231], v[84:87]
s_waitcnt vmcnt(4) lgkmcnt(0)
s_barrier
ds_read_b64_tr_b16 a[176:177], v10 offset:16384
v_mfma_f32_16x16x32_bf16 v[20:23], a[200:203], v[208:211], v[20:23]
ds_read_b64_tr_b16 a[178:179], v10 offset:18432
v_accvgpr_read_b32 v175, a87
v_mfma_f32_16x16x32_bf16 v[20:23], a[204:207], v[220:223], v[20:23]
ds_read_b64_tr_b16 a[180:181], v10 offset:20480
v_accvgpr_read_b32 v176, a88
v_mfma_f32_16x16x32_bf16 v[28:31], a[204:207], v[224:227], v[28:31]
buffer_load_dwordx4 v4, s[36:39], s20 offen offset:0 lds
v_mfma_f32_16x16x32_bf16 v[28:31], a[200:203], v[212:215], v[28:31]
ds_read_b64_tr_b16 a[182:183], v10 offset:22528
v_accvgpr_read_b32 v177, a89
v_mfma_f32_16x16x32_bf16 v[36:39], a[200:203], v[216:219], v[36:39]
ds_read_b64_tr_b16 a[184:185], v10 offset:24576
v_accvgpr_read_b32 v178, a90
v_mfma_f32_16x16x32_bf16 v[36:39], a[204:207], v[228:231], v[36:39]
s_waitcnt lgkmcnt(5)
ds_read_b64_tr_b16 a[186:187], v10 offset:26624
v_accvgpr_read_b32 v179, a91
v_mfma_f32_16x16x32_bf16 v[44:47], a[168:171], v[208:211], v[44:47]
ds_read_b64_tr_b16 a[188:189], v10 offset:28672
v_accvgpr_read_b32 v180, a92
v_mfma_f32_16x16x32_bf16 v[44:47], a[172:175], v[220:223], v[44:47]
ds_read_b64_tr_b16 a[190:191], v10 offset:30720
v_accvgpr_read_b32 v181, a93
v_mfma_f32_16x16x32_bf16 v[52:55], a[172:175], v[224:227], v[52:55]
ds_read_b64_tr_b16 a[192:193], v11 offset:16384
v_accvgpr_read_b32 v182, a94
v_mfma_f32_16x16x32_bf16 v[52:55], a[168:171], v[212:215], v[52:55]
ds_read_b64_tr_b16 a[194:195], v11 offset:18432
v_accvgpr_read_b32 v183, a95
v_mfma_f32_16x16x32_bf16 v[60:63], a[168:171], v[216:219], v[60:63]
buffer_load_dwordx4 v4, s[36:39], s21 offen offset:1024 lds
v_mfma_f32_16x16x32_bf16 v[60:63], a[172:175], v[228:231], v[60:63]
s_waitcnt lgkmcnt(6)
ds_read_b64_tr_b16 a[196:197], v11 offset:20480
v_mfma_f32_16x16x32_bf16 v[64:67], a[176:179], v[232:235], v[64:67]
ds_read_b64_tr_b16 a[198:199], v11 offset:22528
v_mfma_f32_16x16x32_bf16 v[64:67], a[180:183], v[244:247], v[64:67]
ds_read_b64_tr_b16 a[200:201], v11 offset:24576
v_mfma_f32_16x16x32_bf16 v[68:71], a[180:183], v[248:251], v[68:71]
ds_read_b64_tr_b16 a[202:203], v11 offset:26624
v_mfma_f32_16x16x32_bf16 v[68:71], a[176:179], v[236:239], v[68:71]
ds_read_b64_tr_b16 a[204:205], v11 offset:28672
v_mfma_f32_16x16x32_bf16 v[72:75], a[176:179], v[240:243], v[72:75]
ds_read_b64_tr_b16 a[206:207], v11 offset:30720
v_mfma_f32_16x16x32_bf16 v[72:75], a[180:183], v[252:255], v[72:75]
s_waitcnt lgkmcnt(8)
ds_read_b64_tr_b16 a[168:169], v12 offset:16384
v_mfma_f32_16x16x32_bf16 v[64:67], a[184:187], v[16:19], v[64:67]
buffer_load_dwordx4 v4, s[36:39], s22 offen offset:2048 lds
v_mfma_f32_16x16x32_bf16 v[64:67], a[188:191], v[40:43], v[64:67]
ds_read_b64_tr_b16 a[170:171], v12 offset:18432
v_mfma_f32_16x16x32_bf16 v[68:71], a[188:191], v[48:51], v[68:71]
ds_read_b64_tr_b16 a[172:173], v12 offset:20480
v_mfma_f32_16x16x32_bf16 v[68:71], a[184:187], v[24:27], v[68:71]
ds_read_b64_tr_b16 a[174:175], v12 offset:22528
v_mfma_f32_16x16x32_bf16 v[72:75], a[184:187], v[32:35], v[72:75]
ds_read_b64_tr_b16 a[176:177], v12 offset:24576
v_mfma_f32_16x16x32_bf16 v[72:75], a[188:191], v[56:59], v[72:75]
s_waitcnt lgkmcnt(9)
ds_read_b64_tr_b16 a[178:179], v12 offset:26624
v_mfma_f32_16x16x32_bf16 v[76:79], a[192:195], v[232:235], v[76:79]
ds_read_b64_tr_b16 a[180:181], v12 offset:28672
v_mfma_f32_16x16x32_bf16 v[76:79], a[196:199], v[244:247], v[76:79]
ds_read_b64_tr_b16 a[182:183], v12 offset:30720
v_mfma_f32_16x16x32_bf16 v[80:83], a[196:199], v[248:251], v[80:83]
buffer_load_dwordx4 v4, s[36:39], s23 offen offset:3072 lds
v_mfma_f32_16x16x32_bf16 v[80:83], a[192:195], v[236:239], v[80:83]
ds_read_b64_tr_b16 a[184:185], v13 offset:16384
v_mfma_f32_16x16x32_bf16 v[84:87], a[192:195], v[240:243], v[84:87]
ds_read_b64_tr_b16 a[186:187], v13 offset:18432
v_mfma_f32_16x16x32_bf16 v[84:87], a[196:199], v[252:255], v[84:87]
s_waitcnt lgkmcnt(10)
ds_read_b64_tr_b16 a[188:189], v13 offset:20480
v_mfma_f32_16x16x32_bf16 v[76:79], a[200:203], v[16:19], v[76:79]
ds_read_b64_tr_b16 a[190:191], v13 offset:22528
v_mfma_f32_16x16x32_bf16 v[76:79], a[204:207], v[40:43], v[76:79]
ds_read_b64_tr_b16 a[192:193], v13 offset:24576
v_mfma_f32_16x16x32_bf16 v[80:83], a[204:207], v[48:51], v[80:83]
ds_read_b64_tr_b16 a[194:195], v13 offset:26624
v_mfma_f32_16x16x32_bf16 v[80:83], a[200:203], v[24:27], v[80:83]
ds_read_b64_tr_b16 a[196:197], v13 offset:28672
v_mfma_f32_16x16x32_bf16 v[84:87], a[200:203], v[32:35], v[84:87]
ds_read_b64_tr_b16 a[198:199], v13 offset:30720
v_mfma_f32_16x16x32_bf16 v[84:87], a[204:207], v[56:59], v[84:87]
s_waitcnt lgkmcnt(12)
v_mfma_f32_16x16x32_bf16 v[20:23], a[168:171], v[232:235], v[20:23]
v_mfma_f32_16x16x32_bf16 v[20:23], a[172:175], v[244:247], v[20:23]
v_mfma_f32_16x16x32_bf16 v[28:31], a[172:175], v[248:251], v[28:31]
v_mfma_f32_16x16x32_bf16 v[28:31], a[168:171], v[236:239], v[28:31]
v_mfma_f32_16x16x32_bf16 v[36:39], a[168:171], v[240:243], v[36:39]
v_mfma_f32_16x16x32_bf16 v[36:39], a[172:175], v[252:255], v[36:39]
s_waitcnt lgkmcnt(8)
v_add_u32 v9, 0x10000, v9
v_add_u32 v15, 0x10000, v15
v_mfma_f32_16x16x32_bf16 v[20:23], a[176:179], v[16:19], v[20:23]
v_mul_f32 v64, v64, v5
v_mul_f32 v65, v65, v5
v_mfma_f32_16x16x32_bf16 v[20:23], a[180:183], v[40:43], v[20:23]
v_mul_f32 v66, v66, v5
v_mul_f32 v67, v67, v5
v_mfma_f32_16x16x32_bf16 v[28:31], a[180:183], v[48:51], v[28:31]
v_mul_f32 v76, v76, v5
v_mul_f32 v77, v77, v5
v_mfma_f32_16x16x32_bf16 v[28:31], a[176:179], v[24:27], v[28:31]
v_mul_f32 v78, v78, v5
v_mul_f32 v79, v79, v5
v_mfma_f32_16x16x32_bf16 v[36:39], a[176:179], v[32:35], v[36:39]
v_cvt_pk_bf16_f32 v64, v64, v65
v_cvt_pk_bf16_f32 v65, v66, v67
v_mfma_f32_16x16x32_bf16 v[36:39], a[180:183], v[56:59], v[36:39]
s_waitcnt lgkmcnt(4)
ds_read_b64_tr_b16 a[200:201], v9 offset:0
v_cvt_pk_bf16_f32 v66, v76, v77
v_mfma_f32_16x16x32_bf16 v[44:47], a[184:187], v[232:235], v[44:47]
ds_read_b64_tr_b16 a[202:203], v9 offset:2048
v_cvt_pk_bf16_f32 v67, v78, v79
v_mfma_f32_16x16x32_bf16 v[44:47], a[188:191], v[244:247], v[44:47]
ds_read_b64_tr_b16 a[204:205], v9 offset:4096
v_mul_f32 v68, v68, v6
v_mfma_f32_16x16x32_bf16 v[52:55], a[188:191], v[248:251], v[52:55]
ds_read_b64_tr_b16 a[206:207], v9 offset:6144
v_mul_f32 v69, v69, v6
v_mfma_f32_16x16x32_bf16 v[52:55], a[184:187], v[236:239], v[52:55]
ds_read_b64_tr_b16 a[168:169], v15 offset:0
v_mul_f32 v70, v70, v6
v_mfma_f32_16x16x32_bf16 v[60:63], a[184:187], v[240:243], v[60:63]
ds_read_b64_tr_b16 a[170:171], v15 offset:2048
v_mul_f32 v71, v71, v6
v_mfma_f32_16x16x32_bf16 v[60:63], a[188:191], v[252:255], v[60:63]
s_waitcnt lgkmcnt(6)
ds_read_b64_tr_b16 a[172:173], v15 offset:4096
v_mul_f32 v80, v80, v6
v_mfma_f32_16x16x32_bf16 v[44:47], a[192:195], v[16:19], v[44:47]
s_add_u32 s20, s63, 172032
ds_read_b64_tr_b16 a[174:175], v15 offset:6144
v_mul_f32 v81, v81, v6
v_mfma_f32_16x16x32_bf16 v[44:47], a[196:199], v[40:43], v[44:47]
s_add_u32 s21, s63, 178176
ds_read_b64_tr_b16 a[176:177], v9 offset:8192
v_mul_f32 v82, v82, v6
v_mfma_f32_16x16x32_bf16 v[52:55], a[196:199], v[48:51], v[52:55]
s_add_u32 s22, s63, 184320
ds_read_b64_tr_b16 a[178:179], v9 offset:10240
v_mul_f32 v83, v83, v6
v_mfma_f32_16x16x32_bf16 v[52:55], a[192:195], v[24:27], v[52:55]
s_add_u32 s23, s63, 190464
ds_read_b64_tr_b16 a[180:181], v9 offset:12288
v_cvt_pk_bf16_f32 v68, v68, v69
v_mfma_f32_16x16x32_bf16 v[60:63], a[192:195], v[32:35], v[60:63]
s_waitcnt lgkmcnt(15)
ds_read_b64_tr_b16 a[182:183], v9 offset:14336
v_cvt_pk_bf16_f32 v69, v70, v71
v_mfma_f32_16x16x32_bf16 v[60:63], a[196:199], v[56:59], v[60:63]
s_waitcnt lgkmcnt(8)
ds_read_b64_tr_b16 a[184:185], v15 offset:8192
v_cvt_pk_bf16_f32 v70, v80, v81
v_mfma_f32_16x16x32_bf16 v[88:91], a[200:203], a[208:211], v[88:91]
s_add_u32 m0, s59, 81920
ds_read_b64_tr_b16 a[186:187], v15 offset:10240
v_cvt_pk_bf16_f32 v71, v82, v83
v_mfma_f32_16x16x32_bf16 v[88:91], a[204:207], a[220:223], v[88:91]
ds_read_b64_tr_b16 a[188:189], v15 offset:12288
v_mul_f32 v72, v72, v7
v_mfma_f32_16x16x32_bf16 v[96:99], a[204:207], a[224:227], v[96:99]
ds_read_b64_tr_b16 a[190:191], v15 offset:14336
v_mul_f32 v73, v73, v7
v_mfma_f32_16x16x32_bf16 v[96:99], a[200:203], a[212:215], v[96:99]
ds_write_b128 v1, v[64:67] offset:0
v_mfma_f32_16x16x32_bf16 v[104:107], a[200:203], a[216:219], v[104:107]
ds_write_b128 v1, v[68:71] offset:1024
v_mfma_f32_16x16x32_bf16 v[104:107], a[204:207], a[228:231], v[104:107]
s_waitcnt lgkmcnt(10)
v_mul_f32 v74, v74, v7
v_mul_f32 v75, v75, v7
v_mfma_f32_16x16x32_bf16 v[92:95], a[168:171], a[208:211], v[92:95]
v_mul_f32 v84, v84, v7
v_mul_f32 v85, v85, v7
v_mfma_f32_16x16x32_bf16 v[92:95], a[172:175], a[220:223], v[92:95]
v_mul_f32 v86, v86, v7
v_mul_f32 v87, v87, v7
v_mfma_f32_16x16x32_bf16 v[100:103], a[172:175], a[224:227], v[100:103]
v_cvt_pk_bf16_f32 v72, v72, v73
v_cvt_pk_bf16_f32 v73, v74, v75
v_mfma_f32_16x16x32_bf16 v[100:103], a[168:171], a[212:215], v[100:103]
v_cvt_pk_bf16_f32 v74, v84, v85
v_cvt_pk_bf16_f32 v75, v86, v87
v_mfma_f32_16x16x32_bf16 v[108:111], a[168:171], a[216:219], v[108:111]
s_waitcnt lgkmcnt(15)
ds_write_b128 v1, v[72:75] offset:2048
v_mfma_f32_16x16x32_bf16 v[108:111], a[172:175], a[228:231], v[108:111]
s_waitcnt vmcnt(20) lgkmcnt(3)
s_barrier
ds_read_b64_tr_b16 a[192:193], v9 offset:49152
v_mfma_f32_16x16x32_bf16 v[88:91], a[176:179], a[232:235], v[88:91]
ds_read_b64_tr_b16 a[194:195], v9 offset:51200
v_mul_f32 v20, v20, v5
v_mfma_f32_16x16x32_bf16 v[88:91], a[180:183], a[244:247], v[88:91]
ds_read_b64_tr_b16 a[196:197], v9 offset:53248
v_mul_f32 v21, v21, v5
v_mfma_f32_16x16x32_bf16 v[96:99], a[180:183], a[248:251], v[96:99]
buffer_load_dwordx4 v4, s[36:39], s20 offen offset:0 lds
v_mfma_f32_16x16x32_bf16 v[96:99], a[176:179], a[236:239], v[96:99]
ds_read_b64_tr_b16 a[198:199], v9 offset:55296
v_mul_f32 v22, v22, v5
v_mfma_f32_16x16x32_bf16 v[104:107], a[176:179], a[240:243], v[104:107]
ds_read_b64_tr_b16 a[200:201], v15 offset:49152
v_mul_f32 v23, v23, v5
v_mfma_f32_16x16x32_bf16 v[104:107], a[180:183], a[252:255], v[104:107]
s_waitcnt lgkmcnt(8)
ds_read_b64_tr_b16 a[202:203], v15 offset:51200
v_mul_f32 v44, v44, v5
v_mfma_f32_16x16x32_bf16 v[92:95], a[184:187], a[232:235], v[92:95]
ds_read_b64_tr_b16 a[204:205], v15 offset:53248
v_mul_f32 v45, v45, v5
v_mfma_f32_16x16x32_bf16 v[92:95], a[188:191], a[244:247], v[92:95]
buffer_load_dwordx4 v4, s[36:39], s21 offen offset:1024 lds
v_mfma_f32_16x16x32_bf16 v[100:103], a[188:191], a[248:251], v[100:103]
ds_read_b64_tr_b16 a[206:207], v15 offset:55296
v_mul_f32 v46, v46, v5
v_mfma_f32_16x16x32_bf16 v[100:103], a[184:187], a[236:239], v[100:103]
ds_read_b64_tr_b16 a[168:169], v9 offset:57344
v_mul_f32 v47, v47, v5
v_mfma_f32_16x16x32_bf16 v[108:111], a[184:187], a[240:243], v[108:111]
ds_read_b64_tr_b16 a[170:171], v9 offset:59392
v_cvt_pk_bf16_f32 v20, v20, v21
v_mfma_f32_16x16x32_bf16 v[108:111], a[188:191], a[252:255], v[108:111]
s_waitcnt lgkmcnt(6)
ds_read_b64_tr_b16 a[172:173], v9 offset:61440
v_cvt_pk_bf16_f32 v21, v22, v23
v_mfma_f32_16x16x32_bf16 v[112:115], a[192:195], a[208:211], v[112:115]
buffer_load_dwordx4 v4, s[36:39], s22 offen offset:2048 lds
v_mfma_f32_16x16x32_bf16 v[112:115], a[196:199], a[220:223], v[112:115]
ds_read_b64_tr_b16 a[174:175], v9 offset:63488
v_cvt_pk_bf16_f32 v22, v44, v45
v_mfma_f32_16x16x32_bf16 v[120:123], a[196:199], a[224:227], v[120:123]
ds_read_b64_tr_b16 a[176:177], v15 offset:57344
v_cvt_pk_bf16_f32 v23, v46, v47
v_mfma_f32_16x16x32_bf16 v[120:123], a[192:195], a[212:215], v[120:123]
ds_read_b64_tr_b16 a[178:179], v15 offset:59392
v_mul_f32 v28, v28, v6
v_mfma_f32_16x16x32_bf16 v[128:131], a[192:195], a[216:219], v[128:131]
ds_read_b64_tr_b16 a[180:181], v15 offset:61440
v_mul_f32 v29, v29, v6
v_mfma_f32_16x16x32_bf16 v[128:131], a[196:199], a[228:231], v[128:131]
s_waitcnt lgkmcnt(7)
ds_read_b64_tr_b16 a[182:183], v15 offset:63488
v_subrev_u32 v9, 0x10000, v9
v_mfma_f32_16x16x32_bf16 v[116:119], a[200:203], a[208:211], v[116:119]
buffer_load_dwordx4 v4, s[36:39], s23 offen offset:3072 lds
v_mfma_f32_16x16x32_bf16 v[116:119], a[204:207], a[220:223], v[116:119]
s_add_u32 s20, s64, 114688
ds_write_b128 v1, v[20:23] offset:3072
v_mfma_f32_16x16x32_bf16 v[124:127], a[204:207], a[224:227], v[124:127]
s_add_u32 s21, s64, 120832
s_add_u32 s22, s64, 126976
s_add_u32 s23, s64, 133120
v_mfma_f32_16x16x32_bf16 v[124:127], a[200:203], a[212:215], v[124:127]
s_add_u32 m0, s59, 65536
v_subrev_u32 v15, 0x10000, v15
v_mul_f32 v30, v30, v6
v_mfma_f32_16x16x32_bf16 v[132:135], a[200:203], a[216:219], v[132:135]
v_mul_f32 v31, v31, v6
v_mul_f32 v52, v52, v6
v_mfma_f32_16x16x32_bf16 v[132:135], a[204:207], a[228:231], v[132:135]
s_waitcnt lgkmcnt(5)
buffer_load_dwordx4 v4, s[36:39], s20 offen offset:0 lds
v_mfma_f32_16x16x32_bf16 v[112:115], a[168:171], a[232:235], v[112:115]
ds_read_b64_tr_b16 a[184:185], v9 offset:16384
v_mul_f32 v53, v53, v6
v_mfma_f32_16x16x32_bf16 v[112:115], a[172:175], a[244:247], v[112:115]
ds_read_b64_tr_b16 a[186:187], v9 offset:18432
v_mul_f32 v54, v54, v6
v_mfma_f32_16x16x32_bf16 v[120:123], a[172:175], a[248:251], v[120:123]
ds_read_b64_tr_b16 a[188:189], v9 offset:20480
v_mul_f32 v55, v55, v6
v_mfma_f32_16x16x32_bf16 v[120:123], a[168:171], a[236:239], v[120:123]
ds_read_b64_tr_b16 a[190:191], v9 offset:22528
v_cvt_pk_bf16_f32 v28, v28, v29
v_mfma_f32_16x16x32_bf16 v[128:131], a[168:171], a[240:243], v[128:131]
buffer_load_dwordx4 v4, s[36:39], s21 offen offset:1024 lds
v_mfma_f32_16x16x32_bf16 v[128:131], a[172:175], a[252:255], v[128:131]
s_waitcnt lgkmcnt(5)
ds_read_b64_tr_b16 a[192:193], v15 offset:16384
v_cvt_pk_bf16_f32 v29, v30, v31
v_mfma_f32_16x16x32_bf16 v[116:119], a[176:179], a[232:235], v[116:119]
ds_read_b64_tr_b16 a[194:195], v15 offset:18432
v_cvt_pk_bf16_f32 v30, v52, v53
v_mfma_f32_16x16x32_bf16 v[116:119], a[180:183], a[244:247], v[116:119]
ds_read_b64_tr_b16 a[196:197], v15 offset:20480
v_cvt_pk_bf16_f32 v31, v54, v55
v_mfma_f32_16x16x32_bf16 v[124:127], a[180:183], a[248:251], v[124:127]
ds_read_b64_tr_b16 a[198:199], v15 offset:22528
v_mul_f32 v36, v36, v7
v_mfma_f32_16x16x32_bf16 v[124:127], a[176:179], a[236:239], v[124:127]
ds_read_b64_tr_b16 a[200:201], v9 offset:24576
v_mul_f32 v37, v37, v7
v_mfma_f32_16x16x32_bf16 v[132:135], a[176:179], a[240:243], v[132:135]
buffer_load_dwordx4 v4, s[36:39], s22 offen offset:2048 lds
v_mfma_f32_16x16x32_bf16 v[132:135], a[180:183], a[252:255], v[132:135]
s_waitcnt lgkmcnt(5)
ds_read_b64_tr_b16 a[202:203], v9 offset:26624
v_mul_f32 v38, v38, v7
v_mfma_f32_16x16x32_bf16 v[136:139], a[184:187], a[208:211], v[136:139]
ds_read_b64_tr_b16 a[204:205], v9 offset:28672
v_mul_f32 v39, v39, v7
v_mfma_f32_16x16x32_bf16 v[136:139], a[188:191], a[220:223], v[136:139]
ds_read_b64_tr_b16 a[206:207], v9 offset:30720
v_mul_f32 v60, v60, v7
v_mfma_f32_16x16x32_bf16 v[144:147], a[188:191], a[224:227], v[144:147]
ds_read_b64_tr_b16 a[168:169], v15 offset:24576
v_mul_f32 v61, v61, v7
v_mfma_f32_16x16x32_bf16 v[144:147], a[184:187], a[212:215], v[144:147]
buffer_load_dwordx4 v4, s[36:39], s23 offen offset:3072 lds
v_mfma_f32_16x16x32_bf16 v[152:155], a[184:187], a[216:219], v[152:155]
s_add_u32 s20, s64, 172032
ds_read_b64_tr_b16 a[170:171], v15 offset:26624
v_mul_f32 v62, v62, v7
v_mfma_f32_16x16x32_bf16 v[152:155], a[188:191], a[228:231], v[152:155]
s_waitcnt lgkmcnt(6)
ds_read_b64_tr_b16 a[172:173], v15 offset:28672
v_mul_f32 v63, v63, v7
v_mfma_f32_16x16x32_bf16 v[140:143], a[192:195], a[208:211], v[140:143]
s_add_u32 s21, s64, 178176
ds_read_b64_tr_b16 a[174:175], v15 offset:30720
v_cvt_pk_bf16_f32 v36, v36, v37
v_mfma_f32_16x16x32_bf16 v[140:143], a[196:199], a[220:223], v[140:143]
v_cvt_pk_bf16_f32 v37, v38, v39
v_cvt_pk_bf16_f32 v38, v60, v61
v_cvt_pk_bf16_f32 v39, v62, v63
v_mfma_f32_16x16x32_bf16 v[148:151], a[196:199], a[224:227], v[148:151]
s_add_u32 s22, s64, 184320
ds_write_b128 v1, v[28:31] offset:4096
v_mfma_f32_16x16x32_bf16 v[148:151], a[192:195], a[212:215], v[148:151]
s_add_u32 s23, s64, 190464
ds_write_b128 v1, v[36:39] offset:5120
v_mfma_f32_16x16x32_bf16 v[156:159], a[192:195], a[216:219], v[156:159]
s_add_u32 m0, s59, 114688
v_accvgpr_read_b32 v232, a96
v_accvgpr_read_b32 v233, a97
v_mfma_f32_16x16x32_bf16 v[156:159], a[196:199], a[228:231], v[156:159]
s_waitcnt vmcnt(20) lgkmcnt(2)
s_barrier
ds_read_b64_tr_b16 a[176:177], v9 offset:49152
v_mfma_f32_16x16x32_bf16 v[136:139], a[200:203], a[232:235], v[136:139]
ds_read_b64_tr_b16 a[178:179], v9 offset:51200
ds_read_b64_tr_b16 a[180:181], v9 offset:53248
v_mfma_f32_16x16x32_bf16 v[136:139], a[204:207], a[244:247], v[136:139]
ds_read_b64_tr_b16 a[182:183], v9 offset:55296
v_accvgpr_read_b32 v234, a98
v_mfma_f32_16x16x32_bf16 v[144:147], a[204:207], a[248:251], v[144:147]
buffer_load_dwordx4 v4, s[36:39], s20 offen offset:0 lds
v_mfma_f32_16x16x32_bf16 v[144:147], a[200:203], a[236:239], v[144:147]
ds_read_b64_tr_b16 a[184:185], v15 offset:49152
v_accvgpr_read_b32 v235, a99
v_mfma_f32_16x16x32_bf16 v[152:155], a[200:203], a[240:243], v[152:155]
ds_read_b64_tr_b16 a[186:187], v15 offset:51200
v_accvgpr_read_b32 v236, a100
v_mfma_f32_16x16x32_bf16 v[152:155], a[204:207], a[252:255], v[152:155]
s_waitcnt lgkmcnt(8)
ds_read_b64_tr_b16 a[188:189], v15 offset:53248
v_accvgpr_read_b32 v237, a101
v_mfma_f32_16x16x32_bf16 v[140:143], a[168:171], a[232:235], v[140:143]
ds_read_b64_tr_b16 a[190:191], v15 offset:55296
v_accvgpr_read_b32 v238, a102
v_mfma_f32_16x16x32_bf16 v[140:143], a[172:175], a[244:247], v[140:143]
buffer_load_dwordx4 v4, s[36:39], s21 offen offset:1024 lds
v_mfma_f32_16x16x32_bf16 v[148:151], a[172:175], a[248:251], v[148:151]
ds_read_b64_tr_b16 a[192:193], v9 offset:57344
v_accvgpr_read_b32 v239, a103
v_mfma_f32_16x16x32_bf16 v[148:151], a[168:171], a[236:239], v[148:151]
s_waitcnt lgkmcnt(9)
s_barrier
ds_read_b64_tr_b16 a[194:195], v9 offset:59392
v_mfma_f32_16x16x32_bf16 v[156:159], a[168:171], a[240:243], v[156:159]
ds_read_b64_tr_b16 a[196:197], v9 offset:61440
ds_read_b64_tr_b16 a[198:199], v9 offset:63488
v_mfma_f32_16x16x32_bf16 v[156:159], a[172:175], a[252:255], v[156:159]
s_waitcnt lgkmcnt(8)
ds_read_b64_tr_b16 a[200:201], v15 offset:57344
v_lshlrev_b32 v60, 2, v0
v_mfma_f32_16x16x32_bf16 v[160:163], a[176:179], a[208:211], v[160:163]
buffer_load_dwordx4 v4, s[36:39], s22 offen offset:2048 lds
v_mfma_f32_16x16x32_bf16 v[160:163], a[180:183], a[220:223], v[160:163]
ds_read_b64_tr_b16 a[202:203], v15 offset:59392
ds_read_b64_tr_b16 a[204:205], v15 offset:61440
v_mfma_f32_16x16x32_bf16 v[168:171], a[180:183], a[224:227], v[168:171]
s_lshl_b32 s0, 1, s53
ds_read_b64_tr_b16 a[206:207], v15 offset:63488
v_accvgpr_read_b32 v240, a104
v_mfma_f32_16x16x32_bf16 v[168:171], a[176:179], a[212:215], v[168:171]
s_lshl_b32 s67, s53, 2
ds_read_b128 v[184:187], v2 offset:0
v_lshlrev_b32 v61, 12, v0
v_mfma_f32_16x16x32_bf16 v[176:179], a[176:179], a[216:219], v[176:179]
ds_read_b128 v[188:191], v2 offset:1024
v_add_u32 v61, s67, v61
v_mfma_f32_16x16x32_bf16 v[176:179], a[180:183], a[228:231], v[176:179]
s_waitcnt lgkmcnt(10)
ds_read_b128 v[192:195], v2 offset:2048
v_lshrrev_b32 v62, 4, v0
v_mfma_f32_16x16x32_bf16 v[164:167], a[184:187], a[208:211], v[164:167]
buffer_load_dwordx4 v4, s[36:39], s23 offen offset:3072 lds
v_mfma_f32_16x16x32_bf16 v[164:167], a[188:191], a[220:223], v[164:167]
s_add_u32 s20, s65, 114688
ds_read_b128 v[196:199], v2 offset:3072
s_add_u32 s21, s65, 120832
v_mfma_f32_16x16x32_bf16 v[172:175], a[188:191], a[224:227], v[172:175]
s_add_u32 s22, s65, 126976
ds_read_b128 v[200:203], v2 offset:4096
s_add_u32 s23, s65, 133120
v_mfma_f32_16x16x32_bf16 v[172:175], a[184:187], a[212:215], v[172:175]
s_add_u32 m0, s59, 16384
ds_read_b128 v[204:207], v2 offset:5120
v_bfe_u32 v63, v0, 2, 2
v_mfma_f32_16x16x32_bf16 v[180:183], a[184:187], a[216:219], v[180:183]
ds_read_b128 v[208:211], v2 offset:6144
v_cmp_eq_u32 vcc, v62, v63
v_mfma_f32_16x16x32_bf16 v[180:183], a[188:191], a[228:231], v[180:183]
s_waitcnt lgkmcnt(11)
buffer_load_dwordx4 v4, s[36:39], s20 offen offset:0 lds
v_mfma_f32_16x16x32_bf16 v[160:163], a[192:195], a[232:235], v[160:163]
ds_read_b64_tr_b16 a[168:169], v9 offset:0
ds_read_b64_tr_b16 a[170:171], v9 offset:2048
v_mfma_f32_16x16x32_bf16 v[160:163], a[196:199], a[244:247], v[160:163]
ds_read_b64_tr_b16 a[172:173], v9 offset:4096
ds_read_b64_tr_b16 a[174:175], v9 offset:6144
v_mfma_f32_16x16x32_bf16 v[168:171], a[196:199], a[248:251], v[168:171]
ds_read_b64_tr_b16 a[176:177], v15 offset:0
ds_read_b64_tr_b16 a[178:179], v15 offset:2048
v_mfma_f32_16x16x32_bf16 v[168:171], a[192:195], a[236:239], v[168:171]
ds_read_b64_tr_b16 a[180:181], v15 offset:4096
ds_read_b64_tr_b16 a[182:183], v15 offset:6144
v_mfma_f32_16x16x32_bf16 v[176:179], a[192:195], a[240:243], v[176:179]
buffer_load_dwordx4 v4, s[36:39], s21 offen offset:1024 lds
v_mfma_f32_16x16x32_bf16 v[176:179], a[196:199], a[252:255], v[176:179]
s_waitcnt lgkmcnt(15)
ds_read_b128 v[212:215], v2 offset:7168
v_and_b32 v62, 1, v0
v_mfma_f32_16x16x32_bf16 v[164:167], a[200:203], a[232:235], v[164:167]
ds_read_b128 v[216:219], v2 offset:8192
v_lshlrev_b32 v62, 4, v62
v_mfma_f32_16x16x32_bf16 v[164:167], a[204:207], a[244:247], v[164:167]
ds_read_b128 v[220:223], v2 offset:9216
v_mov_b32 v63, 0x3f80
v_mfma_f32_16x16x32_bf16 v[172:175], a[204:207], a[248:251], v[172:175]
ds_read_b128 v[224:227], v2 offset:10240
v_lshlrev_b32 v62, v62, v63
v_mfma_f32_16x16x32_bf16 v[172:175], a[200:203], a[236:239], v[172:175]
ds_read_b128 v[228:231], v2 offset:11264
v_cndmask_b32 v62, 0, v62, vcc
v_mfma_f32_16x16x32_bf16 v[180:183], a[200:203], a[240:243], v[180:183]
s_waitcnt lgkmcnt(14)
buffer_load_dwordx4 v4, s[36:39], s22 offen offset:2048 lds
v_mfma_f32_16x16x32_bf16 v[180:183], a[204:207], a[252:255], v[180:183]
s_waitcnt lgkmcnt(9)
ds_read_b64_tr_b16 a[184:185], v9 offset:8192
v_and_b32 v63, 2, v0
v_mfma_f32_16x16x32_bf16 v[88:91], a[168:171], v[184:187], v[88:91]
ds_read_b64_tr_b16 a[186:187], v9 offset:10240
v_cmp_eq_u32 vcc, 0, v63
v_mfma_f32_16x16x32_bf16 v[88:91], a[172:175], v[196:199], v[88:91]
ds_read_b64_tr_b16 a[188:189], v9 offset:12288
v_mov_b32 v54, 0
v_mfma_f32_16x16x32_bf16 v[96:99], a[172:175], v[200:203], v[96:99]
ds_read_b64_tr_b16 a[190:191], v9 offset:14336
v_mov_b32 v55, 0
v_mfma_f32_16x16x32_bf16 v[96:99], a[168:171], v[188:191], v[96:99]
buffer_load_dwordx4 v4, s[36:39], s23 offen offset:3072 lds
v_mfma_f32_16x16x32_bf16 v[104:107], a[168:171], v[192:195], v[104:107]
s_add_u32 s20, s65, 172032
ds_read_b64_tr_b16 a[192:193], v15 offset:8192
v_cndmask_b32 v52, 0, v62, vcc
v_mfma_f32_16x16x32_bf16 v[104:107], a[172:175], v[204:207], v[104:107]
s_waitcnt lgkmcnt(10)
ds_read_b64_tr_b16 a[194:195], v15 offset:10240
v_sub_u32 v53, v62, v52
v_mfma_f32_16x16x32_bf16 v[92:95], a[176:179], v[184:187], v[92:95]
s_add_u32 s21, s65, 178176
ds_read_b64_tr_b16 a[196:197], v15 offset:12288
v_mov_b32 v56, 0
v_mfma_f32_16x16x32_bf16 v[92:95], a[180:183], v[196:199], v[92:95]
s_add_u32 s22, s65, 184320
ds_read_b64_tr_b16 a[198:199], v15 offset:14336
v_mov_b32 v57, 0
v_mfma_f32_16x16x32_bf16 v[100:103], a[180:183], v[200:203], v[100:103]
s_add_u32 s23, s65, 190464
v_mov_b32 v58, v52
v_mov_b32 v59, v53
v_mfma_f32_16x16x32_bf16 v[100:103], a[176:179], v[188:191], v[100:103]
s_add_u32 m0, s59, 49152
v_mov_b32 v3, 0x10000000
v_accvgpr_read_b32 v241, a105
v_mfma_f32_16x16x32_bf16 v[108:111], a[176:179], v[192:195], v[108:111]
s_waitcnt lgkmcnt(8)
v_accvgpr_read_b32 v242, a106
v_accvgpr_read_b32 v243, a107
v_mfma_f32_16x16x32_bf16 v[108:111], a[180:183], v[204:207], v[108:111]
s_waitcnt vmcnt(16) lgkmcnt(0)
s_barrier
ds_read_b64_tr_b16 a[200:201], v9 offset:32768
v_mfma_f32_16x16x32_bf16 v[88:91], a[184:187], v[208:211], v[88:91]
ds_read_b64_tr_b16 a[202:203], v9 offset:34816
v_accvgpr_read_b32 v244, a108
v_mfma_f32_16x16x32_bf16 v[88:91], a[188:191], v[220:223], v[88:91]
ds_read_b64_tr_b16 a[204:205], v9 offset:36864
v_accvgpr_read_b32 v245, a109
v_mfma_f32_16x16x32_bf16 v[96:99], a[188:191], v[224:227], v[96:99]
buffer_load_dwordx4 v4, s[36:39], s20 offen offset:0 lds
v_mfma_f32_16x16x32_bf16 v[96:99], a[184:187], v[212:215], v[96:99]
ds_read_b64_tr_b16 a[206:207], v9 offset:38912
v_accvgpr_read_b32 v246, a110
v_mfma_f32_16x16x32_bf16 v[104:107], a[184:187], v[216:219], v[104:107]
ds_read_b64_tr_b16 a[168:169], v15 offset:32768
v_accvgpr_read_b32 v247, a111
v_mfma_f32_16x16x32_bf16 v[104:107], a[188:191], v[228:231], v[104:107]
s_waitcnt lgkmcnt(5)
ds_read_b64_tr_b16 a[170:171], v15 offset:34816
v_accvgpr_read_b32 v248, a112
v_mfma_f32_16x16x32_bf16 v[92:95], a[192:195], v[208:211], v[92:95]
ds_read_b64_tr_b16 a[172:173], v15 offset:36864
v_accvgpr_read_b32 v249, a113
v_mfma_f32_16x16x32_bf16 v[92:95], a[196:199], v[220:223], v[92:95]
buffer_load_dwordx4 v4, s[36:39], s21 offen offset:1024 lds
v_mfma_f32_16x16x32_bf16 v[100:103], a[196:199], v[224:227], v[100:103]
ds_read_b64_tr_b16 a[174:175], v15 offset:38912
v_accvgpr_read_b32 v250, a114
v_mfma_f32_16x16x32_bf16 v[100:103], a[192:195], v[212:215], v[100:103]
ds_read_b64_tr_b16 a[176:177], v9 offset:40960
v_accvgpr_read_b32 v251, a115
v_mfma_f32_16x16x32_bf16 v[108:111], a[192:195], v[216:219], v[108:111]
ds_read_b64_tr_b16 a[178:179], v9 offset:43008
v_accvgpr_read_b32 v252, a116
v_mfma_f32_16x16x32_bf16 v[108:111], a[196:199], v[228:231], v[108:111]
s_waitcnt lgkmcnt(6)
ds_read_b64_tr_b16 a[180:181], v9 offset:45056
v_accvgpr_read_b32 v253, a117
v_mfma_f32_16x16x32_bf16 v[112:115], a[200:203], v[184:187], v[112:115]
buffer_load_dwordx4 v4, s[36:39], s22 offen offset:2048 lds
v_mfma_f32_16x16x32_bf16 v[112:115], a[204:207], v[196:199], v[112:115]
ds_read_b64_tr_b16 a[182:183], v9 offset:47104
v_accvgpr_read_b32 v254, a118
v_mfma_f32_16x16x32_bf16 v[120:123], a[204:207], v[200:203], v[120:123]
ds_read_b64_tr_b16 a[184:185], v15 offset:40960
v_accvgpr_read_b32 v255, a119
v_mfma_f32_16x16x32_bf16 v[120:123], a[200:203], v[188:191], v[120:123]
ds_read_b64_tr_b16 a[186:187], v15 offset:43008
v_accvgpr_read_b32 v64, a120
v_mfma_f32_16x16x32_bf16 v[128:131], a[200:203], v[192:195], v[128:131]
ds_read_b64_tr_b16 a[188:189], v15 offset:45056
v_accvgpr_read_b32 v65, a121
v_mfma_f32_16x16x32_bf16 v[128:131], a[204:207], v[204:207], v[128:131]
s_waitcnt lgkmcnt(7)
ds_read_b64_tr_b16 a[190:191], v15 offset:47104
v_add_u32 v9, 0x10000, v9
v_mfma_f32_16x16x32_bf16 v[116:119], a[168:171], v[184:187], v[116:119]
buffer_load_dwordx4 v4, s[36:39], s23 offen offset:3072 lds
v_mfma_f32_16x16x32_bf16 v[116:119], a[172:175], v[196:199], v[116:119]
s_add_u32 s20, s66, 114688
s_add_u32 s21, s66, 120832
s_add_u32 s22, s66, 126976
v_mfma_f32_16x16x32_bf16 v[124:127], a[172:175], v[200:203], v[124:127]
s_add_u32 s23, s66, 133120
s_add_u32 m0, s59, 0
v_add_u32 v15, 0x10000, v15
v_mfma_f32_16x16x32_bf16 v[124:127], a[168:171], v[188:191], v[124:127]
v_accvgpr_read_b32 v66, a122
v_accvgpr_read_b32 v67, a123
v_mfma_f32_16x16x32_bf16 v[132:135], a[168:171], v[192:195], v[132:135]
v_accvgpr_read_b32 v68, a124
v_accvgpr_read_b32 v69, a125
v_mfma_f32_16x16x32_bf16 v[132:135], a[172:175], v[204:207], v[132:135]
s_waitcnt lgkmcnt(4)
buffer_load_dwordx4 v4, s[36:39], s20 offen offset:0 lds
v_mfma_f32_16x16x32_bf16 v[112:115], a[176:179], v[208:211], v[112:115]
ds_read_b64_tr_b16 a[192:193], v9 offset:32768
ds_read_b64_tr_b16 a[194:195], v9 offset:34816
v_mfma_f32_16x16x32_bf16 v[112:115], a[180:183], v[220:223], v[112:115]
s_cmp_eq_u32 s53, 0
s_cselect_b64 s[74:75], -1, 0
ds_read_b64_tr_b16 a[196:197], v9 offset:36864
v_mfma_f32_16x16x32_bf16 v[120:123], a[180:183], v[224:227], v[120:123]
ds_read_b64_tr_b16 a[198:199], v9 offset:38912
v_cndmask_b32 v62, v14, v3, s[74:75]
v_mfma_f32_16x16x32_bf16 v[120:123], a[176:179], v[212:215], v[120:123]
ds_read_b64_tr_b16 a[200:201], v15 offset:32768
v_cvt_pk_bf16_f32 v88, v88, v89
v_mfma_f32_16x16x32_bf16 v[128:131], a[176:179], v[216:219], v[128:131]
v_cvt_pk_bf16_f32 v89, v90, v91
v_cvt_pk_bf16_f32 v90, v92, v93
v_cvt_pk_bf16_f32 v91, v94, v95
v_mfma_f32_16x16x32_bf16 v[128:131], a[180:183], v[228:231], v[128:131]
s_waitcnt lgkmcnt(5)
buffer_load_dwordx4 v4, s[36:39], s21 offen offset:1024 lds
buffer_store_dwordx4 v[88:91], v62, s[40:43], s78 offen sc1
v_mfma_f32_16x16x32_bf16 v[116:119], a[184:187], v[208:211], v[116:119]
s_add_u32 s78, s78, 1024
ds_read_b64_tr_b16 a[202:203], v15 offset:34816
v_cndmask_b32 v40, v40, v88, s[74:75]
v_mfma_f32_16x16x32_bf16 v[116:119], a[188:191], v[220:223], v[116:119]
ds_read_b64_tr_b16 a[204:205], v15 offset:36864
v_cndmask_b32 v41, v41, v89, s[74:75]
v_mfma_f32_16x16x32_bf16 v[124:127], a[188:191], v[224:227], v[124:127]
ds_read_b64_tr_b16 a[206:207], v15 offset:38912
v_cndmask_b32 v42, v42, v90, s[74:75]
v_mfma_f32_16x16x32_bf16 v[124:127], a[184:187], v[212:215], v[124:127]
ds_read_b64_tr_b16 a[168:169], v9 offset:40960
v_cndmask_b32 v43, v43, v91, s[74:75]
v_mfma_f32_16x16x32_bf16 v[132:135], a[184:187], v[216:219], v[132:135]
buffer_load_dwordx4 v4, s[36:39], s22 offen offset:2048 lds
v_mfma_f32_16x16x32_bf16 v[132:135], a[188:191], v[228:231], v[132:135]
s_waitcnt lgkmcnt(5)
ds_read_b64_tr_b16 a[170:171], v9 offset:43008
v_accvgpr_read_b32 v70, a126
v_mfma_f32_16x16x32_bf16 v[136:139], a[192:195], v[184:187], v[136:139]
s_cmp_eq_u32 s53, 1
s_cselect_b64 s[34:35], -1, 0
ds_read_b64_tr_b16 a[172:173], v9 offset:45056
v_mfma_f32_16x16x32_bf16 v[136:139], a[196:199], v[196:199], v[136:139]
ds_read_b64_tr_b16 a[174:175], v9 offset:47104
v_cndmask_b32 v63, v14, v3, s[34:35]
v_mfma_f32_16x16x32_bf16 v[144:147], a[196:199], v[200:203], v[144:147]
ds_read_b64_tr_b16 a[176:177], v15 offset:40960
v_cvt_pk_bf16_f32 v96, v96, v97
v_mfma_f32_16x16x32_bf16 v[144:147], a[192:195], v[188:191], v[144:147]
v_cvt_pk_bf16_f32 v97, v98, v99
v_cvt_pk_bf16_f32 v98, v100, v101
v_cvt_pk_bf16_f32 v99, v102, v103
v_mfma_f32_16x16x32_bf16 v[152:155], a[192:195], v[192:195], v[152:155]
buffer_load_dwordx4 v4, s[36:39], s23 offen offset:3072 lds
buffer_store_dwordx4 v[96:99], v63, s[40:43], s78 offen sc1
v_mfma_f32_16x16x32_bf16 v[152:155], a[196:199], v[204:207], v[152:155]
s_waitcnt lgkmcnt(5)
ds_read_b64_tr_b16 a[178:179], v15 offset:43008
s_add_u32 s78, s78, 1024
v_mfma_f32_16x16x32_bf16 v[140:143], a[200:203], v[184:187], v[140:143]
s_add_u32 s20, s66, 172032
ds_read_b64_tr_b16 a[180:181], v15 offset:45056
v_cndmask_b32 v40, v40, v96, s[34:35]
v_mfma_f32_16x16x32_bf16 v[140:143], a[204:207], v[196:199], v[140:143]
s_add_u32 s21, s66, 178176
ds_read_b64_tr_b16 a[182:183], v15 offset:47104
v_cndmask_b32 v41, v41, v97, s[34:35]
v_mfma_f32_16x16x32_bf16 v[148:151], a[204:207], v[200:203], v[148:151]
s_add_u32 s22, s66, 184320
v_cndmask_b32 v42, v42, v98, s[34:35]
v_cndmask_b32 v43, v43, v99, s[34:35]
v_mfma_f32_16x16x32_bf16 v[148:151], a[200:203], v[188:191], v[148:151]
s_cmp_eq_u32 s53, 2
s_cselect_b64 s[74:75], -1, 0
v_accvgpr_read_b32 v71, a127
v_mfma_f32_16x16x32_bf16 v[156:159], a[200:203], v[192:195], v[156:159]
s_add_u32 s23, s66, 190464
s_add_u32 m0, s59, 32768
v_cndmask_b32 v62, v14, v3, s[74:75]
v_mfma_f32_16x16x32_bf16 v[156:159], a[204:207], v[204:207], v[156:159]
s_waitcnt vmcnt(18) lgkmcnt(0)
s_barrier
ds_read_b64_tr_b16 a[184:185], v9 offset:16384
v_mfma_f32_16x16x32_bf16 v[136:139], a[168:171], v[208:211], v[136:139]
ds_read_b64_tr_b16 a[186:187], v9 offset:18432
v_cvt_pk_bf16_f32 v104, v104, v105
v_mfma_f32_16x16x32_bf16 v[136:139], a[172:175], v[220:223], v[136:139]
ds_read_b64_tr_b16 a[188:189], v9 offset:20480
v_cvt_pk_bf16_f32 v105, v106, v107
v_mfma_f32_16x16x32_bf16 v[144:147], a[172:175], v[224:227], v[144:147]
v_cvt_pk_bf16_f32 v106, v108, v109
v_cvt_pk_bf16_f32 v107, v110, v111
v_mfma_f32_16x16x32_bf16 v[144:147], a[168:171], v[212:215], v[144:147]
buffer_load_dwordx4 v4, s[36:39], s20 offen offset:0 lds
buffer_store_dwordx4 v[104:107], v62, s[40:43], s78 offen sc1
v_mfma_f32_16x16x32_bf16 v[152:155], a[168:171], v[216:219], v[152:155]
s_add_u32 s78, s78, 1024
ds_read_b64_tr_b16 a[190:191], v9 offset:22528
v_cndmask_b32 v40, v40, v104, s[74:75]
v_mfma_f32_16x16x32_bf16 v[152:155], a[172:175], v[228:231], v[152:155]
s_waitcnt lgkmcnt(4)
ds_read_b64_tr_b16 a[192:193], v15 offset:16384
v_cndmask_b32 v41, v41, v105, s[74:75]
v_mfma_f32_16x16x32_bf16 v[140:143], a[176:179], v[208:211], v[140:143]
ds_read_b64_tr_b16 a[194:195], v15 offset:18432
v_cndmask_b32 v42, v42, v106, s[74:75]
v_mfma_f32_16x16x32_bf16 v[140:143], a[180:183], v[220:223], v[140:143]
ds_read_b64_tr_b16 a[196:197], v15 offset:20480
v_cndmask_b32 v43, v43, v107, s[74:75]
v_mfma_f32_16x16x32_bf16 v[148:151], a[180:183], v[224:227], v[148:151]
s_cmp_eq_u32 s53, 3
s_cselect_b64 s[34:35], -1, 0
ds_read_b64_tr_b16 a[198:199], v15 offset:22528
v_mfma_f32_16x16x32_bf16 v[148:151], a[176:179], v[212:215], v[148:151]
ds_read_b64_tr_b16 a[200:201], v9 offset:24576
v_cndmask_b32 v63, v14, v3, s[34:35]
v_mfma_f32_16x16x32_bf16 v[156:159], a[176:179], v[216:219], v[156:159]
buffer_load_dwordx4 v4, s[36:39], s21 offen offset:1024 lds
v_mfma_f32_16x16x32_bf16 v[156:159], a[180:183], v[228:231], v[156:159]
s_waitcnt lgkmcnt(5)
ds_read_b64_tr_b16 a[202:203], v9 offset:26624
v_cvt_pk_bf16_f32 v112, v112, v113
v_mfma_f32_16x16x32_bf16 v[160:163], a[184:187], v[184:187], v[160:163]
ds_read_b64_tr_b16 a[204:205], v9 offset:28672
v_cvt_pk_bf16_f32 v113, v114, v115
v_mfma_f32_16x16x32_bf16 v[160:163], a[188:191], v[196:199], v[160:163]
v_cvt_pk_bf16_f32 v114, v116, v117
v_cvt_pk_bf16_f32 v115, v118, v119
v_mfma_f32_16x16x32_bf16 v[168:171], a[188:191], v[200:203], v[168:171]
buffer_store_dwordx4 v[112:115], v63, s[40:43], s78 offen sc1
v_mfma_f32_16x16x32_bf16 v[168:171], a[184:187], v[188:191], v[168:171]
ds_read_b64_tr_b16 a[206:207], v9 offset:30720
ds_read_b64_tr_b16 a[168:169], v15 offset:24576
v_mfma_f32_16x16x32_bf16 v[176:179], a[184:187], v[192:195], v[176:179]
s_add_u32 s78, s78, 1024
ds_read_b64_tr_b16 a[170:171], v15 offset:26624
v_cndmask_b32 v40, v40, v112, s[34:35]
v_mfma_f32_16x16x32_bf16 v[176:179], a[188:191], v[204:207], v[176:179]
s_waitcnt lgkmcnt(6)
ds_read_b64_tr_b16 a[172:173], v15 offset:28672
v_cndmask_b32 v41, v41, v113, s[34:35]
v_mfma_f32_16x16x32_bf16 v[164:167], a[192:195], v[184:187], v[164:167]
ds_read_b64_tr_b16 a[174:175], v15 offset:30720
v_cndmask_b32 v42, v42, v114, s[34:35]
v_mfma_f32_16x16x32_bf16 v[164:167], a[196:199], v[196:199], v[164:167]
buffer_load_dwordx4 v4, s[36:39], s22 offen offset:2048 lds
v_mfma_f32_16x16x32_bf16 v[172:175], a[196:199], v[200:203], v[172:175]
s_cmp_eq_u32 s53, 4
s_cselect_b64 s[74:75], -1, 0
v_cndmask_b32 v43, v43, v115, s[34:35]
v_mfma_f32_16x16x32_bf16 v[172:175], a[192:195], v[188:191], v[172:175]
v_cndmask_b32 v62, v14, v3, s[74:75]
v_cvt_pk_bf16_f32 v120, v120, v121
v_mfma_f32_16x16x32_bf16 v[180:183], a[192:195], v[192:195], v[180:183]
v_cvt_pk_bf16_f32 v121, v122, v123
v_cvt_pk_bf16_f32 v122, v124, v125
v_mfma_f32_16x16x32_bf16 v[180:183], a[196:199], v[204:207], v[180:183]
s_waitcnt lgkmcnt(4)
ds_read_b64_tr_b16 a[176:177], v9 offset:0
v_cvt_pk_bf16_f32 v123, v126, v127
v_mfma_f32_16x16x32_bf16 v[160:163], a[200:203], v[208:211], v[160:163]
buffer_store_dwordx4 v[120:123], v62, s[40:43], s78 offen sc1
v_mfma_f32_16x16x32_bf16 v[160:163], a[204:207], v[220:223], v[160:163]
s_add_u32 s78, s78, 1024
ds_read_b64_tr_b16 a[178:179], v9 offset:2048
v_cndmask_b32 v40, v40, v120, s[74:75]
v_mfma_f32_16x16x32_bf16 v[168:171], a[204:207], v[224:227], v[168:171]
buffer_load_dwordx4 v4, s[36:39], s23 offen offset:3072 lds
v_mfma_f32_16x16x32_bf16 v[168:171], a[200:203], v[212:215], v[168:171]
ds_read_b64_tr_b16 a[180:181], v9 offset:4096
v_cndmask_b32 v41, v41, v121, s[74:75]
v_mfma_f32_16x16x32_bf16 v[176:179], a[200:203], v[216:219], v[176:179]
ds_read_b64_tr_b16 a[182:183], v9 offset:6144
v_cndmask_b32 v42, v42, v122, s[74:75]
v_mfma_f32_16x16x32_bf16 v[176:179], a[204:207], v[228:231], v[176:179]
s_waitcnt lgkmcnt(4)
ds_read_b64_tr_b16 a[184:185], v15 offset:0
v_cndmask_b32 v43, v43, v123, s[74:75]
v_mfma_f32_16x16x32_bf16 v[164:167], a[168:171], v[208:211], v[164:167]
s_cmp_eq_u32 s53, 5
s_cselect_b64 s[34:35], -1, 0
ds_read_b64_tr_b16 a[186:187], v15 offset:2048
v_mfma_f32_16x16x32_bf16 v[164:167], a[172:175], v[220:223], v[164:167]
ds_read_b64_tr_b16 a[188:189], v15 offset:4096
v_cndmask_b32 v63, v14, v3, s[34:35]
v_mfma_f32_16x16x32_bf16 v[172:175], a[172:175], v[224:227], v[172:175]
ds_read_b64_tr_b16 a[190:191], v15 offset:6144
v_cvt_pk_bf16_f32 v128, v128, v129
v_mfma_f32_16x16x32_bf16 v[172:175], a[168:171], v[212:215], v[172:175]
ds_read_b64_tr_b16 a[192:193], v9 offset:8192
v_cvt_pk_bf16_f32 v129, v130, v131
v_mfma_f32_16x16x32_bf16 v[180:183], a[168:171], v[216:219], v[180:183]
ds_read_b64_tr_b16 a[194:195], v9 offset:10240
v_cvt_pk_bf16_f32 v130, v132, v133
v_mfma_f32_16x16x32_bf16 v[180:183], a[172:175], v[228:231], v[180:183]
s_waitcnt lgkmcnt(6)
ds_read_b64_tr_b16 a[196:197], v9 offset:12288
v_cvt_pk_bf16_f32 v131, v134, v135
v_mfma_f32_16x16x32_bf16 v[232:235], a[176:179], a[208:211], v[232:235]
buffer_store_dwordx4 v[128:131], v63, s[40:43], s78 offen sc1
v_mfma_f32_16x16x32_bf16 v[232:235], a[180:183], a[220:223], v[232:235]
s_add_u32 s78, s78, 1024
ds_read_b64_tr_b16 a[198:199], v9 offset:14336
v_cndmask_b32 v40, v40, v128, s[34:35]
v_mfma_f32_16x16x32_bf16 v[240:243], a[180:183], a[224:227], v[240:243]
ds_read_b64_tr_b16 a[200:201], v15 offset:8192
v_cndmask_b32 v41, v41, v129, s[34:35]
v_mfma_f32_16x16x32_bf16 v[240:243], a[176:179], a[212:215], v[240:243]
ds_read_b64_tr_b16 a[202:203], v15 offset:10240
v_cndmask_b32 v42, v42, v130, s[34:35]
v_mfma_f32_16x16x32_bf16 v[248:251], a[176:179], a[216:219], v[248:251]
ds_read_b64_tr_b16 a[204:205], v15 offset:12288
v_cndmask_b32 v43, v43, v131, s[34:35]
v_mfma_f32_16x16x32_bf16 v[248:251], a[180:183], a[228:231], v[248:251]
s_waitcnt lgkmcnt(7)
ds_read_b64_tr_b16 a[206:207], v15 offset:14336
v_accvgpr_read_b32 v72, a128
v_mfma_f32_16x16x32_bf16 v[236:239], a[184:187], a[208:211], v[236:239]
s_cmp_eq_u32 s53, 6
s_cselect_b64 s[74:75], -1, 0
v_accvgpr_read_b32 v73, a129
v_mfma_f32_16x16x32_bf16 v[236:239], a[188:191], a[220:223], v[236:239]
v_cndmask_b32 v62, v14, v3, s[74:75]
v_cvt_pk_bf16_f32 v136, v136, v137
v_mfma_f32_16x16x32_bf16 v[244:247], a[188:191], a[224:227], v[244:247]
v_cvt_pk_bf16_f32 v137, v138, v139
v_cvt_pk_bf16_f32 v138, v140, v141
v_mfma_f32_16x16x32_bf16 v[244:247], a[184:187], a[212:215], v[244:247]
v_cvt_pk_bf16_f32 v139, v142, v143
v_accvgpr_read_b32 v74, a130
v_mfma_f32_16x16x32_bf16 v[252:255], a[184:187], a[216:219], v[252:255]
buffer_store_dwordx4 v[136:139], v62, s[40:43], s78 offen sc1
v_mfma_f32_16x16x32_bf16 v[252:255], a[188:191], a[228:231], v[252:255]
s_waitcnt vmcnt(19) lgkmcnt(0)
s_barrier
ds_read_b64_tr_b16 a[168:169], v9 offset:49152
v_mfma_f32_16x16x32_bf16 v[232:235], a[192:195], a[232:235], v[232:235]
s_add_u32 s78, s78, 1024
ds_read_b64_tr_b16 a[170:171], v9 offset:51200
v_cndmask_b32 v40, v40, v136, s[74:75]
v_mfma_f32_16x16x32_bf16 v[232:235], a[196:199], a[244:247], v[232:235]
ds_read_b64_tr_b16 a[172:173], v9 offset:53248
v_cndmask_b32 v41, v41, v137, s[74:75]
v_mfma_f32_16x16x32_bf16 v[240:243], a[196:199], a[248:251], v[240:243]
ds_read_b64_tr_b16 a[174:175], v9 offset:55296
v_cndmask_b32 v42, v42, v138, s[74:75]
v_mfma_f32_16x16x32_bf16 v[240:243], a[192:195], a[236:239], v[240:243]
ds_read_b64_tr_b16 a[176:177], v15 offset:49152
v_cndmask_b32 v43, v43, v139, s[74:75]
v_mfma_f32_16x16x32_bf16 v[248:251], a[192:195], a[240:243], v[248:251]
s_cmp_eq_u32 s53, 7
s_cselect_b64 s[34:35], -1, 0
ds_read_b64_tr_b16 a[178:179], v15 offset:51200
v_mfma_f32_16x16x32_bf16 v[248:251], a[196:199], a[252:255], v[248:251]
s_waitcnt lgkmcnt(6)
ds_read_b64_tr_b16 a[180:181], v15 offset:53248
v_cndmask_b32 v63, v14, v3, s[34:35]
v_mfma_f32_16x16x32_bf16 v[236:239], a[200:203], a[232:235], v[236:239]
ds_read_b64_tr_b16 a[182:183], v15 offset:55296
v_cvt_pk_bf16_f32 v144, v144, v145
v_mfma_f32_16x16x32_bf16 v[236:239], a[204:207], a[244:247], v[236:239]
ds_read_b64_tr_b16 a[184:185], v9 offset:57344
v_cvt_pk_bf16_f32 v145, v146, v147
v_mfma_f32_16x16x32_bf16 v[244:247], a[204:207], a[248:251], v[244:247]
ds_read_b64_tr_b16 a[186:187], v9 offset:59392
v_cvt_pk_bf16_f32 v146, v148, v149
v_mfma_f32_16x16x32_bf16 v[244:247], a[200:203], a[236:239], v[244:247]
ds_read_b64_tr_b16 a[188:189], v9 offset:61440
v_cvt_pk_bf16_f32 v147, v150, v151
v_mfma_f32_16x16x32_bf16 v[252:255], a[200:203], a[240:243], v[252:255]
buffer_store_dwordx4 v[144:147], v63, s[40:43], s78 offen sc1
v_mfma_f32_16x16x32_bf16 v[252:255], a[204:207], a[252:255], v[252:255]
s_waitcnt lgkmcnt(7)
ds_read_b64_tr_b16 a[190:191], v9 offset:63488
s_add_u32 s78, s78, 1024
v_mfma_f32_16x16x32_bf16 v[232:235], a[168:171], v[184:187], v[232:235]
ds_read_b64_tr_b16 a[192:193], v15 offset:57344
v_cndmask_b32 v40, v40, v144, s[34:35]
v_mfma_f32_16x16x32_bf16 v[232:235], a[172:175], v[196:199], v[232:235]
ds_read_b64_tr_b16 a[194:195], v15 offset:59392
v_cndmask_b32 v41, v41, v145, s[34:35]
v_mfma_f32_16x16x32_bf16 v[240:243], a[172:175], v[200:203], v[240:243]
ds_read_b64_tr_b16 a[196:197], v15 offset:61440
v_cndmask_b32 v42, v42, v146, s[34:35]
v_mfma_f32_16x16x32_bf16 v[240:243], a[168:171], v[188:191], v[240:243]
ds_read_b64_tr_b16 a[198:199], v15 offset:63488
v_cndmask_b32 v43, v43, v147, s[34:35]
v_mfma_f32_16x16x32_bf16 v[248:251], a[168:171], v[192:195], v[248:251]
s_cmp_eq_u32 s53, 0
s_cselect_b64 s[74:75], -1, 0
v_accvgpr_read_b32 v75, a131
v_mfma_f32_16x16x32_bf16 v[248:251], a[172:175], v[204:207], v[248:251]
s_waitcnt lgkmcnt(8)
v_cndmask_b32 v62, v14, v3, s[74:75]
v_cvt_pk_bf16_f32 v152, v152, v153
v_mfma_f32_16x16x32_bf16 v[236:239], a[176:179], v[184:187], v[236:239]
v_cvt_pk_bf16_f32 v153, v154, v155
v_cvt_pk_bf16_f32 v154, v156, v157
v_mfma_f32_16x16x32_bf16 v[236:239], a[180:183], v[196:199], v[236:239]
v_cvt_pk_bf16_f32 v155, v158, v159
v_subrev_u32 v9, 0x10000, v9
v_mfma_f32_16x16x32_bf16 v[244:247], a[180:183], v[200:203], v[244:247]
buffer_store_dwordx4 v[152:155], v62, s[40:43], s78 offen sc1
v_mfma_f32_16x16x32_bf16 v[244:247], a[176:179], v[188:191], v[244:247]
s_add_u32 s78, s78, 1024
v_subrev_u32 v15, 0x10000, v15
v_cndmask_b32 v44, v44, v152, s[74:75]
v_mfma_f32_16x16x32_bf16 v[252:255], a[176:179], v[192:195], v[252:255]
v_cndmask_b32 v45, v45, v153, s[74:75]
v_cndmask_b32 v46, v46, v154, s[74:75]
v_mfma_f32_16x16x32_bf16 v[252:255], a[180:183], v[204:207], v[252:255]
s_waitcnt lgkmcnt(4)
ds_read_b64_tr_b16 a[200:201], v9 offset:16384
v_cndmask_b32 v47, v47, v155, s[74:75]
v_mfma_f32_16x16x32_bf16 v[232:235], a[184:187], v[208:211], v[232:235]
ds_read_b64_tr_b16 a[202:203], v9 offset:18432
v_accvgpr_read_b32 v76, a132
v_mfma_f32_16x16x32_bf16 v[232:235], a[188:191], v[220:223], v[232:235]
ds_read_b64_tr_b16 a[204:205], v9 offset:20480
v_accvgpr_read_b32 v77, a133
v_mfma_f32_16x16x32_bf16 v[240:243], a[188:191], v[224:227], v[240:243]
ds_read_b64_tr_b16 a[206:207], v9 offset:22528
v_accvgpr_read_b32 v78, a134
v_mfma_f32_16x16x32_bf16 v[240:243], a[184:187], v[212:215], v[240:243]
s_cmp_eq_u32 s53, 1
s_cselect_b64 s[34:35], -1, 0
ds_read_b64_tr_b16 a[168:169], v15 offset:16384
v_mfma_f32_16x16x32_bf16 v[248:251], a[184:187], v[216:219], v[248:251]
ds_read_b64_tr_b16 a[170:171], v15 offset:18432
v_cndmask_b32 v63, v14, v3, s[34:35]
v_mfma_f32_16x16x32_bf16 v[248:251], a[188:191], v[228:231], v[248:251]
s_waitcnt lgkmcnt(6)
ds_read_b64_tr_b16 a[172:173], v15 offset:20480
v_cvt_pk_bf16_f32 v160, v160, v161
v_mfma_f32_16x16x32_bf16 v[236:239], a[192:195], v[208:211], v[236:239]
ds_read_b64_tr_b16 a[174:175], v15 offset:22528
v_cvt_pk_bf16_f32 v161, v162, v163
v_mfma_f32_16x16x32_bf16 v[236:239], a[196:199], v[220:223], v[236:239]
ds_read_b64_tr_b16 a[176:177], v9 offset:24576
v_cvt_pk_bf16_f32 v162, v164, v165
v_mfma_f32_16x16x32_bf16 v[244:247], a[196:199], v[224:227], v[244:247]
ds_read_b64_tr_b16 a[178:179], v9 offset:26624
v_cvt_pk_bf16_f32 v163, v166, v167
v_mfma_f32_16x16x32_bf16 v[244:247], a[192:195], v[212:215], v[244:247]
buffer_store_dwordx4 v[160:163], v63, s[40:43], s78 offen sc1
v_accvgpr_read_b32 v79, a135
v_accvgpr_read_b32 v80, a136
v_accvgpr_read_b32 v81, a137
v_accvgpr_read_b32 v82, a138
v_accvgpr_read_b32 v83, a139
v_accvgpr_read_b32 v84, a140
v_accvgpr_read_b32 v85, a141
v_accvgpr_read_b32 v86, a142
v_accvgpr_read_b32 v87, a143
v_mfma_f32_16x16x32_bf16 v[252:255], a[192:195], v[216:219], v[252:255]
s_add_u32 s78, s78, 1024
ds_read_b64_tr_b16 a[180:181], v9 offset:28672
v_cndmask_b32 v44, v44, v160, s[34:35]
v_mfma_f32_16x16x32_bf16 v[252:255], a[196:199], v[228:231], v[252:255]
s_waitcnt lgkmcnt(7)
ds_read_b64_tr_b16 a[182:183], v9 offset:30720
v_cndmask_b32 v45, v45, v161, s[34:35]
v_mfma_f32_16x16x32_bf16 v[64:67], a[200:203], a[208:211], v[64:67]
ds_read_b64_tr_b16 a[184:185], v15 offset:24576
v_cndmask_b32 v46, v46, v162, s[34:35]
v_mfma_f32_16x16x32_bf16 v[64:67], a[204:207], a[220:223], v[64:67]
ds_read_b64_tr_b16 a[186:187], v15 offset:26624
v_cndmask_b32 v47, v47, v163, s[34:35]
v_mfma_f32_16x16x32_bf16 v[72:75], a[204:207], a[224:227], v[72:75]
s_cmp_eq_u32 s53, 2
s_cselect_b64 s[74:75], -1, 0
ds_read_b64_tr_b16 a[188:189], v15 offset:28672
v_mfma_f32_16x16x32_bf16 v[72:75], a[200:203], a[212:215], v[72:75]
ds_read_b64_tr_b16 a[190:191], v15 offset:30720
v_cndmask_b32 v62, v14, v3, s[74:75]
v_mfma_f32_16x16x32_bf16 v[80:83], a[200:203], a[216:219], v[80:83]
v_cvt_pk_bf16_f32 v168, v168, v169
v_cvt_pk_bf16_f32 v169, v170, v171
v_mfma_f32_16x16x32_bf16 v[80:83], a[204:207], a[228:231], v[80:83]
s_waitcnt lgkmcnt(8)
v_cvt_pk_bf16_f32 v170, v172, v173
v_cvt_pk_bf16_f32 v171, v174, v175
v_mfma_f32_16x16x32_bf16 v[68:71], a[168:171], a[208:211], v[68:71]
buffer_store_dwordx4 v[168:171], v62, s[40:43], s78 offen sc1
v_mfma_f32_16x16x32_bf16 v[68:71], a[172:175], a[220:223], v[68:71]
s_add_u32 s78, s78, 1024
v_cndmask_b32 v44, v44, v168, s[74:75]
v_cndmask_b32 v45, v45, v169, s[74:75]
v_mfma_f32_16x16x32_bf16 v[76:79], a[172:175], a[224:227], v[76:79]
v_cndmask_b32 v46, v46, v170, s[74:75]
v_cndmask_b32 v47, v47, v171, s[74:75]
v_mfma_f32_16x16x32_bf16 v[76:79], a[168:171], a[212:215], v[76:79]
v_accvgpr_read_b32 v16, a144
v_accvgpr_read_b32 v17, a145
v_mfma_f32_16x16x32_bf16 v[84:87], a[168:171], a[216:219], v[84:87]
v_accvgpr_read_b32 v18, a146
v_accvgpr_read_b32 v19, a147
v_mfma_f32_16x16x32_bf16 v[84:87], a[172:175], a[228:231], v[84:87]
s_waitcnt vmcnt(14) lgkmcnt(0)
s_barrier
ds_read_b64_tr_b16 a[192:193], v9 offset:49152
v_mfma_f32_16x16x32_bf16 v[64:67], a[176:179], a[232:235], v[64:67]
ds_read_b64_tr_b16 a[194:195], v9 offset:51200
v_accvgpr_read_b32 v20, a148
v_mfma_f32_16x16x32_bf16 v[64:67], a[180:183], a[244:247], v[64:67]
s_cmp_eq_u32 s53, 3
s_cselect_b64 s[34:35], -1, 0
ds_read_b64_tr_b16 a[196:197], v9 offset:53248
v_mfma_f32_16x16x32_bf16 v[72:75], a[180:183], a[248:251], v[72:75]
ds_read_b64_tr_b16 a[198:199], v9 offset:55296
v_cndmask_b32 v63, v14, v3, s[34:35]
v_mfma_f32_16x16x32_bf16 v[72:75], a[176:179], a[236:239], v[72:75]
ds_read_b64_tr_b16 a[200:201], v15 offset:49152
v_cvt_pk_bf16_f32 v176, v176, v177
v_mfma_f32_16x16x32_bf16 v[80:83], a[176:179], a[240:243], v[80:83]
ds_read_b64_tr_b16 a[202:203], v15 offset:51200
v_cvt_pk_bf16_f32 v177, v178, v179
v_mfma_f32_16x16x32_bf16 v[80:83], a[180:183], a[252:255], v[80:83]
s_waitcnt lgkmcnt(6)
ds_read_b64_tr_b16 a[204:205], v15 offset:53248
v_cvt_pk_bf16_f32 v178, v180, v181
v_mfma_f32_16x16x32_bf16 v[68:71], a[184:187], a[232:235], v[68:71]
ds_read_b64_tr_b16 a[206:207], v15 offset:55296
v_cvt_pk_bf16_f32 v179, v182, v183
v_mfma_f32_16x16x32_bf16 v[68:71], a[188:191], a[244:247], v[68:71]
buffer_store_dwordx4 v[176:179], v63, s[40:43], s78 offen sc1
v_mfma_f32_16x16x32_bf16 v[76:79], a[188:191], a[248:251], v[76:79]
s_add_u32 s78, s78, 1024
ds_read_b64_tr_b16 a[168:169], v9 offset:57344
v_cndmask_b32 v44, v44, v176, s[34:35]
v_mfma_f32_16x16x32_bf16 v[76:79], a[184:187], a[236:239], v[76:79]
ds_read_b64_tr_b16 a[170:171], v9 offset:59392
v_cndmask_b32 v45, v45, v177, s[34:35]
v_mfma_f32_16x16x32_bf16 v[84:87], a[184:187], a[240:243], v[84:87]
ds_read_b64_tr_b16 a[172:173], v9 offset:61440
v_cndmask_b32 v46, v46, v178, s[34:35]
v_mfma_f32_16x16x32_bf16 v[84:87], a[188:191], a[252:255], v[84:87]
s_waitcnt lgkmcnt(7)
ds_read_b64_tr_b16 a[174:175], v9 offset:63488
v_cndmask_b32 v47, v47, v179, s[34:35]
v_mfma_f32_16x16x32_bf16 v[64:67], a[192:195], v[184:187], v[64:67]
s_cmp_eq_u32 s53, 4
s_cselect_b64 s[74:75], -1, 0
ds_read_b64_tr_b16 a[176:177], v15 offset:57344
v_mfma_f32_16x16x32_bf16 v[64:67], a[196:199], v[196:199], v[64:67]
ds_read_b64_tr_b16 a[178:179], v15 offset:59392
v_cndmask_b32 v62, v14, v3, s[74:75]
v_mfma_f32_16x16x32_bf16 v[72:75], a[196:199], v[200:203], v[72:75]
ds_read_b64_tr_b16 a[180:181], v15 offset:61440
v_cvt_pk_bf16_f32 v232, v232, v233
v_mfma_f32_16x16x32_bf16 v[72:75], a[192:195], v[188:191], v[72:75]
ds_read_b64_tr_b16 a[182:183], v15 offset:63488
v_cvt_pk_bf16_f32 v233, v234, v235
v_mfma_f32_16x16x32_bf16 v[80:83], a[192:195], v[192:195], v[80:83]
v_cvt_pk_bf16_f32 v234, v236, v237
v_cvt_pk_bf16_f32 v235, v238, v239
v_mfma_f32_16x16x32_bf16 v[80:83], a[196:199], v[204:207], v[80:83]
s_waitcnt lgkmcnt(8)
buffer_store_dwordx4 v[232:235], v62, s[40:43], s78 offen sc1
v_mfma_f32_16x16x32_bf16 v[68:71], a[200:203], v[184:187], v[68:71]
s_add_u32 s78, s78, 1024
v_cndmask_b32 v44, v44, v232, s[74:75]
v_cndmask_b32 v45, v45, v233, s[74:75]
v_mfma_f32_16x16x32_bf16 v[68:71], a[204:207], v[196:199], v[68:71]
v_cndmask_b32 v46, v46, v234, s[74:75]
v_cndmask_b32 v47, v47, v235, s[74:75]
v_mfma_f32_16x16x32_bf16 v[76:79], a[204:207], v[200:203], v[76:79]
v_accvgpr_read_b32 v21, a149
v_accvgpr_read_b32 v22, a150
v_mfma_f32_16x16x32_bf16 v[76:79], a[200:203], v[188:191], v[76:79]
v_accvgpr_read_b32 v23, a151
v_accvgpr_read_b32 v24, a152
v_mfma_f32_16x16x32_bf16 v[84:87], a[200:203], v[192:195], v[84:87]
v_accvgpr_read_b32 v25, a153
v_accvgpr_read_b32 v26, a154
v_mfma_f32_16x16x32_bf16 v[84:87], a[204:207], v[204:207], v[84:87]
s_waitcnt lgkmcnt(4)
ds_read_b64_tr_b16 a[184:185], v9 offset:0
v_accvgpr_read_b32 v27, a155
v_mfma_f32_16x16x32_bf16 v[64:67], a[168:171], v[208:211], v[64:67]
s_cmp_eq_u32 s53, 5
s_cselect_b64 s[34:35], -1, 0
ds_read_b64_tr_b16 a[186:187], v9 offset:2048
v_mfma_f32_16x16x32_bf16 v[64:67], a[172:175], v[220:223], v[64:67]
ds_read_b64_tr_b16 a[188:189], v9 offset:4096
v_cndmask_b32 v63, v14, v3, s[34:35]
v_mfma_f32_16x16x32_bf16 v[72:75], a[172:175], v[224:227], v[72:75]
ds_read_b64_tr_b16 a[190:191], v9 offset:6144
v_cvt_pk_bf16_f32 v240, v240, v241
v_mfma_f32_16x16x32_bf16 v[72:75], a[168:171], v[212:215], v[72:75]
ds_read_b64_tr_b16 a[192:193], v15 offset:0
v_cvt_pk_bf16_f32 v241, v242, v243
v_mfma_f32_16x16x32_bf16 v[80:83], a[168:171], v[216:219], v[80:83]
v_cvt_pk_bf16_f32 v242, v244, v245
v_cvt_pk_bf16_f32 v243, v246, v247
v_mfma_f32_16x16x32_bf16 v[80:83], a[172:175], v[228:231], v[80:83]
s_waitcnt lgkmcnt(5)
buffer_store_dwordx4 v[240:243], v63, s[40:43], s78 offen sc1
v_mfma_f32_16x16x32_bf16 v[68:71], a[176:179], v[208:211], v[68:71]
s_add_u32 s78, s78, 1024
ds_read_b64_tr_b16 a[194:195], v15 offset:2048
v_accvgpr_read_b32 v28, a156
v_mfma_f32_16x16x32_bf16 v[68:71], a[180:183], v[220:223], v[68:71]
ds_read_b64_tr_b16 a[196:197], v15 offset:4096
v_accvgpr_read_b32 v29, a157
v_mfma_f32_16x16x32_bf16 v[76:79], a[180:183], v[224:227], v[76:79]
ds_read_b64_tr_b16 a[198:199], v15 offset:6144
v_accvgpr_read_b32 v30, a158
v_mfma_f32_16x16x32_bf16 v[76:79], a[176:179], v[212:215], v[76:79]
v_accvgpr_read_b32 v31, a159
v_accvgpr_read_b32 v32, a160
v_accvgpr_read_b32 v33, a161
v_accvgpr_read_b32 v34, a162
v_accvgpr_read_b32 v35, a163
v_accvgpr_read_b32 v36, a164
v_accvgpr_read_b32 v37, a165
v_accvgpr_read_b32 v38, a166
v_accvgpr_read_b32 v39, a167
v_mfma_f32_16x16x32_bf16 v[84:87], a[176:179], v[216:219], v[84:87]
s_cmp_eq_u32 s53, 6
s_cselect_b64 s[74:75], -1, 0
ds_read_b64_tr_b16 a[200:201], v9 offset:8192
v_mfma_f32_16x16x32_bf16 v[84:87], a[180:183], v[228:231], v[84:87]
s_waitcnt lgkmcnt(5)
v_cndmask_b32 v44, v44, v240, s[34:35]
v_cndmask_b32 v45, v45, v241, s[34:35]
v_cndmask_b32 v46, v46, v242, s[34:35]
v_cndmask_b32 v47, v47, v243, s[34:35]
v_mfma_f32_16x16x32_bf16 v[16:19], a[184:187], a[208:211], v[16:19]
ds_read_b64_tr_b16 a[202:203], v9 offset:10240
v_cndmask_b32 v62, v14, v3, s[74:75]
v_mfma_f32_16x16x32_bf16 v[16:19], a[188:191], a[220:223], v[16:19]
ds_read_b64_tr_b16 a[204:205], v9 offset:12288
v_cvt_pk_bf16_f32 v248, v248, v249
v_mfma_f32_16x16x32_bf16 v[24:27], a[188:191], a[224:227], v[24:27]
ds_read_b64_tr_b16 a[206:207], v9 offset:14336
v_cvt_pk_bf16_f32 v249, v250, v251
v_mfma_f32_16x16x32_bf16 v[24:27], a[184:187], a[212:215], v[24:27]
v_cvt_pk_bf16_f32 v250, v252, v253
v_cvt_pk_bf16_f32 v251, v254, v255
v_mfma_f32_16x16x32_bf16 v[32:35], a[184:187], a[216:219], v[32:35]
buffer_store_dwordx4 v[248:251], v62, s[40:43], s78 offen sc1
v_mfma_f32_16x16x32_bf16 v[32:35], a[188:191], a[228:231], v[32:35]
s_waitcnt lgkmcnt(4)
ds_read_b64_tr_b16 a[168:169], v15 offset:8192
ds_read_b64_tr_b16 a[170:171], v15 offset:10240
v_mfma_f32_16x16x32_bf16 v[20:23], a[192:195], a[208:211], v[20:23]
s_add_u32 s78, s78, 1024
ds_read_b64_tr_b16 a[172:173], v15 offset:12288
v_cndmask_b32 v44, v44, v248, s[74:75]
v_mfma_f32_16x16x32_bf16 v[20:23], a[196:199], a[220:223], v[20:23]
ds_read_b64_tr_b16 a[174:175], v15 offset:14336
v_cndmask_b32 v45, v45, v249, s[74:75]
v_mfma_f32_16x16x32_bf16 v[28:31], a[196:199], a[224:227], v[28:31]
v_cndmask_b32 v46, v46, v250, s[74:75]
v_cndmask_b32 v47, v47, v251, s[74:75]
v_mfma_f32_16x16x32_bf16 v[28:31], a[192:195], a[212:215], v[28:31]
s_cmp_eq_u32 s53, 7
s_cselect_b64 s[34:35], -1, 0
v_mfma_f32_16x16x32_bf16 v[36:39], a[192:195], a[216:219], v[36:39]
v_cndmask_b32 v63, v14, v3, s[34:35]
v_cvt_pk_bf16_f32 v64, v64, v65
v_mfma_f32_16x16x32_bf16 v[36:39], a[196:199], a[228:231], v[36:39]
s_waitcnt vmcnt(10) lgkmcnt(0)
s_barrier
ds_read_b64_tr_b16 a[176:177], v9 offset:32768
v_mfma_f32_16x16x32_bf16 v[16:19], a[200:203], a[232:235], v[16:19]
ds_read_b64_tr_b16 a[178:179], v9 offset:34816
v_cvt_pk_bf16_f32 v65, v66, v67
v_mfma_f32_16x16x32_bf16 v[16:19], a[204:207], a[244:247], v[16:19]
ds_read_b64_tr_b16 a[180:181], v9 offset:36864
v_cvt_pk_bf16_f32 v66, v68, v69
v_mfma_f32_16x16x32_bf16 v[24:27], a[204:207], a[248:251], v[24:27]
ds_read_b64_tr_b16 a[182:183], v9 offset:38912
v_cvt_pk_bf16_f32 v67, v70, v71
v_mfma_f32_16x16x32_bf16 v[24:27], a[200:203], a[236:239], v[24:27]
buffer_store_dwordx4 v[64:67], v63, s[40:43], s78 offen sc1
v_mfma_f32_16x16x32_bf16 v[32:35], a[200:203], a[240:243], v[32:35]
s_add_u32 s78, s78, 1024
ds_read_b64_tr_b16 a[184:185], v15 offset:32768
v_cndmask_b32 v44, v44, v64, s[34:35]
v_mfma_f32_16x16x32_bf16 v[32:35], a[204:207], a[252:255], v[32:35]
s_waitcnt lgkmcnt(5)
ds_read_b64_tr_b16 a[186:187], v15 offset:34816
v_cndmask_b32 v45, v45, v65, s[34:35]
v_mfma_f32_16x16x32_bf16 v[20:23], a[168:171], a[232:235], v[20:23]
ds_read_b64_tr_b16 a[188:189], v15 offset:36864
v_cndmask_b32 v46, v46, v66, s[34:35]
v_mfma_f32_16x16x32_bf16 v[20:23], a[172:175], a[244:247], v[20:23]
ds_read_b64_tr_b16 a[190:191], v15 offset:38912
v_cndmask_b32 v47, v47, v67, s[34:35]
v_mfma_f32_16x16x32_bf16 v[28:31], a[172:175], a[248:251], v[28:31]
s_cmp_eq_u32 s53, 0
s_cselect_b64 s[74:75], -1, 0
ds_read_b64_tr_b16 a[192:193], v9 offset:40960
v_mfma_f32_16x16x32_bf16 v[28:31], a[168:171], a[236:239], v[28:31]
ds_read_b64_tr_b16 a[194:195], v9 offset:43008
v_cndmask_b32 v62, v14, v3, s[74:75]
v_mfma_f32_16x16x32_bf16 v[36:39], a[168:171], a[240:243], v[36:39]
ds_read_b64_tr_b16 a[196:197], v9 offset:45056
v_cvt_pk_bf16_f32 v72, v72, v73
v_mfma_f32_16x16x32_bf16 v[36:39], a[172:175], a[252:255], v[36:39]
s_waitcnt lgkmcnt(7)
ds_read_b64_tr_b16 a[198:199], v9 offset:47104
v_cvt_pk_bf16_f32 v73, v74, v75
v_mfma_f32_16x16x32_bf16 v[16:19], a[176:179], v[184:187], v[16:19]
ds_read_b64_tr_b16 a[200:201], v15 offset:40960
v_cvt_pk_bf16_f32 v74, v76, v77
v_mfma_f32_16x16x32_bf16 v[16:19], a[180:183], v[196:199], v[16:19]
ds_read_b64_tr_b16 a[202:203], v15 offset:43008
v_cvt_pk_bf16_f32 v75, v78, v79
v_mfma_f32_16x16x32_bf16 v[24:27], a[180:183], v[200:203], v[24:27]
buffer_store_dwordx4 v[72:75], v62, s[40:43], s78 offen sc1
v_mfma_f32_16x16x32_bf16 v[24:27], a[176:179], v[188:191], v[24:27]
s_add_u32 s78, s78, 1024
ds_read_b64_tr_b16 a[204:205], v15 offset:45056
v_cndmask_b32 v48, v48, v72, s[74:75]
v_mfma_f32_16x16x32_bf16 v[32:35], a[176:179], v[192:195], v[32:35]
ds_read_b64_tr_b16 a[206:207], v15 offset:47104
v_cndmask_b32 v49, v49, v73, s[74:75]
v_mfma_f32_16x16x32_bf16 v[32:35], a[180:183], v[204:207], v[32:35]
s_waitcnt lgkmcnt(8)
v_cndmask_b32 v50, v50, v74, s[74:75]
v_cndmask_b32 v51, v51, v75, s[74:75]
v_mfma_f32_16x16x32_bf16 v[20:23], a[184:187], v[184:187], v[20:23]
s_cmp_eq_u32 s53, 1
s_cselect_b64 s[34:35], -1, 0
v_mfma_f32_16x16x32_bf16 v[20:23], a[188:191], v[196:199], v[20:23]
v_cndmask_b32 v63, v14, v3, s[34:35]
v_cvt_pk_bf16_f32 v80, v80, v81
v_mfma_f32_16x16x32_bf16 v[28:31], a[188:191], v[200:203], v[28:31]
v_cvt_pk_bf16_f32 v81, v82, v83
v_cvt_pk_bf16_f32 v82, v84, v85
v_mfma_f32_16x16x32_bf16 v[28:31], a[184:187], v[188:191], v[28:31]
v_cvt_pk_bf16_f32 v83, v86, v87
v_mfma_f32_16x16x32_bf16 v[36:39], a[184:187], v[192:195], v[36:39]
buffer_store_dwordx4 v[80:83], v63, s[40:43], s78 offen sc1
v_mfma_f32_16x16x32_bf16 v[36:39], a[188:191], v[204:207], v[36:39]
s_waitcnt lgkmcnt(4)
v_cndmask_b32 v48, v48, v80, s[34:35]
v_cndmask_b32 v49, v49, v81, s[34:35]
v_mfma_f32_16x16x32_bf16 v[16:19], a[192:195], v[208:211], v[16:19]
s_add_u32 s78, s78, 1024
v_cndmask_b32 v50, v50, v82, s[34:35]
v_cndmask_b32 v51, v51, v83, s[34:35]
v_mfma_f32_16x16x32_bf16 v[16:19], a[196:199], v[220:223], v[16:19]
v_mfma_f32_16x16x32_bf16 v[24:27], a[196:199], v[224:227], v[24:27]
v_mfma_f32_16x16x32_bf16 v[24:27], a[192:195], v[212:215], v[24:27]
v_mfma_f32_16x16x32_bf16 v[32:35], a[192:195], v[216:219], v[32:35]
v_mfma_f32_16x16x32_bf16 v[32:35], a[196:199], v[228:231], v[32:35]
s_waitcnt lgkmcnt(0)
v_mfma_f32_16x16x32_bf16 v[20:23], a[200:203], v[208:211], v[20:23]
v_mfma_f32_16x16x32_bf16 v[20:23], a[204:207], v[220:223], v[20:23]
v_mfma_f32_16x16x32_bf16 v[28:31], a[204:207], v[224:227], v[28:31]
v_mfma_f32_16x16x32_bf16 v[28:31], a[200:203], v[212:215], v[28:31]
v_mfma_f32_16x16x32_bf16 v[36:39], a[200:203], v[216:219], v[36:39]
v_mfma_f32_16x16x32_bf16 v[36:39], a[204:207], v[228:231], v[36:39]
s_nop 5
s_cmp_eq_u32 s53, 2
s_cselect_b64 s[74:75], -1, 0
v_cndmask_b32 v62, v14, v3, s[74:75]
v_cvt_pk_bf16_f32 v16, v16, v17
v_cvt_pk_bf16_f32 v17, v18, v19
v_cvt_pk_bf16_f32 v18, v20, v21
v_cvt_pk_bf16_f32 v19, v22, v23
buffer_store_dwordx4 v[16:19], v62, s[40:43], s78 offen sc1
s_add_u32 s78, s78, 1024
v_cndmask_b32 v48, v48, v16, s[74:75]
v_cndmask_b32 v49, v49, v17, s[74:75]
v_cndmask_b32 v50, v50, v18, s[74:75]
v_cndmask_b32 v51, v51, v19, s[74:75]
s_cmp_eq_u32 s53, 3
s_cselect_b64 s[34:35], -1, 0
v_cndmask_b32 v63, v14, v3, s[34:35]
v_cvt_pk_bf16_f32 v24, v24, v25
v_cvt_pk_bf16_f32 v25, v26, v27
v_cvt_pk_bf16_f32 v26, v28, v29
v_cvt_pk_bf16_f32 v27, v30, v31
buffer_store_dwordx4 v[24:27], v63, s[40:43], s78 offen sc1
s_add_u32 s78, s78, 1024
v_cndmask_b32 v48, v48, v24, s[34:35]
v_cndmask_b32 v49, v49, v25, s[34:35]
v_cndmask_b32 v50, v50, v26, s[34:35]
v_cndmask_b32 v51, v51, v27, s[34:35]
s_cmp_eq_u32 s53, 4
s_cselect_b64 s[74:75], -1, 0
v_cndmask_b32 v62, v14, v3, s[74:75]
v_cvt_pk_bf16_f32 v32, v32, v33
v_cvt_pk_bf16_f32 v33, v34, v35
v_cvt_pk_bf16_f32 v34, v36, v37
v_cvt_pk_bf16_f32 v35, v38, v39
buffer_store_dwordx4 v[32:35], v62, s[40:43], s78 offen sc1
s_add_u32 s78, s78, 1024
v_cndmask_b32 v48, v48, v32, s[74:75]
v_cndmask_b32 v49, v49, v33, s[74:75]
v_cndmask_b32 v50, v50, v34, s[74:75]
v_cndmask_b32 v51, v51, v35, s[74:75]
s_waitcnt vmcnt(3)
v_mov_b32 v8, 2
buffer_store_dword v8, v61, s[4:7], 0 offen sc1
s_mov_b32 s69, 0
s_waitcnt vmcnt(1)
v_mov_b32 v8, 3
buffer_store_dword v8, v61, s[4:7], 0 offen sc1
v_add_u32 v6, 8192, v14
v_add_u32 v7, 16384, v14
v_and_b32 v5, 15, v0
v_mul_u32_u24 v5, 896, v5
v_bfe_u32 v62, v0, 4, 1
v_lshl_add_u32 v5, v62, 5, v5
v_lshrrev_b32 v62, 5, v0
v_lshl_add_u32 v5, v62, 4, v5
s_mul_i32 s67, s81, 43008
s_lshl_b32 s77, s80, 6
s_add_u32 s67, s67, s77
v_add_u32 v5, s67, v5
s_add_u32 s67, s53, 0
s_mul_i32 s77, s67, 11
s_lshr_b32 s77, s77, 5
s_mul_i32 s76, s77, 3
s_sub_u32 s67, s67, s76
s_mul_i32 s67, s67, 14336
s_add_u32 s77, s77, s54
s_sub_u32 s76, s77, 7
s_cselect_b32 s77, s77, s76
s_lshl_b32 s77, s77, 7
s_add_u32 s70, s67, s77
s_add_u32 s67, s53, 8
s_mul_i32 s77, s67, 11
s_lshr_b32 s77, s77, 5
s_mul_i32 s76, s77, 3
s_sub_u32 s67, s67, s76
s_mul_i32 s67, s67, 14336
s_add_u32 s77, s77, s54
s_sub_u32 s76, s77, 7
s_cselect_b32 s77, s77, s76
s_lshl_b32 s77, s77, 7
s_add_u32 s71, s67, s77
s_add_u32 s67, s53, 16
s_mul_i32 s77, s67, 11
s_lshr_b32 s77, s77, 5
s_mul_i32 s76, s77, 3
s_sub_u32 s67, s67, s76
s_mul_i32 s67, s67, 14336
s_add_u32 s77, s77, s54
s_sub_u32 s76, s77, 7
s_cselect_b32 s77, s77, s76
s_lshl_b32 s77, s77, 7
s_add_u32 s72, s67, s77
s_sub_u32 s83, s53, 2
s_cmp_lt_u32 s83, 3
s_cselect_b32 s83, 3, 2
s_cmp_eq_u32 s69, 0xff
s_cbranch_scc0 L_late0
v_mfma_f32_16x16x32_bf16 v[16:19], v[52:55], v[40:43], 0
v_mfma_f32_16x16x32_bf16 v[20:23], v[56:59], v[40:43], 0
s_waitcnt vmcnt(7)
v_mfma_f32_16x16x32_bf16 v[16:19], v[52:55], v[88:91], v[16:19]
v_mfma_f32_16x16x32_bf16 v[20:23], v[56:59], v[88:91], v[20:23]
s_waitcnt vmcnt(6)
v_mfma_f32_16x16x32_bf16 v[16:19], v[52:55], v[92:95], v[16:19]
v_mfma_f32_16x16x32_bf16 v[20:23], v[56:59], v[92:95], v[20:23]
s_waitcnt vmcnt(5)
v_mfma_f32_16x16x32_bf16 v[16:19], v[52:55], v[96:99], v[16:19]
v_mfma_f32_16x16x32_bf16 v[20:23], v[56:59], v[96:99], v[20:23]
s_waitcnt vmcnt(4)
v_mfma_f32_16x16x32_bf16 v[16:19], v[52:55], v[100:103], v[16:19]
v_mfma_f32_16x16x32_bf16 v[20:23], v[56:59], v[100:103], v[20:23]
s_waitcnt vmcnt(3)
v_mfma_f32_16x16x32_bf16 v[16:19], v[52:55], v[104:107], v[16:19]
v_mfma_f32_16x16x32_bf16 v[20:23], v[56:59], v[104:107], v[20:23]
s_waitcnt vmcnt(2)
v_mfma_f32_16x16x32_bf16 v[16:19], v[52:55], v[108:111], v[16:19]
v_mfma_f32_16x16x32_bf16 v[20:23], v[56:59], v[108:111], v[20:23]
s_waitcnt vmcnt(1)
v_mfma_f32_16x16x32_bf16 v[16:19], v[52:55], v[112:115], v[16:19]
v_mfma_f32_16x16x32_bf16 v[20:23], v[56:59], v[112:115], v[20:23]
s_nop 6
v_cvt_pk_bf16_f32 v16, v16, v17
v_cvt_pk_bf16_f32 v17, v18, v19
v_cvt_pk_bf16_f32 v18, v20, v21
v_cvt_pk_bf16_f32 v19, v22, v23
s_nop 1
v_permlane16_swap_b32 v16, v18
v_permlane16_swap_b32 v17, v19
L_late0:
buffer_load_dword v10, v60, s[4:7], 0 offen sc1
s_sleep 1
buffer_load_dword v11, v60, s[4:7], 0 offen sc1
s_sleep 1
buffer_load_dword v12, v60, s[4:7], 0 offen sc1
s_sleep 1
L_pB:
buffer_load_dword v13, v60, s[4:7], 0 offen sc1
s_waitcnt vmcnt(3)
v_cmp_le_u32 vcc, s83, v10
s_nop 1
s_or_b32 s67, vcc_lo, s0
s_cmp_eq_u32 s67, 0xff
s_cbranch_scc1 L_pB_ok
s_sleep 1
buffer_load_dword v10, v60, s[4:7], 0 offen sc1
s_waitcnt vmcnt(3)
v_cmp_le_u32 vcc, s83, v11
s_nop 1
s_or_b32 s67, vcc_lo, s0
s_cmp_eq_u32 s67, 0xff
s_cbranch_scc1 L_pB_ok
s_sleep 1
buffer_load_dword v11, v60, s[4:7], 0 offen sc1
s_waitcnt vmcnt(3)
v_cmp_le_u32 vcc, s83, v12
s_nop 1
s_or_b32 s67, vcc_lo, s0
s_cmp_eq_u32 s67, 0xff
s_cbranch_scc1 L_pB_ok
s_sleep 1
buffer_load_dword v12, v60, s[4:7], 0 offen sc1
s_waitcnt vmcnt(3)
v_cmp_le_u32 vcc, s83, v13
s_nop 1
s_or_b32 s67, vcc_lo, s0
s_cmp_eq_u32 s67, 0xff
s_cbranch_scc1 L_pB_ok
s_sleep 1
s_branch L_pB
L_pB_ok:
s_cmp_eq_u32 s69, 0xff
s_cbranch_scc1 L_have0
s_cmp_gt_u32 s53, 4
s_cbranch_scc1 L_v01
buffer_load_dwordx4 v[88:91], v14, s[40:43], s84 offen sc1
buffer_load_dwordx4 v[92:95], v14, s[40:43], s85 offen sc1
buffer_load_dwordx4 v[96:99], v14, s[40:43], s86 offen sc1
buffer_load_dwordx4 v[100:103], v14, s[40:43], s87 offen sc1
buffer_load_dwordx4 v[104:107], v14, s[40:43], s88 offen sc1
buffer_load_dwordx4 v[108:111], v14, s[40:43], s89 offen sc1
buffer_load_dwordx4 v[112:115], v14, s[40:43], s90 offen sc1
buffer_load_dwordx4 v[116:119], v6, s[40:43], s84 offen sc1
buffer_load_dwordx4 v[120:123], v6, s[40:43], s85 offen sc1
buffer_load_dwordx4 v[124:127], v6, s[40:43], s86 offen sc1
buffer_load_dwordx4 v[128:131], v6, s[40:43], s87 offen sc1
buffer_load_dwordx4 v[132:135], v6, s[40:43], s88 offen sc1
buffer_load_dwordx4 v[136:139], v6, s[40:43], s89 offen sc1
buffer_load_dwordx4 v[140:143], v6, s[40:43], s90 offen sc1
buffer_load_dwordx4 v[144:147], v7, s[40:43], s84 offen sc1
buffer_load_dwordx4 v[148:151], v7, s[40:43], s85 offen sc1
buffer_load_dwordx4 v[152:155], v7, s[40:43], s86 offen sc1
buffer_load_dwordx4 v[156:159], v7, s[40:43], s87 offen sc1
buffer_load_dwordx4 v[160:163], v7, s[40:43], s88 offen sc1
buffer_load_dwordx4 v[164:167], v7, s[40:43], s89 offen sc1
buffer_load_dwordx4 v[168:171], v7, s[40:43], s90 offen sc1
v_mfma_f32_16x16x32_bf16 v[16:19], v[52:55], v[40:43], 0
v_mfma_f32_16x16x32_bf16 v[20:23], v[56:59], v[40:43], 0
s_waitcnt vmcnt(20)
v_mfma_f32_16x16x32_bf16 v[16:19], v[52:55], v[88:91], v[16:19]
v_mfma_f32_16x16x32_bf16 v[20:23], v[56:59], v[88:91], v[20:23]
s_waitcnt vmcnt(19)
v_mfma_f32_16x16x32_bf16 v[16:19], v[52:55], v[92:95], v[16:19]
v_mfma_f32_16x16x32_bf16 v[20:23], v[56:59], v[92:95], v[20:23]
s_waitcnt vmcnt(18)
v_mfma_f32_16x16x32_bf16 v[16:19], v[52:55], v[96:99], v[16:19]
v_mfma_f32_16x16x32_bf16 v[20:23], v[56:59], v[96:99], v[20:23]
s_waitcnt vmcnt(17)
v_mfma_f32_16x16x32_bf16 v[16:19], v[52:55], v[100:103], v[16:19]
v_mfma_f32_16x16x32_bf16 v[20:23], v[56:59], v[100:103], v[20:23]
s_waitcnt vmcnt(16)
v_mfma_f32_16x16x32_bf16 v[16:19], v[52:55], v[104:107], v[16:19]
v_mfma_f32_16x16x32_bf16 v[20:23], v[56:59], v[104:107], v[20:23]
s_waitcnt vmcnt(15)
v_mfma_f32_16x16x32_bf16 v[16:19], v[52:55], v[108:111], v[16:19]
v_mfma_f32_16x16x32_bf16 v[20:23], v[56:59], v[108:111], v[20:23]
s_waitcnt vmcnt(14)
v_mfma_f32_16x16x32_bf16 v[16:19], v[52:55], v[112:115], v[16:19]
v_mfma_f32_16x16x32_bf16 v[20:23], v[56:59], v[112:115], v[20:23]
v_mfma_f32_16x16x32_bf16 v[24:27], v[52:55], v[44:47], 0
v_mfma_f32_16x16x32_bf16 v[28:31], v[56:59], v[44:47], 0
s_waitcnt vmcnt(13)
v_mfma_f32_16x16x32_bf16 v[24:27], v[52:55], v[116:119], v[24:27]
v_mfma_f32_16x16x32_bf16 v[28:31], v[56:59], v[116:119], v[28:31]
s_waitcnt vmcnt(12)
v_mfma_f32_16x16x32_bf16 v[24:27], v[52:55], v[120:123], v[24:27]
v_mfma_f32_16x16x32_bf16 v[28:31], v[56:59], v[120:123], v[28:31]
s_waitcnt vmcnt(11)
v_mfma_f32_16x16x32_bf16 v[24:27], v[52:55], v[124:127], v[24:27]
v_mfma_f32_16x16x32_bf16 v[28:31], v[56:59], v[124:127], v[28:31]
s_waitcnt vmcnt(10)
v_mfma_f32_16x16x32_bf16 v[24:27], v[52:55], v[128:131], v[24:27]
v_mfma_f32_16x16x32_bf16 v[28:31], v[56:59], v[128:131], v[28:31]
s_waitcnt vmcnt(9)
v_mfma_f32_16x16x32_bf16 v[24:27], v[52:55], v[132:135], v[24:27]
v_mfma_f32_16x16x32_bf16 v[28:31], v[56:59], v[132:135], v[28:31]
s_waitcnt vmcnt(8)
v_mfma_f32_16x16x32_bf16 v[24:27], v[52:55], v[136:139], v[24:27]
v_mfma_f32_16x16x32_bf16 v[28:31], v[56:59], v[136:139], v[28:31]
s_waitcnt vmcnt(7)
v_mfma_f32_16x16x32_bf16 v[24:27], v[52:55], v[140:143], v[24:27]
v_mfma_f32_16x16x32_bf16 v[28:31], v[56:59], v[140:143], v[28:31]
v_cvt_pk_bf16_f32 v16, v16, v17
v_cvt_pk_bf16_f32 v17, v18, v19
v_cvt_pk_bf16_f32 v18, v20, v21
v_cvt_pk_bf16_f32 v19, v22, v23
s_nop 1
v_permlane16_swap_b32 v16, v18
v_permlane16_swap_b32 v17, v19
buffer_store_dwordx4 v[16:19], v5, s[48:51], s70 offen sc1
v_mfma_f32_16x16x32_bf16 v[32:35], v[52:55], v[48:51], 0
v_mfma_f32_16x16x32_bf16 v[36:39], v[56:59], v[48:51], 0
s_waitcnt vmcnt(7)
v_mfma_f32_16x16x32_bf16 v[32:35], v[52:55], v[144:147], v[32:35]
v_mfma_f32_16x16x32_bf16 v[36:39], v[56:59], v[144:147], v[36:39]
s_waitcnt vmcnt(6)
v_mfma_f32_16x16x32_bf16 v[32:35], v[52:55], v[148:151], v[32:35]
v_mfma_f32_16x16x32_bf16 v[36:39], v[56:59], v[148:151], v[36:39]
s_waitcnt vmcnt(5)
v_mfma_f32_16x16x32_bf16 v[32:35], v[52:55], v[152:155], v[32:35]
v_mfma_f32_16x16x32_bf16 v[36:39], v[56:59], v[152:155], v[36:39]
s_waitcnt vmcnt(4)
v_mfma_f32_16x16x32_bf16 v[32:35], v[52:55], v[156:159], v[32:35]
v_mfma_f32_16x16x32_bf16 v[36:39], v[56:59], v[156:159], v[36:39]
s_waitcnt vmcnt(3)
v_mfma_f32_16x16x32_bf16 v[32:35], v[52:55], v[160:163], v[32:35]
v_mfma_f32_16x16x32_bf16 v[36:39], v[56:59], v[160:163], v[36:39]
s_waitcnt vmcnt(2)
v_mfma_f32_16x16x32_bf16 v[32:35], v[52:55], v[164:167], v[32:35]
v_mfma_f32_16x16x32_bf16 v[36:39], v[56:59], v[164:167], v[36:39]
s_waitcnt vmcnt(1)
v_mfma_f32_16x16x32_bf16 v[32:35], v[52:55], v[168:171], v[32:35]
v_mfma_f32_16x16x32_bf16 v[36:39], v[56:59], v[168:171], v[36:39]
v_cvt_pk_bf16_f32 v24, v24, v25
v_cvt_pk_bf16_f32 v25, v26, v27
v_cvt_pk_bf16_f32 v26, v28, v29
v_cvt_pk_bf16_f32 v27, v30, v31
s_nop 1
v_permlane16_swap_b32 v24, v26
v_permlane16_swap_b32 v25, v27
buffer_store_dwordx4 v[24:27], v5, s[48:51], s71 offen sc1
s_nop 6
v_cvt_pk_bf16_f32 v32, v32, v33
v_cvt_pk_bf16_f32 v33, v34, v35
v_cvt_pk_bf16_f32 v34, v36, v37
v_cvt_pk_bf16_f32 v35, v38, v39
s_nop 1
v_permlane16_swap_b32 v32, v34
v_permlane16_swap_b32 v33, v35
buffer_store_dwordx4 v[32:35], v5, s[48:51], s72 offen sc1
s_branch L_fin
L_v01:
buffer_load_dwordx4 v[88:91], v14, s[40:43], s84 offen sc1
buffer_load_dwordx4 v[92:95], v14, s[40:43], s85 offen sc1
buffer_load_dwordx4 v[96:99], v14, s[40:43], s86 offen sc1
buffer_load_dwordx4 v[100:103], v14, s[40:43], s87 offen sc1
buffer_load_dwordx4 v[104:107], v14, s[40:43], s88 offen sc1
buffer_load_dwordx4 v[108:111], v14, s[40:43], s89 offen sc1
buffer_load_dwordx4 v[112:115], v14, s[40:43], s90 offen sc1
buffer_load_dwordx4 v[116:119], v6, s[40:43], s84 offen sc1
buffer_load_dwordx4 v[120:123], v6, s[40:43], s85 offen sc1
buffer_load_dwordx4 v[124:127], v6, s[40:43], s86 offen sc1
buffer_load_dwordx4 v[128:131], v6, s[40:43], s87 offen sc1
buffer_load_dwordx4 v[132:135], v6, s[40:43], s88 offen sc1
buffer_load_dwordx4 v[136:139], v6, s[40:43], s89 offen sc1
buffer_load_dwordx4 v[140:143], v6, s[40:43], s90 offen sc1
v_mfma_f32_16x16x32_bf16 v[16:19], v[52:55], v[40:43], 0
v_mfma_f32_16x16x32_bf16 v[20:23], v[56:59], v[40:43], 0
s_waitcnt vmcnt(13)
v_mfma_f32_16x16x32_bf16 v[16:19], v[52:55], v[88:91], v[16:19]
v_mfma_f32_16x16x32_bf16 v[20:23], v[56:59], v[88:91], v[20:23]
s_waitcnt vmcnt(12)
v_mfma_f32_16x16x32_bf16 v[16:19], v[52:55], v[92:95], v[16:19]
v_mfma_f32_16x16x32_bf16 v[20:23], v[56:59], v[92:95], v[20:23]
s_waitcnt vmcnt(11)
v_mfma_f32_16x16x32_bf16 v[16:19], v[52:55], v[96:99], v[16:19]
v_mfma_f32_16x16x32_bf16 v[20:23], v[56:59], v[96:99], v[20:23]
s_waitcnt vmcnt(10)
v_mfma_f32_16x16x32_bf16 v[16:19], v[52:55], v[100:103], v[16:19]
v_mfma_f32_16x16x32_bf16 v[20:23], v[56:59], v[100:103], v[20:23]
s_waitcnt vmcnt(9)
v_mfma_f32_16x16x32_bf16 v[16:19], v[52:55], v[104:107], v[16:19]
v_mfma_f32_16x16x32_bf16 v[20:23], v[56:59], v[104:107], v[20:23]
s_waitcnt vmcnt(8)
v_mfma_f32_16x16x32_bf16 v[16:19], v[52:55], v[108:111], v[16:19]
v_mfma_f32_16x16x32_bf16 v[20:23], v[56:59], v[108:111], v[20:23]
s_waitcnt vmcnt(7)
v_mfma_f32_16x16x32_bf16 v[16:19], v[52:55], v[112:115], v[16:19]
v_mfma_f32_16x16x32_bf16 v[20:23], v[56:59], v[112:115], v[20:23]
v_mfma_f32_16x16x32_bf16 v[24:27], v[52:55], v[44:47], 0
v_mfma_f32_16x16x32_bf16 v[28:31], v[56:59], v[44:47], 0
s_waitcnt vmcnt(6)
v_mfma_f32_16x16x32_bf16 v[24:27], v[52:55], v[116:119], v[24:27]
v_mfma_f32_16x16x32_bf16 v[28:31], v[56:59], v[116:119], v[28:31]
s_waitcnt vmcnt(5)
v_mfma_f32_16x16x32_bf16 v[24:27], v[52:55], v[120:123], v[24:27]
v_mfma_f32_16x16x32_bf16 v[28:31], v[56:59], v[120:123], v[28:31]
s_waitcnt vmcnt(4)
v_mfma_f32_16x16x32_bf16 v[24:27], v[52:55], v[124:127], v[24:27]
v_mfma_f32_16x16x32_bf16 v[28:31], v[56:59], v[124:127], v[28:31]
s_waitcnt vmcnt(3)
v_mfma_f32_16x16x32_bf16 v[24:27], v[52:55], v[128:131], v[24:27]
v_mfma_f32_16x16x32_bf16 v[28:31], v[56:59], v[128:131], v[28:31]
s_waitcnt vmcnt(2)
v_mfma_f32_16x16x32_bf16 v[24:27], v[52:55], v[132:135], v[24:27]
v_mfma_f32_16x16x32_bf16 v[28:31], v[56:59], v[132:135], v[28:31]
s_waitcnt vmcnt(1)
v_mfma_f32_16x16x32_bf16 v[24:27], v[52:55], v[136:139], v[24:27]
v_mfma_f32_16x16x32_bf16 v[28:31], v[56:59], v[136:139], v[28:31]
s_waitcnt vmcnt(0)
v_mfma_f32_16x16x32_bf16 v[24:27], v[52:55], v[140:143], v[24:27]
v_mfma_f32_16x16x32_bf16 v[28:31], v[56:59], v[140:143], v[28:31]
v_cvt_pk_bf16_f32 v16, v16, v17
v_cvt_pk_bf16_f32 v17, v18, v19
v_cvt_pk_bf16_f32 v18, v20, v21
v_cvt_pk_bf16_f32 v19, v22, v23
s_nop 1
v_permlane16_swap_b32 v16, v18
v_permlane16_swap_b32 v17, v19
buffer_store_dwordx4 v[16:19], v5, s[48:51], s70 offen sc1
s_nop 6
v_cvt_pk_bf16_f32 v24, v24, v25
v_cvt_pk_bf16_f32 v25, v26, v27
v_cvt_pk_bf16_f32 v26, v28, v29
v_cvt_pk_bf16_f32 v27, v30, v31
s_nop 1
v_permlane16_swap_b32 v24, v26
v_permlane16_swap_b32 v25, v27
buffer_store_dwordx4 v[24:27], v5, s[48:51], s71 offen sc1
s_branch L_fin
L_have0:
s_cmp_gt_u32 s53, 4
s_cbranch_scc1 L_v1
buffer_load_dwordx4 v[116:119], v6, s[40:43], s84 offen sc1
buffer_load_dwordx4 v[120:123], v6, s[40:43], s85 offen sc1
buffer_load_dwordx4 v[124:127], v6, s[40:43], s86 offen sc1
buffer_load_dwordx4 v[128:131], v6, s[40:43], s87 offen sc1
buffer_load_dwordx4 v[132:135], v6, s[40:43], s88 offen sc1
buffer_load_dwordx4 v[136:139], v6, s[40:43], s89 offen sc1
buffer_load_dwordx4 v[140:143], v6, s[40:43], s90 offen sc1
buffer_load_dwordx4 v[144:147], v7, s[40:43], s84 offen sc1
buffer_load_dwordx4 v[148:151], v7, s[40:43], s85 offen sc1
buffer_load_dwordx4 v[152:155], v7, s[40:43], s86 offen sc1
buffer_load_dwordx4 v[156:159], v7, s[40:43], s87 offen sc1
buffer_load_dwordx4 v[160:163], v7, s[40:43], s88 offen sc1
buffer_load_dwordx4 v[164:167], v7, s[40:43], s89 offen sc1
buffer_load_dwordx4 v[168:171], v7, s[40:43], s90 offen sc1
buffer_store_dwordx4 v[16:19], v5, s[48:51], s70 offen sc1
v_mfma_f32_16x16x32_bf16 v[24:27], v[52:55], v[44:47], 0
v_mfma_f32_16x16x32_bf16 v[28:31], v[56:59], v[44:47], 0
s_waitcnt vmcnt(14)
v_mfma_f32_16x16x32_bf16 v[24:27], v[52:55], v[116:119], v[24:27]
v_mfma_f32_16x16x32_bf16 v[28:31], v[56:59], v[116:119], v[28:31]
s_waitcnt vmcnt(13)
v_mfma_f32_16x16x32_bf16 v[24:27], v[52:55], v[120:123], v[24:27]
v_mfma_f32_16x16x32_bf16 v[28:31], v[56:59], v[120:123], v[28:31]
s_waitcnt vmcnt(12)
v_mfma_f32_16x16x32_bf16 v[24:27], v[52:55], v[124:127], v[24:27]
v_mfma_f32_16x16x32_bf16 v[28:31], v[56:59], v[124:127], v[28:31]
s_waitcnt vmcnt(11)
v_mfma_f32_16x16x32_bf16 v[24:27], v[52:55], v[128:131], v[24:27]
v_mfma_f32_16x16x32_bf16 v[28:31], v[56:59], v[128:131], v[28:31]
s_waitcnt vmcnt(10)
v_mfma_f32_16x16x32_bf16 v[24:27], v[52:55], v[132:135], v[24:27]
v_mfma_f32_16x16x32_bf16 v[28:31], v[56:59], v[132:135], v[28:31]
s_waitcnt vmcnt(9)
v_mfma_f32_16x16x32_bf16 v[24:27], v[52:55], v[136:139], v[24:27]
v_mfma_f32_16x16x32_bf16 v[28:31], v[56:59], v[136:139], v[28:31]
s_waitcnt vmcnt(8)
v_mfma_f32_16x16x32_bf16 v[24:27], v[52:55], v[140:143], v[24:27]
v_mfma_f32_16x16x32_bf16 v[28:31], v[56:59], v[140:143], v[28:31]
v_mfma_f32_16x16x32_bf16 v[32:35], v[52:55], v[48:51], 0
v_mfma_f32_16x16x32_bf16 v[36:39], v[56:59], v[48:51], 0
s_waitcnt vmcnt(7)
v_mfma_f32_16x16x32_bf16 v[32:35], v[52:55], v[144:147], v[32:35]
v_mfma_f32_16x16x32_bf16 v[36:39], v[56:59], v[144:147], v[36:39]
s_waitcnt vmcnt(6)
v_mfma_f32_16x16x32_bf16 v[32:35], v[52:55], v[148:151], v[32:35]
v_mfma_f32_16x16x32_bf16 v[36:39], v[56:59], v[148:151], v[36:39]
s_waitcnt vmcnt(5)
v_mfma_f32_16x16x32_bf16 v[32:35], v[52:55], v[152:155], v[32:35]
v_mfma_f32_16x16x32_bf16 v[36:39], v[56:59], v[152:155], v[36:39]
s_waitcnt vmcnt(4)
v_mfma_f32_16x16x32_bf16 v[32:35], v[52:55], v[156:159], v[32:35]
v_mfma_f32_16x16x32_bf16 v[36:39], v[56:59], v[156:159], v[36:39]
s_waitcnt vmcnt(3)
v_mfma_f32_16x16x32_bf16 v[32:35], v[52:55], v[160:163], v[32:35]
v_mfma_f32_16x16x32_bf16 v[36:39], v[56:59], v[160:163], v[36:39]
s_waitcnt vmcnt(2)
v_mfma_f32_16x16x32_bf16 v[32:35], v[52:55], v[164:167], v[32:35]
v_mfma_f32_16x16x32_bf16 v[36:39], v[56:59], v[164:167], v[36:39]
s_waitcnt vmcnt(1)
v_mfma_f32_16x16x32_bf16 v[32:35], v[52:55], v[168:171], v[32:35]
v_mfma_f32_16x16x32_bf16 v[36:39], v[56:59], v[168:171], v[36:39]
v_cvt_pk_bf16_f32 v24, v24, v25
v_cvt_pk_bf16_f32 v25, v26, v27
v_cvt_pk_bf16_f32 v26, v28, v29
v_cvt_pk_bf16_f32 v27, v30, v31
s_nop 1
v_permlane16_swap_b32 v24, v26
v_permlane16_swap_b32 v25, v27
buffer_store_dwordx4 v[24:27], v5, s[48:51], s71 offen sc1
s_nop 6
v_cvt_pk_bf16_f32 v32, v32, v33
v_cvt_pk_bf16_f32 v33, v34, v35
v_cvt_pk_bf16_f32 v34, v36, v37
v_cvt_pk_bf16_f32 v35, v38, v39
s_nop 1
v_permlane16_swap_b32 v32, v34
v_permlane16_swap_b32 v33, v35
buffer_store_dwordx4 v[32:35], v5, s[48:51], s72 offen sc1
s_branch L_fin
L_v1:
buffer_load_dwordx4 v[116:119], v6, s[40:43], s84 offen sc1
buffer_load_dwordx4 v[120:123], v6, s[40:43], s85 offen sc1
buffer_load_dwordx4 v[124:127], v6, s[40:43], s86 offen sc1
buffer_load_dwordx4 v[128:131], v6, s[40:43], s87 offen sc1
buffer_load_dwordx4 v[132:135], v6, s[40:43], s88 offen sc1
buffer_load_dwordx4 v[136:139], v6, s[40:43], s89 offen sc1
buffer_load_dwordx4 v[140:143], v6, s[40:43], s90 offen sc1
buffer_store_dwordx4 v[16:19], v5, s[48:51], s70 offen sc1
v_mfma_f32_16x16x32_bf16 v[24:27], v[52:55], v[44:47], 0
v_mfma_f32_16x16x32_bf16 v[28:31], v[56:59], v[44:47], 0
s_waitcnt vmcnt(7)
v_mfma_f32_16x16x32_bf16 v[24:27], v[52:55], v[116:119], v[24:27]
v_mfma_f32_16x16x32_bf16 v[28:31], v[56:59], v[116:119], v[28:31]
s_waitcnt vmcnt(6)
v_mfma_f32_16x16x32_bf16 v[24:27], v[52:55], v[120:123], v[24:27]
v_mfma_f32_16x16x32_bf16 v[28:31], v[56:59], v[120:123], v[28:31]
s_waitcnt vmcnt(5)
v_mfma_f32_16x16x32_bf16 v[24:27], v[52:55], v[124:127], v[24:27]
v_mfma_f32_16x16x32_bf16 v[28:31], v[56:59], v[124:127], v[28:31]
s_waitcnt vmcnt(4)
v_mfma_f32_16x16x32_bf16 v[24:27], v[52:55], v[128:131], v[24:27]
v_mfma_f32_16x16x32_bf16 v[28:31], v[56:59], v[128:131], v[28:31]
s_waitcnt vmcnt(3)
v_mfma_f32_16x16x32_bf16 v[24:27], v[52:55], v[132:135], v[24:27]
v_mfma_f32_16x16x32_bf16 v[28:31], v[56:59], v[132:135], v[28:31]
s_waitcnt vmcnt(2)
v_mfma_f32_16x16x32_bf16 v[24:27], v[52:55], v[136:139], v[24:27]
v_mfma_f32_16x16x32_bf16 v[28:31], v[56:59], v[136:139], v[28:31]
s_waitcnt vmcnt(1)
v_mfma_f32_16x16x32_bf16 v[24:27], v[52:55], v[140:143], v[24:27]
v_mfma_f32_16x16x32_bf16 v[28:31], v[56:59], v[140:143], v[28:31]
s_nop 6
v_cvt_pk_bf16_f32 v24, v24, v25
v_cvt_pk_bf16_f32 v25, v26, v27
v_cvt_pk_bf16_f32 v26, v28, v29
v_cvt_pk_bf16_f32 v27, v30, v31
s_nop 1
v_permlane16_swap_b32 v24, v26
v_permlane16_swap_b32 v25, v27
buffer_store_dwordx4 v[24:27], v5, s[48:51], s71 offen sc1
L_fin:
L_end:
s_endpgm
L_rare_1:
s_call_b64 s[94:95], L_resc_1
s_branch L_ret_1
L_rare_2:
s_call_b64 s[94:95], L_resc_0
s_branch L_ret_2
L_rare_3:
s_call_b64 s[94:95], L_resc_1
s_branch L_ret_3
L_rare_4:
s_call_b64 s[94:95], L_resc_0
s_branch L_ret_4
L_rare_5:
s_call_b64 s[94:95], L_resc_1
s_branch L_ret_5
L_rare_6:
s_call_b64 s[94:95], L_resc_0
s_branch L_ret_6
L_rare_7:
s_call_b64 s[94:95], L_resc_1
s_branch L_ret_7
L_rare_8:
s_call_b64 s[94:95], L_resc_0
s_branch L_ret_8
L_rare_9:
s_call_b64 s[94:95], L_resc_1
s_branch L_ret_9
L_rare_10:
s_call_b64 s[94:95], L_resc_0
s_branch L_ret_10
L_rare_11:
s_call_b64 s[94:95], L_resc_1
s_branch L_ret_11
L_rare_12:
s_call_b64 s[94:95], L_resc_0
s_branch L_ret_12
L_rare_13:
s_call_b64 s[94:95], L_resc_1
s_branch L_ret_13
L_rare_14:
s_call_b64 s[94:95], L_resc_0
s_branch L_ret_14
L_rare_15:
s_call_b64 s[94:95], L_resc_last
s_branch L_ret_15
L_resc_0:
s_nop 7
s_nop 1
s_mov_b32 s67, 0xffff0000
v_max3_f32 v76, v16, v17, v18
v_max3_f32 v76, v76, v19, v20
v_max3_f32 v76, v76, v21, v22
v_max3_f32 v76, v76, v23, 0
v_mov_b32 v77, v76
s_nop 1
v_permlane32_swap_b32 v76, v77
v_max_f32 v76, v76, v77
v_mov_b32 v77, v76
s_nop 1
v_permlane16_swap_b32 v76, v77
v_max_f32 v76, v76, v77
v_ceil_f32 v76, v76
v_sub_f32 v77, 0, v76
v_max_f32 v77, 0xc3480000, v77
v_cvt_i32_f32 v77, v77
v_ldexp_f32 v77, 1.0, v77
v_sub_f32 v16, v16, v76
v_sub_f32 v17, v17, v76
v_sub_f32 v18, v18, v76
v_sub_f32 v19, v19, v76
v_sub_f32 v20, v20, v76
v_sub_f32 v21, v21, v76
v_sub_f32 v22, v22, v76
v_sub_f32 v23, v23, v76
v_sub_f32 v64, v64, v76
v_sub_f32 v65, v65, v76
v_sub_f32 v66, v66, v76
v_sub_f32 v67, v67, v76
v_sub_f32 v40, v40, v76
v_sub_f32 v41, v41, v76
v_sub_f32 v42, v42, v76
v_sub_f32 v43, v43, v76
v_lshlrev_b32 v78, 16, v88
v_and_b32 v79, s67, v88
v_mul_f32 v78, v78, v77
v_mul_f32 v79, v79, v77
v_cvt_pk_bf16_f32 v88, v78, v79
v_lshlrev_b32 v78, 16, v89
v_and_b32 v79, s67, v89
v_mul_f32 v78, v78, v77
v_mul_f32 v79, v79, v77
v_cvt_pk_bf16_f32 v89, v78, v79
v_lshlrev_b32 v78, 16, v90
v_and_b32 v79, s67, v90
v_mul_f32 v78, v78, v77
v_mul_f32 v79, v79, v77
v_cvt_pk_bf16_f32 v90, v78, v79
v_lshlrev_b32 v78, 16, v91
v_and_b32 v79, s67, v91
v_mul_f32 v78, v78, v77
v_mul_f32 v79, v79, v77
v_cvt_pk_bf16_f32 v91, v78, v79
v_lshlrev_b32 v78, 16, v100
v_and_b32 v79, s67, v100
v_mul_f32 v78, v78, v77
v_mul_f32 v79, v79, v77
v_cvt_pk_bf16_f32 v100, v78, v79
v_lshlrev_b32 v78, 16, v101
v_and_b32 v79, s67, v101
v_mul_f32 v78, v78, v77
v_mul_f32 v79, v79, v77
v_cvt_pk_bf16_f32 v101, v78, v79
v_lshlrev_b32 v78, 16, v102
v_and_b32 v79, s67, v102
v_mul_f32 v78, v78, v77
v_mul_f32 v79, v79, v77
v_cvt_pk_bf16_f32 v102, v78, v79
v_lshlrev_b32 v78, 16, v103
v_and_b32 v79, s67, v103
v_mul_f32 v78, v78, v77
v_mul_f32 v79, v79, v77
v_cvt_pk_bf16_f32 v103, v78, v79
v_lshlrev_b32 v78, 16, v112
v_and_b32 v79, s67, v112
v_mul_f32 v78, v78, v77
v_mul_f32 v79, v79, v77
v_cvt_pk_bf16_f32 v112, v78, v79
v_lshlrev_b32 v78, 16, v113
v_and_b32 v79, s67, v113
v_mul_f32 v78, v78, v77
v_mul_f32 v79, v79, v77
v_cvt_pk_bf16_f32 v113, v78, v79
v_lshlrev_b32 v78, 16, v114
v_and_b32 v79, s67, v114
v_mul_f32 v78, v78, v77
v_mul_f32 v79, v79, v77
v_cvt_pk_bf16_f32 v114, v78, v79
v_lshlrev_b32 v78, 16, v115
v_and_b32 v79, s67, v115
v_mul_f32 v78, v78, v77
v_mul_f32 v79, v79, v77
v_cvt_pk_bf16_f32 v115, v78, v79
v_lshlrev_b32 v78, 16, v124
v_and_b32 v79, s67, v124
v_mul_f32 v78, v78, v77
v_mul_f32 v79, v79, v77
v_cvt_pk_bf16_f32 v124, v78, v79
v_lshlrev_b32 v78, 16, v125
v_and_b32 v79, s67, v125
v_mul_f32 v78, v78, v77
v_mul_f32 v79, v79, v77
v_cvt_pk_bf16_f32 v125, v78, v79
v_lshlrev_b32 v78, 16, v126
v_and_b32 v79, s67, v126
v_mul_f32 v78, v78, v77
v_mul_f32 v79, v79, v77
v_cvt_pk_bf16_f32 v126, v78, v79
v_lshlrev_b32 v78, 16, v127
v_and_b32 v79, s67, v127
v_mul_f32 v78, v78, v77
v_mul_f32 v79, v79, v77
v_cvt_pk_bf16_f32 v127, v78, v79
v_lshlrev_b32 v78, 16, v136
v_and_b32 v79, s67, v136
v_mul_f32 v78, v78, v77
v_mul_f32 v79, v79, v77
v_cvt_pk_bf16_f32 v136, v78, v79
v_lshlrev_b32 v78, 16, v137
v_and_b32 v79, s67, v137
v_mul_f32 v78, v78, v77
v_mul_f32 v79, v79, v77
v_cvt_pk_bf16_f32 v137, v78, v79
v_lshlrev_b32 v78, 16, v138
v_and_b32 v79, s67, v138
v_mul_f32 v78, v78, v77
v_mul_f32 v79, v79, v77
v_cvt_pk_bf16_f32 v138, v78, v79
v_lshlrev_b32 v78, 16, v139
v_and_b32 v79, s67, v139
v_mul_f32 v78, v78, v77
v_mul_f32 v79, v79, v77
v_cvt_pk_bf16_f32 v139, v78, v79
v_lshlrev_b32 v78, 16, v148
v_and_b32 v79, s67, v148
v_mul_f32 v78, v78, v77
v_mul_f32 v79, v79, v77
v_cvt_pk_bf16_f32 v148, v78, v79
v_lshlrev_b32 v78, 16, v149
v_and_b32 v79, s67, v149
v_mul_f32 v78, v78, v77
v_mul_f32 v79, v79, v77
v_cvt_pk_bf16_f32 v149, v78, v79
v_lshlrev_b32 v78, 16, v150
v_and_b32 v79, s67, v150
v_mul_f32 v78, v78, v77
v_mul_f32 v79, v79, v77
v_cvt_pk_bf16_f32 v150, v78, v79
v_lshlrev_b32 v78, 16, v151
v_and_b32 v79, s67, v151
v_mul_f32 v78, v78, v77
v_mul_f32 v79, v79, v77
v_cvt_pk_bf16_f32 v151, v78, v79
v_lshlrev_b32 v78, 16, v160
v_and_b32 v79, s67, v160
v_mul_f32 v78, v78, v77
v_mul_f32 v79, v79, v77
v_cvt_pk_bf16_f32 v160, v78, v79
v_lshlrev_b32 v78, 16, v161
v_and_b32 v79, s67, v161
v_mul_f32 v78, v78, v77
v_mul_f32 v79, v79, v77
v_cvt_pk_bf16_f32 v161, v78, v79
v_lshlrev_b32 v78, 16, v162
v_and_b32 v79, s67, v162
v_mul_f32 v78, v78, v77
v_mul_f32 v79, v79, v77
v_cvt_pk_bf16_f32 v162, v78, v79
v_lshlrev_b32 v78, 16, v163
v_and_b32 v79, s67, v163
v_mul_f32 v78, v78, v77
v_mul_f32 v79, v79, v77
v_cvt_pk_bf16_f32 v163, v78, v79
v_lshlrev_b32 v78, 16, v172
v_and_b32 v79, s67, v172
v_mul_f32 v78, v78, v77
v_mul_f32 v79, v79, v77
v_cvt_pk_bf16_f32 v172, v78, v79
v_lshlrev_b32 v78, 16, v173
v_and_b32 v79, s67, v173
v_mul_f32 v78, v78, v77
v_mul_f32 v79, v79, v77
v_cvt_pk_bf16_f32 v173, v78, v79
v_lshlrev_b32 v78, 16, v174
v_and_b32 v79, s67, v174
v_mul_f32 v78, v78, v77
v_mul_f32 v79, v79, v77
v_cvt_pk_bf16_f32 v174, v78, v79
v_lshlrev_b32 v78, 16, v175
v_and_b32 v79, s67, v175
v_mul_f32 v78, v78, v77
v_mul_f32 v79, v79, v77
v_cvt_pk_bf16_f32 v175, v78, v79
v_lshlrev_b32 v78, 16, v184
v_and_b32 v79, s67, v184
v_mul_f32 v78, v78, v77
v_mul_f32 v79, v79, v77
v_cvt_pk_bf16_f32 v184, v78, v79
v_lshlrev_b32 v78, 16, v185
v_and_b32 v79, s67, v185
v_mul_f32 v78, v78, v77
v_mul_f32 v79, v79, v77
v_cvt_pk_bf16_f32 v185, v78, v79
v_lshlrev_b32 v78, 16, v186
v_and_b32 v79, s67, v186
v_mul_f32 v78, v78, v77
v_mul_f32 v79, v79, v77
v_cvt_pk_bf16_f32 v186, v78, v79
v_lshlrev_b32 v78, 16, v187
v_and_b32 v79, s67, v187
v_mul_f32 v78, v78, v77
v_mul_f32 v79, v79, v77
v_cvt_pk_bf16_f32 v187, v78, v79
v_lshlrev_b32 v78, 16, v196
v_and_b32 v79, s67, v196
v_mul_f32 v78, v78, v77
v_mul_f32 v79, v79, v77
v_cvt_pk_bf16_f32 v196, v78, v79
v_lshlrev_b32 v78, 16, v197
v_and_b32 v79, s67, v197
v_mul_f32 v78, v78, v77
v_mul_f32 v79, v79, v77
v_cvt_pk_bf16_f32 v197, v78, v79
v_lshlrev_b32 v78, 16, v198
v_and_b32 v79, s67, v198
v_mul_f32 v78, v78, v77
v_mul_f32 v79, v79, v77
v_cvt_pk_bf16_f32 v198, v78, v79
v_lshlrev_b32 v78, 16, v199
v_and_b32 v79, s67, v199
v_mul_f32 v78, v78, v77
v_mul_f32 v79, v79, v77
v_cvt_pk_bf16_f32 v199, v78, v79
v_lshlrev_b32 v78, 16, v208
v_and_b32 v79, s67, v208
v_mul_f32 v78, v78, v77
v_mul_f32 v79, v79, v77
v_cvt_pk_bf16_f32 v208, v78, v79
v_lshlrev_b32 v78, 16, v209
v_and_b32 v79, s67, v209
v_mul_f32 v78, v78, v77
v_mul_f32 v79, v79, v77
v_cvt_pk_bf16_f32 v209, v78, v79
v_lshlrev_b32 v78, 16, v210
v_and_b32 v79, s67, v210
v_mul_f32 v78, v78, v77
v_mul_f32 v79, v79, v77
v_cvt_pk_bf16_f32 v210, v78, v79
v_lshlrev_b32 v78, 16, v211
v_and_b32 v79, s67, v211
v_mul_f32 v78, v78, v77
v_mul_f32 v79, v79, v77
v_cvt_pk_bf16_f32 v211, v78, v79
v_lshlrev_b32 v78, 16, v220
v_and_b32 v79, s67, v220
v_mul_f32 v78, v78, v77
v_mul_f32 v79, v79, v77
v_cvt_pk_bf16_f32 v220, v78, v79
v_lshlrev_b32 v78, 16, v221
v_and_b32 v79, s67, v221
v_mul_f32 v78, v78, v77
v_mul_f32 v79, v79, v77
v_cvt_pk_bf16_f32 v221, v78, v79
v_lshlrev_b32 v78, 16, v222
v_and_b32 v79, s67, v222
v_mul_f32 v78, v78, v77
v_mul_f32 v79, v79, v77
v_cvt_pk_bf16_f32 v222, v78, v79
v_lshlrev_b32 v78, 16, v223
v_and_b32 v79, s67, v223
v_mul_f32 v78, v78, v77
v_mul_f32 v79, v79, v77
v_cvt_pk_bf16_f32 v223, v78, v79
v_lshlrev_b32 v78, 16, v232
v_and_b32 v79, s67, v232
v_mul_f32 v78, v78, v77
v_mul_f32 v79, v79, v77
v_cvt_pk_bf16_f32 v232, v78, v79
v_lshlrev_b32 v78, 16, v233
v_and_b32 v79, s67, v233
v_mul_f32 v78, v78, v77
v_mul_f32 v79, v79, v77
v_cvt_pk_bf16_f32 v233, v78, v79
v_lshlrev_b32 v78, 16, v234
v_and_b32 v79, s67, v234
v_mul_f32 v78, v78, v77
v_mul_f32 v79, v79, v77
v_cvt_pk_bf16_f32 v234, v78, v79
v_lshlrev_b32 v78, 16, v235
v_and_b32 v79, s67, v235
v_mul_f32 v78, v78, v77
v_mul_f32 v79, v79, v77
v_cvt_pk_bf16_f32 v235, v78, v79
v_lshlrev_b32 v78, 16, v244
v_and_b32 v79, s67, v244
v_mul_f32 v78, v78, v77
v_mul_f32 v79, v79, v77
v_cvt_pk_bf16_f32 v244, v78, v79
v_lshlrev_b32 v78, 16, v245
v_and_b32 v79, s67, v245
v_mul_f32 v78, v78, v77
v_mul_f32 v79, v79, v77
v_cvt_pk_bf16_f32 v245, v78, v79
v_lshlrev_b32 v78, 16, v246
v_and_b32 v79, s67, v246
v_mul_f32 v78, v78, v77
v_mul_f32 v79, v79, v77
v_cvt_pk_bf16_f32 v246, v78, v79
v_lshlrev_b32 v78, 16, v247
v_and_b32 v79, s67, v247
v_mul_f32 v78, v78, v77
v_mul_f32 v79, v79, v77
v_cvt_pk_bf16_f32 v247, v78, v79
v_accvgpr_read_b32 v78, a232
v_mul_f32 v78, v78, v77
v_accvgpr_write_b32 a232, v78
v_accvgpr_read_b32 v78, a233
v_mul_f32 v78, v78, v77
v_accvgpr_write_b32 a233, v78
v_accvgpr_read_b32 v78, a234
v_mul_f32 v78, v78, v77
v_accvgpr_write_b32 a234, v78
v_accvgpr_read_b32 v78, a235
v_mul_f32 v78, v78, v77
v_accvgpr_write_b32 a235, v78
v_max3_f32 v76, v24, v25, v26
v_max3_f32 v76, v76, v27, v28
v_max3_f32 v76, v76, v29, v30
v_max3_f32 v76, v76, v31, 0
v_mov_b32 v77, v76
s_nop 1
v_permlane32_swap_b32 v76, v77
v_max_f32 v76, v76, v77
v_mov_b32 v77, v76
s_nop 1
v_permlane16_swap_b32 v76, v77
v_max_f32 v76, v76, v77
v_ceil_f32 v76, v76
v_sub_f32 v77, 0, v76
v_max_f32 v77, 0xc3480000, v77
v_cvt_i32_f32 v77, v77
v_ldexp_f32 v77, 1.0, v77
v_sub_f32 v24, v24, v76
v_sub_f32 v25, v25, v76
v_sub_f32 v26, v26, v76
v_sub_f32 v27, v27, v76
v_sub_f32 v28, v28, v76
v_sub_f32 v29, v29, v76
v_sub_f32 v30, v30, v76
v_sub_f32 v31, v31, v76
v_sub_f32 v68, v68, v76
v_sub_f32 v69, v69, v76
v_sub_f32 v70, v70, v76
v_sub_f32 v71, v71, v76
v_sub_f32 v48, v48, v76
v_sub_f32 v49, v49, v76
v_sub_f32 v50, v50, v76
v_sub_f32 v51, v51, v76
v_lshlrev_b32 v78, 16, v92
v_and_b32 v79, s67, v92
v_mul_f32 v78, v78, v77
v_mul_f32 v79, v79, v77
v_cvt_pk_bf16_f32 v92, v78, v79
v_lshlrev_b32 v78, 16, v93
v_and_b32 v79, s67, v93
v_mul_f32 v78, v78, v77
v_mul_f32 v79, v79, v77
v_cvt_pk_bf16_f32 v93, v78, v79
v_lshlrev_b32 v78, 16, v94
v_and_b32 v79, s67, v94
v_mul_f32 v78, v78, v77
v_mul_f32 v79, v79, v77
v_cvt_pk_bf16_f32 v94, v78, v79
v_lshlrev_b32 v78, 16, v95
v_and_b32 v79, s67, v95
v_mul_f32 v78, v78, v77
v_mul_f32 v79, v79, v77
v_cvt_pk_bf16_f32 v95, v78, v79
v_lshlrev_b32 v78, 16, v104
v_and_b32 v79, s67, v104
v_mul_f32 v78, v78, v77
v_mul_f32 v79, v79, v77
v_cvt_pk_bf16_f32 v104, v78, v79
v_lshlrev_b32 v78, 16, v105
v_and_b32 v79, s67, v105
v_mul_f32 v78, v78, v77
v_mul_f32 v79, v79, v77
v_cvt_pk_bf16_f32 v105, v78, v79
v_lshlrev_b32 v78, 16, v106
v_and_b32 v79, s67, v106
v_mul_f32 v78, v78, v77
v_mul_f32 v79, v79, v77
v_cvt_pk_bf16_f32 v106, v78, v79
v_lshlrev_b32 v78, 16, v107
v_and_b32 v79, s67, v107
v_mul_f32 v78, v78, v77
v_mul_f32 v79, v79, v77
v_cvt_pk_bf16_f32 v107, v78, v79
v_lshlrev_b32 v78, 16, v116
v_and_b32 v79, s67, v116
v_mul_f32 v78, v78, v77
v_mul_f32 v79, v79, v77
v_cvt_pk_bf16_f32 v116, v78, v79
v_lshlrev_b32 v78, 16, v117
v_and_b32 v79, s67, v117
v_mul_f32 v78, v78, v77
v_mul_f32 v79, v79, v77
v_cvt_pk_bf16_f32 v117, v78, v79
v_lshlrev_b32 v78, 16, v118
v_and_b32 v79, s67, v118
v_mul_f32 v78, v78, v77
v_mul_f32 v79, v79, v77
v_cvt_pk_bf16_f32 v118, v78, v79
v_lshlrev_b32 v78, 16, v119
v_and_b32 v79, s67, v119
v_mul_f32 v78, v78, v77
v_mul_f32 v79, v79, v77
v_cvt_pk_bf16_f32 v119, v78, v79
v_lshlrev_b32 v78, 16, v128
v_and_b32 v79, s67, v128
v_mul_f32 v78, v78, v77
v_mul_f32 v79, v79, v77
v_cvt_pk_bf16_f32 v128, v78, v79
v_lshlrev_b32 v78, 16, v129
v_and_b32 v79, s67, v129
v_mul_f32 v78, v78, v77
v_mul_f32 v79, v79, v77
v_cvt_pk_bf16_f32 v129, v78, v79
v_lshlrev_b32 v78, 16, v130
v_and_b32 v79, s67, v130
v_mul_f32 v78, v78, v77
v_mul_f32 v79, v79, v77
v_cvt_pk_bf16_f32 v130, v78, v79
v_lshlrev_b32 v78, 16, v131
v_and_b32 v79, s67, v131
v_mul_f32 v78, v78, v77
v_mul_f32 v79, v79, v77
v_cvt_pk_bf16_f32 v131, v78, v79
v_lshlrev_b32 v78, 16, v140
v_and_b32 v79, s67, v140
v_mul_f32 v78, v78, v77
v_mul_f32 v79, v79, v77
v_cvt_pk_bf16_f32 v140, v78, v79
v_lshlrev_b32 v78, 16, v141
v_and_b32 v79, s67, v141
v_mul_f32 v78, v78, v77
v_mul_f32 v79, v79, v77
v_cvt_pk_bf16_f32 v141, v78, v79
v_lshlrev_b32 v78, 16, v142
v_and_b32 v79, s67, v142
v_mul_f32 v78, v78, v77
v_mul_f32 v79, v79, v77
v_cvt_pk_bf16_f32 v142, v78, v79
v_lshlrev_b32 v78, 16, v143
v_and_b32 v79, s67, v143
v_mul_f32 v78, v78, v77
v_mul_f32 v79, v79, v77
v_cvt_pk_bf16_f32 v143, v78, v79
v_lshlrev_b32 v78, 16, v152
v_and_b32 v79, s67, v152
v_mul_f32 v78, v78, v77
v_mul_f32 v79, v79, v77
v_cvt_pk_bf16_f32 v152, v78, v79
v_lshlrev_b32 v78, 16, v153
v_and_b32 v79, s67, v153
v_mul_f32 v78, v78, v77
v_mul_f32 v79, v79, v77
v_cvt_pk_bf16_f32 v153, v78, v79
v_lshlrev_b32 v78, 16, v154
v_and_b32 v79, s67, v154
v_mul_f32 v78, v78, v77
v_mul_f32 v79, v79, v77
v_cvt_pk_bf16_f32 v154, v78, v79
v_lshlrev_b32 v78, 16, v155
v_and_b32 v79, s67, v155
v_mul_f32 v78, v78, v77
v_mul_f32 v79, v79, v77
v_cvt_pk_bf16_f32 v155, v78, v79
v_lshlrev_b32 v78, 16, v164
v_and_b32 v79, s67, v164
v_mul_f32 v78, v78, v77
v_mul_f32 v79, v79, v77
v_cvt_pk_bf16_f32 v164, v78, v79
v_lshlrev_b32 v78, 16, v165
v_and_b32 v79, s67, v165
v_mul_f32 v78, v78, v77
v_mul_f32 v79, v79, v77
v_cvt_pk_bf16_f32 v165, v78, v79
v_lshlrev_b32 v78, 16, v166
v_and_b32 v79, s67, v166
v_mul_f32 v78, v78, v77
v_mul_f32 v79, v79, v77
v_cvt_pk_bf16_f32 v166, v78, v79
v_lshlrev_b32 v78, 16, v167
v_and_b32 v79, s67, v167
v_mul_f32 v78, v78, v77
v_mul_f32 v79, v79, v77
v_cvt_pk_bf16_f32 v167, v78, v79
v_lshlrev_b32 v78, 16, v176
v_and_b32 v79, s67, v176
v_mul_f32 v78, v78, v77
v_mul_f32 v79, v79, v77
v_cvt_pk_bf16_f32 v176, v78, v79
v_lshlrev_b32 v78, 16, v177
v_and_b32 v79, s67, v177
v_mul_f32 v78, v78, v77
v_mul_f32 v79, v79, v77
v_cvt_pk_bf16_f32 v177, v78, v79
v_lshlrev_b32 v78, 16, v178
v_and_b32 v79, s67, v178
v_mul_f32 v78, v78, v77
v_mul_f32 v79, v79, v77
v_cvt_pk_bf16_f32 v178, v78, v79
v_lshlrev_b32 v78, 16, v179
v_and_b32 v79, s67, v179
v_mul_f32 v78, v78, v77
v_mul_f32 v79, v79, v77
v_cvt_pk_bf16_f32 v179, v78, v79
v_lshlrev_b32 v78, 16, v188
v_and_b32 v79, s67, v188
v_mul_f32 v78, v78, v77
v_mul_f32 v79, v79, v77
v_cvt_pk_bf16_f32 v188, v78, v79
v_lshlrev_b32 v78, 16, v189
v_and_b32 v79, s67, v189
v_mul_f32 v78, v78, v77
v_mul_f32 v79, v79, v77
v_cvt_pk_bf16_f32 v189, v78, v79
v_lshlrev_b32 v78, 16, v190
v_and_b32 v79, s67, v190
v_mul_f32 v78, v78, v77
v_mul_f32 v79, v79, v77
v_cvt_pk_bf16_f32 v190, v78, v79
v_lshlrev_b32 v78, 16, v191
v_and_b32 v79, s67, v191
v_mul_f32 v78, v78, v77
v_mul_f32 v79, v79, v77
v_cvt_pk_bf16_f32 v191, v78, v79
v_lshlrev_b32 v78, 16, v200
v_and_b32 v79, s67, v200
v_mul_f32 v78, v78, v77
v_mul_f32 v79, v79, v77
v_cvt_pk_bf16_f32 v200, v78, v79
v_lshlrev_b32 v78, 16, v201
v_and_b32 v79, s67, v201
v_mul_f32 v78, v78, v77
v_mul_f32 v79, v79, v77
v_cvt_pk_bf16_f32 v201, v78, v79
v_lshlrev_b32 v78, 16, v202
v_and_b32 v79, s67, v202
v_mul_f32 v78, v78, v77
v_mul_f32 v79, v79, v77
v_cvt_pk_bf16_f32 v202, v78, v79
v_lshlrev_b32 v78, 16, v203
v_and_b32 v79, s67, v203
v_mul_f32 v78, v78, v77
v_mul_f32 v79, v79, v77
v_cvt_pk_bf16_f32 v203, v78, v79
v_lshlrev_b32 v78, 16, v212
v_and_b32 v79, s67, v212
v_mul_f32 v78, v78, v77
v_mul_f32 v79, v79, v77
v_cvt_pk_bf16_f32 v212, v78, v79
v_lshlrev_b32 v78, 16, v213
v_and_b32 v79, s67, v213
v_mul_f32 v78, v78, v77
v_mul_f32 v79, v79, v77
v_cvt_pk_bf16_f32 v213, v78, v79
v_lshlrev_b32 v78, 16, v214
v_and_b32 v79, s67, v214
v_mul_f32 v78, v78, v77
v_mul_f32 v79, v79, v77
v_cvt_pk_bf16_f32 v214, v78, v79
v_lshlrev_b32 v78, 16, v215
v_and_b32 v79, s67, v215
v_mul_f32 v78, v78, v77
v_mul_f32 v79, v79, v77
v_cvt_pk_bf16_f32 v215, v78, v79
v_lshlrev_b32 v78, 16, v224
v_and_b32 v79, s67, v224
v_mul_f32 v78, v78, v77
v_mul_f32 v79, v79, v77
v_cvt_pk_bf16_f32 v224, v78, v79
v_lshlrev_b32 v78, 16, v225
v_and_b32 v79, s67, v225
v_mul_f32 v78, v78, v77
v_mul_f32 v79, v79, v77
v_cvt_pk_bf16_f32 v225, v78, v79
v_lshlrev_b32 v78, 16, v226
v_and_b32 v79, s67, v226
v_mul_f32 v78, v78, v77
v_mul_f32 v79, v79, v77
v_cvt_pk_bf16_f32 v226, v78, v79
v_lshlrev_b32 v78, 16, v227
v_and_b32 v79, s67, v227
v_mul_f32 v78, v78, v77
v_mul_f32 v79, v79, v77
v_cvt_pk_bf16_f32 v227, v78, v79
v_lshlrev_b32 v78, 16, v236
v_and_b32 v79, s67, v236
v_mul_f32 v78, v78, v77
v_mul_f32 v79, v79, v77
v_cvt_pk_bf16_f32 v236, v78, v79
v_lshlrev_b32 v78, 16, v237
v_and_b32 v79, s67, v237
v_mul_f32 v78, v78, v77
v_mul_f32 v79, v79, v77
v_cvt_pk_bf16_f32 v237, v78, v79
v_lshlrev_b32 v78, 16, v238
v_and_b32 v79, s67, v238
v_mul_f32 v78, v78, v77
v_mul_f32 v79, v79, v77
v_cvt_pk_bf16_f32 v238, v78, v79
v_lshlrev_b32 v78, 16, v239
v_and_b32 v79, s67, v239
v_mul_f32 v78, v78, v77
v_mul_f32 v79, v79, v77
v_cvt_pk_bf16_f32 v239, v78, v79
v_lshlrev_b32 v78, 16, v248
v_and_b32 v79, s67, v248
v_mul_f32 v78, v78, v77
v_mul_f32 v79, v79, v77
v_cvt_pk_bf16_f32 v248, v78, v79
v_lshlrev_b32 v78, 16, v249
v_and_b32 v79, s67, v249
v_mul_f32 v78, v78, v77
v_mul_f32 v79, v79, v77
v_cvt_pk_bf16_f32 v249, v78, v79
v_lshlrev_b32 v78, 16, v250
v_and_b32 v79, s67, v250
v_mul_f32 v78, v78, v77
v_mul_f32 v79, v79, v77
v_cvt_pk_bf16_f32 v250, v78, v79
v_lshlrev_b32 v78, 16, v251
v_and_b32 v79, s67, v251
v_mul_f32 v78, v78, v77
v_mul_f32 v79, v79, v77
v_cvt_pk_bf16_f32 v251, v78, v79
v_accvgpr_read_b32 v78, a236
v_mul_f32 v78, v78, v77
v_accvgpr_write_b32 a236, v78
v_accvgpr_read_b32 v78, a237
v_mul_f32 v78, v78, v77
v_accvgpr_write_b32 a237, v78
v_accvgpr_read_b32 v78, a238
v_mul_f32 v78, v78, v77
v_accvgpr_write_b32 a238, v78
v_accvgpr_read_b32 v78, a239
v_mul_f32 v78, v78, v77
v_accvgpr_write_b32 a239, v78
v_max3_f32 v76, v32, v33, v34
v_max3_f32 v76, v76, v35, v36
v_max3_f32 v76, v76, v37, v38
v_max3_f32 v76, v76, v39, 0
v_mov_b32 v77, v76
s_nop 1
v_permlane32_swap_b32 v76, v77
v_max_f32 v76, v76, v77
v_mov_b32 v77, v76
s_nop 1
v_permlane16_swap_b32 v76, v77
v_max_f32 v76, v76, v77
v_ceil_f32 v76, v76
v_sub_f32 v77, 0, v76
v_max_f32 v77, 0xc3480000, v77
v_cvt_i32_f32 v77, v77
v_ldexp_f32 v77, 1.0, v77
v_sub_f32 v32, v32, v76
v_sub_f32 v33, v33, v76
v_sub_f32 v34, v34, v76
v_sub_f32 v35, v35, v76
v_sub_f32 v36, v36, v76
v_sub_f32 v37, v37, v76
v_sub_f32 v38, v38, v76
v_sub_f32 v39, v39, v76
v_sub_f32 v72, v72, v76
v_sub_f32 v73, v73, v76
v_sub_f32 v74, v74, v76
v_sub_f32 v75, v75, v76
v_sub_f32 v56, v56, v76
v_sub_f32 v57, v57, v76
v_sub_f32 v58, v58, v76
v_sub_f32 v59, v59, v76
v_lshlrev_b32 v78, 16, v96
v_and_b32 v79, s67, v96
v_mul_f32 v78, v78, v77
v_mul_f32 v79, v79, v77
v_cvt_pk_bf16_f32 v96, v78, v79
v_lshlrev_b32 v78, 16, v97
v_and_b32 v79, s67, v97
v_mul_f32 v78, v78, v77
v_mul_f32 v79, v79, v77
v_cvt_pk_bf16_f32 v97, v78, v79
v_lshlrev_b32 v78, 16, v98
v_and_b32 v79, s67, v98
v_mul_f32 v78, v78, v77
v_mul_f32 v79, v79, v77
v_cvt_pk_bf16_f32 v98, v78, v79
v_lshlrev_b32 v78, 16, v99
v_and_b32 v79, s67, v99
v_mul_f32 v78, v78, v77
v_mul_f32 v79, v79, v77
v_cvt_pk_bf16_f32 v99, v78, v79
v_lshlrev_b32 v78, 16, v108
v_and_b32 v79, s67, v108
v_mul_f32 v78, v78, v77
v_mul_f32 v79, v79, v77
v_cvt_pk_bf16_f32 v108, v78, v79
v_lshlrev_b32 v78, 16, v109
v_and_b32 v79, s67, v109
v_mul_f32 v78, v78, v77
v_mul_f32 v79, v79, v77
v_cvt_pk_bf16_f32 v109, v78, v79
v_lshlrev_b32 v78, 16, v110
v_and_b32 v79, s67, v110
v_mul_f32 v78, v78, v77
v_mul_f32 v79, v79, v77
v_cvt_pk_bf16_f32 v110, v78, v79
v_lshlrev_b32 v78, 16, v111
v_and_b32 v79, s67, v111
v_mul_f32 v78, v78, v77
v_mul_f32 v79, v79, v77
v_cvt_pk_bf16_f32 v111, v78, v79
v_lshlrev_b32 v78, 16, v120
v_and_b32 v79, s67, v120
v_mul_f32 v78, v78, v77
v_mul_f32 v79, v79, v77
v_cvt_pk_bf16_f32 v120, v78, v79
v_lshlrev_b32 v78, 16, v121
v_and_b32 v79, s67, v121
v_mul_f32 v78, v78, v77
v_mul_f32 v79, v79, v77
v_cvt_pk_bf16_f32 v121, v78, v79
v_lshlrev_b32 v78, 16, v122
v_and_b32 v79, s67, v122
v_mul_f32 v78, v78, v77
v_mul_f32 v79, v79, v77
v_cvt_pk_bf16_f32 v122, v78, v79
v_lshlrev_b32 v78, 16, v123
v_and_b32 v79, s67, v123
v_mul_f32 v78, v78, v77
v_mul_f32 v79, v79, v77
v_cvt_pk_bf16_f32 v123, v78, v79
v_lshlrev_b32 v78, 16, v132
v_and_b32 v79, s67, v132
v_mul_f32 v78, v78, v77
v_mul_f32 v79, v79, v77
v_cvt_pk_bf16_f32 v132, v78, v79
v_lshlrev_b32 v78, 16, v133
v_and_b32 v79, s67, v133
v_mul_f32 v78, v78, v77
v_mul_f32 v79, v79, v77
v_cvt_pk_bf16_f32 v133, v78, v79
v_lshlrev_b32 v78, 16, v134
v_and_b32 v79, s67, v134
v_mul_f32 v78, v78, v77
v_mul_f32 v79, v79, v77
v_cvt_pk_bf16_f32 v134, v78, v79
v_lshlrev_b32 v78, 16, v135
v_and_b32 v79, s67, v135
v_mul_f32 v78, v78, v77
v_mul_f32 v79, v79, v77
v_cvt_pk_bf16_f32 v135, v78, v79
v_lshlrev_b32 v78, 16, v144
v_and_b32 v79, s67, v144
v_mul_f32 v78, v78, v77
v_mul_f32 v79, v79, v77
v_cvt_pk_bf16_f32 v144, v78, v79
v_lshlrev_b32 v78, 16, v145
v_and_b32 v79, s67, v145
v_mul_f32 v78, v78, v77
v_mul_f32 v79, v79, v77
v_cvt_pk_bf16_f32 v145, v78, v79
v_lshlrev_b32 v78, 16, v146
v_and_b32 v79, s67, v146
v_mul_f32 v78, v78, v77
v_mul_f32 v79, v79, v77
v_cvt_pk_bf16_f32 v146, v78, v79
v_lshlrev_b32 v78, 16, v147
v_and_b32 v79, s67, v147
v_mul_f32 v78, v78, v77
v_mul_f32 v79, v79, v77
v_cvt_pk_bf16_f32 v147, v78, v79
v_lshlrev_b32 v78, 16, v156
v_and_b32 v79, s67, v156
v_mul_f32 v78, v78, v77
v_mul_f32 v79, v79, v77
v_cvt_pk_bf16_f32 v156, v78, v79
v_lshlrev_b32 v78, 16, v157
v_and_b32 v79, s67, v157
v_mul_f32 v78, v78, v77
v_mul_f32 v79, v79, v77
v_cvt_pk_bf16_f32 v157, v78, v79
v_lshlrev_b32 v78, 16, v158
v_and_b32 v79, s67, v158
v_mul_f32 v78, v78, v77
v_mul_f32 v79, v79, v77
v_cvt_pk_bf16_f32 v158, v78, v79
v_lshlrev_b32 v78, 16, v159
v_and_b32 v79, s67, v159
v_mul_f32 v78, v78, v77
v_mul_f32 v79, v79, v77
v_cvt_pk_bf16_f32 v159, v78, v79
v_lshlrev_b32 v78, 16, v168
v_and_b32 v79, s67, v168
v_mul_f32 v78, v78, v77
v_mul_f32 v79, v79, v77
v_cvt_pk_bf16_f32 v168, v78, v79
v_lshlrev_b32 v78, 16, v169
v_and_b32 v79, s67, v169
v_mul_f32 v78, v78, v77
v_mul_f32 v79, v79, v77
v_cvt_pk_bf16_f32 v169, v78, v79
v_lshlrev_b32 v78, 16, v170
v_and_b32 v79, s67, v170
v_mul_f32 v78, v78, v77
v_mul_f32 v79, v79, v77
v_cvt_pk_bf16_f32 v170, v78, v79
v_lshlrev_b32 v78, 16, v171
v_and_b32 v79, s67, v171
v_mul_f32 v78, v78, v77
v_mul_f32 v79, v79, v77
v_cvt_pk_bf16_f32 v171, v78, v79
v_lshlrev_b32 v78, 16, v180
v_and_b32 v79, s67, v180
v_mul_f32 v78, v78, v77
v_mul_f32 v79, v79, v77
v_cvt_pk_bf16_f32 v180, v78, v79
v_lshlrev_b32 v78, 16, v181
v_and_b32 v79, s67, v181
v_mul_f32 v78, v78, v77
v_mul_f32 v79, v79, v77
v_cvt_pk_bf16_f32 v181, v78, v79
v_lshlrev_b32 v78, 16, v182
v_and_b32 v79, s67, v182
v_mul_f32 v78, v78, v77
v_mul_f32 v79, v79, v77
v_cvt_pk_bf16_f32 v182, v78, v79
v_lshlrev_b32 v78, 16, v183
v_and_b32 v79, s67, v183
v_mul_f32 v78, v78, v77
v_mul_f32 v79, v79, v77
v_cvt_pk_bf16_f32 v183, v78, v79
v_lshlrev_b32 v78, 16, v192
v_and_b32 v79, s67, v192
v_mul_f32 v78, v78, v77
v_mul_f32 v79, v79, v77
v_cvt_pk_bf16_f32 v192, v78, v79
v_lshlrev_b32 v78, 16, v193
v_and_b32 v79, s67, v193
v_mul_f32 v78, v78, v77
v_mul_f32 v79, v79, v77
v_cvt_pk_bf16_f32 v193, v78, v79
v_lshlrev_b32 v78, 16, v194
v_and_b32 v79, s67, v194
v_mul_f32 v78, v78, v77
v_mul_f32 v79, v79, v77
v_cvt_pk_bf16_f32 v194, v78, v79
v_lshlrev_b32 v78, 16, v195
v_and_b32 v79, s67, v195
v_mul_f32 v78, v78, v77
v_mul_f32 v79, v79, v77
v_cvt_pk_bf16_f32 v195, v78, v79
v_lshlrev_b32 v78, 16, v204
v_and_b32 v79, s67, v204
v_mul_f32 v78, v78, v77
v_mul_f32 v79, v79, v77
v_cvt_pk_bf16_f32 v204, v78, v79
v_lshlrev_b32 v78, 16, v205
v_and_b32 v79, s67, v205
v_mul_f32 v78, v78, v77
v_mul_f32 v79, v79, v77
v_cvt_pk_bf16_f32 v205, v78, v79
v_lshlrev_b32 v78, 16, v206
v_and_b32 v79, s67, v206
v_mul_f32 v78, v78, v77
v_mul_f32 v79, v79, v77
v_cvt_pk_bf16_f32 v206, v78, v79
v_lshlrev_b32 v78, 16, v207
v_and_b32 v79, s67, v207
v_mul_f32 v78, v78, v77
v_mul_f32 v79, v79, v77
v_cvt_pk_bf16_f32 v207, v78, v79
v_lshlrev_b32 v78, 16, v216
v_and_b32 v79, s67, v216
v_mul_f32 v78, v78, v77
v_mul_f32 v79, v79, v77
v_cvt_pk_bf16_f32 v216, v78, v79
v_lshlrev_b32 v78, 16, v217
v_and_b32 v79, s67, v217
v_mul_f32 v78, v78, v77
v_mul_f32 v79, v79, v77
v_cvt_pk_bf16_f32 v217, v78, v79
v_lshlrev_b32 v78, 16, v218
v_and_b32 v79, s67, v218
v_mul_f32 v78, v78, v77
v_mul_f32 v79, v79, v77
v_cvt_pk_bf16_f32 v218, v78, v79
v_lshlrev_b32 v78, 16, v219
v_and_b32 v79, s67, v219
v_mul_f32 v78, v78, v77
v_mul_f32 v79, v79, v77
v_cvt_pk_bf16_f32 v219, v78, v79
v_lshlrev_b32 v78, 16, v228
v_and_b32 v79, s67, v228
v_mul_f32 v78, v78, v77
v_mul_f32 v79, v79, v77
v_cvt_pk_bf16_f32 v228, v78, v79
v_lshlrev_b32 v78, 16, v229
v_and_b32 v79, s67, v229
v_mul_f32 v78, v78, v77
v_mul_f32 v79, v79, v77
v_cvt_pk_bf16_f32 v229, v78, v79
v_lshlrev_b32 v78, 16, v230
v_and_b32 v79, s67, v230
v_mul_f32 v78, v78, v77
v_mul_f32 v79, v79, v77
v_cvt_pk_bf16_f32 v230, v78, v79
v_lshlrev_b32 v78, 16, v231
v_and_b32 v79, s67, v231
v_mul_f32 v78, v78, v77
v_mul_f32 v79, v79, v77
v_cvt_pk_bf16_f32 v231, v78, v79
v_lshlrev_b32 v78, 16, v240
v_and_b32 v79, s67, v240
v_mul_f32 v78, v78, v77
v_mul_f32 v79, v79, v77
v_cvt_pk_bf16_f32 v240, v78, v79
v_lshlrev_b32 v78, 16, v241
v_and_b32 v79, s67, v241
v_mul_f32 v78, v78, v77
v_mul_f32 v79, v79, v77
v_cvt_pk_bf16_f32 v241, v78, v79
v_lshlrev_b32 v78, 16, v242
v_and_b32 v79, s67, v242
v_mul_f32 v78, v78, v77
v_mul_f32 v79, v79, v77
v_cvt_pk_bf16_f32 v242, v78, v79
v_lshlrev_b32 v78, 16, v243
v_and_b32 v79, s67, v243
v_mul_f32 v78, v78, v77
v_mul_f32 v79, v79, v77
v_cvt_pk_bf16_f32 v243, v78, v79
v_lshlrev_b32 v78, 16, v252
v_and_b32 v79, s67, v252
v_mul_f32 v78, v78, v77
v_mul_f32 v79, v79, v77
v_cvt_pk_bf16_f32 v252, v78, v79
v_lshlrev_b32 v78, 16, v253
v_and_b32 v79, s67, v253
v_mul_f32 v78, v78, v77
v_mul_f32 v79, v79, v77
v_cvt_pk_bf16_f32 v253, v78, v79
v_lshlrev_b32 v78, 16, v254
v_and_b32 v79, s67, v254
v_mul_f32 v78, v78, v77
v_mul_f32 v79, v79, v77
v_cvt_pk_bf16_f32 v254, v78, v79
v_lshlrev_b32 v78, 16, v255
v_and_b32 v79, s67, v255
v_mul_f32 v78, v78, v77
v_mul_f32 v79, v79, v77
v_cvt_pk_bf16_f32 v255, v78, v79
v_accvgpr_read_b32 v78, a240
v_mul_f32 v78, v78, v77
v_accvgpr_write_b32 a240, v78
v_accvgpr_read_b32 v78, a241
v_mul_f32 v78, v78, v77
v_accvgpr_write_b32 a241, v78
v_accvgpr_read_b32 v78, a242
v_mul_f32 v78, v78, v77
v_accvgpr_write_b32 a242, v78
v_accvgpr_read_b32 v78, a243
v_mul_f32 v78, v78, v77
v_accvgpr_write_b32 a243, v78
s_nop 1
s_setpc_b64 s[94:95]
L_resc_1:
s_nop 7
s_nop 1
s_mov_b32 s67, 0xffff0000
v_max3_f32 v76, v40, v41, v42
v_max3_f32 v76, v76, v43, v44
v_max3_f32 v76, v76, v45, v46
v_max3_f32 v76, v76, v47, 0
v_mov_b32 v77, v76
s_nop 1
v_permlane32_swap_b32 v76, v77
v_max_f32 v76, v76, v77
v_mov_b32 v77, v76
s_nop 1
v_permlane16_swap_b32 v76, v77
v_max_f32 v76, v76, v77
v_ceil_f32 v76, v76
v_sub_f32 v77, 0, v76
v_max_f32 v77, 0xc3480000, v77
v_cvt_i32_f32 v77, v77
v_ldexp_f32 v77, 1.0, v77
v_sub_f32 v40, v40, v76
v_sub_f32 v41, v41, v76
v_sub_f32 v42, v42, v76
v_sub_f32 v43, v43, v76
v_sub_f32 v44, v44, v76
v_sub_f32 v45, v45, v76
v_sub_f32 v46, v46, v76
v_sub_f32 v47, v47, v76
v_sub_f32 v64, v64, v76
v_sub_f32 v65, v65, v76
v_sub_f32 v66, v66, v76
v_sub_f32 v67, v67, v76
v_sub_f32 v16, v16, v76
v_sub_f32 v17, v17, v76
v_sub_f32 v18, v18, v76
v_sub_f32 v19, v19, v76
v_lshlrev_b32 v78, 16, v88
v_and_b32 v79, s67, v88
v_mul_f32 v78, v78, v77
v_mul_f32 v79, v79, v77
v_cvt_pk_bf16_f32 v88, v78, v79
v_lshlrev_b32 v78, 16, v89
v_and_b32 v79, s67, v89
v_mul_f32 v78, v78, v77
v_mul_f32 v79, v79, v77
v_cvt_pk_bf16_f32 v89, v78, v79
v_lshlrev_b32 v78, 16, v90
v_and_b32 v79, s67, v90
v_mul_f32 v78, v78, v77
v_mul_f32 v79, v79, v77
v_cvt_pk_bf16_f32 v90, v78, v79
v_lshlrev_b32 v78, 16, v91
v_and_b32 v79, s67, v91
v_mul_f32 v78, v78, v77
v_mul_f32 v79, v79, v77
v_cvt_pk_bf16_f32 v91, v78, v79
v_lshlrev_b32 v78, 16, v100
v_and_b32 v79, s67, v100
v_mul_f32 v78, v78, v77
v_mul_f32 v79, v79, v77
v_cvt_pk_bf16_f32 v100, v78, v79
v_lshlrev_b32 v78, 16, v101
v_and_b32 v79, s67, v101
v_mul_f32 v78, v78, v77
v_mul_f32 v79, v79, v77
v_cvt_pk_bf16_f32 v101, v78, v79
v_lshlrev_b32 v78, 16, v102
v_and_b32 v79, s67, v102
v_mul_f32 v78, v78, v77
v_mul_f32 v79, v79, v77
v_cvt_pk_bf16_f32 v102, v78, v79
v_lshlrev_b32 v78, 16, v103
v_and_b32 v79, s67, v103
v_mul_f32 v78, v78, v77
v_mul_f32 v79, v79, v77
v_cvt_pk_bf16_f32 v103, v78, v79
v_lshlrev_b32 v78, 16, v112
v_and_b32 v79, s67, v112
v_mul_f32 v78, v78, v77
v_mul_f32 v79, v79, v77
v_cvt_pk_bf16_f32 v112, v78, v79
v_lshlrev_b32 v78, 16, v113
v_and_b32 v79, s67, v113
v_mul_f32 v78, v78, v77
v_mul_f32 v79, v79, v77
v_cvt_pk_bf16_f32 v113, v78, v79
v_lshlrev_b32 v78, 16, v114
v_and_b32 v79, s67, v114
v_mul_f32 v78, v78, v77
v_mul_f32 v79, v79, v77
v_cvt_pk_bf16_f32 v114, v78, v79
v_lshlrev_b32 v78, 16, v115
v_and_b32 v79, s67, v115
v_mul_f32 v78, v78, v77
v_mul_f32 v79, v79, v77
v_cvt_pk_bf16_f32 v115, v78, v79
v_lshlrev_b32 v78, 16, v124
v_and_b32 v79, s67, v124
v_mul_f32 v78, v78, v77
v_mul_f32 v79, v79, v77
v_cvt_pk_bf16_f32 v124, v78, v79
v_lshlrev_b32 v78, 16, v125
v_and_b32 v79, s67, v125
v_mul_f32 v78, v78, v77
v_mul_f32 v79, v79, v77
v_cvt_pk_bf16_f32 v125, v78, v79
v_lshlrev_b32 v78, 16, v126
v_and_b32 v79, s67, v126
v_mul_f32 v78, v78, v77
v_mul_f32 v79, v79, v77
v_cvt_pk_bf16_f32 v126, v78, v79
v_lshlrev_b32 v78, 16, v127
v_and_b32 v79, s67, v127
v_mul_f32 v78, v78, v77
v_mul_f32 v79, v79, v77
v_cvt_pk_bf16_f32 v127, v78, v79
v_lshlrev_b32 v78, 16, v136
v_and_b32 v79, s67, v136
v_mul_f32 v78, v78, v77
v_mul_f32 v79, v79, v77
v_cvt_pk_bf16_f32 v136, v78, v79
v_lshlrev_b32 v78, 16, v137
v_and_b32 v79, s67, v137
v_mul_f32 v78, v78, v77
v_mul_f32 v79, v79, v77
v_cvt_pk_bf16_f32 v137, v78, v79
v_lshlrev_b32 v78, 16, v138
v_and_b32 v79, s67, v138
v_mul_f32 v78, v78, v77
v_mul_f32 v79, v79, v77
v_cvt_pk_bf16_f32 v138, v78, v79
v_lshlrev_b32 v78, 16, v139
v_and_b32 v79, s67, v139
v_mul_f32 v78, v78, v77
v_mul_f32 v79, v79, v77
v_cvt_pk_bf16_f32 v139, v78, v79
v_lshlrev_b32 v78, 16, v148
v_and_b32 v79, s67, v148
v_mul_f32 v78, v78, v77
v_mul_f32 v79, v79, v77
v_cvt_pk_bf16_f32 v148, v78, v79
v_lshlrev_b32 v78, 16, v149
v_and_b32 v79, s67, v149
v_mul_f32 v78, v78, v77
v_mul_f32 v79, v79, v77
v_cvt_pk_bf16_f32 v149, v78, v79
v_lshlrev_b32 v78, 16, v150
v_and_b32 v79, s67, v150
v_mul_f32 v78, v78, v77
v_mul_f32 v79, v79, v77
v_cvt_pk_bf16_f32 v150, v78, v79
v_lshlrev_b32 v78, 16, v151
v_and_b32 v79, s67, v151
v_mul_f32 v78, v78, v77
v_mul_f32 v79, v79, v77
v_cvt_pk_bf16_f32 v151, v78, v79
v_lshlrev_b32 v78, 16, v160
v_and_b32 v79, s67, v160
v_mul_f32 v78, v78, v77
v_mul_f32 v79, v79, v77
v_cvt_pk_bf16_f32 v160, v78, v79
v_lshlrev_b32 v78, 16, v161
v_and_b32 v79, s67, v161
v_mul_f32 v78, v78, v77
v_mul_f32 v79, v79, v77
v_cvt_pk_bf16_f32 v161, v78, v79
v_lshlrev_b32 v78, 16, v162
v_and_b32 v79, s67, v162
v_mul_f32 v78, v78, v77
v_mul_f32 v79, v79, v77
v_cvt_pk_bf16_f32 v162, v78, v79
v_lshlrev_b32 v78, 16, v163
v_and_b32 v79, s67, v163
v_mul_f32 v78, v78, v77
v_mul_f32 v79, v79, v77
v_cvt_pk_bf16_f32 v163, v78, v79
v_lshlrev_b32 v78, 16, v172
v_and_b32 v79, s67, v172
v_mul_f32 v78, v78, v77
v_mul_f32 v79, v79, v77
v_cvt_pk_bf16_f32 v172, v78, v79
v_lshlrev_b32 v78, 16, v173
v_and_b32 v79, s67, v173
v_mul_f32 v78, v78, v77
v_mul_f32 v79, v79, v77
v_cvt_pk_bf16_f32 v173, v78, v79
v_lshlrev_b32 v78, 16, v174
v_and_b32 v79, s67, v174
v_mul_f32 v78, v78, v77
v_mul_f32 v79, v79, v77
v_cvt_pk_bf16_f32 v174, v78, v79
v_lshlrev_b32 v78, 16, v175
v_and_b32 v79, s67, v175
v_mul_f32 v78, v78, v77
v_mul_f32 v79, v79, v77
v_cvt_pk_bf16_f32 v175, v78, v79
v_lshlrev_b32 v78, 16, v184
v_and_b32 v79, s67, v184
v_mul_f32 v78, v78, v77
v_mul_f32 v79, v79, v77
v_cvt_pk_bf16_f32 v184, v78, v79
v_lshlrev_b32 v78, 16, v185
v_and_b32 v79, s67, v185
v_mul_f32 v78, v78, v77
v_mul_f32 v79, v79, v77
v_cvt_pk_bf16_f32 v185, v78, v79
v_lshlrev_b32 v78, 16, v186
v_and_b32 v79, s67, v186
v_mul_f32 v78, v78, v77
v_mul_f32 v79, v79, v77
v_cvt_pk_bf16_f32 v186, v78, v79
v_lshlrev_b32 v78, 16, v187
v_and_b32 v79, s67, v187
v_mul_f32 v78, v78, v77
v_mul_f32 v79, v79, v77
v_cvt_pk_bf16_f32 v187, v78, v79
v_lshlrev_b32 v78, 16, v196
v_and_b32 v79, s67, v196
v_mul_f32 v78, v78, v77
v_mul_f32 v79, v79, v77
v_cvt_pk_bf16_f32 v196, v78, v79
v_lshlrev_b32 v78, 16, v197
v_and_b32 v79, s67, v197
v_mul_f32 v78, v78, v77
v_mul_f32 v79, v79, v77
v_cvt_pk_bf16_f32 v197, v78, v79
v_lshlrev_b32 v78, 16, v198
v_and_b32 v79, s67, v198
v_mul_f32 v78, v78, v77
v_mul_f32 v79, v79, v77
v_cvt_pk_bf16_f32 v198, v78, v79
v_lshlrev_b32 v78, 16, v199
v_and_b32 v79, s67, v199
v_mul_f32 v78, v78, v77
v_mul_f32 v79, v79, v77
v_cvt_pk_bf16_f32 v199, v78, v79
v_lshlrev_b32 v78, 16, v208
v_and_b32 v79, s67, v208
v_mul_f32 v78, v78, v77
v_mul_f32 v79, v79, v77
v_cvt_pk_bf16_f32 v208, v78, v79
v_lshlrev_b32 v78, 16, v209
v_and_b32 v79, s67, v209
v_mul_f32 v78, v78, v77
v_mul_f32 v79, v79, v77
v_cvt_pk_bf16_f32 v209, v78, v79
v_lshlrev_b32 v78, 16, v210
v_and_b32 v79, s67, v210
v_mul_f32 v78, v78, v77
v_mul_f32 v79, v79, v77
v_cvt_pk_bf16_f32 v210, v78, v79
v_lshlrev_b32 v78, 16, v211
v_and_b32 v79, s67, v211
v_mul_f32 v78, v78, v77
v_mul_f32 v79, v79, v77
v_cvt_pk_bf16_f32 v211, v78, v79
v_lshlrev_b32 v78, 16, v220
v_and_b32 v79, s67, v220
v_mul_f32 v78, v78, v77
v_mul_f32 v79, v79, v77
v_cvt_pk_bf16_f32 v220, v78, v79
v_lshlrev_b32 v78, 16, v221
v_and_b32 v79, s67, v221
v_mul_f32 v78, v78, v77
v_mul_f32 v79, v79, v77
v_cvt_pk_bf16_f32 v221, v78, v79
v_lshlrev_b32 v78, 16, v222
v_and_b32 v79, s67, v222
v_mul_f32 v78, v78, v77
v_mul_f32 v79, v79, v77
v_cvt_pk_bf16_f32 v222, v78, v79
v_lshlrev_b32 v78, 16, v223
v_and_b32 v79, s67, v223
v_mul_f32 v78, v78, v77
v_mul_f32 v79, v79, v77
v_cvt_pk_bf16_f32 v223, v78, v79
v_lshlrev_b32 v78, 16, v232
v_and_b32 v79, s67, v232
v_mul_f32 v78, v78, v77
v_mul_f32 v79, v79, v77
v_cvt_pk_bf16_f32 v232, v78, v79
v_lshlrev_b32 v78, 16, v233
v_and_b32 v79, s67, v233
v_mul_f32 v78, v78, v77
v_mul_f32 v79, v79, v77
v_cvt_pk_bf16_f32 v233, v78, v79
v_lshlrev_b32 v78, 16, v234
v_and_b32 v79, s67, v234
v_mul_f32 v78, v78, v77
v_mul_f32 v79, v79, v77
v_cvt_pk_bf16_f32 v234, v78, v79
v_lshlrev_b32 v78, 16, v235
v_and_b32 v79, s67, v235
v_mul_f32 v78, v78, v77
v_mul_f32 v79, v79, v77
v_cvt_pk_bf16_f32 v235, v78, v79
v_lshlrev_b32 v78, 16, v244
v_and_b32 v79, s67, v244
v_mul_f32 v78, v78, v77
v_mul_f32 v79, v79, v77
v_cvt_pk_bf16_f32 v244, v78, v79
v_lshlrev_b32 v78, 16, v245
v_and_b32 v79, s67, v245
v_mul_f32 v78, v78, v77
v_mul_f32 v79, v79, v77
v_cvt_pk_bf16_f32 v245, v78, v79
v_lshlrev_b32 v78, 16, v246
v_and_b32 v79, s67, v246
v_mul_f32 v78, v78, v77
v_mul_f32 v79, v79, v77
v_cvt_pk_bf16_f32 v246, v78, v79
v_lshlrev_b32 v78, 16, v247
v_and_b32 v79, s67, v247
v_mul_f32 v78, v78, v77
v_mul_f32 v79, v79, v77
v_cvt_pk_bf16_f32 v247, v78, v79
v_accvgpr_read_b32 v78, a232
v_mul_f32 v78, v78, v77
v_accvgpr_write_b32 a232, v78
v_accvgpr_read_b32 v78, a233
v_mul_f32 v78, v78, v77
v_accvgpr_write_b32 a233, v78
v_accvgpr_read_b32 v78, a234
v_mul_f32 v78, v78, v77
v_accvgpr_write_b32 a234, v78
v_accvgpr_read_b32 v78, a235
v_mul_f32 v78, v78, v77
v_accvgpr_write_b32 a235, v78
v_max3_f32 v76, v48, v49, v50
v_max3_f32 v76, v76, v51, v52
v_max3_f32 v76, v76, v53, v54
v_max3_f32 v76, v76, v55, 0
v_mov_b32 v77, v76
s_nop 1
v_permlane32_swap_b32 v76, v77
v_max_f32 v76, v76, v77
v_mov_b32 v77, v76
s_nop 1
v_permlane16_swap_b32 v76, v77
v_max_f32 v76, v76, v77
v_ceil_f32 v76, v76
v_sub_f32 v77, 0, v76
v_max_f32 v77, 0xc3480000, v77
v_cvt_i32_f32 v77, v77
v_ldexp_f32 v77, 1.0, v77
v_sub_f32 v48, v48, v76
v_sub_f32 v49, v49, v76
v_sub_f32 v50, v50, v76
v_sub_f32 v51, v51, v76
v_sub_f32 v52, v52, v76
v_sub_f32 v53, v53, v76
v_sub_f32 v54, v54, v76
v_sub_f32 v55, v55, v76
v_sub_f32 v68, v68, v76
v_sub_f32 v69, v69, v76
v_sub_f32 v70, v70, v76
v_sub_f32 v71, v71, v76
v_sub_f32 v24, v24, v76
v_sub_f32 v25, v25, v76
v_sub_f32 v26, v26, v76
v_sub_f32 v27, v27, v76
v_lshlrev_b32 v78, 16, v92
v_and_b32 v79, s67, v92
v_mul_f32 v78, v78, v77
v_mul_f32 v79, v79, v77
v_cvt_pk_bf16_f32 v92, v78, v79
v_lshlrev_b32 v78, 16, v93
v_and_b32 v79, s67, v93
v_mul_f32 v78, v78, v77
v_mul_f32 v79, v79, v77
v_cvt_pk_bf16_f32 v93, v78, v79
v_lshlrev_b32 v78, 16, v94
v_and_b32 v79, s67, v94
v_mul_f32 v78, v78, v77
v_mul_f32 v79, v79, v77
v_cvt_pk_bf16_f32 v94, v78, v79
v_lshlrev_b32 v78, 16, v95
v_and_b32 v79, s67, v95
v_mul_f32 v78, v78, v77
v_mul_f32 v79, v79, v77
v_cvt_pk_bf16_f32 v95, v78, v79
v_lshlrev_b32 v78, 16, v104
v_and_b32 v79, s67, v104
v_mul_f32 v78, v78, v77
v_mul_f32 v79, v79, v77
v_cvt_pk_bf16_f32 v104, v78, v79
v_lshlrev_b32 v78, 16, v105
v_and_b32 v79, s67, v105
v_mul_f32 v78, v78, v77
v_mul_f32 v79, v79, v77
v_cvt_pk_bf16_f32 v105, v78, v79
v_lshlrev_b32 v78, 16, v106
v_and_b32 v79, s67, v106
v_mul_f32 v78, v78, v77
v_mul_f32 v79, v79, v77
v_cvt_pk_bf16_f32 v106, v78, v79
v_lshlrev_b32 v78, 16, v107
v_and_b32 v79, s67, v107
v_mul_f32 v78, v78, v77
v_mul_f32 v79, v79, v77
v_cvt_pk_bf16_f32 v107, v78, v79
v_lshlrev_b32 v78, 16, v116
v_and_b32 v79, s67, v116
v_mul_f32 v78, v78, v77
v_mul_f32 v79, v79, v77
v_cvt_pk_bf16_f32 v116, v78, v79
v_lshlrev_b32 v78, 16, v117
v_and_b32 v79, s67, v117
v_mul_f32 v78, v78, v77
v_mul_f32 v79, v79, v77
v_cvt_pk_bf16_f32 v117, v78, v79
v_lshlrev_b32 v78, 16, v118
v_and_b32 v79, s67, v118
v_mul_f32 v78, v78, v77
v_mul_f32 v79, v79, v77
v_cvt_pk_bf16_f32 v118, v78, v79
v_lshlrev_b32 v78, 16, v119
v_and_b32 v79, s67, v119
v_mul_f32 v78, v78, v77
v_mul_f32 v79, v79, v77
v_cvt_pk_bf16_f32 v119, v78, v79
v_lshlrev_b32 v78, 16, v128
v_and_b32 v79, s67, v128
v_mul_f32 v78, v78, v77
v_mul_f32 v79, v79, v77
v_cvt_pk_bf16_f32 v128, v78, v79
v_lshlrev_b32 v78, 16, v129
v_and_b32 v79, s67, v129
v_mul_f32 v78, v78, v77
v_mul_f32 v79, v79, v77
v_cvt_pk_bf16_f32 v129, v78, v79
v_lshlrev_b32 v78, 16, v130
v_and_b32 v79, s67, v130
v_mul_f32 v78, v78, v77
v_mul_f32 v79, v79, v77
v_cvt_pk_bf16_f32 v130, v78, v79
v_lshlrev_b32 v78, 16, v131
v_and_b32 v79, s67, v131
v_mul_f32 v78, v78, v77
v_mul_f32 v79, v79, v77
v_cvt_pk_bf16_f32 v131, v78, v79
v_lshlrev_b32 v78, 16, v140
v_and_b32 v79, s67, v140
v_mul_f32 v78, v78, v77
v_mul_f32 v79, v79, v77
v_cvt_pk_bf16_f32 v140, v78, v79
v_lshlrev_b32 v78, 16, v141
v_and_b32 v79, s67, v141
v_mul_f32 v78, v78, v77
v_mul_f32 v79, v79, v77
v_cvt_pk_bf16_f32 v141, v78, v79
v_lshlrev_b32 v78, 16, v142
v_and_b32 v79, s67, v142
v_mul_f32 v78, v78, v77
v_mul_f32 v79, v79, v77
v_cvt_pk_bf16_f32 v142, v78, v79
v_lshlrev_b32 v78, 16, v143
v_and_b32 v79, s67, v143
v_mul_f32 v78, v78, v77
v_mul_f32 v79, v79, v77
v_cvt_pk_bf16_f32 v143, v78, v79
v_lshlrev_b32 v78, 16, v152
v_and_b32 v79, s67, v152
v_mul_f32 v78, v78, v77
v_mul_f32 v79, v79, v77
v_cvt_pk_bf16_f32 v152, v78, v79
v_lshlrev_b32 v78, 16, v153
v_and_b32 v79, s67, v153
v_mul_f32 v78, v78, v77
v_mul_f32 v79, v79, v77
v_cvt_pk_bf16_f32 v153, v78, v79
v_lshlrev_b32 v78, 16, v154
v_and_b32 v79, s67, v154
v_mul_f32 v78, v78, v77
v_mul_f32 v79, v79, v77
v_cvt_pk_bf16_f32 v154, v78, v79
v_lshlrev_b32 v78, 16, v155
v_and_b32 v79, s67, v155
v_mul_f32 v78, v78, v77
v_mul_f32 v79, v79, v77
v_cvt_pk_bf16_f32 v155, v78, v79
v_lshlrev_b32 v78, 16, v164
v_and_b32 v79, s67, v164
v_mul_f32 v78, v78, v77
v_mul_f32 v79, v79, v77
v_cvt_pk_bf16_f32 v164, v78, v79
v_lshlrev_b32 v78, 16, v165
v_and_b32 v79, s67, v165
v_mul_f32 v78, v78, v77
v_mul_f32 v79, v79, v77
v_cvt_pk_bf16_f32 v165, v78, v79
v_lshlrev_b32 v78, 16, v166
v_and_b32 v79, s67, v166
v_mul_f32 v78, v78, v77
v_mul_f32 v79, v79, v77
v_cvt_pk_bf16_f32 v166, v78, v79
v_lshlrev_b32 v78, 16, v167
v_and_b32 v79, s67, v167
v_mul_f32 v78, v78, v77
v_mul_f32 v79, v79, v77
v_cvt_pk_bf16_f32 v167, v78, v79
v_lshlrev_b32 v78, 16, v176
v_and_b32 v79, s67, v176
v_mul_f32 v78, v78, v77
v_mul_f32 v79, v79, v77
v_cvt_pk_bf16_f32 v176, v78, v79
v_lshlrev_b32 v78, 16, v177
v_and_b32 v79, s67, v177
v_mul_f32 v78, v78, v77
v_mul_f32 v79, v79, v77
v_cvt_pk_bf16_f32 v177, v78, v79
v_lshlrev_b32 v78, 16, v178
v_and_b32 v79, s67, v178
v_mul_f32 v78, v78, v77
v_mul_f32 v79, v79, v77
v_cvt_pk_bf16_f32 v178, v78, v79
v_lshlrev_b32 v78, 16, v179
v_and_b32 v79, s67, v179
v_mul_f32 v78, v78, v77
v_mul_f32 v79, v79, v77
v_cvt_pk_bf16_f32 v179, v78, v79
v_lshlrev_b32 v78, 16, v188
v_and_b32 v79, s67, v188
v_mul_f32 v78, v78, v77
v_mul_f32 v79, v79, v77
v_cvt_pk_bf16_f32 v188, v78, v79
v_lshlrev_b32 v78, 16, v189
v_and_b32 v79, s67, v189
v_mul_f32 v78, v78, v77
v_mul_f32 v79, v79, v77
v_cvt_pk_bf16_f32 v189, v78, v79
v_lshlrev_b32 v78, 16, v190
v_and_b32 v79, s67, v190
v_mul_f32 v78, v78, v77
v_mul_f32 v79, v79, v77
v_cvt_pk_bf16_f32 v190, v78, v79
v_lshlrev_b32 v78, 16, v191
v_and_b32 v79, s67, v191
v_mul_f32 v78, v78, v77
v_mul_f32 v79, v79, v77
v_cvt_pk_bf16_f32 v191, v78, v79
v_lshlrev_b32 v78, 16, v200
v_and_b32 v79, s67, v200
v_mul_f32 v78, v78, v77
v_mul_f32 v79, v79, v77
v_cvt_pk_bf16_f32 v200, v78, v79
v_lshlrev_b32 v78, 16, v201
v_and_b32 v79, s67, v201
v_mul_f32 v78, v78, v77
v_mul_f32 v79, v79, v77
v_cvt_pk_bf16_f32 v201, v78, v79
v_lshlrev_b32 v78, 16, v202
v_and_b32 v79, s67, v202
v_mul_f32 v78, v78, v77
v_mul_f32 v79, v79, v77
v_cvt_pk_bf16_f32 v202, v78, v79
v_lshlrev_b32 v78, 16, v203
v_and_b32 v79, s67, v203
v_mul_f32 v78, v78, v77
v_mul_f32 v79, v79, v77
v_cvt_pk_bf16_f32 v203, v78, v79
v_lshlrev_b32 v78, 16, v212
v_and_b32 v79, s67, v212
v_mul_f32 v78, v78, v77
v_mul_f32 v79, v79, v77
v_cvt_pk_bf16_f32 v212, v78, v79
v_lshlrev_b32 v78, 16, v213
v_and_b32 v79, s67, v213
v_mul_f32 v78, v78, v77
v_mul_f32 v79, v79, v77
v_cvt_pk_bf16_f32 v213, v78, v79
v_lshlrev_b32 v78, 16, v214
v_and_b32 v79, s67, v214
v_mul_f32 v78, v78, v77
v_mul_f32 v79, v79, v77
v_cvt_pk_bf16_f32 v214, v78, v79
v_lshlrev_b32 v78, 16, v215
v_and_b32 v79, s67, v215
v_mul_f32 v78, v78, v77
v_mul_f32 v79, v79, v77
v_cvt_pk_bf16_f32 v215, v78, v79
v_lshlrev_b32 v78, 16, v224
v_and_b32 v79, s67, v224
v_mul_f32 v78, v78, v77
v_mul_f32 v79, v79, v77
v_cvt_pk_bf16_f32 v224, v78, v79
v_lshlrev_b32 v78, 16, v225
v_and_b32 v79, s67, v225
v_mul_f32 v78, v78, v77
v_mul_f32 v79, v79, v77
v_cvt_pk_bf16_f32 v225, v78, v79
v_lshlrev_b32 v78, 16, v226
v_and_b32 v79, s67, v226
v_mul_f32 v78, v78, v77
v_mul_f32 v79, v79, v77
v_cvt_pk_bf16_f32 v226, v78, v79
v_lshlrev_b32 v78, 16, v227
v_and_b32 v79, s67, v227
v_mul_f32 v78, v78, v77
v_mul_f32 v79, v79, v77
v_cvt_pk_bf16_f32 v227, v78, v79
v_lshlrev_b32 v78, 16, v236
v_and_b32 v79, s67, v236
v_mul_f32 v78, v78, v77
v_mul_f32 v79, v79, v77
v_cvt_pk_bf16_f32 v236, v78, v79
v_lshlrev_b32 v78, 16, v237
v_and_b32 v79, s67, v237
v_mul_f32 v78, v78, v77
v_mul_f32 v79, v79, v77
v_cvt_pk_bf16_f32 v237, v78, v79
v_lshlrev_b32 v78, 16, v238
v_and_b32 v79, s67, v238
v_mul_f32 v78, v78, v77
v_mul_f32 v79, v79, v77
v_cvt_pk_bf16_f32 v238, v78, v79
v_lshlrev_b32 v78, 16, v239
v_and_b32 v79, s67, v239
v_mul_f32 v78, v78, v77
v_mul_f32 v79, v79, v77
v_cvt_pk_bf16_f32 v239, v78, v79
v_lshlrev_b32 v78, 16, v248
v_and_b32 v79, s67, v248
v_mul_f32 v78, v78, v77
v_mul_f32 v79, v79, v77
v_cvt_pk_bf16_f32 v248, v78, v79
v_lshlrev_b32 v78, 16, v249
v_and_b32 v79, s67, v249
v_mul_f32 v78, v78, v77
v_mul_f32 v79, v79, v77
v_cvt_pk_bf16_f32 v249, v78, v79
v_lshlrev_b32 v78, 16, v250
v_and_b32 v79, s67, v250
v_mul_f32 v78, v78, v77
v_mul_f32 v79, v79, v77
v_cvt_pk_bf16_f32 v250, v78, v79
v_lshlrev_b32 v78, 16, v251
v_and_b32 v79, s67, v251
v_mul_f32 v78, v78, v77
v_mul_f32 v79, v79, v77
v_cvt_pk_bf16_f32 v251, v78, v79
v_accvgpr_read_b32 v78, a236
v_mul_f32 v78, v78, v77
v_accvgpr_write_b32 a236, v78
v_accvgpr_read_b32 v78, a237
v_mul_f32 v78, v78, v77
v_accvgpr_write_b32 a237, v78
v_accvgpr_read_b32 v78, a238
v_mul_f32 v78, v78, v77
v_accvgpr_write_b32 a238, v78
v_accvgpr_read_b32 v78, a239
v_mul_f32 v78, v78, v77
v_accvgpr_write_b32 a239, v78
v_max3_f32 v76, v56, v57, v58
v_max3_f32 v76, v76, v59, v60
v_max3_f32 v76, v76, v61, v62
v_max3_f32 v76, v76, v63, 0
v_mov_b32 v77, v76
s_nop 1
v_permlane32_swap_b32 v76, v77
v_max_f32 v76, v76, v77
v_mov_b32 v77, v76
s_nop 1
v_permlane16_swap_b32 v76, v77
v_max_f32 v76, v76, v77
v_ceil_f32 v76, v76
v_sub_f32 v77, 0, v76
v_max_f32 v77, 0xc3480000, v77
v_cvt_i32_f32 v77, v77
v_ldexp_f32 v77, 1.0, v77
v_sub_f32 v56, v56, v76
v_sub_f32 v57, v57, v76
v_sub_f32 v58, v58, v76
v_sub_f32 v59, v59, v76
v_sub_f32 v60, v60, v76
v_sub_f32 v61, v61, v76
v_sub_f32 v62, v62, v76
v_sub_f32 v63, v63, v76
v_sub_f32 v72, v72, v76
v_sub_f32 v73, v73, v76
v_sub_f32 v74, v74, v76
v_sub_f32 v75, v75, v76
v_sub_f32 v32, v32, v76
v_sub_f32 v33, v33, v76
v_sub_f32 v34, v34, v76
v_sub_f32 v35, v35, v76
v_lshlrev_b32 v78, 16, v96
v_and_b32 v79, s67, v96
v_mul_f32 v78, v78, v77
v_mul_f32 v79, v79, v77
v_cvt_pk_bf16_f32 v96, v78, v79
v_lshlrev_b32 v78, 16, v97
v_and_b32 v79, s67, v97
v_mul_f32 v78, v78, v77
v_mul_f32 v79, v79, v77
v_cvt_pk_bf16_f32 v97, v78, v79
v_lshlrev_b32 v78, 16, v98
v_and_b32 v79, s67, v98
v_mul_f32 v78, v78, v77
v_mul_f32 v79, v79, v77
v_cvt_pk_bf16_f32 v98, v78, v79
v_lshlrev_b32 v78, 16, v99
v_and_b32 v79, s67, v99
v_mul_f32 v78, v78, v77
v_mul_f32 v79, v79, v77
v_cvt_pk_bf16_f32 v99, v78, v79
v_lshlrev_b32 v78, 16, v108
v_and_b32 v79, s67, v108
v_mul_f32 v78, v78, v77
v_mul_f32 v79, v79, v77
v_cvt_pk_bf16_f32 v108, v78, v79
v_lshlrev_b32 v78, 16, v109
v_and_b32 v79, s67, v109
v_mul_f32 v78, v78, v77
v_mul_f32 v79, v79, v77
v_cvt_pk_bf16_f32 v109, v78, v79
v_lshlrev_b32 v78, 16, v110
v_and_b32 v79, s67, v110
v_mul_f32 v78, v78, v77
v_mul_f32 v79, v79, v77
v_cvt_pk_bf16_f32 v110, v78, v79
v_lshlrev_b32 v78, 16, v111
v_and_b32 v79, s67, v111
v_mul_f32 v78, v78, v77
v_mul_f32 v79, v79, v77
v_cvt_pk_bf16_f32 v111, v78, v79
v_lshlrev_b32 v78, 16, v120
v_and_b32 v79, s67, v120
v_mul_f32 v78, v78, v77
v_mul_f32 v79, v79, v77
v_cvt_pk_bf16_f32 v120, v78, v79
v_lshlrev_b32 v78, 16, v121
v_and_b32 v79, s67, v121
v_mul_f32 v78, v78, v77
v_mul_f32 v79, v79, v77
v_cvt_pk_bf16_f32 v121, v78, v79
v_lshlrev_b32 v78, 16, v122
v_and_b32 v79, s67, v122
v_mul_f32 v78, v78, v77
v_mul_f32 v79, v79, v77
v_cvt_pk_bf16_f32 v122, v78, v79
v_lshlrev_b32 v78, 16, v123
v_and_b32 v79, s67, v123
v_mul_f32 v78, v78, v77
v_mul_f32 v79, v79, v77
v_cvt_pk_bf16_f32 v123, v78, v79
v_lshlrev_b32 v78, 16, v132
v_and_b32 v79, s67, v132
v_mul_f32 v78, v78, v77
v_mul_f32 v79, v79, v77
v_cvt_pk_bf16_f32 v132, v78, v79
v_lshlrev_b32 v78, 16, v133
v_and_b32 v79, s67, v133
v_mul_f32 v78, v78, v77
v_mul_f32 v79, v79, v77
v_cvt_pk_bf16_f32 v133, v78, v79
v_lshlrev_b32 v78, 16, v134
v_and_b32 v79, s67, v134
v_mul_f32 v78, v78, v77
v_mul_f32 v79, v79, v77
v_cvt_pk_bf16_f32 v134, v78, v79
v_lshlrev_b32 v78, 16, v135
v_and_b32 v79, s67, v135
v_mul_f32 v78, v78, v77
v_mul_f32 v79, v79, v77
v_cvt_pk_bf16_f32 v135, v78, v79
v_lshlrev_b32 v78, 16, v144
v_and_b32 v79, s67, v144
v_mul_f32 v78, v78, v77
v_mul_f32 v79, v79, v77
v_cvt_pk_bf16_f32 v144, v78, v79
v_lshlrev_b32 v78, 16, v145
v_and_b32 v79, s67, v145
v_mul_f32 v78, v78, v77
v_mul_f32 v79, v79, v77
v_cvt_pk_bf16_f32 v145, v78, v79
v_lshlrev_b32 v78, 16, v146
v_and_b32 v79, s67, v146
v_mul_f32 v78, v78, v77
v_mul_f32 v79, v79, v77
v_cvt_pk_bf16_f32 v146, v78, v79
v_lshlrev_b32 v78, 16, v147
v_and_b32 v79, s67, v147
v_mul_f32 v78, v78, v77
v_mul_f32 v79, v79, v77
v_cvt_pk_bf16_f32 v147, v78, v79
v_lshlrev_b32 v78, 16, v156
v_and_b32 v79, s67, v156
v_mul_f32 v78, v78, v77
v_mul_f32 v79, v79, v77
v_cvt_pk_bf16_f32 v156, v78, v79
v_lshlrev_b32 v78, 16, v157
v_and_b32 v79, s67, v157
v_mul_f32 v78, v78, v77
v_mul_f32 v79, v79, v77
v_cvt_pk_bf16_f32 v157, v78, v79
v_lshlrev_b32 v78, 16, v158
v_and_b32 v79, s67, v158
v_mul_f32 v78, v78, v77
v_mul_f32 v79, v79, v77
v_cvt_pk_bf16_f32 v158, v78, v79
v_lshlrev_b32 v78, 16, v159
v_and_b32 v79, s67, v159
v_mul_f32 v78, v78, v77
v_mul_f32 v79, v79, v77
v_cvt_pk_bf16_f32 v159, v78, v79
v_lshlrev_b32 v78, 16, v168
v_and_b32 v79, s67, v168
v_mul_f32 v78, v78, v77
v_mul_f32 v79, v79, v77
v_cvt_pk_bf16_f32 v168, v78, v79
v_lshlrev_b32 v78, 16, v169
v_and_b32 v79, s67, v169
v_mul_f32 v78, v78, v77
v_mul_f32 v79, v79, v77
v_cvt_pk_bf16_f32 v169, v78, v79
v_lshlrev_b32 v78, 16, v170
v_and_b32 v79, s67, v170
v_mul_f32 v78, v78, v77
v_mul_f32 v79, v79, v77
v_cvt_pk_bf16_f32 v170, v78, v79
v_lshlrev_b32 v78, 16, v171
v_and_b32 v79, s67, v171
v_mul_f32 v78, v78, v77
v_mul_f32 v79, v79, v77
v_cvt_pk_bf16_f32 v171, v78, v79
v_lshlrev_b32 v78, 16, v180
v_and_b32 v79, s67, v180
v_mul_f32 v78, v78, v77
v_mul_f32 v79, v79, v77
v_cvt_pk_bf16_f32 v180, v78, v79
v_lshlrev_b32 v78, 16, v181
v_and_b32 v79, s67, v181
v_mul_f32 v78, v78, v77
v_mul_f32 v79, v79, v77
v_cvt_pk_bf16_f32 v181, v78, v79
v_lshlrev_b32 v78, 16, v182
v_and_b32 v79, s67, v182
v_mul_f32 v78, v78, v77
v_mul_f32 v79, v79, v77
v_cvt_pk_bf16_f32 v182, v78, v79
v_lshlrev_b32 v78, 16, v183
v_and_b32 v79, s67, v183
v_mul_f32 v78, v78, v77
v_mul_f32 v79, v79, v77
v_cvt_pk_bf16_f32 v183, v78, v79
v_lshlrev_b32 v78, 16, v192
v_and_b32 v79, s67, v192
v_mul_f32 v78, v78, v77
v_mul_f32 v79, v79, v77
v_cvt_pk_bf16_f32 v192, v78, v79
v_lshlrev_b32 v78, 16, v193
v_and_b32 v79, s67, v193
v_mul_f32 v78, v78, v77
v_mul_f32 v79, v79, v77
v_cvt_pk_bf16_f32 v193, v78, v79
v_lshlrev_b32 v78, 16, v194
v_and_b32 v79, s67, v194
v_mul_f32 v78, v78, v77
v_mul_f32 v79, v79, v77
v_cvt_pk_bf16_f32 v194, v78, v79
v_lshlrev_b32 v78, 16, v195
v_and_b32 v79, s67, v195
v_mul_f32 v78, v78, v77
v_mul_f32 v79, v79, v77
v_cvt_pk_bf16_f32 v195, v78, v79
v_lshlrev_b32 v78, 16, v204
v_and_b32 v79, s67, v204
v_mul_f32 v78, v78, v77
v_mul_f32 v79, v79, v77
v_cvt_pk_bf16_f32 v204, v78, v79
v_lshlrev_b32 v78, 16, v205
v_and_b32 v79, s67, v205
v_mul_f32 v78, v78, v77
v_mul_f32 v79, v79, v77
v_cvt_pk_bf16_f32 v205, v78, v79
v_lshlrev_b32 v78, 16, v206
v_and_b32 v79, s67, v206
v_mul_f32 v78, v78, v77
v_mul_f32 v79, v79, v77
v_cvt_pk_bf16_f32 v206, v78, v79
v_lshlrev_b32 v78, 16, v207
v_and_b32 v79, s67, v207
v_mul_f32 v78, v78, v77
v_mul_f32 v79, v79, v77
v_cvt_pk_bf16_f32 v207, v78, v79
v_lshlrev_b32 v78, 16, v216
v_and_b32 v79, s67, v216
v_mul_f32 v78, v78, v77
v_mul_f32 v79, v79, v77
v_cvt_pk_bf16_f32 v216, v78, v79
v_lshlrev_b32 v78, 16, v217
v_and_b32 v79, s67, v217
v_mul_f32 v78, v78, v77
v_mul_f32 v79, v79, v77
v_cvt_pk_bf16_f32 v217, v78, v79
v_lshlrev_b32 v78, 16, v218
v_and_b32 v79, s67, v218
v_mul_f32 v78, v78, v77
v_mul_f32 v79, v79, v77
v_cvt_pk_bf16_f32 v218, v78, v79
v_lshlrev_b32 v78, 16, v219
v_and_b32 v79, s67, v219
v_mul_f32 v78, v78, v77
v_mul_f32 v79, v79, v77
v_cvt_pk_bf16_f32 v219, v78, v79
v_lshlrev_b32 v78, 16, v228
v_and_b32 v79, s67, v228
v_mul_f32 v78, v78, v77
v_mul_f32 v79, v79, v77
v_cvt_pk_bf16_f32 v228, v78, v79
v_lshlrev_b32 v78, 16, v229
v_and_b32 v79, s67, v229
v_mul_f32 v78, v78, v77
v_mul_f32 v79, v79, v77
v_cvt_pk_bf16_f32 v229, v78, v79
v_lshlrev_b32 v78, 16, v230
v_and_b32 v79, s67, v230
v_mul_f32 v78, v78, v77
v_mul_f32 v79, v79, v77
v_cvt_pk_bf16_f32 v230, v78, v79
v_lshlrev_b32 v78, 16, v231
v_and_b32 v79, s67, v231
v_mul_f32 v78, v78, v77
v_mul_f32 v79, v79, v77
v_cvt_pk_bf16_f32 v231, v78, v79
v_lshlrev_b32 v78, 16, v240
v_and_b32 v79, s67, v240
v_mul_f32 v78, v78, v77
v_mul_f32 v79, v79, v77
v_cvt_pk_bf16_f32 v240, v78, v79
v_lshlrev_b32 v78, 16, v241
v_and_b32 v79, s67, v241
v_mul_f32 v78, v78, v77
v_mul_f32 v79, v79, v77
v_cvt_pk_bf16_f32 v241, v78, v79
v_lshlrev_b32 v78, 16, v242
v_and_b32 v79, s67, v242
v_mul_f32 v78, v78, v77
v_mul_f32 v79, v79, v77
v_cvt_pk_bf16_f32 v242, v78, v79
v_lshlrev_b32 v78, 16, v243
v_and_b32 v79, s67, v243
v_mul_f32 v78, v78, v77
v_mul_f32 v79, v79, v77
v_cvt_pk_bf16_f32 v243, v78, v79
v_lshlrev_b32 v78, 16, v252
v_and_b32 v79, s67, v252
v_mul_f32 v78, v78, v77
v_mul_f32 v79, v79, v77
v_cvt_pk_bf16_f32 v252, v78, v79
v_lshlrev_b32 v78, 16, v253
v_and_b32 v79, s67, v253
v_mul_f32 v78, v78, v77
v_mul_f32 v79, v79, v77
v_cvt_pk_bf16_f32 v253, v78, v79
v_lshlrev_b32 v78, 16, v254
v_and_b32 v79, s67, v254
v_mul_f32 v78, v78, v77
v_mul_f32 v79, v79, v77
v_cvt_pk_bf16_f32 v254, v78, v79
v_lshlrev_b32 v78, 16, v255
v_and_b32 v79, s67, v255
v_mul_f32 v78, v78, v77
v_mul_f32 v79, v79, v77
v_cvt_pk_bf16_f32 v255, v78, v79
v_accvgpr_read_b32 v78, a240
v_mul_f32 v78, v78, v77
v_accvgpr_write_b32 a240, v78
v_accvgpr_read_b32 v78, a241
v_mul_f32 v78, v78, v77
v_accvgpr_write_b32 a241, v78
v_accvgpr_read_b32 v78, a242
v_mul_f32 v78, v78, v77
v_accvgpr_write_b32 a242, v78
v_accvgpr_read_b32 v78, a243
v_mul_f32 v78, v78, v77
v_accvgpr_write_b32 a243, v78
s_nop 1
s_setpc_b64 s[94:95]
L_resc_last:
s_nop 7
s_nop 1
s_mov_b32 s67, 0xffff0000
v_max3_f32 v76, v40, v41, v42
v_max3_f32 v76, v76, v43, v44
v_max3_f32 v76, v76, v45, v46
v_max3_f32 v76, v76, v47, 0
v_mov_b32 v77, v76
s_nop 1
v_permlane32_swap_b32 v76, v77
v_max_f32 v76, v76, v77
v_mov_b32 v77, v76
s_nop 1
v_permlane16_swap_b32 v76, v77
v_max_f32 v76, v76, v77
v_ceil_f32 v76, v76
v_sub_f32 v77, 0, v76
v_max_f32 v77, 0xc3480000, v77
v_cvt_i32_f32 v77, v77
v_ldexp_f32 v77, 1.0, v77
v_sub_f32 v40, v40, v76
v_sub_f32 v41, v41, v76
v_sub_f32 v42, v42, v76
v_sub_f32 v43, v43, v76
v_sub_f32 v44, v44, v76
v_sub_f32 v45, v45, v76
v_sub_f32 v46, v46, v76
v_sub_f32 v47, v47, v76
v_sub_f32 v64, v64, v76
v_sub_f32 v65, v65, v76
v_sub_f32 v66, v66, v76
v_sub_f32 v67, v67, v76
v_lshlrev_b32 v78, 16, v88
v_and_b32 v79, s67, v88
v_mul_f32 v78, v78, v77
v_mul_f32 v79, v79, v77
v_cvt_pk_bf16_f32 v88, v78, v79
v_lshlrev_b32 v78, 16, v89
v_and_b32 v79, s67, v89
v_mul_f32 v78, v78, v77
v_mul_f32 v79, v79, v77
v_cvt_pk_bf16_f32 v89, v78, v79
v_lshlrev_b32 v78, 16, v90
v_and_b32 v79, s67, v90
v_mul_f32 v78, v78, v77
v_mul_f32 v79, v79, v77
v_cvt_pk_bf16_f32 v90, v78, v79
v_lshlrev_b32 v78, 16, v91
v_and_b32 v79, s67, v91
v_mul_f32 v78, v78, v77
v_mul_f32 v79, v79, v77
v_cvt_pk_bf16_f32 v91, v78, v79
v_lshlrev_b32 v78, 16, v100
v_and_b32 v79, s67, v100
v_mul_f32 v78, v78, v77
v_mul_f32 v79, v79, v77
v_cvt_pk_bf16_f32 v100, v78, v79
v_lshlrev_b32 v78, 16, v101
v_and_b32 v79, s67, v101
v_mul_f32 v78, v78, v77
v_mul_f32 v79, v79, v77
v_cvt_pk_bf16_f32 v101, v78, v79
v_lshlrev_b32 v78, 16, v102
v_and_b32 v79, s67, v102
v_mul_f32 v78, v78, v77
v_mul_f32 v79, v79, v77
v_cvt_pk_bf16_f32 v102, v78, v79
v_lshlrev_b32 v78, 16, v103
v_and_b32 v79, s67, v103
v_mul_f32 v78, v78, v77
v_mul_f32 v79, v79, v77
v_cvt_pk_bf16_f32 v103, v78, v79
v_lshlrev_b32 v78, 16, v112
v_and_b32 v79, s67, v112
v_mul_f32 v78, v78, v77
v_mul_f32 v79, v79, v77
v_cvt_pk_bf16_f32 v112, v78, v79
v_lshlrev_b32 v78, 16, v113
v_and_b32 v79, s67, v113
v_mul_f32 v78, v78, v77
v_mul_f32 v79, v79, v77
v_cvt_pk_bf16_f32 v113, v78, v79
v_lshlrev_b32 v78, 16, v114
v_and_b32 v79, s67, v114
v_mul_f32 v78, v78, v77
v_mul_f32 v79, v79, v77
v_cvt_pk_bf16_f32 v114, v78, v79
v_lshlrev_b32 v78, 16, v115
v_and_b32 v79, s67, v115
v_mul_f32 v78, v78, v77
v_mul_f32 v79, v79, v77
v_cvt_pk_bf16_f32 v115, v78, v79
v_lshlrev_b32 v78, 16, v124
v_and_b32 v79, s67, v124
v_mul_f32 v78, v78, v77
v_mul_f32 v79, v79, v77
v_cvt_pk_bf16_f32 v124, v78, v79
v_lshlrev_b32 v78, 16, v125
v_and_b32 v79, s67, v125
v_mul_f32 v78, v78, v77
v_mul_f32 v79, v79, v77
v_cvt_pk_bf16_f32 v125, v78, v79
v_lshlrev_b32 v78, 16, v126
v_and_b32 v79, s67, v126
v_mul_f32 v78, v78, v77
v_mul_f32 v79, v79, v77
v_cvt_pk_bf16_f32 v126, v78, v79
v_lshlrev_b32 v78, 16, v127
v_and_b32 v79, s67, v127
v_mul_f32 v78, v78, v77
v_mul_f32 v79, v79, v77
v_cvt_pk_bf16_f32 v127, v78, v79
v_lshlrev_b32 v78, 16, v136
v_and_b32 v79, s67, v136
v_mul_f32 v78, v78, v77
v_mul_f32 v79, v79, v77
v_cvt_pk_bf16_f32 v136, v78, v79
v_lshlrev_b32 v78, 16, v137
v_and_b32 v79, s67, v137
v_mul_f32 v78, v78, v77
v_mul_f32 v79, v79, v77
v_cvt_pk_bf16_f32 v137, v78, v79
v_lshlrev_b32 v78, 16, v138
v_and_b32 v79, s67, v138
v_mul_f32 v78, v78, v77
v_mul_f32 v79, v79, v77
v_cvt_pk_bf16_f32 v138, v78, v79
v_lshlrev_b32 v78, 16, v139
v_and_b32 v79, s67, v139
v_mul_f32 v78, v78, v77
v_mul_f32 v79, v79, v77
v_cvt_pk_bf16_f32 v139, v78, v79
v_lshlrev_b32 v78, 16, v148
v_and_b32 v79, s67, v148
v_mul_f32 v78, v78, v77
v_mul_f32 v79, v79, v77
v_cvt_pk_bf16_f32 v148, v78, v79
v_lshlrev_b32 v78, 16, v149
v_and_b32 v79, s67, v149
v_mul_f32 v78, v78, v77
v_mul_f32 v79, v79, v77
v_cvt_pk_bf16_f32 v149, v78, v79
v_lshlrev_b32 v78, 16, v150
v_and_b32 v79, s67, v150
v_mul_f32 v78, v78, v77
v_mul_f32 v79, v79, v77
v_cvt_pk_bf16_f32 v150, v78, v79
v_lshlrev_b32 v78, 16, v151
v_and_b32 v79, s67, v151
v_mul_f32 v78, v78, v77
v_mul_f32 v79, v79, v77
v_cvt_pk_bf16_f32 v151, v78, v79
v_lshlrev_b32 v78, 16, v160
v_and_b32 v79, s67, v160
v_mul_f32 v78, v78, v77
v_mul_f32 v79, v79, v77
v_cvt_pk_bf16_f32 v160, v78, v79
v_lshlrev_b32 v78, 16, v161
v_and_b32 v79, s67, v161
v_mul_f32 v78, v78, v77
v_mul_f32 v79, v79, v77
v_cvt_pk_bf16_f32 v161, v78, v79
v_lshlrev_b32 v78, 16, v162
v_and_b32 v79, s67, v162
v_mul_f32 v78, v78, v77
v_mul_f32 v79, v79, v77
v_cvt_pk_bf16_f32 v162, v78, v79
v_lshlrev_b32 v78, 16, v163
v_and_b32 v79, s67, v163
v_mul_f32 v78, v78, v77
v_mul_f32 v79, v79, v77
v_cvt_pk_bf16_f32 v163, v78, v79
v_lshlrev_b32 v78, 16, v172
v_and_b32 v79, s67, v172
v_mul_f32 v78, v78, v77
v_mul_f32 v79, v79, v77
v_cvt_pk_bf16_f32 v172, v78, v79
v_lshlrev_b32 v78, 16, v173
v_and_b32 v79, s67, v173
v_mul_f32 v78, v78, v77
v_mul_f32 v79, v79, v77
v_cvt_pk_bf16_f32 v173, v78, v79
v_lshlrev_b32 v78, 16, v174
v_and_b32 v79, s67, v174
v_mul_f32 v78, v78, v77
v_mul_f32 v79, v79, v77
v_cvt_pk_bf16_f32 v174, v78, v79
v_lshlrev_b32 v78, 16, v175
v_and_b32 v79, s67, v175
v_mul_f32 v78, v78, v77
v_mul_f32 v79, v79, v77
v_cvt_pk_bf16_f32 v175, v78, v79
v_lshlrev_b32 v78, 16, v184
v_and_b32 v79, s67, v184
v_mul_f32 v78, v78, v77
v_mul_f32 v79, v79, v77
v_cvt_pk_bf16_f32 v184, v78, v79
v_lshlrev_b32 v78, 16, v185
v_and_b32 v79, s67, v185
v_mul_f32 v78, v78, v77
v_mul_f32 v79, v79, v77
v_cvt_pk_bf16_f32 v185, v78, v79
v_lshlrev_b32 v78, 16, v186
v_and_b32 v79, s67, v186
v_mul_f32 v78, v78, v77
v_mul_f32 v79, v79, v77
v_cvt_pk_bf16_f32 v186, v78, v79
v_lshlrev_b32 v78, 16, v187
v_and_b32 v79, s67, v187
v_mul_f32 v78, v78, v77
v_mul_f32 v79, v79, v77
v_cvt_pk_bf16_f32 v187, v78, v79
v_lshlrev_b32 v78, 16, v196
v_and_b32 v79, s67, v196
v_mul_f32 v78, v78, v77
v_mul_f32 v79, v79, v77
v_cvt_pk_bf16_f32 v196, v78, v79
v_lshlrev_b32 v78, 16, v197
v_and_b32 v79, s67, v197
v_mul_f32 v78, v78, v77
v_mul_f32 v79, v79, v77
v_cvt_pk_bf16_f32 v197, v78, v79
v_lshlrev_b32 v78, 16, v198
v_and_b32 v79, s67, v198
v_mul_f32 v78, v78, v77
v_mul_f32 v79, v79, v77
v_cvt_pk_bf16_f32 v198, v78, v79
v_lshlrev_b32 v78, 16, v199
v_and_b32 v79, s67, v199
v_mul_f32 v78, v78, v77
v_mul_f32 v79, v79, v77
v_cvt_pk_bf16_f32 v199, v78, v79
v_lshlrev_b32 v78, 16, v208
v_and_b32 v79, s67, v208
v_mul_f32 v78, v78, v77
v_mul_f32 v79, v79, v77
v_cvt_pk_bf16_f32 v208, v78, v79
v_lshlrev_b32 v78, 16, v209
v_and_b32 v79, s67, v209
v_mul_f32 v78, v78, v77
v_mul_f32 v79, v79, v77
v_cvt_pk_bf16_f32 v209, v78, v79
v_lshlrev_b32 v78, 16, v210
v_and_b32 v79, s67, v210
v_mul_f32 v78, v78, v77
v_mul_f32 v79, v79, v77
v_cvt_pk_bf16_f32 v210, v78, v79
v_lshlrev_b32 v78, 16, v211
v_and_b32 v79, s67, v211
v_mul_f32 v78, v78, v77
v_mul_f32 v79, v79, v77
v_cvt_pk_bf16_f32 v211, v78, v79
v_lshlrev_b32 v78, 16, v220
v_and_b32 v79, s67, v220
v_mul_f32 v78, v78, v77
v_mul_f32 v79, v79, v77
v_cvt_pk_bf16_f32 v220, v78, v79
v_lshlrev_b32 v78, 16, v221
v_and_b32 v79, s67, v221
v_mul_f32 v78, v78, v77
v_mul_f32 v79, v79, v77
v_cvt_pk_bf16_f32 v221, v78, v79
v_lshlrev_b32 v78, 16, v222
v_and_b32 v79, s67, v222
v_mul_f32 v78, v78, v77
v_mul_f32 v79, v79, v77
v_cvt_pk_bf16_f32 v222, v78, v79
v_lshlrev_b32 v78, 16, v223
v_and_b32 v79, s67, v223
v_mul_f32 v78, v78, v77
v_mul_f32 v79, v79, v77
v_cvt_pk_bf16_f32 v223, v78, v79
v_lshlrev_b32 v78, 16, v232
v_and_b32 v79, s67, v232
v_mul_f32 v78, v78, v77
v_mul_f32 v79, v79, v77
v_cvt_pk_bf16_f32 v232, v78, v79
v_lshlrev_b32 v78, 16, v233
v_and_b32 v79, s67, v233
v_mul_f32 v78, v78, v77
v_mul_f32 v79, v79, v77
v_cvt_pk_bf16_f32 v233, v78, v79
v_lshlrev_b32 v78, 16, v234
v_and_b32 v79, s67, v234
v_mul_f32 v78, v78, v77
v_mul_f32 v79, v79, v77
v_cvt_pk_bf16_f32 v234, v78, v79
v_lshlrev_b32 v78, 16, v235
v_and_b32 v79, s67, v235
v_mul_f32 v78, v78, v77
v_mul_f32 v79, v79, v77
v_cvt_pk_bf16_f32 v235, v78, v79
v_lshlrev_b32 v78, 16, v244
v_and_b32 v79, s67, v244
v_mul_f32 v78, v78, v77
v_mul_f32 v79, v79, v77
v_cvt_pk_bf16_f32 v244, v78, v79
v_lshlrev_b32 v78, 16, v245
v_and_b32 v79, s67, v245
v_mul_f32 v78, v78, v77
v_mul_f32 v79, v79, v77
v_cvt_pk_bf16_f32 v245, v78, v79
v_lshlrev_b32 v78, 16, v246
v_and_b32 v79, s67, v246
v_mul_f32 v78, v78, v77
v_mul_f32 v79, v79, v77
v_cvt_pk_bf16_f32 v246, v78, v79
v_lshlrev_b32 v78, 16, v247
v_and_b32 v79, s67, v247
v_mul_f32 v78, v78, v77
v_mul_f32 v79, v79, v77
v_cvt_pk_bf16_f32 v247, v78, v79
v_lshlrev_b32 v78, 16, v16
v_and_b32 v79, s67, v16
v_mul_f32 v78, v78, v77
v_mul_f32 v79, v79, v77
v_cvt_pk_bf16_f32 v16, v78, v79
v_lshlrev_b32 v78, 16, v17
v_and_b32 v79, s67, v17
v_mul_f32 v78, v78, v77
v_mul_f32 v79, v79, v77
v_cvt_pk_bf16_f32 v17, v78, v79
v_lshlrev_b32 v78, 16, v18
v_and_b32 v79, s67, v18
v_mul_f32 v78, v78, v77
v_mul_f32 v79, v79, v77
v_cvt_pk_bf16_f32 v18, v78, v79
v_lshlrev_b32 v78, 16, v19
v_and_b32 v79, s67, v19
v_mul_f32 v78, v78, v77
v_mul_f32 v79, v79, v77
v_cvt_pk_bf16_f32 v19, v78, v79
v_accvgpr_read_b32 v78, a232
v_mul_f32 v78, v78, v77
v_accvgpr_write_b32 a232, v78
v_accvgpr_read_b32 v78, a233
v_mul_f32 v78, v78, v77
v_accvgpr_write_b32 a233, v78
v_accvgpr_read_b32 v78, a234
v_mul_f32 v78, v78, v77
v_accvgpr_write_b32 a234, v78
v_accvgpr_read_b32 v78, a235
v_mul_f32 v78, v78, v77
v_accvgpr_write_b32 a235, v78
v_max3_f32 v76, v48, v49, v50
v_max3_f32 v76, v76, v51, v52
v_max3_f32 v76, v76, v53, v54
v_max3_f32 v76, v76, v55, 0
v_mov_b32 v77, v76
s_nop 1
v_permlane32_swap_b32 v76, v77
v_max_f32 v76, v76, v77
v_mov_b32 v77, v76
s_nop 1
v_permlane16_swap_b32 v76, v77
v_max_f32 v76, v76, v77
v_ceil_f32 v76, v76
v_sub_f32 v77, 0, v76
v_max_f32 v77, 0xc3480000, v77
v_cvt_i32_f32 v77, v77
v_ldexp_f32 v77, 1.0, v77
v_sub_f32 v48, v48, v76
v_sub_f32 v49, v49, v76
v_sub_f32 v50, v50, v76
v_sub_f32 v51, v51, v76
v_sub_f32 v52, v52, v76
v_sub_f32 v53, v53, v76
v_sub_f32 v54, v54, v76
v_sub_f32 v55, v55, v76
v_sub_f32 v68, v68, v76
v_sub_f32 v69, v69, v76
v_sub_f32 v70, v70, v76
v_sub_f32 v71, v71, v76
v_lshlrev_b32 v78, 16, v92
v_and_b32 v79, s67, v92
v_mul_f32 v78, v78, v77
v_mul_f32 v79, v79, v77
v_cvt_pk_bf16_f32 v92, v78, v79
v_lshlrev_b32 v78, 16, v93
v_and_b32 v79, s67, v93
v_mul_f32 v78, v78, v77
v_mul_f32 v79, v79, v77
v_cvt_pk_bf16_f32 v93, v78, v79
v_lshlrev_b32 v78, 16, v94
v_and_b32 v79, s67, v94
v_mul_f32 v78, v78, v77
v_mul_f32 v79, v79, v77
v_cvt_pk_bf16_f32 v94, v78, v79
v_lshlrev_b32 v78, 16, v95
v_and_b32 v79, s67, v95
v_mul_f32 v78, v78, v77
v_mul_f32 v79, v79, v77
v_cvt_pk_bf16_f32 v95, v78, v79
v_lshlrev_b32 v78, 16, v104
v_and_b32 v79, s67, v104
v_mul_f32 v78, v78, v77
v_mul_f32 v79, v79, v77
v_cvt_pk_bf16_f32 v104, v78, v79
v_lshlrev_b32 v78, 16, v105
v_and_b32 v79, s67, v105
v_mul_f32 v78, v78, v77
v_mul_f32 v79, v79, v77
v_cvt_pk_bf16_f32 v105, v78, v79
v_lshlrev_b32 v78, 16, v106
v_and_b32 v79, s67, v106
v_mul_f32 v78, v78, v77
v_mul_f32 v79, v79, v77
v_cvt_pk_bf16_f32 v106, v78, v79
v_lshlrev_b32 v78, 16, v107
v_and_b32 v79, s67, v107
v_mul_f32 v78, v78, v77
v_mul_f32 v79, v79, v77
v_cvt_pk_bf16_f32 v107, v78, v79
v_lshlrev_b32 v78, 16, v116
v_and_b32 v79, s67, v116
v_mul_f32 v78, v78, v77
v_mul_f32 v79, v79, v77
v_cvt_pk_bf16_f32 v116, v78, v79
v_lshlrev_b32 v78, 16, v117
v_and_b32 v79, s67, v117
v_mul_f32 v78, v78, v77
v_mul_f32 v79, v79, v77
v_cvt_pk_bf16_f32 v117, v78, v79
v_lshlrev_b32 v78, 16, v118
v_and_b32 v79, s67, v118
v_mul_f32 v78, v78, v77
v_mul_f32 v79, v79, v77
v_cvt_pk_bf16_f32 v118, v78, v79
v_lshlrev_b32 v78, 16, v119
v_and_b32 v79, s67, v119
v_mul_f32 v78, v78, v77
v_mul_f32 v79, v79, v77
v_cvt_pk_bf16_f32 v119, v78, v79
v_lshlrev_b32 v78, 16, v128
v_and_b32 v79, s67, v128
v_mul_f32 v78, v78, v77
v_mul_f32 v79, v79, v77
v_cvt_pk_bf16_f32 v128, v78, v79
v_lshlrev_b32 v78, 16, v129
v_and_b32 v79, s67, v129
v_mul_f32 v78, v78, v77
v_mul_f32 v79, v79, v77
v_cvt_pk_bf16_f32 v129, v78, v79
v_lshlrev_b32 v78, 16, v130
v_and_b32 v79, s67, v130
v_mul_f32 v78, v78, v77
v_mul_f32 v79, v79, v77
v_cvt_pk_bf16_f32 v130, v78, v79
v_lshlrev_b32 v78, 16, v131
v_and_b32 v79, s67, v131
v_mul_f32 v78, v78, v77
v_mul_f32 v79, v79, v77
v_cvt_pk_bf16_f32 v131, v78, v79
v_lshlrev_b32 v78, 16, v140
v_and_b32 v79, s67, v140
v_mul_f32 v78, v78, v77
v_mul_f32 v79, v79, v77
v_cvt_pk_bf16_f32 v140, v78, v79
v_lshlrev_b32 v78, 16, v141
v_and_b32 v79, s67, v141
v_mul_f32 v78, v78, v77
v_mul_f32 v79, v79, v77
v_cvt_pk_bf16_f32 v141, v78, v79
v_lshlrev_b32 v78, 16, v142
v_and_b32 v79, s67, v142
v_mul_f32 v78, v78, v77
v_mul_f32 v79, v79, v77
v_cvt_pk_bf16_f32 v142, v78, v79
v_lshlrev_b32 v78, 16, v143
v_and_b32 v79, s67, v143
v_mul_f32 v78, v78, v77
v_mul_f32 v79, v79, v77
v_cvt_pk_bf16_f32 v143, v78, v79
v_lshlrev_b32 v78, 16, v152
v_and_b32 v79, s67, v152
v_mul_f32 v78, v78, v77
v_mul_f32 v79, v79, v77
v_cvt_pk_bf16_f32 v152, v78, v79
v_lshlrev_b32 v78, 16, v153
v_and_b32 v79, s67, v153
v_mul_f32 v78, v78, v77
v_mul_f32 v79, v79, v77
v_cvt_pk_bf16_f32 v153, v78, v79
v_lshlrev_b32 v78, 16, v154
v_and_b32 v79, s67, v154
v_mul_f32 v78, v78, v77
v_mul_f32 v79, v79, v77
v_cvt_pk_bf16_f32 v154, v78, v79
v_lshlrev_b32 v78, 16, v155
v_and_b32 v79, s67, v155
v_mul_f32 v78, v78, v77
v_mul_f32 v79, v79, v77
v_cvt_pk_bf16_f32 v155, v78, v79
v_lshlrev_b32 v78, 16, v164
v_and_b32 v79, s67, v164
v_mul_f32 v78, v78, v77
v_mul_f32 v79, v79, v77
v_cvt_pk_bf16_f32 v164, v78, v79
v_lshlrev_b32 v78, 16, v165
v_and_b32 v79, s67, v165
v_mul_f32 v78, v78, v77
v_mul_f32 v79, v79, v77
v_cvt_pk_bf16_f32 v165, v78, v79
v_lshlrev_b32 v78, 16, v166
v_and_b32 v79, s67, v166
v_mul_f32 v78, v78, v77
v_mul_f32 v79, v79, v77
v_cvt_pk_bf16_f32 v166, v78, v79
v_lshlrev_b32 v78, 16, v167
v_and_b32 v79, s67, v167
v_mul_f32 v78, v78, v77
v_mul_f32 v79, v79, v77
v_cvt_pk_bf16_f32 v167, v78, v79
v_lshlrev_b32 v78, 16, v176
v_and_b32 v79, s67, v176
v_mul_f32 v78, v78, v77
v_mul_f32 v79, v79, v77
v_cvt_pk_bf16_f32 v176, v78, v79
v_lshlrev_b32 v78, 16, v177
v_and_b32 v79, s67, v177
v_mul_f32 v78, v78, v77
v_mul_f32 v79, v79, v77
v_cvt_pk_bf16_f32 v177, v78, v79
v_lshlrev_b32 v78, 16, v178
v_and_b32 v79, s67, v178
v_mul_f32 v78, v78, v77
v_mul_f32 v79, v79, v77
v_cvt_pk_bf16_f32 v178, v78, v79
v_lshlrev_b32 v78, 16, v179
v_and_b32 v79, s67, v179
v_mul_f32 v78, v78, v77
v_mul_f32 v79, v79, v77
v_cvt_pk_bf16_f32 v179, v78, v79
v_lshlrev_b32 v78, 16, v188
v_and_b32 v79, s67, v188
v_mul_f32 v78, v78, v77
v_mul_f32 v79, v79, v77
v_cvt_pk_bf16_f32 v188, v78, v79
v_lshlrev_b32 v78, 16, v189
v_and_b32 v79, s67, v189
v_mul_f32 v78, v78, v77
v_mul_f32 v79, v79, v77
v_cvt_pk_bf16_f32 v189, v78, v79
v_lshlrev_b32 v78, 16, v190
v_and_b32 v79, s67, v190
v_mul_f32 v78, v78, v77
v_mul_f32 v79, v79, v77
v_cvt_pk_bf16_f32 v190, v78, v79
v_lshlrev_b32 v78, 16, v191
v_and_b32 v79, s67, v191
v_mul_f32 v78, v78, v77
v_mul_f32 v79, v79, v77
v_cvt_pk_bf16_f32 v191, v78, v79
v_lshlrev_b32 v78, 16, v200
v_and_b32 v79, s67, v200
v_mul_f32 v78, v78, v77
v_mul_f32 v79, v79, v77
v_cvt_pk_bf16_f32 v200, v78, v79
v_lshlrev_b32 v78, 16, v201
v_and_b32 v79, s67, v201
v_mul_f32 v78, v78, v77
v_mul_f32 v79, v79, v77
v_cvt_pk_bf16_f32 v201, v78, v79
v_lshlrev_b32 v78, 16, v202
v_and_b32 v79, s67, v202
v_mul_f32 v78, v78, v77
v_mul_f32 v79, v79, v77
v_cvt_pk_bf16_f32 v202, v78, v79
v_lshlrev_b32 v78, 16, v203
v_and_b32 v79, s67, v203
v_mul_f32 v78, v78, v77
v_mul_f32 v79, v79, v77
v_cvt_pk_bf16_f32 v203, v78, v79
v_lshlrev_b32 v78, 16, v212
v_and_b32 v79, s67, v212
v_mul_f32 v78, v78, v77
v_mul_f32 v79, v79, v77
v_cvt_pk_bf16_f32 v212, v78, v79
v_lshlrev_b32 v78, 16, v213
v_and_b32 v79, s67, v213
v_mul_f32 v78, v78, v77
v_mul_f32 v79, v79, v77
v_cvt_pk_bf16_f32 v213, v78, v79
v_lshlrev_b32 v78, 16, v214
v_and_b32 v79, s67, v214
v_mul_f32 v78, v78, v77
v_mul_f32 v79, v79, v77
v_cvt_pk_bf16_f32 v214, v78, v79
v_lshlrev_b32 v78, 16, v215
v_and_b32 v79, s67, v215
v_mul_f32 v78, v78, v77
v_mul_f32 v79, v79, v77
v_cvt_pk_bf16_f32 v215, v78, v79
v_lshlrev_b32 v78, 16, v224
v_and_b32 v79, s67, v224
v_mul_f32 v78, v78, v77
v_mul_f32 v79, v79, v77
v_cvt_pk_bf16_f32 v224, v78, v79
v_lshlrev_b32 v78, 16, v225
v_and_b32 v79, s67, v225
v_mul_f32 v78, v78, v77
v_mul_f32 v79, v79, v77
v_cvt_pk_bf16_f32 v225, v78, v79
v_lshlrev_b32 v78, 16, v226
v_and_b32 v79, s67, v226
v_mul_f32 v78, v78, v77
v_mul_f32 v79, v79, v77
v_cvt_pk_bf16_f32 v226, v78, v79
v_lshlrev_b32 v78, 16, v227
v_and_b32 v79, s67, v227
v_mul_f32 v78, v78, v77
v_mul_f32 v79, v79, v77
v_cvt_pk_bf16_f32 v227, v78, v79
v_lshlrev_b32 v78, 16, v236
v_and_b32 v79, s67, v236
v_mul_f32 v78, v78, v77
v_mul_f32 v79, v79, v77
v_cvt_pk_bf16_f32 v236, v78, v79
v_lshlrev_b32 v78, 16, v237
v_and_b32 v79, s67, v237
v_mul_f32 v78, v78, v77
v_mul_f32 v79, v79, v77
v_cvt_pk_bf16_f32 v237, v78, v79
v_lshlrev_b32 v78, 16, v238
v_and_b32 v79, s67, v238
v_mul_f32 v78, v78, v77
v_mul_f32 v79, v79, v77
v_cvt_pk_bf16_f32 v238, v78, v79
v_lshlrev_b32 v78, 16, v239
v_and_b32 v79, s67, v239
v_mul_f32 v78, v78, v77
v_mul_f32 v79, v79, v77
v_cvt_pk_bf16_f32 v239, v78, v79
v_lshlrev_b32 v78, 16, v248
v_and_b32 v79, s67, v248
v_mul_f32 v78, v78, v77
v_mul_f32 v79, v79, v77
v_cvt_pk_bf16_f32 v248, v78, v79
v_lshlrev_b32 v78, 16, v249
v_and_b32 v79, s67, v249
v_mul_f32 v78, v78, v77
v_mul_f32 v79, v79, v77
v_cvt_pk_bf16_f32 v249, v78, v79
v_lshlrev_b32 v78, 16, v250
v_and_b32 v79, s67, v250
v_mul_f32 v78, v78, v77
v_mul_f32 v79, v79, v77
v_cvt_pk_bf16_f32 v250, v78, v79
v_lshlrev_b32 v78, 16, v251
v_and_b32 v79, s67, v251
v_mul_f32 v78, v78, v77
v_mul_f32 v79, v79, v77
v_cvt_pk_bf16_f32 v251, v78, v79
v_lshlrev_b32 v78, 16, v24
v_and_b32 v79, s67, v24
v_mul_f32 v78, v78, v77
v_mul_f32 v79, v79, v77
v_cvt_pk_bf16_f32 v24, v78, v79
v_lshlrev_b32 v78, 16, v25
v_and_b32 v79, s67, v25
v_mul_f32 v78, v78, v77
v_mul_f32 v79, v79, v77
v_cvt_pk_bf16_f32 v25, v78, v79
v_lshlrev_b32 v78, 16, v26
v_and_b32 v79, s67, v26
v_mul_f32 v78, v78, v77
v_mul_f32 v79, v79, v77
v_cvt_pk_bf16_f32 v26, v78, v79
v_lshlrev_b32 v78, 16, v27
v_and_b32 v79, s67, v27
v_mul_f32 v78, v78, v77
v_mul_f32 v79, v79, v77
v_cvt_pk_bf16_f32 v27, v78, v79
v_accvgpr_read_b32 v78, a236
v_mul_f32 v78, v78, v77
v_accvgpr_write_b32 a236, v78
v_accvgpr_read_b32 v78, a237
v_mul_f32 v78, v78, v77
v_accvgpr_write_b32 a237, v78
v_accvgpr_read_b32 v78, a238
v_mul_f32 v78, v78, v77
v_accvgpr_write_b32 a238, v78
v_accvgpr_read_b32 v78, a239
v_mul_f32 v78, v78, v77
v_accvgpr_write_b32 a239, v78
v_max3_f32 v76, v56, v57, v58
v_max3_f32 v76, v76, v59, v60
v_max3_f32 v76, v76, v61, v62
v_max3_f32 v76, v76, v63, 0
v_mov_b32 v77, v76
s_nop 1
v_permlane32_swap_b32 v76, v77
v_max_f32 v76, v76, v77
v_mov_b32 v77, v76
s_nop 1
v_permlane16_swap_b32 v76, v77
v_max_f32 v76, v76, v77
v_ceil_f32 v76, v76
v_sub_f32 v77, 0, v76
v_max_f32 v77, 0xc3480000, v77
v_cvt_i32_f32 v77, v77
v_ldexp_f32 v77, 1.0, v77
v_sub_f32 v56, v56, v76
v_sub_f32 v57, v57, v76
v_sub_f32 v58, v58, v76
v_sub_f32 v59, v59, v76
v_sub_f32 v60, v60, v76
v_sub_f32 v61, v61, v76
v_sub_f32 v62, v62, v76
v_sub_f32 v63, v63, v76
v_sub_f32 v72, v72, v76
v_sub_f32 v73, v73, v76
v_sub_f32 v74, v74, v76
v_sub_f32 v75, v75, v76
v_lshlrev_b32 v78, 16, v96
v_and_b32 v79, s67, v96
v_mul_f32 v78, v78, v77
v_mul_f32 v79, v79, v77
v_cvt_pk_bf16_f32 v96, v78, v79
v_lshlrev_b32 v78, 16, v97
v_and_b32 v79, s67, v97
v_mul_f32 v78, v78, v77
v_mul_f32 v79, v79, v77
v_cvt_pk_bf16_f32 v97, v78, v79
v_lshlrev_b32 v78, 16, v98
v_and_b32 v79, s67, v98
v_mul_f32 v78, v78, v77
v_mul_f32 v79, v79, v77
v_cvt_pk_bf16_f32 v98, v78, v79
v_lshlrev_b32 v78, 16, v99
v_and_b32 v79, s67, v99
v_mul_f32 v78, v78, v77
v_mul_f32 v79, v79, v77
v_cvt_pk_bf16_f32 v99, v78, v79
v_lshlrev_b32 v78, 16, v108
v_and_b32 v79, s67, v108
v_mul_f32 v78, v78, v77
v_mul_f32 v79, v79, v77
v_cvt_pk_bf16_f32 v108, v78, v79
v_lshlrev_b32 v78, 16, v109
v_and_b32 v79, s67, v109
v_mul_f32 v78, v78, v77
v_mul_f32 v79, v79, v77
v_cvt_pk_bf16_f32 v109, v78, v79
v_lshlrev_b32 v78, 16, v110
v_and_b32 v79, s67, v110
v_mul_f32 v78, v78, v77
v_mul_f32 v79, v79, v77
v_cvt_pk_bf16_f32 v110, v78, v79
v_lshlrev_b32 v78, 16, v111
v_and_b32 v79, s67, v111
v_mul_f32 v78, v78, v77
v_mul_f32 v79, v79, v77
v_cvt_pk_bf16_f32 v111, v78, v79
v_lshlrev_b32 v78, 16, v120
v_and_b32 v79, s67, v120
v_mul_f32 v78, v78, v77
v_mul_f32 v79, v79, v77
v_cvt_pk_bf16_f32 v120, v78, v79
v_lshlrev_b32 v78, 16, v121
v_and_b32 v79, s67, v121
v_mul_f32 v78, v78, v77
v_mul_f32 v79, v79, v77
v_cvt_pk_bf16_f32 v121, v78, v79
v_lshlrev_b32 v78, 16, v122
v_and_b32 v79, s67, v122
v_mul_f32 v78, v78, v77
v_mul_f32 v79, v79, v77
v_cvt_pk_bf16_f32 v122, v78, v79
v_lshlrev_b32 v78, 16, v123
v_and_b32 v79, s67, v123
v_mul_f32 v78, v78, v77
v_mul_f32 v79, v79, v77
v_cvt_pk_bf16_f32 v123, v78, v79
v_lshlrev_b32 v78, 16, v132
v_and_b32 v79, s67, v132
v_mul_f32 v78, v78, v77
v_mul_f32 v79, v79, v77
v_cvt_pk_bf16_f32 v132, v78, v79
v_lshlrev_b32 v78, 16, v133
v_and_b32 v79, s67, v133
v_mul_f32 v78, v78, v77
v_mul_f32 v79, v79, v77
v_cvt_pk_bf16_f32 v133, v78, v79
v_lshlrev_b32 v78, 16, v134
v_and_b32 v79, s67, v134
v_mul_f32 v78, v78, v77
v_mul_f32 v79, v79, v77
v_cvt_pk_bf16_f32 v134, v78, v79
v_lshlrev_b32 v78, 16, v135
v_and_b32 v79, s67, v135
v_mul_f32 v78, v78, v77
v_mul_f32 v79, v79, v77
v_cvt_pk_bf16_f32 v135, v78, v79
v_lshlrev_b32 v78, 16, v144
v_and_b32 v79, s67, v144
v_mul_f32 v78, v78, v77
v_mul_f32 v79, v79, v77
v_cvt_pk_bf16_f32 v144, v78, v79
v_lshlrev_b32 v78, 16, v145
v_and_b32 v79, s67, v145
v_mul_f32 v78, v78, v77
v_mul_f32 v79, v79, v77
v_cvt_pk_bf16_f32 v145, v78, v79
v_lshlrev_b32 v78, 16, v146
v_and_b32 v79, s67, v146
v_mul_f32 v78, v78, v77
v_mul_f32 v79, v79, v77
v_cvt_pk_bf16_f32 v146, v78, v79
v_lshlrev_b32 v78, 16, v147
v_and_b32 v79, s67, v147
v_mul_f32 v78, v78, v77
v_mul_f32 v79, v79, v77
v_cvt_pk_bf16_f32 v147, v78, v79
v_lshlrev_b32 v78, 16, v156
v_and_b32 v79, s67, v156
v_mul_f32 v78, v78, v77
v_mul_f32 v79, v79, v77
v_cvt_pk_bf16_f32 v156, v78, v79
v_lshlrev_b32 v78, 16, v157
v_and_b32 v79, s67, v157
v_mul_f32 v78, v78, v77
v_mul_f32 v79, v79, v77
v_cvt_pk_bf16_f32 v157, v78, v79
v_lshlrev_b32 v78, 16, v158
v_and_b32 v79, s67, v158
v_mul_f32 v78, v78, v77
v_mul_f32 v79, v79, v77
v_cvt_pk_bf16_f32 v158, v78, v79
v_lshlrev_b32 v78, 16, v159
v_and_b32 v79, s67, v159
v_mul_f32 v78, v78, v77
v_mul_f32 v79, v79, v77
v_cvt_pk_bf16_f32 v159, v78, v79
v_lshlrev_b32 v78, 16, v168
v_and_b32 v79, s67, v168
v_mul_f32 v78, v78, v77
v_mul_f32 v79, v79, v77
v_cvt_pk_bf16_f32 v168, v78, v79
v_lshlrev_b32 v78, 16, v169
v_and_b32 v79, s67, v169
v_mul_f32 v78, v78, v77
v_mul_f32 v79, v79, v77
v_cvt_pk_bf16_f32 v169, v78, v79
v_lshlrev_b32 v78, 16, v170
v_and_b32 v79, s67, v170
v_mul_f32 v78, v78, v77
v_mul_f32 v79, v79, v77
v_cvt_pk_bf16_f32 v170, v78, v79
v_lshlrev_b32 v78, 16, v171
v_and_b32 v79, s67, v171
v_mul_f32 v78, v78, v77
v_mul_f32 v79, v79, v77
v_cvt_pk_bf16_f32 v171, v78, v79
v_lshlrev_b32 v78, 16, v180
v_and_b32 v79, s67, v180
v_mul_f32 v78, v78, v77
v_mul_f32 v79, v79, v77
v_cvt_pk_bf16_f32 v180, v78, v79
v_lshlrev_b32 v78, 16, v181
v_and_b32 v79, s67, v181
v_mul_f32 v78, v78, v77
v_mul_f32 v79, v79, v77
v_cvt_pk_bf16_f32 v181, v78, v79
v_lshlrev_b32 v78, 16, v182
v_and_b32 v79, s67, v182
v_mul_f32 v78, v78, v77
v_mul_f32 v79, v79, v77
v_cvt_pk_bf16_f32 v182, v78, v79
v_lshlrev_b32 v78, 16, v183
v_and_b32 v79, s67, v183
v_mul_f32 v78, v78, v77
v_mul_f32 v79, v79, v77
v_cvt_pk_bf16_f32 v183, v78, v79
v_lshlrev_b32 v78, 16, v192
v_and_b32 v79, s67, v192
v_mul_f32 v78, v78, v77
v_mul_f32 v79, v79, v77
v_cvt_pk_bf16_f32 v192, v78, v79
v_lshlrev_b32 v78, 16, v193
v_and_b32 v79, s67, v193
v_mul_f32 v78, v78, v77
v_mul_f32 v79, v79, v77
v_cvt_pk_bf16_f32 v193, v78, v79
v_lshlrev_b32 v78, 16, v194
v_and_b32 v79, s67, v194
v_mul_f32 v78, v78, v77
v_mul_f32 v79, v79, v77
v_cvt_pk_bf16_f32 v194, v78, v79
v_lshlrev_b32 v78, 16, v195
v_and_b32 v79, s67, v195
v_mul_f32 v78, v78, v77
v_mul_f32 v79, v79, v77
v_cvt_pk_bf16_f32 v195, v78, v79
v_lshlrev_b32 v78, 16, v204
v_and_b32 v79, s67, v204
v_mul_f32 v78, v78, v77
v_mul_f32 v79, v79, v77
v_cvt_pk_bf16_f32 v204, v78, v79
v_lshlrev_b32 v78, 16, v205
v_and_b32 v79, s67, v205
v_mul_f32 v78, v78, v77
v_mul_f32 v79, v79, v77
v_cvt_pk_bf16_f32 v205, v78, v79
v_lshlrev_b32 v78, 16, v206
v_and_b32 v79, s67, v206
v_mul_f32 v78, v78, v77
v_mul_f32 v79, v79, v77
v_cvt_pk_bf16_f32 v206, v78, v79
v_lshlrev_b32 v78, 16, v207
v_and_b32 v79, s67, v207
v_mul_f32 v78, v78, v77
v_mul_f32 v79, v79, v77
v_cvt_pk_bf16_f32 v207, v78, v79
v_lshlrev_b32 v78, 16, v216
v_and_b32 v79, s67, v216
v_mul_f32 v78, v78, v77
v_mul_f32 v79, v79, v77
v_cvt_pk_bf16_f32 v216, v78, v79
v_lshlrev_b32 v78, 16, v217
v_and_b32 v79, s67, v217
v_mul_f32 v78, v78, v77
v_mul_f32 v79, v79, v77
v_cvt_pk_bf16_f32 v217, v78, v79
v_lshlrev_b32 v78, 16, v218
v_and_b32 v79, s67, v218
v_mul_f32 v78, v78, v77
v_mul_f32 v79, v79, v77
v_cvt_pk_bf16_f32 v218, v78, v79
v_lshlrev_b32 v78, 16, v219
v_and_b32 v79, s67, v219
v_mul_f32 v78, v78, v77
v_mul_f32 v79, v79, v77
v_cvt_pk_bf16_f32 v219, v78, v79
v_lshlrev_b32 v78, 16, v228
v_and_b32 v79, s67, v228
v_mul_f32 v78, v78, v77
v_mul_f32 v79, v79, v77
v_cvt_pk_bf16_f32 v228, v78, v79
v_lshlrev_b32 v78, 16, v229
v_and_b32 v79, s67, v229
v_mul_f32 v78, v78, v77
v_mul_f32 v79, v79, v77
v_cvt_pk_bf16_f32 v229, v78, v79
v_lshlrev_b32 v78, 16, v230
v_and_b32 v79, s67, v230
v_mul_f32 v78, v78, v77
v_mul_f32 v79, v79, v77
v_cvt_pk_bf16_f32 v230, v78, v79
v_lshlrev_b32 v78, 16, v231
v_and_b32 v79, s67, v231
v_mul_f32 v78, v78, v77
v_mul_f32 v79, v79, v77
v_cvt_pk_bf16_f32 v231, v78, v79
v_lshlrev_b32 v78, 16, v240
v_and_b32 v79, s67, v240
v_mul_f32 v78, v78, v77
v_mul_f32 v79, v79, v77
v_cvt_pk_bf16_f32 v240, v78, v79
v_lshlrev_b32 v78, 16, v241
v_and_b32 v79, s67, v241
v_mul_f32 v78, v78, v77
v_mul_f32 v79, v79, v77
v_cvt_pk_bf16_f32 v241, v78, v79
v_lshlrev_b32 v78, 16, v242
v_and_b32 v79, s67, v242
v_mul_f32 v78, v78, v77
v_mul_f32 v79, v79, v77
v_cvt_pk_bf16_f32 v242, v78, v79
v_lshlrev_b32 v78, 16, v243
v_and_b32 v79, s67, v243
v_mul_f32 v78, v78, v77
v_mul_f32 v79, v79, v77
v_cvt_pk_bf16_f32 v243, v78, v79
v_lshlrev_b32 v78, 16, v252
v_and_b32 v79, s67, v252
v_mul_f32 v78, v78, v77
v_mul_f32 v79, v79, v77
v_cvt_pk_bf16_f32 v252, v78, v79
v_lshlrev_b32 v78, 16, v253
v_and_b32 v79, s67, v253
v_mul_f32 v78, v78, v77
v_mul_f32 v79, v79, v77
v_cvt_pk_bf16_f32 v253, v78, v79
v_lshlrev_b32 v78, 16, v254
v_and_b32 v79, s67, v254
v_mul_f32 v78, v78, v77
v_mul_f32 v79, v79, v77
v_cvt_pk_bf16_f32 v254, v78, v79
v_lshlrev_b32 v78, 16, v255
v_and_b32 v79, s67, v255
v_mul_f32 v78, v78, v77
v_mul_f32 v79, v79, v77
v_cvt_pk_bf16_f32 v255, v78, v79
v_lshlrev_b32 v78, 16, v32
v_and_b32 v79, s67, v32
v_mul_f32 v78, v78, v77
v_mul_f32 v79, v79, v77
v_cvt_pk_bf16_f32 v32, v78, v79
v_lshlrev_b32 v78, 16, v33
v_and_b32 v79, s67, v33
v_mul_f32 v78, v78, v77
v_mul_f32 v79, v79, v77
v_cvt_pk_bf16_f32 v33, v78, v79
v_lshlrev_b32 v78, 16, v34
v_and_b32 v79, s67, v34
v_mul_f32 v78, v78, v77
v_mul_f32 v79, v79, v77
v_cvt_pk_bf16_f32 v34, v78, v79
v_lshlrev_b32 v78, 16, v35
v_and_b32 v79, s67, v35
v_mul_f32 v78, v78, v77
v_mul_f32 v79, v79, v77
v_cvt_pk_bf16_f32 v35, v78, v79
v_accvgpr_read_b32 v78, a240
v_mul_f32 v78, v78, v77
v_accvgpr_write_b32 a240, v78
v_accvgpr_read_b32 v78, a241
v_mul_f32 v78, v78, v77
v_accvgpr_write_b32 a241, v78
v_accvgpr_read_b32 v78, a242
v_mul_f32 v78, v78, v77
v_accvgpr_write_b32 a242, v78
v_accvgpr_read_b32 v78, a243
v_mul_f32 v78, v78, v77
v_accvgpr_write_b32 a243, v78
s_nop 1
s_setpc_b64 s[94:95]
L_clr_wait:
s_sleep 4
buffer_load_dword v87, v86, s[44:47], 0 offen sc1
s_waitcnt vmcnt(0)
v_readfirstlane_b32 s69, v87
s_nop 1
s_cmp_lt_u32 s69, 8
s_cbranch_scc1 L_clr_wait
s_branch L_clr_ok
s_endpgm
.section .rodata,"a"
.p2align 6
.amdhsa_kernel standalone__gqa_block_cached__near_ridge_kernel
  .amdhsa_next_free_vgpr 512
  .amdhsa_next_free_sgpr 102
  .amdhsa_accum_offset 256
  .amdhsa_group_segment_fixed_size 0
  .amdhsa_kernarg_size 64
  .amdhsa_user_sgpr_count 2
  .amdhsa_user_sgpr_kernarg_segment_ptr 1
  .amdhsa_system_sgpr_workgroup_id_x 1
  .amdhsa_float_denorm_mode_32 3
.end_amdhsa_kernel
```
